```python
import torch

def _softmax(x, axis=-1):
    return torch.softmax(x, dim=axis)

def _gelu(x):
    return torch.nn.functional.gelu(x, approximate='tanh')

def _silu(x):
    return torch.nn.functional.silu(x)

def _sigmoid(x):
    return torch.sigmoid(x)

def _layernorm(x, axis=-1, eps=1e-05):
    m = x.mean(dim=axis, keepdim=True)
    v = x.var(dim=axis, keepdim=True, unbiased=False)
    return (x - m) / torch.sqrt(v + eps)

def _scatter_add(tgt, idx, src, axis=0):
    return tgt.clone().index_add_(axis, idx, src)

def _segment_sum(src, seg, n):
    out = torch.zeros((n,) + src.shape[1:], dtype=src.dtype)
    return out.index_add_(0, seg, src)

def _pad(x, pw):
    flat = tuple((v for pair in reversed(pw) for v in pair))
    return torch.nn.functional.pad(x, flat)
kernel_name = 'adaLN_cond__sliding_block_cached__mixer_gmlp__prompt'

def setup_inputs():

    _w = lambda a: (lambda t: t.to(torch.bfloat16) if t.is_floating_point() else t)(torch.as_tensor(a))

    def _A_setup():
        B, Sq, D = (1, 2048, 448)
        Hq, Hkv, Sk, Dh = (16, 8, 2048, 256)
        assert Hq % Hkv == 0, (Hq, Hkv)
        return {'x': _w((lambda *s: torch.randn(*s, dtype=torch.bfloat16) * 0.1)(B, Sq, D)), 'k_cache': _w((lambda *s: torch.randn(*s, dtype=torch.bfloat16) * 0.8)(B, Hkv, Sk, Dh)), 'v_cache': _w((lambda *s: torch.randn(*s, dtype=torch.bfloat16) * 1.6)(B, Hkv, Sk, Dh)), 'wq': _w((lambda *s: torch.randn(*s, dtype=torch.bfloat16) * 0.8)(D, Hq * Dh) * D ** (-0.5)), 'wo': _w((lambda *s: torch.randn(*s, dtype=torch.bfloat16) * 1.6)(Hq * Dh, D) * (Hq * Dh) ** (-0.5))}
    _A_in = _A_setup()

    def _B_setup():
        B, S, D, F = (1, 2048, 448, 1792)
        Fh = F // 2
        return {'x': _w((lambda *s: torch.randn(*s, dtype=torch.bfloat16) * 0.1)(B, S, D)), 'w_in': _w((lambda *s: torch.randn(*s, dtype=torch.bfloat16) * 1.6)(D, 2 * Fh)), 'w_sp': _w(0.01 * (lambda *s: torch.randn(*s, dtype=torch.bfloat16) * 1.6)(S, S)), 'b_sp': _w(1.0 + 0.01 * (lambda *s: torch.randn(*s, dtype=torch.bfloat16) * 0.2)(S)), 'w_out': _w((lambda *s: torch.randn(*s, dtype=torch.bfloat16) * 0.2)(Fh, D))}
    _B_in = _B_setup()
    return {'A_x': _A_in['x'], 'A_k_cache': _A_in['k_cache'], 'A_v_cache': _A_in['v_cache'], 'A_wq': _A_in['wq'], 'A_wo': _A_in['wo'], 'B_x': _B_in['x'], 'B_w_in': _B_in['w_in'], 'B_w_sp': _B_in['w_sp'], 'B_b_sp': _B_in['b_sp'], 'B_w_out': _B_in['w_out'], 'c': _w((lambda *s: torch.randn(*s, dtype=torch.bfloat16) * 0.8)(1, 448) * 8.0), 'w_mod': _w((lambda *s: torch.randn(*s, dtype=torch.bfloat16) * 0.8)(448, 6 * 448) * 448 ** (-0.5) * 8.0)}

def reference(A_x, A_k_cache, A_v_cache, A_wq, A_wo, B_x, B_w_in, B_w_sp, B_b_sp, B_w_out, c, w_mod):

    def _A_ref(x, k_cache, v_cache, wq, wo):
        B, Sq, D = x.shape
        Hq, Dh = (16, 256)
        Hkv, Sk = (k_cache.shape[1], k_cache.shape[2])
        W = min(4096, max(256, Sk // 4))
        rep = Hq // Hkv
        q = (lambda x, *d: x.permute(*d))((x @ wq).reshape(B, Sq, Hq, Dh), 0, 2, 1, 3)
        k = (lambda x, n, axis: torch.repeat_interleave(x, n, dim=axis))(k_cache[:, :, Sk - W:, :], rep, axis=1)
        v = (lambda x, n, axis: torch.repeat_interleave(x, n, dim=axis))(v_cache[:, :, Sk - W:, :], rep, axis=1)
        scores = torch.einsum('bhqd,bhkd->bhqk', q, k) * Dh ** (-0.5)
        p = _softmax(scores, axis=-1)
        o = torch.einsum('bhqk,bhkd->bhqd', p, v)
        return (lambda x, *d: x.permute(*d))(o, 0, 2, 1, 3).reshape(B, Sq, Hq * Dh) @ wo

    def _B_ref(x, w_in, w_sp, b_sp, w_out):
        B, S, D = x.shape
        F = w_in.shape[-1]
        Fh = F // 2
        z = _gelu(torch.einsum('bsd,df->bsf', x, w_in))
        z1 = z[..., :Fh].clone()
        z2 = _layernorm(z[..., Fh:], axis=-1)
        g = torch.einsum('ts,bsf->btf', w_sp, z2) + b_sp[None, :, None]
        return torch.einsum('bsf,fd->bsd', z1 * g, w_out)
    x = A_x
    mod = (_silu(c) @ w_mod).reshape(c.shape[0], 6, 1, -1)
    sa, ca, ga, sb, cb, gb = (mod[:, 0].clone(), mod[:, 1].clone(), mod[:, 2].clone(), mod[:, 3].clone(), mod[:, 4].clone(), mod[:, 5].clone())
    h = _layernorm(x, axis=-1) * (1 + ca) + sa
    x = x + ga * _A_ref(h, A_k_cache, A_v_cache, A_wq, A_wo)
    h = _layernorm(x, axis=-1) * (1 + cb) + sb
    x = x + gb * _B_ref(h, B_w_in, B_w_sp, B_b_sp, B_w_out)
    return x
```

```asm
; @launch kernel=k1_kernel grid=(256,1,1) block=(256,1,1) lds=163840
.amdgcn_target "amdgcn-amd-amdhsa--gfx950"
.text
.globl k1_kernel
.p2align 8
.type k1_kernel,@function
k1_kernel:
    s_load_dwordx4 s[28:31], s[0:1], 8
    s_load_dwordx4 s[32:35], s[0:1], 24
    s_load_dwordx2 s[6:7], s[0:1], 112
    s_load_dwordx4 s[96:99], s[0:1], 48
    s_load_dwordx2 s[100:101], s[0:1], 72
    s_load_dwordx2 s[54:55], s[0:1], 0
    s_load_dwordx4 s[80:83], s[0:1], 80
    s_load_dwordx2 s[84:85], s[0:1], 104
    v_and_b32 v1, 63, v0
    v_lshrrev_b32 v22, 6, v0
    s_cmp_ge_u32 s2, 256
    s_cbranch_scc1 k1_kernel_end
    v_readfirstlane_b32 s48, v22
    s_getpc_b64 s[92:93]
k1_kernel_pc:
    s_mov_b32 s94, k1_kernel_end-k1_kernel_pc
    s_mov_b32 s95, 0x20000
    s_lshr_b32 s5, s2, 3
    s_lshl_b32 s5, s5, 12
    v_lshlrev_b32 v23, 4, v0
    buffer_load_dwordx4 a[240:243], v23, s[92:95], s5 offen
    s_and_b32 s3, s2, 1
    s_lshl_b32 s3, s3, 2
    s_bfe_u32 s4, s2, 0x20003
    s_add_u32 s3, s3, s4
    s_bfe_u32 s4, s2, 0x20001
    s_lshl_b32 s4, s4, 3
    s_lshr_b32 s5, s2, 5
    s_add_u32 s4, s4, s5
    s_mov_b32 s47, 0xffff0000
    s_lshl_b32 s40, s48, 13
    s_lshl_b32 s41, s48, 12
    s_lshl_b32 s5, s3, 10
    s_add_u32 s42, s5, s40
    s_lshl_b32 s5, s3, 20
    s_add_u32 s43, s5, 786432
    s_lshl_b32 s50, s4, 13
    s_add_u32 s50, s50, s43
    s_add_u32 s43, s43, s41
    s_lshr_b32 s36, s48, 1
    s_and_b32 s37, s48, 1
    s_lshl_b32 s5, s3, 9
    s_lshl_b32 s38, s36, 8
    s_add_u32 s5, s5, s38
    s_lshl_b32 s38, s37, 6
    s_add_u32 s5, s5, s38
    s_mul_i32 s44, s5, 896
    s_mul_i32 s51, s3, 458752
    s_mul_i32 s5, s4, 14336
    s_add_u32 s51, s51, s5
    s_mul_i32 s46, s3, 1835008
    s_lshl_b32 s5, s4, 1
    s_add_u32 s5, s5, s37
    s_mul_i32 s5, s5, 28672
    s_add_u32 s46, s46, s5
    s_lshl_b32 s5, s36, 11
    s_add_u32 s46, s46, s5
    s_add_u32 s46, s46, 2097152
    s_lshl_b32 s5, s4, 2
    s_add_u32 s5, s5, s48
    s_mul_i32 s52, s5, 14336
    s_lshr_b32 s38, s2, 3
    s_mul_i32 s39, s38, 9363
    s_lshr_b32 s39, s39, 16
    s_mul_i32 s5, s39, 7
    s_sub_u32 s38, s38, s5
    s_and_b32 s5, s2, 1
    s_mul_i32 s5, s5, 7
    s_add_u32 s38, s38, s5
    s_and_b32 s5, s2, 6
    s_lshl_b32 s5, s5, 1
    s_add_u32 s39, s39, s5
    s_mul_i32 s53, s48, 28672
    s_lshl_b32 s5, s38, 7
    s_add_u32 s53, s53, s5
    v_lshlrev_b32 v23, 4, v1
    s_lshl_b32 s5, s48, 6
    v_xor_b32 v2, s5, v23
    v_add_u32 v3, 31744, v2
    v_add_u32 v4, 63488, v2
    v_add_u32 v5, 95232, v2
    s_waitcnt lgkmcnt(0)
    s_mov_b32 s86, s52
    s_mov_b32 s92, s82
    s_mov_b32 s93, s83
    s_mov_b32 s94, 2408448
    s_mov_b32 s95, 0x20000
    s_mov_b32 s88, s80
    s_mov_b32 s89, s81
    s_mov_b32 s90, 896
    s_mov_b32 s91, 0x20000
    s_sub_u32 s5, s2, 56
    s_cmp_lt_u32 s2, 56
    s_cselect_b32 s5, s2, s5
    s_movk_i32 s50, 2341
    s_cselect_b32 s50, 4682, s50
    s_cselect_b32 s52, 14, 28
    s_mul_i32 s51, s5, s50
    s_lshr_b32 s51, s51, 16
    s_mul_i32 s52, s52, s51
    s_sub_u32 s50, s5, s52
    s_cmp_lt_u32 s2, 56
    s_cselect_b32 s5, 0, 14
    s_add_u32 s50, s50, s5
    s_cmp_lt_u32 s2, 168
    s_cselect_b32 s94, s94, 0
    s_cselect_b32 s90, s90, 0
    s_mul_i32 s5, s51, 602112
    s_lshl_b32 s52, s50, 7
    s_add_u32 s5, s5, s52
    v_lshrrev_b32 v10, 3, v0
    v_mul_u32_u24 v11, 5376, v10
    v_and_b32 v12, 7, v0
    v_lshl_add_u32 v11, v12, 4, v11
    v_mov_b32 v13, 0x7ffffff0
    v_cmp_gt_u32 vcc, 16, v10
    s_nop 1
    v_cndmask_b32 v14, v13, v11, vcc
    v_lshlrev_b32 v15, 2, v0
    s_mul_i32 s52, s51, 224
    buffer_load_dword v240, v15, s[88:91], s52 offen
    buffer_load_dwordx4 v[224:227], v11, s[92:95], s5 offen
    s_add_u32 s5, s5, 172032
    buffer_load_dwordx4 v[228:231], v11, s[92:95], s5 offen
    s_add_u32 s5, s5, 172032
    buffer_load_dwordx4 v[232:235], v11, s[92:95], s5 offen
    s_add_u32 s5, s5, 172032
    buffer_load_dwordx4 v[236:239], v14, s[92:95], s5 offen
    s_mov_b32 s24, s6
    s_mov_b32 s25, s7
    s_mov_b32 s26, 34078720
    s_mov_b32 s27, 0x20000
    s_mov_b32 s8, s32
    s_mov_b32 s9, s33
    s_mov_b32 s10, 3670016
    s_mov_b32 s11, 0x20000
    s_mov_b32 s12, s28
    s_mov_b32 s13, s29
    s_mov_b32 s14, 8388608
    s_mov_b32 s15, 0x20000
    s_mov_b32 s16, s30
    s_mov_b32 s17, s31
    s_mov_b32 s18, 8388608
    s_mov_b32 s19, 0x20000
    s_mov_b32 s20, s34
    s_mov_b32 s21, s35
    s_mov_b32 s22, 3670016
    s_mov_b32 s23, 0x20000
    s_cmp_lt_u32 s2, 56
    s_cselect_b32 s5, s48, 0
    s_cmp_eq_u32 s5, 1
    s_cselect_b64 vcc, -1, 0
    v_cndmask_b32 v16, v13, v23, vcc
    s_cmp_lt_u32 s2, 56
    s_cselect_b32 s5, 0, s48
    s_cmp_eq_u32 s5, 0
    s_cselect_b64 vcc, -1, 0
    v_cndmask_b32 v19, v23, v13, vcc
    v_mov_b32 v244, -1
    v_mov_b32 v245, -1
    v_mov_b32 v246, -1
    v_mov_b32 v247, -1
    s_mul_i32 s5, s2, 4400
    s_add_u32 s5, s5, 29360128
    buffer_store_dwordx4 v[244:247], v16, s[24:27], s5 offen offset:0 sc1
    buffer_store_dwordx4 v[244:247], v16, s[24:27], s5 offen offset:1024 sc1
    buffer_store_dwordx4 v[244:247], v16, s[24:27], s5 offen offset:2048 sc1
    buffer_store_dwordx4 v[244:247], v16, s[24:27], s5 offen offset:3072 sc1
    buffer_store_dwordx4 v[244:247], v16, s[24:27], s5 offen offset:3376 sc1
    s_mov_b32 s88, s54
    s_mov_b32 s89, s55
    s_mov_b32 s90, 1835008
    s_mov_b32 s91, 0x20000
    s_mov_b32 exec_hi, 0x00ffffff
    buffer_load_dwordx4 v[160:163], v23, s[88:91], s86 offen offset:0
    buffer_load_dwordx4 v[164:167], v23, s[88:91], s86 offen offset:896
    buffer_load_dwordx4 v[168:171], v23, s[88:91], s86 offen offset:1792
    buffer_load_dwordx4 v[172:175], v23, s[88:91], s86 offen offset:2688
    s_add_u32 s86, s86, 3584
    buffer_load_dwordx4 v[176:179], v23, s[88:91], s86 offen offset:0
    buffer_load_dwordx4 v[180:183], v23, s[88:91], s86 offen offset:896
    buffer_load_dwordx4 v[184:187], v23, s[88:91], s86 offen offset:1792
    buffer_load_dwordx4 v[188:191], v23, s[88:91], s86 offen offset:2688
    s_add_u32 s86, s86, 3584
    buffer_load_dwordx4 v[192:195], v23, s[88:91], s86 offen offset:0
    buffer_load_dwordx4 v[196:199], v23, s[88:91], s86 offen offset:896
    buffer_load_dwordx4 v[200:203], v23, s[88:91], s86 offen offset:1792
    buffer_load_dwordx4 v[204:207], v23, s[88:91], s86 offen offset:2688
    s_add_u32 s86, s86, 3584
    buffer_load_dwordx4 v[208:211], v23, s[88:91], s86 offen offset:0
    buffer_load_dwordx4 v[212:215], v23, s[88:91], s86 offen offset:896
    buffer_load_dwordx4 v[216:219], v23, s[88:91], s86 offen offset:1792
    buffer_load_dwordx4 v[220:223], v23, s[88:91], s86 offen offset:2688
    s_mov_b32 exec_hi, -1
    v_lshrrev_b32 v24, 5, v1
    v_and_b32 v25, 31, v1
    v_bfe_u32 v26, v1, 2, 2
    v_bfe_u32 v27, v1, 4, 1
    v_and_b32 v28, 3, v1
    v_lshlrev_b32 v29, 5, v27
    v_lshl_add_u32 v30, v28, 3, v29
    v_and_b32 v31, 1, v28
    v_lshlrev_b32 v31, 1, v31
    v_lshrrev_b32 v28, 1, v28
    v_or_b32 v28, v28, v31
    v_lshl_add_u32 v29, v28, 3, v29
    v_mul_u32_u24 v6, 8256, v26
    v_lshl_add_u32 v6, v24, 11, v6
    v_add_u32 v6, v6, v29
    s_lshl_b32 s5, s36, 9
    v_add_u32 v6, s5, v6
    v_and_b32 v31, 15, v25
    v_xor_b32 v31, v31, v24
    v_lshlrev_b32 v31, 4, v31
    v_lshl_add_u32 v7, v25, 9, v31
    v_mul_u32_u24 v8, 576, v26
    v_lshl_add_u32 v8, v24, 11, v8
    v_add_u32 v8, v8, v30
    v_lshlrev_b32 v9, 7, v26
    v_lshl_add_u32 v9, v24, 9, v9
    v_add_u32 v9, v9, v29
    v_lshrrev_b32 v31, 1, v26
    v_xor_b32 v31, s36, v31
    v_lshl_add_u32 v9, v31, 6, v9
    s_lshl_b32 s5, s36, 14
    v_add_u32 v9, s5, v9
    v_lshlrev_b32 v18, 4, v25
    v_lshl_add_u32 v18, v24, 9, v18
    s_lshl_b32 s5, s37, 3
    v_xor_b32 v31, s5, v25
    v_xor_b32 v31, v31, v24
    v_lshlrev_b32 v31, 4, v31
    v_lshl_add_u32 v31, v24, 9, v31
    v_accvgpr_write_b32 a176, v31
    v_lshlrev_b32 v31, 2, v24
    v_xor_b32 v31, v31, v25
    v_lshlrev_b32 v31, 4, v31
    v_lshl_add_u32 v31, v24, 9, v31
    v_accvgpr_write_b32 a177, v31
    v_lshrrev_b32 v31, 3, v1
    v_mul_u32_u24 v31, 896, v31
    v_lshlrev_b32 v27, 2, v27
    v_and_b32 v28, 7, v1
    v_xor_b32 v28, v28, v27
    v_lshl_add_u32 v31, v28, 4, v31
    v_accvgpr_write_b32 a178, v31
    s_mul_i32 s5, s48, 14592
    s_add_u32 s5, s5, 98304
    v_add_u32 v23, s5, v23
    s_mul_i32 s5, s37, 29184
    s_add_u32 s5, s5, 98304
    v_mul_u32_u24 v22, 912, v25
    v_lshl_add_u32 v22, v24, 4, v22
    v_add_u32 v22, s5, v22
    s_mov_b32 s49, 0x3db8aa3b
    s_mov_b32 s92, s84
    s_mov_b32 s93, s85
    s_mov_b32 s94, 256
    s_mov_b32 s95, 0x20000
    s_cmp_ge_u32 s2, 168
    s_cbranch_scc1 k1_kernel_nog
    s_mov_b32 s88, 0xbfb8aa3b
    s_mov_b32 s89, 0xb2a57060
    s_waitcnt vmcnt(25)
    v_and_b32 v241, s47, v240
    v_lshlrev_b32 v240, 16, v240
    v_mul_f32 v10, s88, v240
    v_mul_f32 v14, s88, v241
    v_fma_f32 v11, s88, v240, -v10
    v_fma_f32 v15, s88, v241, -v14
    v_fmac_f32 v11, s89, v240
    v_fmac_f32 v15, s89, v241
    v_min_f32 v10, 0x42fc0000, v10
    v_min_f32 v14, 0x42fc0000, v14
    v_exp_f32 v10, v10
    v_exp_f32 v14, v14
    v_mul_f32 v11, 0x3f317218, v11
    v_mul_f32 v15, 0x3f317218, v15
    v_fmac_f32 v10, v10, v11
    v_fmac_f32 v14, v14, v15
    v_add_f32 v10, 1.0, v10
    v_add_f32 v14, 1.0, v14
    v_rcp_f32 v11, v10
    v_rcp_f32 v15, v14
    v_mul_f32 v12, v240, v11
    v_mul_f32 v16, v241, v15
    v_fma_f32 v13, -v12, v10, v240
    v_fma_f32 v17, -v16, v14, v241
    v_fma_f32 v240, v13, v11, v12
    v_fma_f32 v241, v17, v15, v16
    v_cvt_pk_bf16_f32 v240, 0, v240
    v_cvt_pk_bf16_f32 v241, 0, v241
    v_lshlrev_b32 v10, 3, v0
    v_add_u32 v10, 156672, v10
    ds_write_b64 v10, v[240:241]
    v_lshrrev_b32 v11, 3, v0
    v_lshlrev_b32 v11, 2, v11
    v_add_u32 v11, 156672, v11
    s_waitcnt lgkmcnt(0)
    s_barrier
    ds_read_b32 v240, v11 offset:0
    ds_read_b32 v241, v11 offset:128
    ds_read_b32 v242, v11 offset:256
    ds_read_b32 v243, v11 offset:384
    s_waitcnt vmcnt(24)
    v_lshlrev_b32 v24, 16, v224
    v_and_b32 v25, s47, v224
    v_lshlrev_b32 v26, 16, v225
    v_and_b32 v27, s47, v225
    v_lshlrev_b32 v28, 16, v226
    v_and_b32 v29, s47, v226
    v_lshlrev_b32 v30, 16, v227
    v_and_b32 v31, s47, v227
    s_waitcnt lgkmcnt(3)
    v_mul_f32 v244, v24, v240
    v_mul_f32 v245, v25, v240
    v_mul_f32 v246, v26, v240
    v_mul_f32 v247, v27, v240
    v_mul_f32 v248, v28, v240
    v_mul_f32 v249, v29, v240
    v_mul_f32 v250, v30, v240
    v_mul_f32 v251, v31, v240
    s_waitcnt vmcnt(23)
    v_lshlrev_b32 v24, 16, v228
    v_and_b32 v25, s47, v228
    v_lshlrev_b32 v26, 16, v229
    v_and_b32 v27, s47, v229
    v_lshlrev_b32 v28, 16, v230
    v_and_b32 v29, s47, v230
    v_lshlrev_b32 v30, 16, v231
    v_and_b32 v31, s47, v231
    s_waitcnt lgkmcnt(2)
    v_fmac_f32 v244, v24, v241
    v_fmac_f32 v245, v25, v241
    v_fmac_f32 v246, v26, v241
    v_fmac_f32 v247, v27, v241
    v_fmac_f32 v248, v28, v241
    v_fmac_f32 v249, v29, v241
    v_fmac_f32 v250, v30, v241
    v_fmac_f32 v251, v31, v241
    s_waitcnt vmcnt(22)
    v_lshlrev_b32 v24, 16, v232
    v_and_b32 v25, s47, v232
    v_lshlrev_b32 v26, 16, v233
    v_and_b32 v27, s47, v233
    v_lshlrev_b32 v28, 16, v234
    v_and_b32 v29, s47, v234
    v_lshlrev_b32 v30, 16, v235
    v_and_b32 v31, s47, v235
    s_waitcnt lgkmcnt(1)
    v_fmac_f32 v244, v24, v242
    v_fmac_f32 v245, v25, v242
    v_fmac_f32 v246, v26, v242
    v_fmac_f32 v247, v27, v242
    v_fmac_f32 v248, v28, v242
    v_fmac_f32 v249, v29, v242
    v_fmac_f32 v250, v30, v242
    v_fmac_f32 v251, v31, v242
    s_waitcnt vmcnt(21)
    v_lshlrev_b32 v24, 16, v236
    v_and_b32 v25, s47, v236
    v_lshlrev_b32 v26, 16, v237
    v_and_b32 v27, s47, v237
    v_lshlrev_b32 v28, 16, v238
    v_and_b32 v29, s47, v238
    v_lshlrev_b32 v30, 16, v239
    v_and_b32 v31, s47, v239
    s_waitcnt lgkmcnt(0)
    v_fmac_f32 v244, v24, v243
    v_fmac_f32 v245, v25, v243
    v_fmac_f32 v246, v26, v243
    v_fmac_f32 v247, v27, v243
    v_fmac_f32 v248, v28, v243
    v_fmac_f32 v249, v29, v243
    v_fmac_f32 v250, v30, v243
    v_fmac_f32 v251, v31, v243
    v_add_f32_dpp v244, v244, v244 row_ror:8 row_mask:0xf bank_mask:0xf
    v_add_f32_dpp v245, v245, v245 row_ror:8 row_mask:0xf bank_mask:0xf
    v_add_f32_dpp v246, v246, v246 row_ror:8 row_mask:0xf bank_mask:0xf
    v_add_f32_dpp v247, v247, v247 row_ror:8 row_mask:0xf bank_mask:0xf
    v_add_f32_dpp v248, v248, v248 row_ror:8 row_mask:0xf bank_mask:0xf
    v_add_f32_dpp v249, v249, v249 row_ror:8 row_mask:0xf bank_mask:0xf
    v_add_f32_dpp v250, v250, v250 row_ror:8 row_mask:0xf bank_mask:0xf
    v_add_f32_dpp v251, v251, v251 row_ror:8 row_mask:0xf bank_mask:0xf
    v_mov_b32 v24, v244
    v_mov_b32 v25, v245
    v_mov_b32 v26, v246
    v_mov_b32 v27, v247
    v_mov_b32 v28, v248
    v_mov_b32 v29, v249
    v_mov_b32 v30, v250
    v_mov_b32 v31, v251
    v_permlane16_swap_b32 v244, v24
    v_permlane16_swap_b32 v245, v25
    v_permlane16_swap_b32 v246, v26
    v_permlane16_swap_b32 v247, v27
    v_permlane16_swap_b32 v248, v28
    v_permlane16_swap_b32 v249, v29
    v_permlane16_swap_b32 v250, v30
    v_permlane16_swap_b32 v251, v31
    v_add_f32 v244, v244, v24
    v_add_f32 v245, v245, v25
    v_add_f32 v246, v246, v26
    v_add_f32 v247, v247, v27
    v_add_f32 v248, v248, v28
    v_add_f32 v249, v249, v29
    v_add_f32 v250, v250, v30
    v_add_f32 v251, v251, v31
    v_mov_b32 v24, v244
    v_mov_b32 v25, v245
    v_mov_b32 v26, v246
    v_mov_b32 v27, v247
    v_mov_b32 v28, v248
    v_mov_b32 v29, v249
    v_mov_b32 v30, v250
    v_mov_b32 v31, v251
    v_permlane32_swap_b32 v244, v24
    v_permlane32_swap_b32 v245, v25
    v_permlane32_swap_b32 v246, v26
    v_permlane32_swap_b32 v247, v27
    v_permlane32_swap_b32 v248, v28
    v_permlane32_swap_b32 v249, v29
    v_permlane32_swap_b32 v250, v30
    v_permlane32_swap_b32 v251, v31
    v_add_f32 v244, v244, v24
    v_add_f32 v245, v245, v25
    v_add_f32 v246, v246, v26
    v_add_f32 v247, v247, v27
    v_add_f32 v248, v248, v28
    v_add_f32 v249, v249, v29
    v_add_f32 v250, v250, v30
    v_add_f32 v251, v251, v31
    v_and_b32 v10, 7, v0
    v_lshlrev_b32 v10, 5, v10
    s_lshl_b32 s5, s48, 8
    s_add_u32 s5, s5, 158720
    v_add_u32 v10, s5, v10
    ds_write_b128 v10, v[244:247]
    ds_write_b128 v10, v[248:251] offset:16
    v_lshlrev_b32 v11, 2, v1
    v_add_u32 v12, 158720, v11
    s_waitcnt vmcnt(16) lgkmcnt(0)
    s_barrier
    s_cmp_lg_u32 s48, 0
    s_cbranch_scc1 k1_kernel_nog
    ds_read_b32 v13, v12
    ds_read_b32 v14, v12 offset:256
    ds_read_b32 v15, v12 offset:512
    ds_read_b32 v16, v12 offset:768
    s_mul_i32 s5, s51, 10752
    s_lshl_b32 s52, s50, 8
    s_add_u32 s5, s5, s52
    s_add_u32 s5, s5, 65536
    s_lshl_b32 s52, s50, 2
    s_add_u32 s52, s52, s51
    s_cmp_lt_u32 s2, 56
    s_cselect_b32 s51, 0, 72
    s_add_u32 s52, s52, s51
    s_waitcnt lgkmcnt(2)
    v_add_f32 v13, v13, v14
    s_waitcnt lgkmcnt(0)
    v_add_f32 v15, v15, v16
    v_add_f32 v13, v13, v15
    buffer_store_dword v13, v11, s[24:27], s5 offen sc1
    v_mov_b32 v14, 0
    v_mov_b32 v15, 1
    s_waitcnt vmcnt(0)
    buffer_store_byte v15, v14, s[92:95], s52 offen sc1
    s_branch k1_kernel_join
k1_kernel_nog:
    s_waitcnt vmcnt(0)
k1_kernel_join:
    s_mul_i32 s28, s2, 3
    s_add_u32 s28, s28, s48
    s_sub_u32 s28, s28, 169
    s_max_i32 s28, s28, 0
    s_mul_i32 s29, s28, 6128
    s_mul_i32 s30, s28, 874
    s_lshr_b32 s30, s30, 16
    s_mul_i32 s31, s30, 75
    s_sub_u32 s31, s28, s31
    s_mul_i32 s31, s31, 3504
    s_lshl_b32 s30, s30, 20
    s_add_u32 s30, s30, s31
    s_add_u32 s30, s30, 786432
    s_add_u32 s31, s29, 4096
    s_cmp_eq_u32 s48, 0
    s_cbranch_scc1 k1_kernel_nd
    s_cmp_lt_u32 s2, 56
    s_cbranch_scc1 k1_kernel_nd
    s_add_u32 m0, s40, 0
    s_add_u32 s45, s42, 0
    buffer_load_dwordx4 v2, s[8:11], s45 offen offset:0 lds
    buffer_load_dwordx4 v3, s[8:11], s45 offen offset:1024 lds
    buffer_load_dwordx4 v4, s[8:11], s45 offen offset:2048 lds
    buffer_load_dwordx4 v5, s[8:11], s45 offen offset:3072 lds
    s_add_u32 m0, s40, 4096
    s_add_u32 s45, s42, 131072
    buffer_load_dwordx4 v2, s[8:11], s45 offen offset:0 lds
    buffer_load_dwordx4 v3, s[8:11], s45 offen offset:1024 lds
    buffer_load_dwordx4 v4, s[8:11], s45 offen offset:2048 lds
    buffer_load_dwordx4 v5, s[8:11], s45 offen offset:3072 lds
    s_add_u32 m0, s40, 32768
    s_add_u32 s45, s42, 262144
    buffer_load_dwordx4 v2, s[8:11], s45 offen offset:0 lds
    buffer_load_dwordx4 v3, s[8:11], s45 offen offset:1024 lds
    buffer_load_dwordx4 v4, s[8:11], s45 offen offset:2048 lds
    buffer_load_dwordx4 v5, s[8:11], s45 offen offset:3072 lds
    s_add_u32 m0, s40, 36864
    s_add_u32 s45, s42, 393216
    buffer_load_dwordx4 v2, s[8:11], s45 offen offset:0 lds
    buffer_load_dwordx4 v3, s[8:11], s45 offen offset:1024 lds
    buffer_load_dwordx4 v4, s[8:11], s45 offen offset:2048 lds
    buffer_load_dwordx4 v5, s[8:11], s45 offen offset:3072 lds
    s_add_u32 m0, s40, 65536
    s_add_u32 s45, s42, 524288
    buffer_load_dwordx4 v2, s[8:11], s45 offen offset:0 lds
    buffer_load_dwordx4 v3, s[8:11], s45 offen offset:1024 lds
    buffer_load_dwordx4 v4, s[8:11], s45 offen offset:2048 lds
    buffer_load_dwordx4 v5, s[8:11], s45 offen offset:3072 lds
    s_add_u32 m0, s40, 69632
    s_add_u32 s45, s42, 655360
    buffer_load_dwordx4 v2, s[8:11], s45 offen offset:0 lds
    buffer_load_dwordx4 v3, s[8:11], s45 offen offset:1024 lds
    buffer_load_dwordx4 v4, s[8:11], s45 offen offset:2048 lds
    buffer_load_dwordx4 v5, s[8:11], s45 offen offset:3072 lds
k1_kernel_nd:
    v_cmp_gt_u32 vcc, 56, v1
    v_lshlrev_b32 v32, 16, v160
    v_and_b32 v33, s47, v160
    v_lshlrev_b32 v34, 16, v161
    v_and_b32 v35, s47, v161
    v_lshlrev_b32 v36, 16, v162
    v_and_b32 v37, s47, v162
    v_lshlrev_b32 v38, 16, v163
    v_and_b32 v39, s47, v163
    v_pk_add_f32 v[20:21], v[32:33], v[34:35]
    v_pk_add_f32 v[252:253], v[36:37], v[38:39]
    v_pk_add_f32 v[20:21], v[20:21], v[252:253]
    v_add_f32 v10, v20, v21
    v_cndmask_b32 v10, 0, v10, vcc
    v_lshlrev_b32 v40, 16, v164
    v_and_b32 v41, s47, v164
    v_lshlrev_b32 v42, 16, v165
    v_and_b32 v43, s47, v165
    v_lshlrev_b32 v44, 16, v166
    v_and_b32 v45, s47, v166
    v_lshlrev_b32 v46, 16, v167
    v_and_b32 v47, s47, v167
    v_pk_add_f32 v[20:21], v[40:41], v[42:43]
    v_pk_add_f32 v[252:253], v[44:45], v[46:47]
    v_pk_add_f32 v[20:21], v[20:21], v[252:253]
    v_add_f32 v11, v20, v21
    v_cndmask_b32 v11, 0, v11, vcc
    v_lshlrev_b32 v48, 16, v168
    v_and_b32 v49, s47, v168
    v_lshlrev_b32 v50, 16, v169
    v_and_b32 v51, s47, v169
    v_lshlrev_b32 v52, 16, v170
    v_and_b32 v53, s47, v170
    v_lshlrev_b32 v54, 16, v171
    v_and_b32 v55, s47, v171
    v_pk_add_f32 v[20:21], v[48:49], v[50:51]
    v_pk_add_f32 v[252:253], v[52:53], v[54:55]
    v_pk_add_f32 v[20:21], v[20:21], v[252:253]
    v_add_f32 v12, v20, v21
    v_cndmask_b32 v12, 0, v12, vcc
    v_lshlrev_b32 v56, 16, v172
    v_and_b32 v57, s47, v172
    v_lshlrev_b32 v58, 16, v173
    v_and_b32 v59, s47, v173
    v_lshlrev_b32 v60, 16, v174
    v_and_b32 v61, s47, v174
    v_lshlrev_b32 v62, 16, v175
    v_and_b32 v63, s47, v175
    v_pk_add_f32 v[20:21], v[56:57], v[58:59]
    v_pk_add_f32 v[252:253], v[60:61], v[62:63]
    v_pk_add_f32 v[20:21], v[20:21], v[252:253]
    v_add_f32 v13, v20, v21
    v_cndmask_b32 v13, 0, v13, vcc
    v_lshlrev_b32 v64, 16, v176
    v_and_b32 v65, s47, v176
    v_lshlrev_b32 v66, 16, v177
    v_and_b32 v67, s47, v177
    v_lshlrev_b32 v68, 16, v178
    v_and_b32 v69, s47, v178
    v_lshlrev_b32 v70, 16, v179
    v_and_b32 v71, s47, v179
    v_pk_add_f32 v[20:21], v[64:65], v[66:67]
    v_pk_add_f32 v[252:253], v[68:69], v[70:71]
    v_pk_add_f32 v[20:21], v[20:21], v[252:253]
    v_add_f32 v14, v20, v21
    v_cndmask_b32 v14, 0, v14, vcc
    v_lshlrev_b32 v72, 16, v180
    v_and_b32 v73, s47, v180
    v_lshlrev_b32 v74, 16, v181
    v_and_b32 v75, s47, v181
    v_lshlrev_b32 v76, 16, v182
    v_and_b32 v77, s47, v182
    v_lshlrev_b32 v78, 16, v183
    v_and_b32 v79, s47, v183
    v_pk_add_f32 v[20:21], v[72:73], v[74:75]
    v_pk_add_f32 v[252:253], v[76:77], v[78:79]
    v_pk_add_f32 v[20:21], v[20:21], v[252:253]
    v_add_f32 v15, v20, v21
    v_cndmask_b32 v15, 0, v15, vcc
    v_lshlrev_b32 v80, 16, v184
    v_and_b32 v81, s47, v184
    v_lshlrev_b32 v82, 16, v185
    v_and_b32 v83, s47, v185
    v_lshlrev_b32 v84, 16, v186
    v_and_b32 v85, s47, v186
    v_lshlrev_b32 v86, 16, v187
    v_and_b32 v87, s47, v187
    v_pk_add_f32 v[20:21], v[80:81], v[82:83]
    v_pk_add_f32 v[252:253], v[84:85], v[86:87]
    v_pk_add_f32 v[20:21], v[20:21], v[252:253]
    v_add_f32 v16, v20, v21
    v_cndmask_b32 v16, 0, v16, vcc
    v_lshlrev_b32 v88, 16, v188
    v_and_b32 v89, s47, v188
    v_lshlrev_b32 v90, 16, v189
    v_and_b32 v91, s47, v189
    v_lshlrev_b32 v92, 16, v190
    v_and_b32 v93, s47, v190
    v_lshlrev_b32 v94, 16, v191
    v_and_b32 v95, s47, v191
    v_pk_add_f32 v[20:21], v[88:89], v[90:91]
    v_pk_add_f32 v[252:253], v[92:93], v[94:95]
    v_pk_add_f32 v[20:21], v[20:21], v[252:253]
    v_add_f32 v17, v20, v21
    v_cndmask_b32 v17, 0, v17, vcc
    v_permlane32_swap_b32 v10, v11
    v_permlane32_swap_b32 v12, v13
    v_permlane32_swap_b32 v14, v15
    v_permlane32_swap_b32 v16, v17
    v_add_f32 v10, v10, v11
    v_add_f32 v12, v12, v13
    v_add_f32 v14, v14, v15
    v_add_f32 v16, v16, v17
    v_permlane16_swap_b32 v10, v12
    s_nop 0
    v_permlane16_swap_b32 v14, v16
    v_add_f32 v10, v10, v12
    v_add_f32 v14, v14, v16
    s_nop 0
    v_add_f32_dpp v10, v10, v10 quad_perm:[1,0,3,2] row_mask:0xf bank_mask:0xf
    v_add_f32_dpp v14, v14, v14 quad_perm:[1,0,3,2] row_mask:0xf bank_mask:0xf
    s_nop 0
    v_add_f32_dpp v10, v10, v10 quad_perm:[2,3,0,1] row_mask:0xf bank_mask:0xf
    v_add_f32_dpp v14, v14, v14 quad_perm:[2,3,0,1] row_mask:0xf bank_mask:0xf
    s_nop 0
    v_add_f32_dpp v10, v10, v10 row_half_mirror row_mask:0xf bank_mask:0xf
    v_add_f32_dpp v14, v14, v14 row_half_mirror row_mask:0xf bank_mask:0xf
    s_nop 0
    v_add_f32_dpp v10, v10, v10 row_mirror row_mask:0xf bank_mask:0xf
    v_add_f32_dpp v14, v14, v14 row_mirror row_mask:0xf bank_mask:0xf
    v_mul_f32 v10, 0x3b124925, v10
    v_mul_f32 v14, 0x3b124925, v14
    v_readlane_b32 s88, v10, 0
    v_readlane_b32 s90, v10, 32
    s_nop 0
    v_pk_add_f32 v[252:253], v[32:33], s[88:89] op_sel_hi:[1,0] neg_lo:[0,1] neg_hi:[0,1]
    v_pk_mul_f32 v[20:21], v[252:253], v[252:253]
    v_pk_add_f32 v[254:255], v[34:35], s[88:89] op_sel_hi:[1,0] neg_lo:[0,1] neg_hi:[0,1]
    v_pk_fma_f32 v[20:21], v[254:255], v[254:255], v[20:21]
    v_pk_add_f32 v[252:253], v[36:37], s[88:89] op_sel_hi:[1,0] neg_lo:[0,1] neg_hi:[0,1]
    v_pk_fma_f32 v[20:21], v[252:253], v[252:253], v[20:21]
    v_pk_add_f32 v[254:255], v[38:39], s[88:89] op_sel_hi:[1,0] neg_lo:[0,1] neg_hi:[0,1]
    v_pk_fma_f32 v[20:21], v[254:255], v[254:255], v[20:21]
    v_add_f32 v24, v20, v21
    v_cndmask_b32 v24, 0, v24, vcc
    v_readlane_b32 s88, v10, 16
    v_pk_add_f32 v[252:253], v[40:41], s[90:91] op_sel_hi:[1,0] neg_lo:[0,1] neg_hi:[0,1]
    v_pk_mul_f32 v[20:21], v[252:253], v[252:253]
    v_pk_add_f32 v[254:255], v[42:43], s[90:91] op_sel_hi:[1,0] neg_lo:[0,1] neg_hi:[0,1]
    v_pk_fma_f32 v[20:21], v[254:255], v[254:255], v[20:21]
    v_pk_add_f32 v[252:253], v[44:45], s[90:91] op_sel_hi:[1,0] neg_lo:[0,1] neg_hi:[0,1]
    v_pk_fma_f32 v[20:21], v[252:253], v[252:253], v[20:21]
    v_pk_add_f32 v[254:255], v[46:47], s[90:91] op_sel_hi:[1,0] neg_lo:[0,1] neg_hi:[0,1]
    v_pk_fma_f32 v[20:21], v[254:255], v[254:255], v[20:21]
    v_add_f32 v25, v20, v21
    v_cndmask_b32 v25, 0, v25, vcc
    v_readlane_b32 s90, v10, 48
    v_pk_add_f32 v[252:253], v[48:49], s[88:89] op_sel_hi:[1,0] neg_lo:[0,1] neg_hi:[0,1]
    v_pk_mul_f32 v[20:21], v[252:253], v[252:253]
    v_pk_add_f32 v[254:255], v[50:51], s[88:89] op_sel_hi:[1,0] neg_lo:[0,1] neg_hi:[0,1]
    v_pk_fma_f32 v[20:21], v[254:255], v[254:255], v[20:21]
    v_pk_add_f32 v[252:253], v[52:53], s[88:89] op_sel_hi:[1,0] neg_lo:[0,1] neg_hi:[0,1]
    v_pk_fma_f32 v[20:21], v[252:253], v[252:253], v[20:21]
    v_pk_add_f32 v[254:255], v[54:55], s[88:89] op_sel_hi:[1,0] neg_lo:[0,1] neg_hi:[0,1]
    v_pk_fma_f32 v[20:21], v[254:255], v[254:255], v[20:21]
    v_add_f32 v26, v20, v21
    v_cndmask_b32 v26, 0, v26, vcc
    v_readlane_b32 s88, v14, 0
    v_pk_add_f32 v[252:253], v[56:57], s[90:91] op_sel_hi:[1,0] neg_lo:[0,1] neg_hi:[0,1]
    v_pk_mul_f32 v[20:21], v[252:253], v[252:253]
    v_pk_add_f32 v[254:255], v[58:59], s[90:91] op_sel_hi:[1,0] neg_lo:[0,1] neg_hi:[0,1]
    v_pk_fma_f32 v[20:21], v[254:255], v[254:255], v[20:21]
    v_pk_add_f32 v[252:253], v[60:61], s[90:91] op_sel_hi:[1,0] neg_lo:[0,1] neg_hi:[0,1]
    v_pk_fma_f32 v[20:21], v[252:253], v[252:253], v[20:21]
    v_pk_add_f32 v[254:255], v[62:63], s[90:91] op_sel_hi:[1,0] neg_lo:[0,1] neg_hi:[0,1]
    v_pk_fma_f32 v[20:21], v[254:255], v[254:255], v[20:21]
    v_add_f32 v27, v20, v21
    v_cndmask_b32 v27, 0, v27, vcc
    v_readlane_b32 s90, v14, 32
    v_pk_add_f32 v[252:253], v[64:65], s[88:89] op_sel_hi:[1,0] neg_lo:[0,1] neg_hi:[0,1]
    v_pk_mul_f32 v[20:21], v[252:253], v[252:253]
    v_pk_add_f32 v[254:255], v[66:67], s[88:89] op_sel_hi:[1,0] neg_lo:[0,1] neg_hi:[0,1]
    v_pk_fma_f32 v[20:21], v[254:255], v[254:255], v[20:21]
    v_pk_add_f32 v[252:253], v[68:69], s[88:89] op_sel_hi:[1,0] neg_lo:[0,1] neg_hi:[0,1]
    v_pk_fma_f32 v[20:21], v[252:253], v[252:253], v[20:21]
    v_pk_add_f32 v[254:255], v[70:71], s[88:89] op_sel_hi:[1,0] neg_lo:[0,1] neg_hi:[0,1]
    v_pk_fma_f32 v[20:21], v[254:255], v[254:255], v[20:21]
    v_add_f32 v28, v20, v21
    v_cndmask_b32 v28, 0, v28, vcc
    v_readlane_b32 s88, v14, 16
    v_pk_add_f32 v[252:253], v[72:73], s[90:91] op_sel_hi:[1,0] neg_lo:[0,1] neg_hi:[0,1]
    v_pk_mul_f32 v[20:21], v[252:253], v[252:253]
    v_pk_add_f32 v[254:255], v[74:75], s[90:91] op_sel_hi:[1,0] neg_lo:[0,1] neg_hi:[0,1]
    v_pk_fma_f32 v[20:21], v[254:255], v[254:255], v[20:21]
    v_pk_add_f32 v[252:253], v[76:77], s[90:91] op_sel_hi:[1,0] neg_lo:[0,1] neg_hi:[0,1]
    v_pk_fma_f32 v[20:21], v[252:253], v[252:253], v[20:21]
    v_pk_add_f32 v[254:255], v[78:79], s[90:91] op_sel_hi:[1,0] neg_lo:[0,1] neg_hi:[0,1]
    v_pk_fma_f32 v[20:21], v[254:255], v[254:255], v[20:21]
    v_add_f32 v29, v20, v21
    v_cndmask_b32 v29, 0, v29, vcc
    v_readlane_b32 s90, v14, 48
    v_pk_add_f32 v[252:253], v[80:81], s[88:89] op_sel_hi:[1,0] neg_lo:[0,1] neg_hi:[0,1]
    v_pk_mul_f32 v[20:21], v[252:253], v[252:253]
    v_pk_add_f32 v[254:255], v[82:83], s[88:89] op_sel_hi:[1,0] neg_lo:[0,1] neg_hi:[0,1]
    v_pk_fma_f32 v[20:21], v[254:255], v[254:255], v[20:21]
    v_pk_add_f32 v[252:253], v[84:85], s[88:89] op_sel_hi:[1,0] neg_lo:[0,1] neg_hi:[0,1]
    v_pk_fma_f32 v[20:21], v[252:253], v[252:253], v[20:21]
    v_pk_add_f32 v[254:255], v[86:87], s[88:89] op_sel_hi:[1,0] neg_lo:[0,1] neg_hi:[0,1]
    v_pk_fma_f32 v[20:21], v[254:255], v[254:255], v[20:21]
    v_add_f32 v30, v20, v21
    v_cndmask_b32 v30, 0, v30, vcc
    v_pk_add_f32 v[252:253], v[88:89], s[90:91] op_sel_hi:[1,0] neg_lo:[0,1] neg_hi:[0,1]
    v_pk_mul_f32 v[20:21], v[252:253], v[252:253]
    v_pk_add_f32 v[254:255], v[90:91], s[90:91] op_sel_hi:[1,0] neg_lo:[0,1] neg_hi:[0,1]
    v_pk_fma_f32 v[20:21], v[254:255], v[254:255], v[20:21]
    v_pk_add_f32 v[252:253], v[92:93], s[90:91] op_sel_hi:[1,0] neg_lo:[0,1] neg_hi:[0,1]
    v_pk_fma_f32 v[20:21], v[252:253], v[252:253], v[20:21]
    v_pk_add_f32 v[254:255], v[94:95], s[90:91] op_sel_hi:[1,0] neg_lo:[0,1] neg_hi:[0,1]
    v_pk_fma_f32 v[20:21], v[254:255], v[254:255], v[20:21]
    v_add_f32 v31, v20, v21
    v_cndmask_b32 v31, 0, v31, vcc
    v_permlane32_swap_b32 v24, v25
    v_permlane32_swap_b32 v26, v27
    v_permlane32_swap_b32 v28, v29
    v_permlane32_swap_b32 v30, v31
    v_add_f32 v24, v24, v25
    v_add_f32 v26, v26, v27
    v_add_f32 v28, v28, v29
    v_add_f32 v30, v30, v31
    v_permlane16_swap_b32 v24, v26
    s_nop 0
    v_permlane16_swap_b32 v28, v30
    v_add_f32 v24, v24, v26
    v_add_f32 v28, v28, v30
    s_nop 0
    v_add_f32_dpp v24, v24, v24 quad_perm:[1,0,3,2] row_mask:0xf bank_mask:0xf
    v_add_f32_dpp v28, v28, v28 quad_perm:[1,0,3,2] row_mask:0xf bank_mask:0xf
    s_nop 0
    v_add_f32_dpp v24, v24, v24 quad_perm:[2,3,0,1] row_mask:0xf bank_mask:0xf
    v_add_f32_dpp v28, v28, v28 quad_perm:[2,3,0,1] row_mask:0xf bank_mask:0xf
    s_nop 0
    v_add_f32_dpp v24, v24, v24 row_half_mirror row_mask:0xf bank_mask:0xf
    v_add_f32_dpp v28, v28, v28 row_half_mirror row_mask:0xf bank_mask:0xf
    s_nop 0
    v_add_f32_dpp v24, v24, v24 row_mirror row_mask:0xf bank_mask:0xf
    v_add_f32_dpp v28, v28, v28 row_mirror row_mask:0xf bank_mask:0xf
    v_mul_f32 v24, 0x3b124925, v24
    v_cvt_pk_bf16_f32 v24, 0, v24
    v_cvt_pk_bf16_f32 v10, 0, v10
    v_add_f32 v24, 0x3727c5ac, v24
    v_cvt_pk_bf16_f32 v24, 0, v24
    v_sqrt_f32 v24, v24
    s_nop 0
    v_cvt_pk_bf16_f32 v24, 0, v24
    v_rcp_f32 v24, v24
    v_mul_f32 v28, 0x3b124925, v28
    v_cvt_pk_bf16_f32 v28, 0, v28
    v_cvt_pk_bf16_f32 v14, 0, v14
    v_add_f32 v28, 0x3727c5ac, v28
    v_cvt_pk_bf16_f32 v28, 0, v28
    v_sqrt_f32 v28, v28
    s_nop 0
    v_cvt_pk_bf16_f32 v28, 0, v28
    v_rcp_f32 v28, v28
    v_readlane_b32 s88, v10, 0
    v_readlane_b32 s89, v24, 0
    v_readlane_b32 s90, v10, 32
    v_readlane_b32 s91, v24, 32
    buffer_load_dwordx4 a[240:243], v19, s[8:11], s29 offen offset:0
    v_pk_add_f32 v[32:33], v[32:33], s[88:89] op_sel_hi:[1,0] neg_lo:[0,1] neg_hi:[0,1]
    v_pk_add_f32 v[34:35], v[34:35], s[88:89] op_sel_hi:[1,0] neg_lo:[0,1] neg_hi:[0,1]
    v_pk_add_f32 v[36:37], v[36:37], s[88:89] op_sel_hi:[1,0] neg_lo:[0,1] neg_hi:[0,1]
    v_pk_add_f32 v[38:39], v[38:39], s[88:89] op_sel_hi:[1,0] neg_lo:[0,1] neg_hi:[0,1]
    v_cvt_pk_bf16_f32 v32, 0, v32
    v_cvt_pk_bf16_f32 v33, 0, v33
    v_cvt_pk_bf16_f32 v34, 0, v34
    v_cvt_pk_bf16_f32 v35, 0, v35
    v_cvt_pk_bf16_f32 v36, 0, v36
    v_cvt_pk_bf16_f32 v37, 0, v37
    v_cvt_pk_bf16_f32 v38, 0, v38
    v_cvt_pk_bf16_f32 v39, 0, v39
    v_pk_mul_f32 v[32:33], v[32:33], s[88:89] op_sel:[0,1] op_sel_hi:[1,1]
    v_pk_mul_f32 v[34:35], v[34:35], s[88:89] op_sel:[0,1] op_sel_hi:[1,1]
    v_pk_mul_f32 v[36:37], v[36:37], s[88:89] op_sel:[0,1] op_sel_hi:[1,1]
    v_pk_mul_f32 v[38:39], v[38:39], s[88:89] op_sel:[0,1] op_sel_hi:[1,1]
    v_cvt_pk_bf16_f32 v32, 0, v32
    v_cvt_pk_bf16_f32 v33, 0, v33
    v_cvt_pk_bf16_f32 v34, 0, v34
    v_cvt_pk_bf16_f32 v35, 0, v35
    v_cvt_pk_bf16_f32 v36, 0, v36
    v_cvt_pk_bf16_f32 v37, 0, v37
    v_cvt_pk_bf16_f32 v38, 0, v38
    v_cvt_pk_bf16_f32 v39, 0, v39
    v_readlane_b32 s88, v10, 16
    v_readlane_b32 s89, v24, 16
    buffer_load_dwordx4 a[240:243], v19, s[8:11], s29 offen offset:1024
    v_pk_add_f32 v[40:41], v[40:41], s[90:91] op_sel_hi:[1,0] neg_lo:[0,1] neg_hi:[0,1]
    v_pk_add_f32 v[42:43], v[42:43], s[90:91] op_sel_hi:[1,0] neg_lo:[0,1] neg_hi:[0,1]
    v_pk_add_f32 v[44:45], v[44:45], s[90:91] op_sel_hi:[1,0] neg_lo:[0,1] neg_hi:[0,1]
    v_pk_add_f32 v[46:47], v[46:47], s[90:91] op_sel_hi:[1,0] neg_lo:[0,1] neg_hi:[0,1]
    v_cvt_pk_bf16_f32 v40, 0, v40
    v_cvt_pk_bf16_f32 v41, 0, v41
    v_cvt_pk_bf16_f32 v42, 0, v42
    v_cvt_pk_bf16_f32 v43, 0, v43
    v_cvt_pk_bf16_f32 v44, 0, v44
    v_cvt_pk_bf16_f32 v45, 0, v45
    v_cvt_pk_bf16_f32 v46, 0, v46
    v_cvt_pk_bf16_f32 v47, 0, v47
    v_pk_mul_f32 v[40:41], v[40:41], s[90:91] op_sel:[0,1] op_sel_hi:[1,1]
    v_pk_mul_f32 v[42:43], v[42:43], s[90:91] op_sel:[0,1] op_sel_hi:[1,1]
    v_pk_mul_f32 v[44:45], v[44:45], s[90:91] op_sel:[0,1] op_sel_hi:[1,1]
    v_pk_mul_f32 v[46:47], v[46:47], s[90:91] op_sel:[0,1] op_sel_hi:[1,1]
    v_cvt_pk_bf16_f32 v40, 0, v40
    v_cvt_pk_bf16_f32 v41, 0, v41
    v_cvt_pk_bf16_f32 v42, 0, v42
    v_cvt_pk_bf16_f32 v43, 0, v43
    v_cvt_pk_bf16_f32 v44, 0, v44
    v_cvt_pk_bf16_f32 v45, 0, v45
    v_cvt_pk_bf16_f32 v46, 0, v46
    v_cvt_pk_bf16_f32 v47, 0, v47
    v_readlane_b32 s90, v10, 48
    v_readlane_b32 s91, v24, 48
    buffer_load_dwordx4 a[240:243], v19, s[8:11], s29 offen offset:2048
    v_pk_add_f32 v[48:49], v[48:49], s[88:89] op_sel_hi:[1,0] neg_lo:[0,1] neg_hi:[0,1]
    v_pk_add_f32 v[50:51], v[50:51], s[88:89] op_sel_hi:[1,0] neg_lo:[0,1] neg_hi:[0,1]
    v_pk_add_f32 v[52:53], v[52:53], s[88:89] op_sel_hi:[1,0] neg_lo:[0,1] neg_hi:[0,1]
    v_pk_add_f32 v[54:55], v[54:55], s[88:89] op_sel_hi:[1,0] neg_lo:[0,1] neg_hi:[0,1]
    v_cvt_pk_bf16_f32 v48, 0, v48
    v_cvt_pk_bf16_f32 v49, 0, v49
    v_cvt_pk_bf16_f32 v50, 0, v50
    v_cvt_pk_bf16_f32 v51, 0, v51
    v_cvt_pk_bf16_f32 v52, 0, v52
    v_cvt_pk_bf16_f32 v53, 0, v53
    v_cvt_pk_bf16_f32 v54, 0, v54
    v_cvt_pk_bf16_f32 v55, 0, v55
    v_pk_mul_f32 v[48:49], v[48:49], s[88:89] op_sel:[0,1] op_sel_hi:[1,1]
    v_pk_mul_f32 v[50:51], v[50:51], s[88:89] op_sel:[0,1] op_sel_hi:[1,1]
    v_pk_mul_f32 v[52:53], v[52:53], s[88:89] op_sel:[0,1] op_sel_hi:[1,1]
    v_pk_mul_f32 v[54:55], v[54:55], s[88:89] op_sel:[0,1] op_sel_hi:[1,1]
    v_cvt_pk_bf16_f32 v48, 0, v48
    v_cvt_pk_bf16_f32 v49, 0, v49
    v_cvt_pk_bf16_f32 v50, 0, v50
    v_cvt_pk_bf16_f32 v51, 0, v51
    v_cvt_pk_bf16_f32 v52, 0, v52
    v_cvt_pk_bf16_f32 v53, 0, v53
    v_cvt_pk_bf16_f32 v54, 0, v54
    v_cvt_pk_bf16_f32 v55, 0, v55
    v_readlane_b32 s88, v14, 0
    v_readlane_b32 s89, v28, 0
    buffer_load_dwordx4 a[240:243], v19, s[8:11], s29 offen offset:3072
    v_pk_add_f32 v[56:57], v[56:57], s[90:91] op_sel_hi:[1,0] neg_lo:[0,1] neg_hi:[0,1]
    v_pk_add_f32 v[58:59], v[58:59], s[90:91] op_sel_hi:[1,0] neg_lo:[0,1] neg_hi:[0,1]
    v_pk_add_f32 v[60:61], v[60:61], s[90:91] op_sel_hi:[1,0] neg_lo:[0,1] neg_hi:[0,1]
    v_pk_add_f32 v[62:63], v[62:63], s[90:91] op_sel_hi:[1,0] neg_lo:[0,1] neg_hi:[0,1]
    v_cvt_pk_bf16_f32 v56, 0, v56
    v_cvt_pk_bf16_f32 v57, 0, v57
    v_cvt_pk_bf16_f32 v58, 0, v58
    v_cvt_pk_bf16_f32 v59, 0, v59
    v_cvt_pk_bf16_f32 v60, 0, v60
    v_cvt_pk_bf16_f32 v61, 0, v61
    v_cvt_pk_bf16_f32 v62, 0, v62
    v_cvt_pk_bf16_f32 v63, 0, v63
    v_pk_mul_f32 v[56:57], v[56:57], s[90:91] op_sel:[0,1] op_sel_hi:[1,1]
    v_pk_mul_f32 v[58:59], v[58:59], s[90:91] op_sel:[0,1] op_sel_hi:[1,1]
    v_pk_mul_f32 v[60:61], v[60:61], s[90:91] op_sel:[0,1] op_sel_hi:[1,1]
    v_pk_mul_f32 v[62:63], v[62:63], s[90:91] op_sel:[0,1] op_sel_hi:[1,1]
    v_cvt_pk_bf16_f32 v56, 0, v56
    v_cvt_pk_bf16_f32 v57, 0, v57
    v_cvt_pk_bf16_f32 v58, 0, v58
    v_cvt_pk_bf16_f32 v59, 0, v59
    v_cvt_pk_bf16_f32 v60, 0, v60
    v_cvt_pk_bf16_f32 v61, 0, v61
    v_cvt_pk_bf16_f32 v62, 0, v62
    v_cvt_pk_bf16_f32 v63, 0, v63
    v_readlane_b32 s90, v14, 32
    v_readlane_b32 s91, v28, 32
    buffer_load_dwordx4 a[240:243], v19, s[8:11], s31 offen offset:0
    v_pk_add_f32 v[64:65], v[64:65], s[88:89] op_sel_hi:[1,0] neg_lo:[0,1] neg_hi:[0,1]
    v_pk_add_f32 v[66:67], v[66:67], s[88:89] op_sel_hi:[1,0] neg_lo:[0,1] neg_hi:[0,1]
    v_pk_add_f32 v[68:69], v[68:69], s[88:89] op_sel_hi:[1,0] neg_lo:[0,1] neg_hi:[0,1]
    v_pk_add_f32 v[70:71], v[70:71], s[88:89] op_sel_hi:[1,0] neg_lo:[0,1] neg_hi:[0,1]
    v_cvt_pk_bf16_f32 v64, 0, v64
    v_cvt_pk_bf16_f32 v65, 0, v65
    v_cvt_pk_bf16_f32 v66, 0, v66
    v_cvt_pk_bf16_f32 v67, 0, v67
    v_cvt_pk_bf16_f32 v68, 0, v68
    v_cvt_pk_bf16_f32 v69, 0, v69
    v_cvt_pk_bf16_f32 v70, 0, v70
    v_cvt_pk_bf16_f32 v71, 0, v71
    v_pk_mul_f32 v[64:65], v[64:65], s[88:89] op_sel:[0,1] op_sel_hi:[1,1]
    v_pk_mul_f32 v[66:67], v[66:67], s[88:89] op_sel:[0,1] op_sel_hi:[1,1]
    v_pk_mul_f32 v[68:69], v[68:69], s[88:89] op_sel:[0,1] op_sel_hi:[1,1]
    v_pk_mul_f32 v[70:71], v[70:71], s[88:89] op_sel:[0,1] op_sel_hi:[1,1]
    v_cvt_pk_bf16_f32 v64, 0, v64
    v_cvt_pk_bf16_f32 v65, 0, v65
    v_cvt_pk_bf16_f32 v66, 0, v66
    v_cvt_pk_bf16_f32 v67, 0, v67
    v_cvt_pk_bf16_f32 v68, 0, v68
    v_cvt_pk_bf16_f32 v69, 0, v69
    v_cvt_pk_bf16_f32 v70, 0, v70
    v_cvt_pk_bf16_f32 v71, 0, v71
    v_readlane_b32 s88, v14, 16
    v_readlane_b32 s89, v28, 16
    buffer_load_dwordx4 a[240:243], v19, s[8:11], s31 offen offset:1008
    v_pk_add_f32 v[72:73], v[72:73], s[90:91] op_sel_hi:[1,0] neg_lo:[0,1] neg_hi:[0,1]
    v_pk_add_f32 v[74:75], v[74:75], s[90:91] op_sel_hi:[1,0] neg_lo:[0,1] neg_hi:[0,1]
    v_pk_add_f32 v[76:77], v[76:77], s[90:91] op_sel_hi:[1,0] neg_lo:[0,1] neg_hi:[0,1]
    v_pk_add_f32 v[78:79], v[78:79], s[90:91] op_sel_hi:[1,0] neg_lo:[0,1] neg_hi:[0,1]
    v_cvt_pk_bf16_f32 v72, 0, v72
    v_cvt_pk_bf16_f32 v73, 0, v73
    v_cvt_pk_bf16_f32 v74, 0, v74
    v_cvt_pk_bf16_f32 v75, 0, v75
    v_cvt_pk_bf16_f32 v76, 0, v76
    v_cvt_pk_bf16_f32 v77, 0, v77
    v_cvt_pk_bf16_f32 v78, 0, v78
    v_cvt_pk_bf16_f32 v79, 0, v79
    v_pk_mul_f32 v[72:73], v[72:73], s[90:91] op_sel:[0,1] op_sel_hi:[1,1]
    v_pk_mul_f32 v[74:75], v[74:75], s[90:91] op_sel:[0,1] op_sel_hi:[1,1]
    v_pk_mul_f32 v[76:77], v[76:77], s[90:91] op_sel:[0,1] op_sel_hi:[1,1]
    v_pk_mul_f32 v[78:79], v[78:79], s[90:91] op_sel:[0,1] op_sel_hi:[1,1]
    v_cvt_pk_bf16_f32 v72, 0, v72
    v_cvt_pk_bf16_f32 v73, 0, v73
    v_cvt_pk_bf16_f32 v74, 0, v74
    v_cvt_pk_bf16_f32 v75, 0, v75
    v_cvt_pk_bf16_f32 v76, 0, v76
    v_cvt_pk_bf16_f32 v77, 0, v77
    v_cvt_pk_bf16_f32 v78, 0, v78
    v_cvt_pk_bf16_f32 v79, 0, v79
    v_readlane_b32 s90, v14, 48
    v_readlane_b32 s91, v28, 48
    buffer_load_dwordx4 a[240:243], v19, s[12:15], s30 offen offset:0
    v_pk_add_f32 v[80:81], v[80:81], s[88:89] op_sel_hi:[1,0] neg_lo:[0,1] neg_hi:[0,1]
    v_pk_add_f32 v[82:83], v[82:83], s[88:89] op_sel_hi:[1,0] neg_lo:[0,1] neg_hi:[0,1]
    v_pk_add_f32 v[84:85], v[84:85], s[88:89] op_sel_hi:[1,0] neg_lo:[0,1] neg_hi:[0,1]
    v_pk_add_f32 v[86:87], v[86:87], s[88:89] op_sel_hi:[1,0] neg_lo:[0,1] neg_hi:[0,1]
    v_cvt_pk_bf16_f32 v80, 0, v80
    v_cvt_pk_bf16_f32 v81, 0, v81
    v_cvt_pk_bf16_f32 v82, 0, v82
    v_cvt_pk_bf16_f32 v83, 0, v83
    v_cvt_pk_bf16_f32 v84, 0, v84
    v_cvt_pk_bf16_f32 v85, 0, v85
    v_cvt_pk_bf16_f32 v86, 0, v86
    v_cvt_pk_bf16_f32 v87, 0, v87
    v_pk_mul_f32 v[80:81], v[80:81], s[88:89] op_sel:[0,1] op_sel_hi:[1,1]
    v_pk_mul_f32 v[82:83], v[82:83], s[88:89] op_sel:[0,1] op_sel_hi:[1,1]
    v_pk_mul_f32 v[84:85], v[84:85], s[88:89] op_sel:[0,1] op_sel_hi:[1,1]
    v_pk_mul_f32 v[86:87], v[86:87], s[88:89] op_sel:[0,1] op_sel_hi:[1,1]
    v_cvt_pk_bf16_f32 v80, 0, v80
    v_cvt_pk_bf16_f32 v81, 0, v81
    v_cvt_pk_bf16_f32 v82, 0, v82
    v_cvt_pk_bf16_f32 v83, 0, v83
    v_cvt_pk_bf16_f32 v84, 0, v84
    v_cvt_pk_bf16_f32 v85, 0, v85
    v_cvt_pk_bf16_f32 v86, 0, v86
    v_cvt_pk_bf16_f32 v87, 0, v87
    buffer_load_dwordx4 a[240:243], v19, s[12:15], s30 offen offset:1024
    v_pk_add_f32 v[88:89], v[88:89], s[90:91] op_sel_hi:[1,0] neg_lo:[0,1] neg_hi:[0,1]
    v_pk_add_f32 v[90:91], v[90:91], s[90:91] op_sel_hi:[1,0] neg_lo:[0,1] neg_hi:[0,1]
    v_pk_add_f32 v[92:93], v[92:93], s[90:91] op_sel_hi:[1,0] neg_lo:[0,1] neg_hi:[0,1]
    v_pk_add_f32 v[94:95], v[94:95], s[90:91] op_sel_hi:[1,0] neg_lo:[0,1] neg_hi:[0,1]
    v_cvt_pk_bf16_f32 v88, 0, v88
    v_cvt_pk_bf16_f32 v89, 0, v89
    v_cvt_pk_bf16_f32 v90, 0, v90
    v_cvt_pk_bf16_f32 v91, 0, v91
    v_cvt_pk_bf16_f32 v92, 0, v92
    v_cvt_pk_bf16_f32 v93, 0, v93
    v_cvt_pk_bf16_f32 v94, 0, v94
    v_cvt_pk_bf16_f32 v95, 0, v95
    v_pk_mul_f32 v[88:89], v[88:89], s[90:91] op_sel:[0,1] op_sel_hi:[1,1]
    v_pk_mul_f32 v[90:91], v[90:91], s[90:91] op_sel:[0,1] op_sel_hi:[1,1]
    v_pk_mul_f32 v[92:93], v[92:93], s[90:91] op_sel:[0,1] op_sel_hi:[1,1]
    v_pk_mul_f32 v[94:95], v[94:95], s[90:91] op_sel:[0,1] op_sel_hi:[1,1]
    v_cvt_pk_bf16_f32 v88, 0, v88
    v_cvt_pk_bf16_f32 v89, 0, v89
    v_cvt_pk_bf16_f32 v90, 0, v90
    v_cvt_pk_bf16_f32 v91, 0, v91
    v_cvt_pk_bf16_f32 v92, 0, v92
    v_cvt_pk_bf16_f32 v93, 0, v93
    v_cvt_pk_bf16_f32 v94, 0, v94
    v_cvt_pk_bf16_f32 v95, 0, v95
    s_cmp_lt_u32 s2, 56
    s_cselect_b32 s5, s48, 0
    s_cmp_eq_u32 s5, 0
    s_cbranch_scc1 k1_kernel_nd2
    s_waitcnt vmcnt(16)
    s_add_u32 m0, s40, 0
    s_add_u32 s45, s42, 0
    buffer_load_dwordx4 v2, s[8:11], s45 offen offset:0 lds
    buffer_load_dwordx4 v3, s[8:11], s45 offen offset:1024 lds
    buffer_load_dwordx4 v4, s[8:11], s45 offen offset:2048 lds
    buffer_load_dwordx4 v5, s[8:11], s45 offen offset:3072 lds
    s_add_u32 m0, s40, 4096
    s_add_u32 s45, s42, 131072
    buffer_load_dwordx4 v2, s[8:11], s45 offen offset:0 lds
    buffer_load_dwordx4 v3, s[8:11], s45 offen offset:1024 lds
    buffer_load_dwordx4 v4, s[8:11], s45 offen offset:2048 lds
    buffer_load_dwordx4 v5, s[8:11], s45 offen offset:3072 lds
    s_add_u32 m0, s40, 32768
    s_add_u32 s45, s42, 262144
    buffer_load_dwordx4 v2, s[8:11], s45 offen offset:0 lds
    buffer_load_dwordx4 v3, s[8:11], s45 offen offset:1024 lds
    buffer_load_dwordx4 v4, s[8:11], s45 offen offset:2048 lds
    buffer_load_dwordx4 v5, s[8:11], s45 offen offset:3072 lds
    s_add_u32 m0, s40, 36864
    s_add_u32 s45, s42, 393216
    buffer_load_dwordx4 v2, s[8:11], s45 offen offset:0 lds
    buffer_load_dwordx4 v3, s[8:11], s45 offen offset:1024 lds
    buffer_load_dwordx4 v4, s[8:11], s45 offen offset:2048 lds
    buffer_load_dwordx4 v5, s[8:11], s45 offen offset:3072 lds
    s_add_u32 m0, s40, 65536
    s_add_u32 s45, s42, 524288
    buffer_load_dwordx4 v2, s[8:11], s45 offen offset:0 lds
    buffer_load_dwordx4 v3, s[8:11], s45 offen offset:1024 lds
    buffer_load_dwordx4 v4, s[8:11], s45 offen offset:2048 lds
    buffer_load_dwordx4 v5, s[8:11], s45 offen offset:3072 lds
    s_add_u32 m0, s40, 69632
    s_add_u32 s45, s42, 655360
    buffer_load_dwordx4 v2, s[8:11], s45 offen offset:0 lds
    buffer_load_dwordx4 v3, s[8:11], s45 offen offset:1024 lds
    buffer_load_dwordx4 v4, s[8:11], s45 offen offset:2048 lds
    buffer_load_dwordx4 v5, s[8:11], s45 offen offset:3072 lds
k1_kernel_nd2:
    v_lshlrev_b32 v96, 16, v192
    v_and_b32 v97, s47, v192
    v_lshlrev_b32 v98, 16, v193
    v_and_b32 v99, s47, v193
    v_lshlrev_b32 v100, 16, v194
    v_and_b32 v101, s47, v194
    v_lshlrev_b32 v102, 16, v195
    v_and_b32 v103, s47, v195
    v_pk_add_f32 v[20:21], v[96:97], v[98:99]
    v_pk_add_f32 v[252:253], v[100:101], v[102:103]
    v_pk_add_f32 v[20:21], v[20:21], v[252:253]
    v_add_f32 v10, v20, v21
    v_cndmask_b32 v10, 0, v10, vcc
    v_lshlrev_b32 v104, 16, v196
    v_and_b32 v105, s47, v196
    v_lshlrev_b32 v106, 16, v197
    v_and_b32 v107, s47, v197
    v_lshlrev_b32 v108, 16, v198
    v_and_b32 v109, s47, v198
    v_lshlrev_b32 v110, 16, v199
    v_and_b32 v111, s47, v199
    v_pk_add_f32 v[20:21], v[104:105], v[106:107]
    v_pk_add_f32 v[252:253], v[108:109], v[110:111]
    v_pk_add_f32 v[20:21], v[20:21], v[252:253]
    v_add_f32 v11, v20, v21
    v_cndmask_b32 v11, 0, v11, vcc
    v_lshlrev_b32 v112, 16, v200
    v_and_b32 v113, s47, v200
    v_lshlrev_b32 v114, 16, v201
    v_and_b32 v115, s47, v201
    v_lshlrev_b32 v116, 16, v202
    v_and_b32 v117, s47, v202
    v_lshlrev_b32 v118, 16, v203
    v_and_b32 v119, s47, v203
    v_pk_add_f32 v[20:21], v[112:113], v[114:115]
    v_pk_add_f32 v[252:253], v[116:117], v[118:119]
    v_pk_add_f32 v[20:21], v[20:21], v[252:253]
    v_add_f32 v12, v20, v21
    v_cndmask_b32 v12, 0, v12, vcc
    v_lshlrev_b32 v120, 16, v204
    v_and_b32 v121, s47, v204
    v_lshlrev_b32 v122, 16, v205
    v_and_b32 v123, s47, v205
    v_lshlrev_b32 v124, 16, v206
    v_and_b32 v125, s47, v206
    v_lshlrev_b32 v126, 16, v207
    v_and_b32 v127, s47, v207
    v_pk_add_f32 v[20:21], v[120:121], v[122:123]
    v_pk_add_f32 v[252:253], v[124:125], v[126:127]
    v_pk_add_f32 v[20:21], v[20:21], v[252:253]
    v_add_f32 v13, v20, v21
    v_cndmask_b32 v13, 0, v13, vcc
    v_lshlrev_b32 v128, 16, v208
    v_and_b32 v129, s47, v208
    v_lshlrev_b32 v130, 16, v209
    v_and_b32 v131, s47, v209
    v_lshlrev_b32 v132, 16, v210
    v_and_b32 v133, s47, v210
    v_lshlrev_b32 v134, 16, v211
    v_and_b32 v135, s47, v211
    v_pk_add_f32 v[20:21], v[128:129], v[130:131]
    v_pk_add_f32 v[252:253], v[132:133], v[134:135]
    v_pk_add_f32 v[20:21], v[20:21], v[252:253]
    v_add_f32 v14, v20, v21
    v_cndmask_b32 v14, 0, v14, vcc
    v_lshlrev_b32 v136, 16, v212
    v_and_b32 v137, s47, v212
    v_lshlrev_b32 v138, 16, v213
    v_and_b32 v139, s47, v213
    v_lshlrev_b32 v140, 16, v214
    v_and_b32 v141, s47, v214
    v_lshlrev_b32 v142, 16, v215
    v_and_b32 v143, s47, v215
    v_pk_add_f32 v[20:21], v[136:137], v[138:139]
    v_pk_add_f32 v[252:253], v[140:141], v[142:143]
    v_pk_add_f32 v[20:21], v[20:21], v[252:253]
    v_add_f32 v15, v20, v21
    v_cndmask_b32 v15, 0, v15, vcc
    v_lshlrev_b32 v144, 16, v216
    v_and_b32 v145, s47, v216
    v_lshlrev_b32 v146, 16, v217
    v_and_b32 v147, s47, v217
    v_lshlrev_b32 v148, 16, v218
    v_and_b32 v149, s47, v218
    v_lshlrev_b32 v150, 16, v219
    v_and_b32 v151, s47, v219
    v_pk_add_f32 v[20:21], v[144:145], v[146:147]
    v_pk_add_f32 v[252:253], v[148:149], v[150:151]
    v_pk_add_f32 v[20:21], v[20:21], v[252:253]
    v_add_f32 v16, v20, v21
    v_cndmask_b32 v16, 0, v16, vcc
    v_lshlrev_b32 v152, 16, v220
    v_and_b32 v153, s47, v220
    v_lshlrev_b32 v154, 16, v221
    v_and_b32 v155, s47, v221
    v_lshlrev_b32 v156, 16, v222
    v_and_b32 v157, s47, v222
    v_lshlrev_b32 v158, 16, v223
    v_and_b32 v159, s47, v223
    v_pk_add_f32 v[20:21], v[152:153], v[154:155]
    v_pk_add_f32 v[252:253], v[156:157], v[158:159]
    v_pk_add_f32 v[20:21], v[20:21], v[252:253]
    v_add_f32 v17, v20, v21
    v_cndmask_b32 v17, 0, v17, vcc
    v_permlane32_swap_b32 v10, v11
    v_permlane32_swap_b32 v12, v13
    v_permlane32_swap_b32 v14, v15
    v_permlane32_swap_b32 v16, v17
    v_add_f32 v10, v10, v11
    v_add_f32 v12, v12, v13
    v_add_f32 v14, v14, v15
    v_add_f32 v16, v16, v17
    v_permlane16_swap_b32 v10, v12
    s_nop 0
    v_permlane16_swap_b32 v14, v16
    v_add_f32 v10, v10, v12
    v_add_f32 v14, v14, v16
    s_nop 0
    v_add_f32_dpp v10, v10, v10 quad_perm:[1,0,3,2] row_mask:0xf bank_mask:0xf
    v_add_f32_dpp v14, v14, v14 quad_perm:[1,0,3,2] row_mask:0xf bank_mask:0xf
    s_nop 0
    v_add_f32_dpp v10, v10, v10 quad_perm:[2,3,0,1] row_mask:0xf bank_mask:0xf
    v_add_f32_dpp v14, v14, v14 quad_perm:[2,3,0,1] row_mask:0xf bank_mask:0xf
    s_nop 0
    v_add_f32_dpp v10, v10, v10 row_half_mirror row_mask:0xf bank_mask:0xf
    v_add_f32_dpp v14, v14, v14 row_half_mirror row_mask:0xf bank_mask:0xf
    s_nop 0
    v_add_f32_dpp v10, v10, v10 row_mirror row_mask:0xf bank_mask:0xf
    v_add_f32_dpp v14, v14, v14 row_mirror row_mask:0xf bank_mask:0xf
    v_mul_f32 v10, 0x3b124925, v10
    v_mul_f32 v14, 0x3b124925, v14
    v_readlane_b32 s88, v10, 0
    v_readlane_b32 s90, v10, 32
    s_nop 0
    v_pk_add_f32 v[252:253], v[96:97], s[88:89] op_sel_hi:[1,0] neg_lo:[0,1] neg_hi:[0,1]
    v_pk_mul_f32 v[20:21], v[252:253], v[252:253]
    v_pk_add_f32 v[254:255], v[98:99], s[88:89] op_sel_hi:[1,0] neg_lo:[0,1] neg_hi:[0,1]
    v_pk_fma_f32 v[20:21], v[254:255], v[254:255], v[20:21]
    v_pk_add_f32 v[252:253], v[100:101], s[88:89] op_sel_hi:[1,0] neg_lo:[0,1] neg_hi:[0,1]
    v_pk_fma_f32 v[20:21], v[252:253], v[252:253], v[20:21]
    v_pk_add_f32 v[254:255], v[102:103], s[88:89] op_sel_hi:[1,0] neg_lo:[0,1] neg_hi:[0,1]
    v_pk_fma_f32 v[20:21], v[254:255], v[254:255], v[20:21]
    v_add_f32 v24, v20, v21
    v_cndmask_b32 v24, 0, v24, vcc
    v_readlane_b32 s88, v10, 16
    v_pk_add_f32 v[252:253], v[104:105], s[90:91] op_sel_hi:[1,0] neg_lo:[0,1] neg_hi:[0,1]
    v_pk_mul_f32 v[20:21], v[252:253], v[252:253]
    v_pk_add_f32 v[254:255], v[106:107], s[90:91] op_sel_hi:[1,0] neg_lo:[0,1] neg_hi:[0,1]
    v_pk_fma_f32 v[20:21], v[254:255], v[254:255], v[20:21]
    v_pk_add_f32 v[252:253], v[108:109], s[90:91] op_sel_hi:[1,0] neg_lo:[0,1] neg_hi:[0,1]
    v_pk_fma_f32 v[20:21], v[252:253], v[252:253], v[20:21]
    v_pk_add_f32 v[254:255], v[110:111], s[90:91] op_sel_hi:[1,0] neg_lo:[0,1] neg_hi:[0,1]
    v_pk_fma_f32 v[20:21], v[254:255], v[254:255], v[20:21]
    v_add_f32 v25, v20, v21
    v_cndmask_b32 v25, 0, v25, vcc
    v_readlane_b32 s90, v10, 48
    v_pk_add_f32 v[252:253], v[112:113], s[88:89] op_sel_hi:[1,0] neg_lo:[0,1] neg_hi:[0,1]
    v_pk_mul_f32 v[20:21], v[252:253], v[252:253]
    v_pk_add_f32 v[254:255], v[114:115], s[88:89] op_sel_hi:[1,0] neg_lo:[0,1] neg_hi:[0,1]
    v_pk_fma_f32 v[20:21], v[254:255], v[254:255], v[20:21]
    v_pk_add_f32 v[252:253], v[116:117], s[88:89] op_sel_hi:[1,0] neg_lo:[0,1] neg_hi:[0,1]
    v_pk_fma_f32 v[20:21], v[252:253], v[252:253], v[20:21]
    v_pk_add_f32 v[254:255], v[118:119], s[88:89] op_sel_hi:[1,0] neg_lo:[0,1] neg_hi:[0,1]
    v_pk_fma_f32 v[20:21], v[254:255], v[254:255], v[20:21]
    v_add_f32 v26, v20, v21
    v_cndmask_b32 v26, 0, v26, vcc
    v_readlane_b32 s88, v14, 0
    v_pk_add_f32 v[252:253], v[120:121], s[90:91] op_sel_hi:[1,0] neg_lo:[0,1] neg_hi:[0,1]
    v_pk_mul_f32 v[20:21], v[252:253], v[252:253]
    v_pk_add_f32 v[254:255], v[122:123], s[90:91] op_sel_hi:[1,0] neg_lo:[0,1] neg_hi:[0,1]
    v_pk_fma_f32 v[20:21], v[254:255], v[254:255], v[20:21]
    v_pk_add_f32 v[252:253], v[124:125], s[90:91] op_sel_hi:[1,0] neg_lo:[0,1] neg_hi:[0,1]
    v_pk_fma_f32 v[20:21], v[252:253], v[252:253], v[20:21]
    v_pk_add_f32 v[254:255], v[126:127], s[90:91] op_sel_hi:[1,0] neg_lo:[0,1] neg_hi:[0,1]
    v_pk_fma_f32 v[20:21], v[254:255], v[254:255], v[20:21]
    v_add_f32 v27, v20, v21
    v_cndmask_b32 v27, 0, v27, vcc
    v_readlane_b32 s90, v14, 32
    v_pk_add_f32 v[252:253], v[128:129], s[88:89] op_sel_hi:[1,0] neg_lo:[0,1] neg_hi:[0,1]
    v_pk_mul_f32 v[20:21], v[252:253], v[252:253]
    v_pk_add_f32 v[254:255], v[130:131], s[88:89] op_sel_hi:[1,0] neg_lo:[0,1] neg_hi:[0,1]
    v_pk_fma_f32 v[20:21], v[254:255], v[254:255], v[20:21]
    v_pk_add_f32 v[252:253], v[132:133], s[88:89] op_sel_hi:[1,0] neg_lo:[0,1] neg_hi:[0,1]
    v_pk_fma_f32 v[20:21], v[252:253], v[252:253], v[20:21]
    v_pk_add_f32 v[254:255], v[134:135], s[88:89] op_sel_hi:[1,0] neg_lo:[0,1] neg_hi:[0,1]
    v_pk_fma_f32 v[20:21], v[254:255], v[254:255], v[20:21]
    v_add_f32 v28, v20, v21
    v_cndmask_b32 v28, 0, v28, vcc
    v_readlane_b32 s88, v14, 16
    v_pk_add_f32 v[252:253], v[136:137], s[90:91] op_sel_hi:[1,0] neg_lo:[0,1] neg_hi:[0,1]
    v_pk_mul_f32 v[20:21], v[252:253], v[252:253]
    v_pk_add_f32 v[254:255], v[138:139], s[90:91] op_sel_hi:[1,0] neg_lo:[0,1] neg_hi:[0,1]
    v_pk_fma_f32 v[20:21], v[254:255], v[254:255], v[20:21]
    v_pk_add_f32 v[252:253], v[140:141], s[90:91] op_sel_hi:[1,0] neg_lo:[0,1] neg_hi:[0,1]
    v_pk_fma_f32 v[20:21], v[252:253], v[252:253], v[20:21]
    v_pk_add_f32 v[254:255], v[142:143], s[90:91] op_sel_hi:[1,0] neg_lo:[0,1] neg_hi:[0,1]
    v_pk_fma_f32 v[20:21], v[254:255], v[254:255], v[20:21]
    v_add_f32 v29, v20, v21
    v_cndmask_b32 v29, 0, v29, vcc
    v_readlane_b32 s90, v14, 48
    v_pk_add_f32 v[252:253], v[144:145], s[88:89] op_sel_hi:[1,0] neg_lo:[0,1] neg_hi:[0,1]
    v_pk_mul_f32 v[20:21], v[252:253], v[252:253]
    v_pk_add_f32 v[254:255], v[146:147], s[88:89] op_sel_hi:[1,0] neg_lo:[0,1] neg_hi:[0,1]
    v_pk_fma_f32 v[20:21], v[254:255], v[254:255], v[20:21]
    v_pk_add_f32 v[252:253], v[148:149], s[88:89] op_sel_hi:[1,0] neg_lo:[0,1] neg_hi:[0,1]
    v_pk_fma_f32 v[20:21], v[252:253], v[252:253], v[20:21]
    v_pk_add_f32 v[254:255], v[150:151], s[88:89] op_sel_hi:[1,0] neg_lo:[0,1] neg_hi:[0,1]
    v_pk_fma_f32 v[20:21], v[254:255], v[254:255], v[20:21]
    v_add_f32 v30, v20, v21
    v_cndmask_b32 v30, 0, v30, vcc
    v_pk_add_f32 v[252:253], v[152:153], s[90:91] op_sel_hi:[1,0] neg_lo:[0,1] neg_hi:[0,1]
    v_pk_mul_f32 v[20:21], v[252:253], v[252:253]
    v_pk_add_f32 v[254:255], v[154:155], s[90:91] op_sel_hi:[1,0] neg_lo:[0,1] neg_hi:[0,1]
    v_pk_fma_f32 v[20:21], v[254:255], v[254:255], v[20:21]
    v_pk_add_f32 v[252:253], v[156:157], s[90:91] op_sel_hi:[1,0] neg_lo:[0,1] neg_hi:[0,1]
    v_pk_fma_f32 v[20:21], v[252:253], v[252:253], v[20:21]
    v_pk_add_f32 v[254:255], v[158:159], s[90:91] op_sel_hi:[1,0] neg_lo:[0,1] neg_hi:[0,1]
    v_pk_fma_f32 v[20:21], v[254:255], v[254:255], v[20:21]
    v_add_f32 v31, v20, v21
    v_cndmask_b32 v31, 0, v31, vcc
    v_permlane32_swap_b32 v24, v25
    v_permlane32_swap_b32 v26, v27
    v_permlane32_swap_b32 v28, v29
    v_permlane32_swap_b32 v30, v31
    v_add_f32 v24, v24, v25
    v_add_f32 v26, v26, v27
    v_add_f32 v28, v28, v29
    v_add_f32 v30, v30, v31
    v_permlane16_swap_b32 v24, v26
    s_nop 0
    v_permlane16_swap_b32 v28, v30
    v_add_f32 v24, v24, v26
    v_add_f32 v28, v28, v30
    s_nop 0
    v_add_f32_dpp v24, v24, v24 quad_perm:[1,0,3,2] row_mask:0xf bank_mask:0xf
    v_add_f32_dpp v28, v28, v28 quad_perm:[1,0,3,2] row_mask:0xf bank_mask:0xf
    s_nop 0
    v_add_f32_dpp v24, v24, v24 quad_perm:[2,3,0,1] row_mask:0xf bank_mask:0xf
    v_add_f32_dpp v28, v28, v28 quad_perm:[2,3,0,1] row_mask:0xf bank_mask:0xf
    s_nop 0
    v_add_f32_dpp v24, v24, v24 row_half_mirror row_mask:0xf bank_mask:0xf
    v_add_f32_dpp v28, v28, v28 row_half_mirror row_mask:0xf bank_mask:0xf
    s_nop 0
    v_add_f32_dpp v24, v24, v24 row_mirror row_mask:0xf bank_mask:0xf
    v_add_f32_dpp v28, v28, v28 row_mirror row_mask:0xf bank_mask:0xf
    v_mul_f32 v24, 0x3b124925, v24
    v_cvt_pk_bf16_f32 v24, 0, v24
    v_cvt_pk_bf16_f32 v10, 0, v10
    v_add_f32 v24, 0x3727c5ac, v24
    v_cvt_pk_bf16_f32 v24, 0, v24
    v_sqrt_f32 v24, v24
    s_nop 0
    v_cvt_pk_bf16_f32 v24, 0, v24
    v_rcp_f32 v24, v24
    v_mul_f32 v28, 0x3b124925, v28
    v_cvt_pk_bf16_f32 v28, 0, v28
    v_cvt_pk_bf16_f32 v14, 0, v14
    v_add_f32 v28, 0x3727c5ac, v28
    v_cvt_pk_bf16_f32 v28, 0, v28
    v_sqrt_f32 v28, v28
    s_nop 0
    v_cvt_pk_bf16_f32 v28, 0, v28
    v_rcp_f32 v28, v28
    v_readlane_b32 s88, v10, 0
    v_readlane_b32 s89, v24, 0
    v_readlane_b32 s90, v10, 32
    v_readlane_b32 s91, v24, 32
    buffer_load_dwordx4 a[240:243], v19, s[12:15], s30 offen offset:2048
    v_pk_add_f32 v[96:97], v[96:97], s[88:89] op_sel_hi:[1,0] neg_lo:[0,1] neg_hi:[0,1]
    v_pk_add_f32 v[98:99], v[98:99], s[88:89] op_sel_hi:[1,0] neg_lo:[0,1] neg_hi:[0,1]
    v_pk_add_f32 v[100:101], v[100:101], s[88:89] op_sel_hi:[1,0] neg_lo:[0,1] neg_hi:[0,1]
    v_pk_add_f32 v[102:103], v[102:103], s[88:89] op_sel_hi:[1,0] neg_lo:[0,1] neg_hi:[0,1]
    v_cvt_pk_bf16_f32 v96, 0, v96
    v_cvt_pk_bf16_f32 v97, 0, v97
    v_cvt_pk_bf16_f32 v98, 0, v98
    v_cvt_pk_bf16_f32 v99, 0, v99
    v_cvt_pk_bf16_f32 v100, 0, v100
    v_cvt_pk_bf16_f32 v101, 0, v101
    v_cvt_pk_bf16_f32 v102, 0, v102
    v_cvt_pk_bf16_f32 v103, 0, v103
    v_pk_mul_f32 v[96:97], v[96:97], s[88:89] op_sel:[0,1] op_sel_hi:[1,1]
    v_pk_mul_f32 v[98:99], v[98:99], s[88:89] op_sel:[0,1] op_sel_hi:[1,1]
    v_pk_mul_f32 v[100:101], v[100:101], s[88:89] op_sel:[0,1] op_sel_hi:[1,1]
    v_pk_mul_f32 v[102:103], v[102:103], s[88:89] op_sel:[0,1] op_sel_hi:[1,1]
    v_cvt_pk_bf16_f32 v96, 0, v96
    v_cvt_pk_bf16_f32 v97, 0, v97
    v_cvt_pk_bf16_f32 v98, 0, v98
    v_cvt_pk_bf16_f32 v99, 0, v99
    v_cvt_pk_bf16_f32 v100, 0, v100
    v_cvt_pk_bf16_f32 v101, 0, v101
    v_cvt_pk_bf16_f32 v102, 0, v102
    v_cvt_pk_bf16_f32 v103, 0, v103
    v_readlane_b32 s88, v10, 16
    v_readlane_b32 s89, v24, 16
    buffer_load_dwordx4 a[240:243], v19, s[12:15], s30 offen offset:2480
    v_pk_add_f32 v[104:105], v[104:105], s[90:91] op_sel_hi:[1,0] neg_lo:[0,1] neg_hi:[0,1]
    v_pk_add_f32 v[106:107], v[106:107], s[90:91] op_sel_hi:[1,0] neg_lo:[0,1] neg_hi:[0,1]
    v_pk_add_f32 v[108:109], v[108:109], s[90:91] op_sel_hi:[1,0] neg_lo:[0,1] neg_hi:[0,1]
    v_pk_add_f32 v[110:111], v[110:111], s[90:91] op_sel_hi:[1,0] neg_lo:[0,1] neg_hi:[0,1]
    v_cvt_pk_bf16_f32 v104, 0, v104
    v_cvt_pk_bf16_f32 v105, 0, v105
    v_cvt_pk_bf16_f32 v106, 0, v106
    v_cvt_pk_bf16_f32 v107, 0, v107
    v_cvt_pk_bf16_f32 v108, 0, v108
    v_cvt_pk_bf16_f32 v109, 0, v109
    v_cvt_pk_bf16_f32 v110, 0, v110
    v_cvt_pk_bf16_f32 v111, 0, v111
    v_pk_mul_f32 v[104:105], v[104:105], s[90:91] op_sel:[0,1] op_sel_hi:[1,1]
    v_pk_mul_f32 v[106:107], v[106:107], s[90:91] op_sel:[0,1] op_sel_hi:[1,1]
    v_pk_mul_f32 v[108:109], v[108:109], s[90:91] op_sel:[0,1] op_sel_hi:[1,1]
    v_pk_mul_f32 v[110:111], v[110:111], s[90:91] op_sel:[0,1] op_sel_hi:[1,1]
    v_cvt_pk_bf16_f32 v104, 0, v104
    v_cvt_pk_bf16_f32 v105, 0, v105
    v_cvt_pk_bf16_f32 v106, 0, v106
    v_cvt_pk_bf16_f32 v107, 0, v107
    v_cvt_pk_bf16_f32 v108, 0, v108
    v_cvt_pk_bf16_f32 v109, 0, v109
    v_cvt_pk_bf16_f32 v110, 0, v110
    v_cvt_pk_bf16_f32 v111, 0, v111
    v_readlane_b32 s90, v10, 48
    v_readlane_b32 s91, v24, 48
    buffer_load_dwordx4 a[240:243], v19, s[16:19], s30 offen offset:0
    v_pk_add_f32 v[112:113], v[112:113], s[88:89] op_sel_hi:[1,0] neg_lo:[0,1] neg_hi:[0,1]
    v_pk_add_f32 v[114:115], v[114:115], s[88:89] op_sel_hi:[1,0] neg_lo:[0,1] neg_hi:[0,1]
    v_pk_add_f32 v[116:117], v[116:117], s[88:89] op_sel_hi:[1,0] neg_lo:[0,1] neg_hi:[0,1]
    v_pk_add_f32 v[118:119], v[118:119], s[88:89] op_sel_hi:[1,0] neg_lo:[0,1] neg_hi:[0,1]
    v_cvt_pk_bf16_f32 v112, 0, v112
    v_cvt_pk_bf16_f32 v113, 0, v113
    v_cvt_pk_bf16_f32 v114, 0, v114
    v_cvt_pk_bf16_f32 v115, 0, v115
    v_cvt_pk_bf16_f32 v116, 0, v116
    v_cvt_pk_bf16_f32 v117, 0, v117
    v_cvt_pk_bf16_f32 v118, 0, v118
    v_cvt_pk_bf16_f32 v119, 0, v119
    v_pk_mul_f32 v[112:113], v[112:113], s[88:89] op_sel:[0,1] op_sel_hi:[1,1]
    v_pk_mul_f32 v[114:115], v[114:115], s[88:89] op_sel:[0,1] op_sel_hi:[1,1]
    v_pk_mul_f32 v[116:117], v[116:117], s[88:89] op_sel:[0,1] op_sel_hi:[1,1]
    v_pk_mul_f32 v[118:119], v[118:119], s[88:89] op_sel:[0,1] op_sel_hi:[1,1]
    v_cvt_pk_bf16_f32 v112, 0, v112
    v_cvt_pk_bf16_f32 v113, 0, v113
    v_cvt_pk_bf16_f32 v114, 0, v114
    v_cvt_pk_bf16_f32 v115, 0, v115
    v_cvt_pk_bf16_f32 v116, 0, v116
    v_cvt_pk_bf16_f32 v117, 0, v117
    v_cvt_pk_bf16_f32 v118, 0, v118
    v_cvt_pk_bf16_f32 v119, 0, v119
    v_readlane_b32 s88, v14, 0
    v_readlane_b32 s89, v28, 0
    buffer_load_dwordx4 a[240:243], v19, s[16:19], s30 offen offset:1024
    v_pk_add_f32 v[120:121], v[120:121], s[90:91] op_sel_hi:[1,0] neg_lo:[0,1] neg_hi:[0,1]
    v_pk_add_f32 v[122:123], v[122:123], s[90:91] op_sel_hi:[1,0] neg_lo:[0,1] neg_hi:[0,1]
    v_pk_add_f32 v[124:125], v[124:125], s[90:91] op_sel_hi:[1,0] neg_lo:[0,1] neg_hi:[0,1]
    v_pk_add_f32 v[126:127], v[126:127], s[90:91] op_sel_hi:[1,0] neg_lo:[0,1] neg_hi:[0,1]
    v_cvt_pk_bf16_f32 v120, 0, v120
    v_cvt_pk_bf16_f32 v121, 0, v121
    v_cvt_pk_bf16_f32 v122, 0, v122
    v_cvt_pk_bf16_f32 v123, 0, v123
    v_cvt_pk_bf16_f32 v124, 0, v124
    v_cvt_pk_bf16_f32 v125, 0, v125
    v_cvt_pk_bf16_f32 v126, 0, v126
    v_cvt_pk_bf16_f32 v127, 0, v127
    v_pk_mul_f32 v[120:121], v[120:121], s[90:91] op_sel:[0,1] op_sel_hi:[1,1]
    v_pk_mul_f32 v[122:123], v[122:123], s[90:91] op_sel:[0,1] op_sel_hi:[1,1]
    v_pk_mul_f32 v[124:125], v[124:125], s[90:91] op_sel:[0,1] op_sel_hi:[1,1]
    v_pk_mul_f32 v[126:127], v[126:127], s[90:91] op_sel:[0,1] op_sel_hi:[1,1]
    v_cvt_pk_bf16_f32 v120, 0, v120
    v_cvt_pk_bf16_f32 v121, 0, v121
    v_cvt_pk_bf16_f32 v122, 0, v122
    v_cvt_pk_bf16_f32 v123, 0, v123
    v_cvt_pk_bf16_f32 v124, 0, v124
    v_cvt_pk_bf16_f32 v125, 0, v125
    v_cvt_pk_bf16_f32 v126, 0, v126
    v_cvt_pk_bf16_f32 v127, 0, v127
    v_readlane_b32 s90, v14, 32
    v_readlane_b32 s91, v28, 32
    buffer_load_dwordx4 a[240:243], v19, s[16:19], s30 offen offset:2048
    v_pk_add_f32 v[128:129], v[128:129], s[88:89] op_sel_hi:[1,0] neg_lo:[0,1] neg_hi:[0,1]
    v_pk_add_f32 v[130:131], v[130:131], s[88:89] op_sel_hi:[1,0] neg_lo:[0,1] neg_hi:[0,1]
    v_pk_add_f32 v[132:133], v[132:133], s[88:89] op_sel_hi:[1,0] neg_lo:[0,1] neg_hi:[0,1]
    v_pk_add_f32 v[134:135], v[134:135], s[88:89] op_sel_hi:[1,0] neg_lo:[0,1] neg_hi:[0,1]
    v_cvt_pk_bf16_f32 v128, 0, v128
    v_cvt_pk_bf16_f32 v129, 0, v129
    v_cvt_pk_bf16_f32 v130, 0, v130
    v_cvt_pk_bf16_f32 v131, 0, v131
    v_cvt_pk_bf16_f32 v132, 0, v132
    v_cvt_pk_bf16_f32 v133, 0, v133
    v_cvt_pk_bf16_f32 v134, 0, v134
    v_cvt_pk_bf16_f32 v135, 0, v135
    v_pk_mul_f32 v[128:129], v[128:129], s[88:89] op_sel:[0,1] op_sel_hi:[1,1]
    v_pk_mul_f32 v[130:131], v[130:131], s[88:89] op_sel:[0,1] op_sel_hi:[1,1]
    v_pk_mul_f32 v[132:133], v[132:133], s[88:89] op_sel:[0,1] op_sel_hi:[1,1]
    v_pk_mul_f32 v[134:135], v[134:135], s[88:89] op_sel:[0,1] op_sel_hi:[1,1]
    v_cvt_pk_bf16_f32 v128, 0, v128
    v_cvt_pk_bf16_f32 v129, 0, v129
    v_cvt_pk_bf16_f32 v130, 0, v130
    v_cvt_pk_bf16_f32 v131, 0, v131
    v_cvt_pk_bf16_f32 v132, 0, v132
    v_cvt_pk_bf16_f32 v133, 0, v133
    v_cvt_pk_bf16_f32 v134, 0, v134
    v_cvt_pk_bf16_f32 v135, 0, v135
    v_readlane_b32 s88, v14, 16
    v_readlane_b32 s89, v28, 16
    buffer_load_dwordx4 a[240:243], v19, s[16:19], s30 offen offset:2480
    v_pk_add_f32 v[136:137], v[136:137], s[90:91] op_sel_hi:[1,0] neg_lo:[0,1] neg_hi:[0,1]
    v_pk_add_f32 v[138:139], v[138:139], s[90:91] op_sel_hi:[1,0] neg_lo:[0,1] neg_hi:[0,1]
    v_pk_add_f32 v[140:141], v[140:141], s[90:91] op_sel_hi:[1,0] neg_lo:[0,1] neg_hi:[0,1]
    v_pk_add_f32 v[142:143], v[142:143], s[90:91] op_sel_hi:[1,0] neg_lo:[0,1] neg_hi:[0,1]
    v_cvt_pk_bf16_f32 v136, 0, v136
    v_cvt_pk_bf16_f32 v137, 0, v137
    v_cvt_pk_bf16_f32 v138, 0, v138
    v_cvt_pk_bf16_f32 v139, 0, v139
    v_cvt_pk_bf16_f32 v140, 0, v140
    v_cvt_pk_bf16_f32 v141, 0, v141
    v_cvt_pk_bf16_f32 v142, 0, v142
    v_cvt_pk_bf16_f32 v143, 0, v143
    v_pk_mul_f32 v[136:137], v[136:137], s[90:91] op_sel:[0,1] op_sel_hi:[1,1]
    v_pk_mul_f32 v[138:139], v[138:139], s[90:91] op_sel:[0,1] op_sel_hi:[1,1]
    v_pk_mul_f32 v[140:141], v[140:141], s[90:91] op_sel:[0,1] op_sel_hi:[1,1]
    v_pk_mul_f32 v[142:143], v[142:143], s[90:91] op_sel:[0,1] op_sel_hi:[1,1]
    v_cvt_pk_bf16_f32 v136, 0, v136
    v_cvt_pk_bf16_f32 v137, 0, v137
    v_cvt_pk_bf16_f32 v138, 0, v138
    v_cvt_pk_bf16_f32 v139, 0, v139
    v_cvt_pk_bf16_f32 v140, 0, v140
    v_cvt_pk_bf16_f32 v141, 0, v141
    v_cvt_pk_bf16_f32 v142, 0, v142
    v_cvt_pk_bf16_f32 v143, 0, v143
    v_readlane_b32 s90, v14, 48
    v_readlane_b32 s91, v28, 48
    v_pk_add_f32 v[144:145], v[144:145], s[88:89] op_sel_hi:[1,0] neg_lo:[0,1] neg_hi:[0,1]
    v_pk_add_f32 v[146:147], v[146:147], s[88:89] op_sel_hi:[1,0] neg_lo:[0,1] neg_hi:[0,1]
    v_pk_add_f32 v[148:149], v[148:149], s[88:89] op_sel_hi:[1,0] neg_lo:[0,1] neg_hi:[0,1]
    v_pk_add_f32 v[150:151], v[150:151], s[88:89] op_sel_hi:[1,0] neg_lo:[0,1] neg_hi:[0,1]
    v_cvt_pk_bf16_f32 v144, 0, v144
    v_cvt_pk_bf16_f32 v145, 0, v145
    v_cvt_pk_bf16_f32 v146, 0, v146
    v_cvt_pk_bf16_f32 v147, 0, v147
    v_cvt_pk_bf16_f32 v148, 0, v148
    v_cvt_pk_bf16_f32 v149, 0, v149
    v_cvt_pk_bf16_f32 v150, 0, v150
    v_cvt_pk_bf16_f32 v151, 0, v151
    v_pk_mul_f32 v[144:145], v[144:145], s[88:89] op_sel:[0,1] op_sel_hi:[1,1]
    v_pk_mul_f32 v[146:147], v[146:147], s[88:89] op_sel:[0,1] op_sel_hi:[1,1]
    v_pk_mul_f32 v[148:149], v[148:149], s[88:89] op_sel:[0,1] op_sel_hi:[1,1]
    v_pk_mul_f32 v[150:151], v[150:151], s[88:89] op_sel:[0,1] op_sel_hi:[1,1]
    v_cvt_pk_bf16_f32 v144, 0, v144
    v_cvt_pk_bf16_f32 v145, 0, v145
    v_cvt_pk_bf16_f32 v146, 0, v146
    v_cvt_pk_bf16_f32 v147, 0, v147
    v_cvt_pk_bf16_f32 v148, 0, v148
    v_cvt_pk_bf16_f32 v149, 0, v149
    v_cvt_pk_bf16_f32 v150, 0, v150
    v_cvt_pk_bf16_f32 v151, 0, v151
    v_pk_add_f32 v[152:153], v[152:153], s[90:91] op_sel_hi:[1,0] neg_lo:[0,1] neg_hi:[0,1]
    v_pk_add_f32 v[154:155], v[154:155], s[90:91] op_sel_hi:[1,0] neg_lo:[0,1] neg_hi:[0,1]
    v_pk_add_f32 v[156:157], v[156:157], s[90:91] op_sel_hi:[1,0] neg_lo:[0,1] neg_hi:[0,1]
    v_pk_add_f32 v[158:159], v[158:159], s[90:91] op_sel_hi:[1,0] neg_lo:[0,1] neg_hi:[0,1]
    v_cvt_pk_bf16_f32 v152, 0, v152
    v_cvt_pk_bf16_f32 v153, 0, v153
    v_cvt_pk_bf16_f32 v154, 0, v154
    v_cvt_pk_bf16_f32 v155, 0, v155
    v_cvt_pk_bf16_f32 v156, 0, v156
    v_cvt_pk_bf16_f32 v157, 0, v157
    v_cvt_pk_bf16_f32 v158, 0, v158
    v_cvt_pk_bf16_f32 v159, 0, v159
    v_pk_mul_f32 v[152:153], v[152:153], s[90:91] op_sel:[0,1] op_sel_hi:[1,1]
    v_pk_mul_f32 v[154:155], v[154:155], s[90:91] op_sel:[0,1] op_sel_hi:[1,1]
    v_pk_mul_f32 v[156:157], v[156:157], s[90:91] op_sel:[0,1] op_sel_hi:[1,1]
    v_pk_mul_f32 v[158:159], v[158:159], s[90:91] op_sel:[0,1] op_sel_hi:[1,1]
    v_cvt_pk_bf16_f32 v152, 0, v152
    v_cvt_pk_bf16_f32 v153, 0, v153
    v_cvt_pk_bf16_f32 v154, 0, v154
    v_cvt_pk_bf16_f32 v155, 0, v155
    v_cvt_pk_bf16_f32 v156, 0, v156
    v_cvt_pk_bf16_f32 v157, 0, v157
    v_cvt_pk_bf16_f32 v158, 0, v158
    v_cvt_pk_bf16_f32 v159, 0, v159
    s_mov_b32 s28, 0x7ffffff0
    v_lshlrev_b32 v12, 5, v1
    v_add_u32 v12, 159744, v12
    s_cmp_lg_u32 s48, 0
    s_cbranch_scc1 k1_kernel_sh
    s_sub_u32 s50, s2, 154
    s_cmp_lt_u32 s50, 42
    s_cselect_b32 s5, s50, 0
    s_cmp_ge_u32 s50, 14
    s_cselect_b32 s50, s5, 0
    v_min_u32 v10, 14, v1
    v_cmp_eq_u32 vcc, 14, v10
    s_add_u32 s5, s50, 18
    s_cmp_lg_u32 s50, 0
    s_cselect_b32 s5, s5, 0
    v_mov_b32 v11, s5
    v_cndmask_b32 v10, v10, v11, vcc
    v_lshlrev_b32 v10, 2, v10
    s_mov_b32 s5, 0
    s_mov_b32 s51, 0x01010101
k1_kernel_L1:
    buffer_load_dword v11, v10, s[92:95], 0 offen sc1
    s_add_u32 s5, s5, 1
    s_waitcnt vmcnt(0)
    v_cmp_ne_u32 vcc, s51, v11
    s_nop 4
    s_cbranch_vccz k1_kernel_L1_ok
    s_cmp_lt_u32 s5, 0x20000
    s_cbranch_scc1 k1_kernel_L1
k1_kernel_L1_ok:
    v_lshlrev_b32 v10, 4, v1
    v_lshlrev_b32 v11, 2, v1
    v_mov_b32 v13, 0x7ffffff0
    v_cmp_gt_u32 vcc, 56, v1
    s_nop 1
    v_cndmask_b32 v14, v13, v10, vcc
    s_cmp_lg_u32 s50, 0
    s_cselect_b64 vcc, -1, 0
    v_cndmask_b32 v11, v13, v11, vcc
    s_lshl_b32 s51, s50, 8
    s_add_u32 s51, s51, 65536
    s_mov_b32 s5, 65536
    buffer_load_dwordx4 v[160:163], v14, s[24:27], s5 offen offset:0
    buffer_load_dwordx4 v[164:167], v14, s[24:27], s5 offen offset:896
    buffer_load_dwordx4 v[168:171], v14, s[24:27], s5 offen offset:1792
    buffer_load_dwordx4 v[172:175], v14, s[24:27], s5 offen offset:2688
    s_add_u32 s5, s5, 10752
    buffer_load_dwordx4 v[176:179], v14, s[24:27], s5 offen offset:0
    buffer_load_dwordx4 v[180:183], v14, s[24:27], s5 offen offset:896
    buffer_load_dwordx4 v[184:187], v14, s[24:27], s5 offen offset:1792
    buffer_load_dwordx4 v[188:191], v14, s[24:27], s5 offen offset:2688
    s_add_u32 s5, s5, 10752
    buffer_load_dwordx4 v[192:195], v14, s[24:27], s5 offen offset:0
    buffer_load_dwordx4 v[196:199], v14, s[24:27], s5 offen offset:896
    buffer_load_dwordx4 v[200:203], v14, s[24:27], s5 offen offset:1792
    buffer_load_dwordx4 v[204:207], v14, s[24:27], s5 offen offset:2688
    s_add_u32 s5, s5, 10752
    buffer_load_dwordx4 v[208:211], v14, s[24:27], s5 offen offset:0
    buffer_load_dwordx4 v[212:215], v14, s[24:27], s5 offen offset:896
    buffer_load_dwordx4 v[216:219], v14, s[24:27], s5 offen offset:1792
    buffer_load_dwordx4 v[220:223], v14, s[24:27], s5 offen offset:2688
    buffer_load_dword v240, v11, s[24:27], s51 offen sc1
    s_add_u32 s51, s51, 10752
    buffer_load_dword v241, v11, s[24:27], s51 offen sc1
    s_add_u32 s51, s51, 10752
    buffer_load_dword v242, v11, s[24:27], s51 offen sc1
    s_add_u32 s51, s51, 10752
    buffer_load_dword v243, v11, s[24:27], s51 offen sc1
    v_add_u32 v10, 159744, v10
    s_mov_b32 exec_hi, 0x00ffffff
    s_waitcnt vmcnt(15)
    v_pk_add_f32 v[160:161], v[160:161], v[176:177]
    v_pk_add_f32 v[162:163], v[162:163], v[178:179]
    s_waitcnt vmcnt(14)
    v_pk_add_f32 v[164:165], v[164:165], v[180:181]
    v_pk_add_f32 v[166:167], v[166:167], v[182:183]
    s_waitcnt vmcnt(13)
    v_pk_add_f32 v[168:169], v[168:169], v[184:185]
    v_pk_add_f32 v[170:171], v[170:171], v[186:187]
    s_waitcnt vmcnt(12)
    v_pk_add_f32 v[172:173], v[172:173], v[188:189]
    v_pk_add_f32 v[174:175], v[174:175], v[190:191]
    s_waitcnt vmcnt(7)
    v_pk_add_f32 v[192:193], v[192:193], v[208:209]
    v_pk_add_f32 v[160:161], v[160:161], v[192:193]
    v_pk_add_f32 v[194:195], v[194:195], v[210:211]
    v_pk_add_f32 v[162:163], v[162:163], v[194:195]
    s_waitcnt vmcnt(6)
    v_pk_add_f32 v[196:197], v[196:197], v[212:213]
    v_pk_add_f32 v[164:165], v[164:165], v[196:197]
    v_pk_add_f32 v[198:199], v[198:199], v[214:215]
    v_pk_add_f32 v[166:167], v[166:167], v[198:199]
    s_waitcnt vmcnt(5)
    v_pk_add_f32 v[200:201], v[200:201], v[216:217]
    v_pk_add_f32 v[168:169], v[168:169], v[200:201]
    v_pk_add_f32 v[202:203], v[202:203], v[218:219]
    v_pk_add_f32 v[170:171], v[170:171], v[202:203]
    s_waitcnt vmcnt(4)
    v_pk_add_f32 v[204:205], v[204:205], v[220:221]
    v_pk_add_f32 v[172:173], v[172:173], v[204:205]
    v_pk_add_f32 v[206:207], v[206:207], v[222:223]
    v_pk_add_f32 v[174:175], v[174:175], v[206:207]
    v_cvt_pk_bf16_f32 v160, 0, v160
    v_cvt_pk_bf16_f32 v161, 0, v161
    v_cvt_pk_bf16_f32 v162, 0, v162
    v_cvt_pk_bf16_f32 v163, 0, v163
    v_cvt_pk_bf16_f32 v164, 0, v164
    v_cvt_pk_bf16_f32 v165, 0, v165
    v_cvt_pk_bf16_f32 v166, 0, v166
    v_cvt_pk_bf16_f32 v167, 0, v167
    v_cvt_pk_bf16_f32 v168, 0, v168
    v_add_f32 v168, 1.0, v168
    v_cvt_pk_bf16_f32 v168, 0, v168
    v_cvt_pk_bf16_f32 v169, 0, v169
    v_add_f32 v169, 1.0, v169
    v_cvt_pk_bf16_f32 v169, 0, v169
    v_cvt_pk_bf16_f32 v170, 0, v170
    v_add_f32 v170, 1.0, v170
    v_cvt_pk_bf16_f32 v170, 0, v170
    v_cvt_pk_bf16_f32 v171, 0, v171
    v_add_f32 v171, 1.0, v171
    v_cvt_pk_bf16_f32 v171, 0, v171
    v_cvt_pk_bf16_f32 v172, 0, v172
    v_add_f32 v172, 1.0, v172
    v_cvt_pk_bf16_f32 v172, 0, v172
    v_cvt_pk_bf16_f32 v173, 0, v173
    v_add_f32 v173, 1.0, v173
    v_cvt_pk_bf16_f32 v173, 0, v173
    v_cvt_pk_bf16_f32 v174, 0, v174
    v_add_f32 v174, 1.0, v174
    v_cvt_pk_bf16_f32 v174, 0, v174
    v_cvt_pk_bf16_f32 v175, 0, v175
    v_add_f32 v175, 1.0, v175
    v_cvt_pk_bf16_f32 v175, 0, v175
    ds_write_b128 v10, v[160:163] offset:0
    ds_write_b128 v10, v[164:167] offset:896
    ds_write_b128 v10, v[168:171] offset:1792
    ds_write_b128 v10, v[172:175] offset:2688
    s_mov_b32 exec_hi, -1
    s_waitcnt vmcnt(2)
    v_add_f32 v240, v240, v241
    s_waitcnt vmcnt(0)
    v_add_f32 v242, v242, v243
    v_add_f32 v240, v240, v242
    v_cvt_pk_bf16_f32 v240, v240, v240
    v_lshlrev_b32 v11, 1, v1
    v_cndmask_b32 v11, v13, v11, vcc
    s_cmp_lg_u32 s50, 0
    s_cselect_b32 s28, 252, s28
    s_lshl_b32 s51, s50, 7
    s_waitcnt lgkmcnt(0)
    s_barrier
    buffer_store_short v240, v11, s[24:27], s51 offen sc1
    s_add_u32 m0, s40, 0
    s_add_u32 s45, s42, 0
    buffer_load_dwordx4 v2, s[8:11], s45 offen offset:0 lds
    buffer_load_dwordx4 v3, s[8:11], s45 offen offset:1024 lds
    buffer_load_dwordx4 v4, s[8:11], s45 offen offset:2048 lds
    buffer_load_dwordx4 v5, s[8:11], s45 offen offset:3072 lds
    s_add_u32 m0, s40, 4096
    s_add_u32 s45, s42, 131072
    buffer_load_dwordx4 v2, s[8:11], s45 offen offset:0 lds
    buffer_load_dwordx4 v3, s[8:11], s45 offen offset:1024 lds
    buffer_load_dwordx4 v4, s[8:11], s45 offen offset:2048 lds
    buffer_load_dwordx4 v5, s[8:11], s45 offen offset:3072 lds
    s_add_u32 m0, s40, 32768
    s_add_u32 s45, s42, 262144
    buffer_load_dwordx4 v2, s[8:11], s45 offen offset:0 lds
    buffer_load_dwordx4 v3, s[8:11], s45 offen offset:1024 lds
    buffer_load_dwordx4 v4, s[8:11], s45 offen offset:2048 lds
    buffer_load_dwordx4 v5, s[8:11], s45 offen offset:3072 lds
    s_add_u32 m0, s40, 36864
    s_add_u32 s45, s42, 393216
    buffer_load_dwordx4 v2, s[8:11], s45 offen offset:0 lds
    buffer_load_dwordx4 v3, s[8:11], s45 offen offset:1024 lds
    buffer_load_dwordx4 v4, s[8:11], s45 offen offset:2048 lds
    buffer_load_dwordx4 v5, s[8:11], s45 offen offset:3072 lds
    s_add_u32 m0, s40, 65536
    s_add_u32 s45, s42, 524288
    buffer_load_dwordx4 v2, s[8:11], s45 offen offset:0 lds
    buffer_load_dwordx4 v3, s[8:11], s45 offen offset:1024 lds
    buffer_load_dwordx4 v4, s[8:11], s45 offen offset:2048 lds
    buffer_load_dwordx4 v5, s[8:11], s45 offen offset:3072 lds
    s_add_u32 m0, s40, 69632
    s_add_u32 s45, s42, 655360
    buffer_load_dwordx4 v2, s[8:11], s45 offen offset:0 lds
    buffer_load_dwordx4 v3, s[8:11], s45 offen offset:1024 lds
    buffer_load_dwordx4 v4, s[8:11], s45 offen offset:2048 lds
    buffer_load_dwordx4 v5, s[8:11], s45 offen offset:3072 lds
    s_branch k1_kernel_md
k1_kernel_sh:
    s_barrier
k1_kernel_md:
    ds_read_b128 v[224:227], v12 offset:0
    ds_read_b128 v[232:235], v12 offset:1792
    ds_read_b128 v[228:231], v12 offset:16
    ds_read_b128 v[236:239], v12 offset:1808
    s_mov_b32 exec_hi, 0x00ffffff
    s_waitcnt lgkmcnt(2)
    v_pk_mul_f32 v[32:33], v[32:33], v[232:233]
    v_pk_mul_f32 v[34:35], v[34:35], v[234:235]
    s_waitcnt lgkmcnt(0)
    v_pk_mul_f32 v[36:37], v[36:37], v[236:237]
    v_pk_mul_f32 v[38:39], v[38:39], v[238:239]
    v_cvt_pk_bf16_f32 v32, 0, v32
    v_cvt_pk_bf16_f32 v33, 0, v33
    v_cvt_pk_bf16_f32 v34, 0, v34
    v_cvt_pk_bf16_f32 v35, 0, v35
    v_cvt_pk_bf16_f32 v36, 0, v36
    v_cvt_pk_bf16_f32 v37, 0, v37
    v_cvt_pk_bf16_f32 v38, 0, v38
    v_cvt_pk_bf16_f32 v39, 0, v39
    v_pk_add_f32 v[32:33], v[32:33], v[224:225]
    v_pk_add_f32 v[34:35], v[34:35], v[226:227]
    v_pk_add_f32 v[36:37], v[36:37], v[228:229]
    v_pk_add_f32 v[38:39], v[38:39], v[230:231]
    v_cvt_pk_bf16_f32 v32, v32, v33
    v_cvt_pk_bf16_f32 v33, v34, v35
    v_cvt_pk_bf16_f32 v34, v36, v37
    v_cvt_pk_bf16_f32 v35, v38, v39
    ds_write_b128 v23, v[32:35] offset:0
    v_pk_mul_f32 v[40:41], v[40:41], v[232:233]
    v_pk_mul_f32 v[42:43], v[42:43], v[234:235]
    v_pk_mul_f32 v[44:45], v[44:45], v[236:237]
    v_pk_mul_f32 v[46:47], v[46:47], v[238:239]
    v_cvt_pk_bf16_f32 v40, 0, v40
    v_cvt_pk_bf16_f32 v41, 0, v41
    v_cvt_pk_bf16_f32 v42, 0, v42
    v_cvt_pk_bf16_f32 v43, 0, v43
    v_cvt_pk_bf16_f32 v44, 0, v44
    v_cvt_pk_bf16_f32 v45, 0, v45
    v_cvt_pk_bf16_f32 v46, 0, v46
    v_cvt_pk_bf16_f32 v47, 0, v47
    v_pk_add_f32 v[40:41], v[40:41], v[224:225]
    v_pk_add_f32 v[42:43], v[42:43], v[226:227]
    v_pk_add_f32 v[44:45], v[44:45], v[228:229]
    v_pk_add_f32 v[46:47], v[46:47], v[230:231]
    v_cvt_pk_bf16_f32 v40, v40, v41
    v_cvt_pk_bf16_f32 v41, v42, v43
    v_cvt_pk_bf16_f32 v42, v44, v45
    v_cvt_pk_bf16_f32 v43, v46, v47
    ds_write_b128 v23, v[40:43] offset:912
    v_pk_mul_f32 v[48:49], v[48:49], v[232:233]
    v_pk_mul_f32 v[50:51], v[50:51], v[234:235]
    v_pk_mul_f32 v[52:53], v[52:53], v[236:237]
    v_pk_mul_f32 v[54:55], v[54:55], v[238:239]
    v_cvt_pk_bf16_f32 v48, 0, v48
    v_cvt_pk_bf16_f32 v49, 0, v49
    v_cvt_pk_bf16_f32 v50, 0, v50
    v_cvt_pk_bf16_f32 v51, 0, v51
    v_cvt_pk_bf16_f32 v52, 0, v52
    v_cvt_pk_bf16_f32 v53, 0, v53
    v_cvt_pk_bf16_f32 v54, 0, v54
    v_cvt_pk_bf16_f32 v55, 0, v55
    v_pk_add_f32 v[48:49], v[48:49], v[224:225]
    v_pk_add_f32 v[50:51], v[50:51], v[226:227]
    v_pk_add_f32 v[52:53], v[52:53], v[228:229]
    v_pk_add_f32 v[54:55], v[54:55], v[230:231]
    v_cvt_pk_bf16_f32 v48, v48, v49
    v_cvt_pk_bf16_f32 v49, v50, v51
    v_cvt_pk_bf16_f32 v50, v52, v53
    v_cvt_pk_bf16_f32 v51, v54, v55
    ds_write_b128 v23, v[48:51] offset:1824
    v_pk_mul_f32 v[56:57], v[56:57], v[232:233]
    v_pk_mul_f32 v[58:59], v[58:59], v[234:235]
    v_pk_mul_f32 v[60:61], v[60:61], v[236:237]
    v_pk_mul_f32 v[62:63], v[62:63], v[238:239]
    v_cvt_pk_bf16_f32 v56, 0, v56
    v_cvt_pk_bf16_f32 v57, 0, v57
    v_cvt_pk_bf16_f32 v58, 0, v58
    v_cvt_pk_bf16_f32 v59, 0, v59
    v_cvt_pk_bf16_f32 v60, 0, v60
    v_cvt_pk_bf16_f32 v61, 0, v61
    v_cvt_pk_bf16_f32 v62, 0, v62
    v_cvt_pk_bf16_f32 v63, 0, v63
    v_pk_add_f32 v[56:57], v[56:57], v[224:225]
    v_pk_add_f32 v[58:59], v[58:59], v[226:227]
    v_pk_add_f32 v[60:61], v[60:61], v[228:229]
    v_pk_add_f32 v[62:63], v[62:63], v[230:231]
    v_cvt_pk_bf16_f32 v56, v56, v57
    v_cvt_pk_bf16_f32 v57, v58, v59
    v_cvt_pk_bf16_f32 v58, v60, v61
    v_cvt_pk_bf16_f32 v59, v62, v63
    ds_write_b128 v23, v[56:59] offset:2736
    v_pk_mul_f32 v[64:65], v[64:65], v[232:233]
    v_pk_mul_f32 v[66:67], v[66:67], v[234:235]
    v_pk_mul_f32 v[68:69], v[68:69], v[236:237]
    v_pk_mul_f32 v[70:71], v[70:71], v[238:239]
    v_cvt_pk_bf16_f32 v64, 0, v64
    v_cvt_pk_bf16_f32 v65, 0, v65
    v_cvt_pk_bf16_f32 v66, 0, v66
    v_cvt_pk_bf16_f32 v67, 0, v67
    v_cvt_pk_bf16_f32 v68, 0, v68
    v_cvt_pk_bf16_f32 v69, 0, v69
    v_cvt_pk_bf16_f32 v70, 0, v70
    v_cvt_pk_bf16_f32 v71, 0, v71
    v_pk_add_f32 v[64:65], v[64:65], v[224:225]
    v_pk_add_f32 v[66:67], v[66:67], v[226:227]
    v_pk_add_f32 v[68:69], v[68:69], v[228:229]
    v_pk_add_f32 v[70:71], v[70:71], v[230:231]
    v_cvt_pk_bf16_f32 v64, v64, v65
    v_cvt_pk_bf16_f32 v65, v66, v67
    v_cvt_pk_bf16_f32 v66, v68, v69
    v_cvt_pk_bf16_f32 v67, v70, v71
    ds_write_b128 v23, v[64:67] offset:3648
    v_pk_mul_f32 v[72:73], v[72:73], v[232:233]
    v_pk_mul_f32 v[74:75], v[74:75], v[234:235]
    v_pk_mul_f32 v[76:77], v[76:77], v[236:237]
    v_pk_mul_f32 v[78:79], v[78:79], v[238:239]
    v_cvt_pk_bf16_f32 v72, 0, v72
    v_cvt_pk_bf16_f32 v73, 0, v73
    v_cvt_pk_bf16_f32 v74, 0, v74
    v_cvt_pk_bf16_f32 v75, 0, v75
    v_cvt_pk_bf16_f32 v76, 0, v76
    v_cvt_pk_bf16_f32 v77, 0, v77
    v_cvt_pk_bf16_f32 v78, 0, v78
    v_cvt_pk_bf16_f32 v79, 0, v79
    v_pk_add_f32 v[72:73], v[72:73], v[224:225]
    v_pk_add_f32 v[74:75], v[74:75], v[226:227]
    v_pk_add_f32 v[76:77], v[76:77], v[228:229]
    v_pk_add_f32 v[78:79], v[78:79], v[230:231]
    v_cvt_pk_bf16_f32 v72, v72, v73
    v_cvt_pk_bf16_f32 v73, v74, v75
    v_cvt_pk_bf16_f32 v74, v76, v77
    v_cvt_pk_bf16_f32 v75, v78, v79
    ds_write_b128 v23, v[72:75] offset:4560
    v_pk_mul_f32 v[80:81], v[80:81], v[232:233]
    v_pk_mul_f32 v[82:83], v[82:83], v[234:235]
    v_pk_mul_f32 v[84:85], v[84:85], v[236:237]
    v_pk_mul_f32 v[86:87], v[86:87], v[238:239]
    v_cvt_pk_bf16_f32 v80, 0, v80
    v_cvt_pk_bf16_f32 v81, 0, v81
    v_cvt_pk_bf16_f32 v82, 0, v82
    v_cvt_pk_bf16_f32 v83, 0, v83
    v_cvt_pk_bf16_f32 v84, 0, v84
    v_cvt_pk_bf16_f32 v85, 0, v85
    v_cvt_pk_bf16_f32 v86, 0, v86
    v_cvt_pk_bf16_f32 v87, 0, v87
    v_pk_add_f32 v[80:81], v[80:81], v[224:225]
    v_pk_add_f32 v[82:83], v[82:83], v[226:227]
    v_pk_add_f32 v[84:85], v[84:85], v[228:229]
    v_pk_add_f32 v[86:87], v[86:87], v[230:231]
    v_cvt_pk_bf16_f32 v80, v80, v81
    v_cvt_pk_bf16_f32 v81, v82, v83
    v_cvt_pk_bf16_f32 v82, v84, v85
    v_cvt_pk_bf16_f32 v83, v86, v87
    ds_write_b128 v23, v[80:83] offset:5472
    v_pk_mul_f32 v[88:89], v[88:89], v[232:233]
    v_pk_mul_f32 v[90:91], v[90:91], v[234:235]
    v_pk_mul_f32 v[92:93], v[92:93], v[236:237]
    v_pk_mul_f32 v[94:95], v[94:95], v[238:239]
    v_cvt_pk_bf16_f32 v88, 0, v88
    v_cvt_pk_bf16_f32 v89, 0, v89
    v_cvt_pk_bf16_f32 v90, 0, v90
    v_cvt_pk_bf16_f32 v91, 0, v91
    v_cvt_pk_bf16_f32 v92, 0, v92
    v_cvt_pk_bf16_f32 v93, 0, v93
    v_cvt_pk_bf16_f32 v94, 0, v94
    v_cvt_pk_bf16_f32 v95, 0, v95
    v_pk_add_f32 v[88:89], v[88:89], v[224:225]
    v_pk_add_f32 v[90:91], v[90:91], v[226:227]
    v_pk_add_f32 v[92:93], v[92:93], v[228:229]
    v_pk_add_f32 v[94:95], v[94:95], v[230:231]
    v_cvt_pk_bf16_f32 v88, v88, v89
    v_cvt_pk_bf16_f32 v89, v90, v91
    v_cvt_pk_bf16_f32 v90, v92, v93
    v_cvt_pk_bf16_f32 v91, v94, v95
    ds_write_b128 v23, v[88:91] offset:6384
    v_pk_mul_f32 v[96:97], v[96:97], v[232:233]
    v_pk_mul_f32 v[98:99], v[98:99], v[234:235]
    v_pk_mul_f32 v[100:101], v[100:101], v[236:237]
    v_pk_mul_f32 v[102:103], v[102:103], v[238:239]
    v_cvt_pk_bf16_f32 v96, 0, v96
    v_cvt_pk_bf16_f32 v97, 0, v97
    v_cvt_pk_bf16_f32 v98, 0, v98
    v_cvt_pk_bf16_f32 v99, 0, v99
    v_cvt_pk_bf16_f32 v100, 0, v100
    v_cvt_pk_bf16_f32 v101, 0, v101
    v_cvt_pk_bf16_f32 v102, 0, v102
    v_cvt_pk_bf16_f32 v103, 0, v103
    v_pk_add_f32 v[96:97], v[96:97], v[224:225]
    v_pk_add_f32 v[98:99], v[98:99], v[226:227]
    v_pk_add_f32 v[100:101], v[100:101], v[228:229]
    v_pk_add_f32 v[102:103], v[102:103], v[230:231]
    v_cvt_pk_bf16_f32 v96, v96, v97
    v_cvt_pk_bf16_f32 v97, v98, v99
    v_cvt_pk_bf16_f32 v98, v100, v101
    v_cvt_pk_bf16_f32 v99, v102, v103
    ds_write_b128 v23, v[96:99] offset:7296
    v_pk_mul_f32 v[104:105], v[104:105], v[232:233]
    v_pk_mul_f32 v[106:107], v[106:107], v[234:235]
    v_pk_mul_f32 v[108:109], v[108:109], v[236:237]
    v_pk_mul_f32 v[110:111], v[110:111], v[238:239]
    v_cvt_pk_bf16_f32 v104, 0, v104
    v_cvt_pk_bf16_f32 v105, 0, v105
    v_cvt_pk_bf16_f32 v106, 0, v106
    v_cvt_pk_bf16_f32 v107, 0, v107
    v_cvt_pk_bf16_f32 v108, 0, v108
    v_cvt_pk_bf16_f32 v109, 0, v109
    v_cvt_pk_bf16_f32 v110, 0, v110
    v_cvt_pk_bf16_f32 v111, 0, v111
    v_pk_add_f32 v[104:105], v[104:105], v[224:225]
    v_pk_add_f32 v[106:107], v[106:107], v[226:227]
    v_pk_add_f32 v[108:109], v[108:109], v[228:229]
    v_pk_add_f32 v[110:111], v[110:111], v[230:231]
    v_cvt_pk_bf16_f32 v104, v104, v105
    v_cvt_pk_bf16_f32 v105, v106, v107
    v_cvt_pk_bf16_f32 v106, v108, v109
    v_cvt_pk_bf16_f32 v107, v110, v111
    ds_write_b128 v23, v[104:107] offset:8208
    v_pk_mul_f32 v[112:113], v[112:113], v[232:233]
    v_pk_mul_f32 v[114:115], v[114:115], v[234:235]
    v_pk_mul_f32 v[116:117], v[116:117], v[236:237]
    v_pk_mul_f32 v[118:119], v[118:119], v[238:239]
    v_cvt_pk_bf16_f32 v112, 0, v112
    v_cvt_pk_bf16_f32 v113, 0, v113
    v_cvt_pk_bf16_f32 v114, 0, v114
    v_cvt_pk_bf16_f32 v115, 0, v115
    v_cvt_pk_bf16_f32 v116, 0, v116
    v_cvt_pk_bf16_f32 v117, 0, v117
    v_cvt_pk_bf16_f32 v118, 0, v118
    v_cvt_pk_bf16_f32 v119, 0, v119
    v_pk_add_f32 v[112:113], v[112:113], v[224:225]
    v_pk_add_f32 v[114:115], v[114:115], v[226:227]
    v_pk_add_f32 v[116:117], v[116:117], v[228:229]
    v_pk_add_f32 v[118:119], v[118:119], v[230:231]
    v_cvt_pk_bf16_f32 v112, v112, v113
    v_cvt_pk_bf16_f32 v113, v114, v115
    v_cvt_pk_bf16_f32 v114, v116, v117
    v_cvt_pk_bf16_f32 v115, v118, v119
    ds_write_b128 v23, v[112:115] offset:9120
    v_pk_mul_f32 v[120:121], v[120:121], v[232:233]
    v_pk_mul_f32 v[122:123], v[122:123], v[234:235]
    v_pk_mul_f32 v[124:125], v[124:125], v[236:237]
    v_pk_mul_f32 v[126:127], v[126:127], v[238:239]
    v_cvt_pk_bf16_f32 v120, 0, v120
    v_cvt_pk_bf16_f32 v121, 0, v121
    v_cvt_pk_bf16_f32 v122, 0, v122
    v_cvt_pk_bf16_f32 v123, 0, v123
    v_cvt_pk_bf16_f32 v124, 0, v124
    v_cvt_pk_bf16_f32 v125, 0, v125
    v_cvt_pk_bf16_f32 v126, 0, v126
    v_cvt_pk_bf16_f32 v127, 0, v127
    v_pk_add_f32 v[120:121], v[120:121], v[224:225]
    v_pk_add_f32 v[122:123], v[122:123], v[226:227]
    v_pk_add_f32 v[124:125], v[124:125], v[228:229]
    v_pk_add_f32 v[126:127], v[126:127], v[230:231]
    v_cvt_pk_bf16_f32 v120, v120, v121
    v_cvt_pk_bf16_f32 v121, v122, v123
    v_cvt_pk_bf16_f32 v122, v124, v125
    v_cvt_pk_bf16_f32 v123, v126, v127
    ds_write_b128 v23, v[120:123] offset:10032
    v_pk_mul_f32 v[128:129], v[128:129], v[232:233]
    v_pk_mul_f32 v[130:131], v[130:131], v[234:235]
    v_pk_mul_f32 v[132:133], v[132:133], v[236:237]
    v_pk_mul_f32 v[134:135], v[134:135], v[238:239]
    v_cvt_pk_bf16_f32 v128, 0, v128
    v_cvt_pk_bf16_f32 v129, 0, v129
    v_cvt_pk_bf16_f32 v130, 0, v130
    v_cvt_pk_bf16_f32 v131, 0, v131
    v_cvt_pk_bf16_f32 v132, 0, v132
    v_cvt_pk_bf16_f32 v133, 0, v133
    v_cvt_pk_bf16_f32 v134, 0, v134
    v_cvt_pk_bf16_f32 v135, 0, v135
    v_pk_add_f32 v[128:129], v[128:129], v[224:225]
    v_pk_add_f32 v[130:131], v[130:131], v[226:227]
    v_pk_add_f32 v[132:133], v[132:133], v[228:229]
    v_pk_add_f32 v[134:135], v[134:135], v[230:231]
    v_cvt_pk_bf16_f32 v128, v128, v129
    v_cvt_pk_bf16_f32 v129, v130, v131
    v_cvt_pk_bf16_f32 v130, v132, v133
    v_cvt_pk_bf16_f32 v131, v134, v135
    ds_write_b128 v23, v[128:131] offset:10944
    v_pk_mul_f32 v[136:137], v[136:137], v[232:233]
    v_pk_mul_f32 v[138:139], v[138:139], v[234:235]
    v_pk_mul_f32 v[140:141], v[140:141], v[236:237]
    v_pk_mul_f32 v[142:143], v[142:143], v[238:239]
    v_cvt_pk_bf16_f32 v136, 0, v136
    v_cvt_pk_bf16_f32 v137, 0, v137
    v_cvt_pk_bf16_f32 v138, 0, v138
    v_cvt_pk_bf16_f32 v139, 0, v139
    v_cvt_pk_bf16_f32 v140, 0, v140
    v_cvt_pk_bf16_f32 v141, 0, v141
    v_cvt_pk_bf16_f32 v142, 0, v142
    v_cvt_pk_bf16_f32 v143, 0, v143
    v_pk_add_f32 v[136:137], v[136:137], v[224:225]
    v_pk_add_f32 v[138:139], v[138:139], v[226:227]
    v_pk_add_f32 v[140:141], v[140:141], v[228:229]
    v_pk_add_f32 v[142:143], v[142:143], v[230:231]
    v_cvt_pk_bf16_f32 v136, v136, v137
    v_cvt_pk_bf16_f32 v137, v138, v139
    v_cvt_pk_bf16_f32 v138, v140, v141
    v_cvt_pk_bf16_f32 v139, v142, v143
    ds_write_b128 v23, v[136:139] offset:11856
    v_pk_mul_f32 v[144:145], v[144:145], v[232:233]
    v_pk_mul_f32 v[146:147], v[146:147], v[234:235]
    v_pk_mul_f32 v[148:149], v[148:149], v[236:237]
    v_pk_mul_f32 v[150:151], v[150:151], v[238:239]
    v_cvt_pk_bf16_f32 v144, 0, v144
    v_cvt_pk_bf16_f32 v145, 0, v145
    v_cvt_pk_bf16_f32 v146, 0, v146
    v_cvt_pk_bf16_f32 v147, 0, v147
    v_cvt_pk_bf16_f32 v148, 0, v148
    v_cvt_pk_bf16_f32 v149, 0, v149
    v_cvt_pk_bf16_f32 v150, 0, v150
    v_cvt_pk_bf16_f32 v151, 0, v151
    v_pk_add_f32 v[144:145], v[144:145], v[224:225]
    v_pk_add_f32 v[146:147], v[146:147], v[226:227]
    v_pk_add_f32 v[148:149], v[148:149], v[228:229]
    v_pk_add_f32 v[150:151], v[150:151], v[230:231]
    v_cvt_pk_bf16_f32 v144, v144, v145
    v_cvt_pk_bf16_f32 v145, v146, v147
    v_cvt_pk_bf16_f32 v146, v148, v149
    v_cvt_pk_bf16_f32 v147, v150, v151
    ds_write_b128 v23, v[144:147] offset:12768
    v_pk_mul_f32 v[152:153], v[152:153], v[232:233]
    v_pk_mul_f32 v[154:155], v[154:155], v[234:235]
    v_pk_mul_f32 v[156:157], v[156:157], v[236:237]
    v_pk_mul_f32 v[158:159], v[158:159], v[238:239]
    v_cvt_pk_bf16_f32 v152, 0, v152
    v_cvt_pk_bf16_f32 v153, 0, v153
    v_cvt_pk_bf16_f32 v154, 0, v154
    v_cvt_pk_bf16_f32 v155, 0, v155
    v_cvt_pk_bf16_f32 v156, 0, v156
    v_cvt_pk_bf16_f32 v157, 0, v157
    v_cvt_pk_bf16_f32 v158, 0, v158
    v_cvt_pk_bf16_f32 v159, 0, v159
    v_pk_add_f32 v[152:153], v[152:153], v[224:225]
    v_pk_add_f32 v[154:155], v[154:155], v[226:227]
    v_pk_add_f32 v[156:157], v[156:157], v[228:229]
    v_pk_add_f32 v[158:159], v[158:159], v[230:231]
    v_cvt_pk_bf16_f32 v152, v152, v153
    v_cvt_pk_bf16_f32 v153, v154, v155
    v_cvt_pk_bf16_f32 v154, v156, v157
    v_cvt_pk_bf16_f32 v155, v158, v159
    ds_write_b128 v23, v[152:155] offset:13680
    s_mov_b32 exec_hi, -1
    s_waitcnt vmcnt(16) lgkmcnt(0)
    s_barrier
    ds_read_b128 a[0:3], v22 offset:0
    ds_read_b128 a[4:7], v22 offset:32
    v_xor_b32 v10, 0, v6
    ds_read_b64_tr_b16 a[112:113], v10 offset:0
    ds_read_b64_tr_b16 a[114:115], v10 offset:1024
    v_xor_b32 v11, 64, v6
    ds_read_b64_tr_b16 a[116:117], v11 offset:0
    ds_read_b64_tr_b16 a[118:119], v11 offset:1024
    v_xor_b32 v12, 128, v6
    ds_read_b64_tr_b16 a[120:121], v12 offset:0
    ds_read_b64_tr_b16 a[122:123], v12 offset:1024
    v_xor_b32 v13, 192, v6
    ds_read_b64_tr_b16 a[124:125], v13 offset:0
    ds_read_b64_tr_b16 a[126:127], v13 offset:1024
    ds_read_b64_tr_b16 a[128:129], v10 offset:256
    ds_read_b64_tr_b16 a[130:131], v10 offset:1280
    ds_read_b64_tr_b16 a[132:133], v11 offset:256
    ds_read_b64_tr_b16 a[134:135], v11 offset:1280
    s_waitcnt lgkmcnt(10)
    v_mfma_f32_32x32x16_bf16 v[32:47], a[112:115], a[0:3], 0
    ds_read_b64_tr_b16 a[136:137], v12 offset:256
    ds_read_b64_tr_b16 a[138:139], v12 offset:1280
    ds_read_b128 a[8:11], v22 offset:64
    ds_read_b128 a[12:15], v22 offset:96
    ds_read_b128 a[16:19], v22 offset:128
    s_waitcnt lgkmcnt(13)
    v_mfma_f32_32x32x16_bf16 v[48:63], a[116:119], a[0:3], 0
    ds_read_b64_tr_b16 a[140:141], v13 offset:256
    ds_read_b64_tr_b16 a[142:143], v13 offset:1280
    ds_read_b128 a[20:23], v22 offset:160
    ds_read_b128 a[24:27], v22 offset:192
    ds_read_b128 a[28:31], v22 offset:224
    s_waitcnt lgkmcnt(15)
    v_mfma_f32_32x32x16_bf16 v[64:79], a[120:123], a[0:3], 0
    ds_read_b64_tr_b16 a[112:113], v10 offset:4096
    ds_read_b64_tr_b16 a[114:115], v10 offset:5120
    ds_read_b128 a[32:35], v22 offset:256
    ds_read_b128 a[36:39], v22 offset:288
    ds_read_b128 a[40:43], v22 offset:320
    s_waitcnt lgkmcnt(15)
    v_mfma_f32_32x32x16_bf16 v[80:95], a[124:127], a[0:3], 0
    ds_read_b64_tr_b16 a[116:117], v11 offset:4096
    ds_read_b64_tr_b16 a[118:119], v11 offset:5120
    ds_read_b128 a[44:47], v22 offset:352
    ds_read_b128 a[48:51], v22 offset:384
    ds_read_b128 a[52:55], v22 offset:416
    v_mfma_f32_32x32x16_bf16 v[96:111], a[128:131], a[0:3], 0
    ds_read_b64_tr_b16 a[120:121], v12 offset:4096
    ds_read_b64_tr_b16 a[122:123], v12 offset:5120
    ds_read_b128 a[56:59], v22 offset:448
    ds_read_b128 a[60:63], v22 offset:480
    ds_read_b128 a[64:67], v22 offset:512
    v_mfma_f32_32x32x16_bf16 v[112:127], a[132:135], a[0:3], 0
    ds_read_b64_tr_b16 a[124:125], v13 offset:4096
    ds_read_b64_tr_b16 a[126:127], v13 offset:5120
    ds_read_b128 a[68:71], v22 offset:544
    ds_read_b128 a[72:75], v22 offset:576
    ds_read_b128 a[76:79], v22 offset:608
    s_waitcnt lgkmcnt(15)
    v_mfma_f32_32x32x16_bf16 v[128:143], a[136:139], a[0:3], 0
    ds_read_b64_tr_b16 a[128:129], v10 offset:4352
    ds_read_b64_tr_b16 a[130:131], v10 offset:5376
    ds_read_b128 a[80:83], v22 offset:640
    ds_read_b128 a[84:87], v22 offset:672
    ds_read_b128 a[88:91], v22 offset:704
    v_mfma_f32_32x32x16_bf16 v[144:159], a[140:143], a[0:3], 0
    ds_read_b64_tr_b16 a[132:133], v11 offset:4352
    ds_read_b64_tr_b16 a[134:135], v11 offset:5376
    ds_read_b128 a[92:95], v22 offset:736
    ds_read_b128 a[96:99], v22 offset:768
    ds_read_b128 a[100:103], v22 offset:800
    v_mfma_f32_32x32x16_bf16 v[32:47], a[112:115], a[4:7], v[32:47]
    ds_read_b64_tr_b16 a[136:137], v12 offset:4352
    ds_read_b64_tr_b16 a[138:139], v12 offset:5376
    ds_read_b128 a[104:107], v22 offset:832
    ds_read_b128 a[108:111], v22 offset:864
    s_waitcnt lgkmcnt(15)
    v_mfma_f32_32x32x16_bf16 v[48:63], a[116:119], a[4:7], v[48:63]
    ds_read_b64_tr_b16 a[140:141], v13 offset:4352
    ds_read_b64_tr_b16 a[142:143], v13 offset:5376
    v_mfma_f32_32x32x16_bf16 v[64:79], a[120:123], a[4:7], v[64:79]
    s_waitcnt vmcnt(8) lgkmcnt(2)
    s_barrier
    v_xor_b32 v10, 32768, v6
    ds_read_b64_tr_b16 a[112:113], v10 offset:0
    ds_read_b64_tr_b16 a[114:115], v10 offset:1024
    s_add_u32 m0, s40, 98304
    s_add_u32 s45, s42, 786432
    buffer_load_dwordx4 v2, s[8:11], s45 offen offset:0 lds
    v_mfma_f32_32x32x16_bf16 v[80:95], a[124:127], a[4:7], v[80:95]
    v_xor_b32 v11, 32832, v6
    ds_read_b64_tr_b16 a[116:117], v11 offset:0
    ds_read_b64_tr_b16 a[118:119], v11 offset:1024
    buffer_load_dwordx4 v3, s[8:11], s45 offen offset:1024 lds
    v_mfma_f32_32x32x16_bf16 v[96:111], a[128:131], a[4:7], v[96:111]
    v_xor_b32 v12, 32896, v6
    ds_read_b64_tr_b16 a[120:121], v12 offset:0
    ds_read_b64_tr_b16 a[122:123], v12 offset:1024
    buffer_load_dwordx4 v4, s[8:11], s45 offen offset:2048 lds
    v_mfma_f32_32x32x16_bf16 v[112:127], a[132:135], a[4:7], v[112:127]
    v_xor_b32 v13, 32960, v6
    ds_read_b64_tr_b16 a[124:125], v13 offset:0
    ds_read_b64_tr_b16 a[126:127], v13 offset:1024
    buffer_load_dwordx4 v5, s[8:11], s45 offen offset:3072 lds
    v_mfma_f32_32x32x16_bf16 v[128:143], a[136:139], a[4:7], v[128:143]
    ds_read_b64_tr_b16 a[128:129], v10 offset:256
    ds_read_b64_tr_b16 a[130:131], v10 offset:1280
    s_add_u32 m0, s40, 102400
    s_add_u32 s45, s42, 917504
    buffer_load_dwordx4 v2, s[8:11], s45 offen offset:0 lds
    s_waitcnt lgkmcnt(10)
    v_mfma_f32_32x32x16_bf16 v[144:159], a[140:143], a[4:7], v[144:159]
    ds_read_b64_tr_b16 a[132:133], v11 offset:256
    ds_read_b64_tr_b16 a[134:135], v11 offset:1280
    buffer_load_dwordx4 v3, s[8:11], s45 offen offset:1024 lds
    s_waitcnt lgkmcnt(10)
    v_mfma_f32_32x32x16_bf16 v[32:47], a[112:115], a[8:11], v[32:47]
    ds_read_b64_tr_b16 a[136:137], v12 offset:256
    ds_read_b64_tr_b16 a[138:139], v12 offset:1280
    buffer_load_dwordx4 v4, s[8:11], s45 offen offset:2048 lds
    s_waitcnt lgkmcnt(10)
    v_mfma_f32_32x32x16_bf16 v[48:63], a[116:119], a[8:11], v[48:63]
    ds_read_b64_tr_b16 a[140:141], v13 offset:256
    ds_read_b64_tr_b16 a[142:143], v13 offset:1280
    buffer_load_dwordx4 v5, s[8:11], s45 offen offset:3072 lds
    s_waitcnt lgkmcnt(10)
    v_mfma_f32_32x32x16_bf16 v[64:79], a[120:123], a[8:11], v[64:79]
    ds_read_b64_tr_b16 a[112:113], v10 offset:4096
    ds_read_b64_tr_b16 a[114:115], v10 offset:5120
    s_add_u32 m0, s40, 131072
    s_add_u32 s45, s42, 1048576
    buffer_load_dwordx4 v2, s[8:11], s45 offen offset:0 lds
    s_waitcnt lgkmcnt(10)
    v_mfma_f32_32x32x16_bf16 v[80:95], a[124:127], a[8:11], v[80:95]
    ds_read_b64_tr_b16 a[116:117], v11 offset:4096
    ds_read_b64_tr_b16 a[118:119], v11 offset:5120
    s_waitcnt lgkmcnt(10)
    v_mfma_f32_32x32x16_bf16 v[96:111], a[128:131], a[8:11], v[96:111]
    ds_read_b64_tr_b16 a[120:121], v12 offset:4096
    ds_read_b64_tr_b16 a[122:123], v12 offset:5120
    buffer_load_dwordx4 v3, s[8:11], s45 offen offset:1024 lds
    s_waitcnt lgkmcnt(10)
    v_mfma_f32_32x32x16_bf16 v[112:127], a[132:135], a[8:11], v[112:127]
    ds_read_b64_tr_b16 a[124:125], v13 offset:4096
    ds_read_b64_tr_b16 a[126:127], v13 offset:5120
    s_waitcnt lgkmcnt(10)
    v_mfma_f32_32x32x16_bf16 v[128:143], a[136:139], a[8:11], v[128:143]
    ds_read_b64_tr_b16 a[128:129], v10 offset:4352
    ds_read_b64_tr_b16 a[130:131], v10 offset:5376
    buffer_load_dwordx4 v4, s[8:11], s45 offen offset:2048 lds
    s_waitcnt lgkmcnt(10)
    v_mfma_f32_32x32x16_bf16 v[144:159], a[140:143], a[8:11], v[144:159]
    ds_read_b64_tr_b16 a[132:133], v11 offset:4352
    ds_read_b64_tr_b16 a[134:135], v11 offset:5376
    s_waitcnt lgkmcnt(10)
    v_mfma_f32_32x32x16_bf16 v[32:47], a[112:115], a[12:15], v[32:47]
    ds_read_b64_tr_b16 a[136:137], v12 offset:4352
    ds_read_b64_tr_b16 a[138:139], v12 offset:5376
    buffer_load_dwordx4 v5, s[8:11], s45 offen offset:3072 lds
    s_waitcnt lgkmcnt(10)
    v_mfma_f32_32x32x16_bf16 v[48:63], a[116:119], a[12:15], v[48:63]
    ds_read_b64_tr_b16 a[140:141], v13 offset:4352
    ds_read_b64_tr_b16 a[142:143], v13 offset:5376
    s_waitcnt lgkmcnt(10)
    v_mfma_f32_32x32x16_bf16 v[64:79], a[120:123], a[12:15], v[64:79]
    s_waitcnt vmcnt(12)
    s_barrier
    v_xor_b32 v10, 65536, v6
    ds_read_b64_tr_b16 a[112:113], v10 offset:0
    ds_read_b64_tr_b16 a[114:115], v10 offset:1024
    s_add_u32 m0, s40, 135168
    s_add_u32 s45, s42, 1179648
    buffer_load_dwordx4 v2, s[8:11], s45 offen offset:0 lds
    s_waitcnt lgkmcnt(10)
    v_mfma_f32_32x32x16_bf16 v[80:95], a[124:127], a[12:15], v[80:95]
    v_xor_b32 v11, 65600, v6
    ds_read_b64_tr_b16 a[116:117], v11 offset:0
    ds_read_b64_tr_b16 a[118:119], v11 offset:1024
    buffer_load_dwordx4 v3, s[8:11], s45 offen offset:1024 lds
    s_waitcnt lgkmcnt(10)
    v_mfma_f32_32x32x16_bf16 v[96:111], a[128:131], a[12:15], v[96:111]
    v_xor_b32 v12, 65664, v6
    ds_read_b64_tr_b16 a[120:121], v12 offset:0
    ds_read_b64_tr_b16 a[122:123], v12 offset:1024
    buffer_load_dwordx4 v4, s[8:11], s45 offen offset:2048 lds
    s_waitcnt lgkmcnt(10)
    v_mfma_f32_32x32x16_bf16 v[112:127], a[132:135], a[12:15], v[112:127]
    v_xor_b32 v13, 65728, v6
    ds_read_b64_tr_b16 a[124:125], v13 offset:0
    ds_read_b64_tr_b16 a[126:127], v13 offset:1024
    buffer_load_dwordx4 v5, s[8:11], s45 offen offset:3072 lds
    s_waitcnt lgkmcnt(10)
    v_mfma_f32_32x32x16_bf16 v[128:143], a[136:139], a[12:15], v[128:143]
    ds_read_b64_tr_b16 a[128:129], v10 offset:256
    ds_read_b64_tr_b16 a[130:131], v10 offset:1280
    s_add_u32 m0, s40, 0
    s_add_u32 s45, s42, 1310720
    buffer_load_dwordx4 v2, s[8:11], s45 offen offset:0 lds
    s_waitcnt lgkmcnt(10)
    v_mfma_f32_32x32x16_bf16 v[144:159], a[140:143], a[12:15], v[144:159]
    ds_read_b64_tr_b16 a[132:133], v11 offset:256
    ds_read_b64_tr_b16 a[134:135], v11 offset:1280
    s_waitcnt lgkmcnt(10)
    v_mfma_f32_32x32x16_bf16 v[32:47], a[112:115], a[16:19], v[32:47]
    ds_read_b64_tr_b16 a[136:137], v12 offset:256
    ds_read_b64_tr_b16 a[138:139], v12 offset:1280
    buffer_load_dwordx4 v3, s[8:11], s45 offen offset:1024 lds
    s_waitcnt lgkmcnt(10)
    v_mfma_f32_32x32x16_bf16 v[48:63], a[116:119], a[16:19], v[48:63]
    ds_read_b64_tr_b16 a[140:141], v13 offset:256
    ds_read_b64_tr_b16 a[142:143], v13 offset:1280
    s_waitcnt lgkmcnt(10)
    v_mfma_f32_32x32x16_bf16 v[64:79], a[120:123], a[16:19], v[64:79]
    ds_read_b64_tr_b16 a[112:113], v10 offset:4096
    ds_read_b64_tr_b16 a[114:115], v10 offset:5120
    buffer_load_dwordx4 v4, s[8:11], s45 offen offset:2048 lds
    s_waitcnt lgkmcnt(10)
    v_mfma_f32_32x32x16_bf16 v[80:95], a[124:127], a[16:19], v[80:95]
    ds_read_b64_tr_b16 a[116:117], v11 offset:4096
    ds_read_b64_tr_b16 a[118:119], v11 offset:5120
    s_waitcnt lgkmcnt(10)
    v_mfma_f32_32x32x16_bf16 v[96:111], a[128:131], a[16:19], v[96:111]
    ds_read_b64_tr_b16 a[120:121], v12 offset:4096
    ds_read_b64_tr_b16 a[122:123], v12 offset:5120
    buffer_load_dwordx4 v5, s[8:11], s45 offen offset:3072 lds
    s_waitcnt lgkmcnt(10)
    v_mfma_f32_32x32x16_bf16 v[112:127], a[132:135], a[16:19], v[112:127]
    ds_read_b64_tr_b16 a[124:125], v13 offset:4096
    ds_read_b64_tr_b16 a[126:127], v13 offset:5120
    s_waitcnt lgkmcnt(10)
    v_mfma_f32_32x32x16_bf16 v[128:143], a[136:139], a[16:19], v[128:143]
    ds_read_b64_tr_b16 a[128:129], v10 offset:4352
    ds_read_b64_tr_b16 a[130:131], v10 offset:5376
    s_add_u32 m0, s40, 4096
    s_add_u32 s45, s42, 1441792
    buffer_load_dwordx4 v2, s[8:11], s45 offen offset:0 lds
    s_waitcnt lgkmcnt(10)
    v_mfma_f32_32x32x16_bf16 v[144:159], a[140:143], a[16:19], v[144:159]
    ds_read_b64_tr_b16 a[132:133], v11 offset:4352
    ds_read_b64_tr_b16 a[134:135], v11 offset:5376
    s_waitcnt lgkmcnt(10)
    v_mfma_f32_32x32x16_bf16 v[32:47], a[112:115], a[20:23], v[32:47]
    ds_read_b64_tr_b16 a[136:137], v12 offset:4352
    ds_read_b64_tr_b16 a[138:139], v12 offset:5376
    buffer_load_dwordx4 v3, s[8:11], s45 offen offset:1024 lds
    s_waitcnt lgkmcnt(10)
    v_mfma_f32_32x32x16_bf16 v[48:63], a[116:119], a[20:23], v[48:63]
    ds_read_b64_tr_b16 a[140:141], v13 offset:4352
    ds_read_b64_tr_b16 a[142:143], v13 offset:5376
    s_waitcnt lgkmcnt(10)
    v_mfma_f32_32x32x16_bf16 v[64:79], a[120:123], a[20:23], v[64:79]
    s_waitcnt vmcnt(14)
    s_barrier
    v_xor_b32 v10, 98304, v6
    ds_read_b64_tr_b16 a[112:113], v10 offset:0
    ds_read_b64_tr_b16 a[114:115], v10 offset:1024
    buffer_load_dwordx4 v4, s[8:11], s45 offen offset:2048 lds
    s_waitcnt lgkmcnt(10)
    v_mfma_f32_32x32x16_bf16 v[80:95], a[124:127], a[20:23], v[80:95]
    v_xor_b32 v11, 98368, v6
    ds_read_b64_tr_b16 a[116:117], v11 offset:0
    ds_read_b64_tr_b16 a[118:119], v11 offset:1024
    buffer_load_dwordx4 v5, s[8:11], s45 offen offset:3072 lds
    s_waitcnt lgkmcnt(10)
    v_mfma_f32_32x32x16_bf16 v[96:111], a[128:131], a[20:23], v[96:111]
    v_xor_b32 v12, 98432, v6
    ds_read_b64_tr_b16 a[120:121], v12 offset:0
    ds_read_b64_tr_b16 a[122:123], v12 offset:1024
    s_add_u32 m0, s40, 32768
    s_add_u32 s45, s42, 1572864
    buffer_load_dwordx4 v2, s[8:11], s45 offen offset:0 lds
    s_waitcnt lgkmcnt(10)
    v_mfma_f32_32x32x16_bf16 v[112:127], a[132:135], a[20:23], v[112:127]
    v_xor_b32 v13, 98496, v6
    ds_read_b64_tr_b16 a[124:125], v13 offset:0
    ds_read_b64_tr_b16 a[126:127], v13 offset:1024
    s_waitcnt lgkmcnt(10)
    v_mfma_f32_32x32x16_bf16 v[128:143], a[136:139], a[20:23], v[128:143]
    ds_read_b64_tr_b16 a[128:129], v10 offset:256
    ds_read_b64_tr_b16 a[130:131], v10 offset:1280
    buffer_load_dwordx4 v3, s[8:11], s45 offen offset:1024 lds
    s_waitcnt lgkmcnt(10)
    v_mfma_f32_32x32x16_bf16 v[144:159], a[140:143], a[20:23], v[144:159]
    ds_read_b64_tr_b16 a[132:133], v11 offset:256
    ds_read_b64_tr_b16 a[134:135], v11 offset:1280
    s_waitcnt lgkmcnt(10)
    v_mfma_f32_32x32x16_bf16 v[32:47], a[112:115], a[24:27], v[32:47]
    ds_read_b64_tr_b16 a[136:137], v12 offset:256
    ds_read_b64_tr_b16 a[138:139], v12 offset:1280
    buffer_load_dwordx4 v4, s[8:11], s45 offen offset:2048 lds
    s_waitcnt lgkmcnt(10)
    v_mfma_f32_32x32x16_bf16 v[48:63], a[116:119], a[24:27], v[48:63]
    ds_read_b64_tr_b16 a[140:141], v13 offset:256
    ds_read_b64_tr_b16 a[142:143], v13 offset:1280
    s_waitcnt lgkmcnt(10)
    v_mfma_f32_32x32x16_bf16 v[64:79], a[120:123], a[24:27], v[64:79]
    ds_read_b64_tr_b16 a[112:113], v10 offset:4096
    ds_read_b64_tr_b16 a[114:115], v10 offset:5120
    buffer_load_dwordx4 v5, s[8:11], s45 offen offset:3072 lds
    s_waitcnt lgkmcnt(10)
    v_mfma_f32_32x32x16_bf16 v[80:95], a[124:127], a[24:27], v[80:95]
    ds_read_b64_tr_b16 a[116:117], v11 offset:4096
    ds_read_b64_tr_b16 a[118:119], v11 offset:5120
    s_waitcnt lgkmcnt(10)
    v_mfma_f32_32x32x16_bf16 v[96:111], a[128:131], a[24:27], v[96:111]
    ds_read_b64_tr_b16 a[120:121], v12 offset:4096
    ds_read_b64_tr_b16 a[122:123], v12 offset:5120
    s_add_u32 m0, s40, 36864
    s_add_u32 s45, s42, 1703936
    buffer_load_dwordx4 v2, s[8:11], s45 offen offset:0 lds
    s_waitcnt lgkmcnt(10)
    v_mfma_f32_32x32x16_bf16 v[112:127], a[132:135], a[24:27], v[112:127]
    ds_read_b64_tr_b16 a[124:125], v13 offset:4096
    ds_read_b64_tr_b16 a[126:127], v13 offset:5120
    s_waitcnt lgkmcnt(10)
    v_mfma_f32_32x32x16_bf16 v[128:143], a[136:139], a[24:27], v[128:143]
    ds_read_b64_tr_b16 a[128:129], v10 offset:4352
    ds_read_b64_tr_b16 a[130:131], v10 offset:5376
    buffer_load_dwordx4 v3, s[8:11], s45 offen offset:1024 lds
    s_waitcnt lgkmcnt(10)
    v_mfma_f32_32x32x16_bf16 v[144:159], a[140:143], a[24:27], v[144:159]
    ds_read_b64_tr_b16 a[132:133], v11 offset:4352
    ds_read_b64_tr_b16 a[134:135], v11 offset:5376
    s_waitcnt lgkmcnt(10)
    v_mfma_f32_32x32x16_bf16 v[32:47], a[112:115], a[28:31], v[32:47]
    ds_read_b64_tr_b16 a[136:137], v12 offset:4352
    ds_read_b64_tr_b16 a[138:139], v12 offset:5376
    buffer_load_dwordx4 v4, s[8:11], s45 offen offset:2048 lds
    s_waitcnt lgkmcnt(10)
    v_mfma_f32_32x32x16_bf16 v[48:63], a[116:119], a[28:31], v[48:63]
    ds_read_b64_tr_b16 a[140:141], v13 offset:4352
    ds_read_b64_tr_b16 a[142:143], v13 offset:5376
    s_waitcnt lgkmcnt(10)
    v_mfma_f32_32x32x16_bf16 v[64:79], a[120:123], a[28:31], v[64:79]
    s_waitcnt vmcnt(15)
    s_barrier
    v_xor_b32 v10, 131072, v6
    ds_read_b64_tr_b16 a[112:113], v10 offset:0
    ds_read_b64_tr_b16 a[114:115], v10 offset:1024
    buffer_load_dwordx4 v5, s[8:11], s45 offen offset:3072 lds
    s_waitcnt lgkmcnt(10)
    v_mfma_f32_32x32x16_bf16 v[80:95], a[124:127], a[28:31], v[80:95]
    v_xor_b32 v11, 131136, v6
    ds_read_b64_tr_b16 a[116:117], v11 offset:0
    ds_read_b64_tr_b16 a[118:119], v11 offset:1024
    s_waitcnt lgkmcnt(10)
    v_mfma_f32_32x32x16_bf16 v[96:111], a[128:131], a[28:31], v[96:111]
    v_xor_b32 v12, 131200, v6
    ds_read_b64_tr_b16 a[120:121], v12 offset:0
    ds_read_b64_tr_b16 a[122:123], v12 offset:1024
    s_add_u32 m0, s40, 65536
    s_add_u32 s45, s42, 1835008
    buffer_load_dwordx4 v2, s[8:11], s45 offen offset:0 lds
    s_waitcnt lgkmcnt(10)
    v_mfma_f32_32x32x16_bf16 v[112:127], a[132:135], a[28:31], v[112:127]
    v_xor_b32 v13, 131264, v6
    ds_read_b64_tr_b16 a[124:125], v13 offset:0
    ds_read_b64_tr_b16 a[126:127], v13 offset:1024
    s_waitcnt lgkmcnt(10)
    v_mfma_f32_32x32x16_bf16 v[128:143], a[136:139], a[28:31], v[128:143]
    ds_read_b64_tr_b16 a[128:129], v10 offset:256
    ds_read_b64_tr_b16 a[130:131], v10 offset:1280
    buffer_load_dwordx4 v3, s[8:11], s45 offen offset:1024 lds
    s_waitcnt lgkmcnt(10)
    v_mfma_f32_32x32x16_bf16 v[144:159], a[140:143], a[28:31], v[144:159]
    ds_read_b64_tr_b16 a[132:133], v11 offset:256
    ds_read_b64_tr_b16 a[134:135], v11 offset:1280
    s_waitcnt lgkmcnt(10)
    v_mfma_f32_32x32x16_bf16 v[32:47], a[112:115], a[32:35], v[32:47]
    ds_read_b64_tr_b16 a[136:137], v12 offset:256
    ds_read_b64_tr_b16 a[138:139], v12 offset:1280
    buffer_load_dwordx4 v4, s[8:11], s45 offen offset:2048 lds
    s_waitcnt lgkmcnt(10)
    v_mfma_f32_32x32x16_bf16 v[48:63], a[116:119], a[32:35], v[48:63]
    ds_read_b64_tr_b16 a[140:141], v13 offset:256
    ds_read_b64_tr_b16 a[142:143], v13 offset:1280
    s_waitcnt lgkmcnt(10)
    v_mfma_f32_32x32x16_bf16 v[64:79], a[120:123], a[32:35], v[64:79]
    ds_read_b64_tr_b16 a[112:113], v10 offset:4096
    ds_read_b64_tr_b16 a[114:115], v10 offset:5120
    buffer_load_dwordx4 v5, s[8:11], s45 offen offset:3072 lds
    s_waitcnt lgkmcnt(10)
    v_mfma_f32_32x32x16_bf16 v[80:95], a[124:127], a[32:35], v[80:95]
    ds_read_b64_tr_b16 a[116:117], v11 offset:4096
    ds_read_b64_tr_b16 a[118:119], v11 offset:5120
    s_waitcnt lgkmcnt(10)
    v_mfma_f32_32x32x16_bf16 v[96:111], a[128:131], a[32:35], v[96:111]
    ds_read_b64_tr_b16 a[120:121], v12 offset:4096
    ds_read_b64_tr_b16 a[122:123], v12 offset:5120
    s_add_u32 m0, s40, 69632
    s_add_u32 s45, s42, 1966080
    buffer_load_dwordx4 v2, s[8:11], s45 offen offset:0 lds
    s_waitcnt lgkmcnt(10)
    v_mfma_f32_32x32x16_bf16 v[112:127], a[132:135], a[32:35], v[112:127]
    ds_read_b64_tr_b16 a[124:125], v13 offset:4096
    ds_read_b64_tr_b16 a[126:127], v13 offset:5120
    s_waitcnt lgkmcnt(10)
    v_mfma_f32_32x32x16_bf16 v[128:143], a[136:139], a[32:35], v[128:143]
    ds_read_b64_tr_b16 a[128:129], v10 offset:4352
    ds_read_b64_tr_b16 a[130:131], v10 offset:5376
    v_mov_b32 v30, s28
    v_mov_b32 v31, 1
    s_mov_b64 exec, 1
    s_waitcnt vmcnt(61)
    buffer_atomic_add v31, v30, s[92:95], 0 offen sc1
    s_mov_b64 exec, -1
    buffer_load_dwordx4 v3, s[8:11], s45 offen offset:1024 lds
    s_waitcnt lgkmcnt(10)
    v_mfma_f32_32x32x16_bf16 v[144:159], a[140:143], a[32:35], v[144:159]
    ds_read_b64_tr_b16 a[132:133], v11 offset:4352
    ds_read_b64_tr_b16 a[134:135], v11 offset:5376
    s_waitcnt lgkmcnt(10)
    v_mfma_f32_32x32x16_bf16 v[32:47], a[112:115], a[36:39], v[32:47]
    ds_read_b64_tr_b16 a[136:137], v12 offset:4352
    ds_read_b64_tr_b16 a[138:139], v12 offset:5376
    buffer_load_dwordx4 v4, s[8:11], s45 offen offset:2048 lds
    s_waitcnt lgkmcnt(10)
    v_mfma_f32_32x32x16_bf16 v[48:63], a[116:119], a[36:39], v[48:63]
    ds_read_b64_tr_b16 a[140:141], v13 offset:4352
    ds_read_b64_tr_b16 a[142:143], v13 offset:5376
    s_waitcnt lgkmcnt(10)
    v_mfma_f32_32x32x16_bf16 v[64:79], a[120:123], a[36:39], v[64:79]
    s_waitcnt vmcnt(16)
    s_barrier
    v_xor_b32 v10, 0, v6
    ds_read_b64_tr_b16 a[112:113], v10 offset:0
    ds_read_b64_tr_b16 a[114:115], v10 offset:1024
    buffer_load_dwordx4 v5, s[8:11], s45 offen offset:3072 lds
    s_waitcnt lgkmcnt(10)
    v_mfma_f32_32x32x16_bf16 v[80:95], a[124:127], a[36:39], v[80:95]
    v_xor_b32 v11, 64, v6
    ds_read_b64_tr_b16 a[116:117], v11 offset:0
    ds_read_b64_tr_b16 a[118:119], v11 offset:1024
    s_waitcnt lgkmcnt(10)
    v_mfma_f32_32x32x16_bf16 v[96:111], a[128:131], a[36:39], v[96:111]
    v_xor_b32 v12, 128, v6
    ds_read_b64_tr_b16 a[120:121], v12 offset:0
    ds_read_b64_tr_b16 a[122:123], v12 offset:1024
    s_add_u32 m0, s40, 98304
    s_add_u32 s45, s42, 2097152
    buffer_load_dwordx4 v2, s[8:11], s45 offen offset:0 lds
    s_waitcnt lgkmcnt(10)
    v_mfma_f32_32x32x16_bf16 v[112:127], a[132:135], a[36:39], v[112:127]
    v_xor_b32 v13, 192, v6
    ds_read_b64_tr_b16 a[124:125], v13 offset:0
    ds_read_b64_tr_b16 a[126:127], v13 offset:1024
    s_waitcnt lgkmcnt(10)
    v_mfma_f32_32x32x16_bf16 v[128:143], a[136:139], a[36:39], v[128:143]
    ds_read_b64_tr_b16 a[128:129], v10 offset:256
    ds_read_b64_tr_b16 a[130:131], v10 offset:1280
    buffer_load_dwordx4 v3, s[8:11], s45 offen offset:1024 lds
    s_waitcnt lgkmcnt(10)
    v_mfma_f32_32x32x16_bf16 v[144:159], a[140:143], a[36:39], v[144:159]
    ds_read_b64_tr_b16 a[132:133], v11 offset:256
    ds_read_b64_tr_b16 a[134:135], v11 offset:1280
    s_waitcnt lgkmcnt(10)
    v_mfma_f32_32x32x16_bf16 v[32:47], a[112:115], a[40:43], v[32:47]
    ds_read_b64_tr_b16 a[136:137], v12 offset:256
    ds_read_b64_tr_b16 a[138:139], v12 offset:1280
    buffer_load_dwordx4 v4, s[8:11], s45 offen offset:2048 lds
    s_waitcnt lgkmcnt(10)
    v_mfma_f32_32x32x16_bf16 v[48:63], a[116:119], a[40:43], v[48:63]
    ds_read_b64_tr_b16 a[140:141], v13 offset:256
    ds_read_b64_tr_b16 a[142:143], v13 offset:1280
    s_waitcnt lgkmcnt(10)
    v_mfma_f32_32x32x16_bf16 v[64:79], a[120:123], a[40:43], v[64:79]
    ds_read_b64_tr_b16 a[112:113], v10 offset:4096
    ds_read_b64_tr_b16 a[114:115], v10 offset:5120
    buffer_load_dwordx4 v5, s[8:11], s45 offen offset:3072 lds
    s_waitcnt lgkmcnt(10)
    v_mfma_f32_32x32x16_bf16 v[80:95], a[124:127], a[40:43], v[80:95]
    ds_read_b64_tr_b16 a[116:117], v11 offset:4096
    ds_read_b64_tr_b16 a[118:119], v11 offset:5120
    s_waitcnt lgkmcnt(10)
    v_mfma_f32_32x32x16_bf16 v[96:111], a[128:131], a[40:43], v[96:111]
    ds_read_b64_tr_b16 a[120:121], v12 offset:4096
    ds_read_b64_tr_b16 a[122:123], v12 offset:5120
    s_add_u32 m0, s40, 102400
    s_add_u32 s45, s42, 2228224
    buffer_load_dwordx4 v2, s[8:11], s45 offen offset:0 lds
    s_waitcnt lgkmcnt(10)
    v_mfma_f32_32x32x16_bf16 v[112:127], a[132:135], a[40:43], v[112:127]
    ds_read_b64_tr_b16 a[124:125], v13 offset:4096
    ds_read_b64_tr_b16 a[126:127], v13 offset:5120
    s_waitcnt lgkmcnt(10)
    v_mfma_f32_32x32x16_bf16 v[128:143], a[136:139], a[40:43], v[128:143]
    ds_read_b64_tr_b16 a[128:129], v10 offset:4352
    ds_read_b64_tr_b16 a[130:131], v10 offset:5376
    buffer_load_dwordx4 v3, s[8:11], s45 offen offset:1024 lds
    s_waitcnt lgkmcnt(10)
    v_mfma_f32_32x32x16_bf16 v[144:159], a[140:143], a[40:43], v[144:159]
    ds_read_b64_tr_b16 a[132:133], v11 offset:4352
    ds_read_b64_tr_b16 a[134:135], v11 offset:5376
    s_waitcnt lgkmcnt(10)
    v_mfma_f32_32x32x16_bf16 v[32:47], a[112:115], a[44:47], v[32:47]
    ds_read_b64_tr_b16 a[136:137], v12 offset:4352
    ds_read_b64_tr_b16 a[138:139], v12 offset:5376
    buffer_load_dwordx4 v4, s[8:11], s45 offen offset:2048 lds
    s_waitcnt lgkmcnt(10)
    v_mfma_f32_32x32x16_bf16 v[48:63], a[116:119], a[44:47], v[48:63]
    ds_read_b64_tr_b16 a[140:141], v13 offset:4352
    ds_read_b64_tr_b16 a[142:143], v13 offset:5376
    s_waitcnt lgkmcnt(10)
    v_mfma_f32_32x32x16_bf16 v[64:79], a[120:123], a[44:47], v[64:79]
    s_waitcnt vmcnt(16)
    s_barrier
    v_xor_b32 v10, 32768, v6
    ds_read_b64_tr_b16 a[112:113], v10 offset:0
    ds_read_b64_tr_b16 a[114:115], v10 offset:1024
    buffer_load_dwordx4 v5, s[8:11], s45 offen offset:3072 lds
    s_waitcnt lgkmcnt(10)
    v_mfma_f32_32x32x16_bf16 v[80:95], a[124:127], a[44:47], v[80:95]
    v_xor_b32 v11, 32832, v6
    ds_read_b64_tr_b16 a[116:117], v11 offset:0
    ds_read_b64_tr_b16 a[118:119], v11 offset:1024
    s_waitcnt lgkmcnt(10)
    v_mfma_f32_32x32x16_bf16 v[96:111], a[128:131], a[44:47], v[96:111]
    v_xor_b32 v12, 32896, v6
    ds_read_b64_tr_b16 a[120:121], v12 offset:0
    ds_read_b64_tr_b16 a[122:123], v12 offset:1024
    s_add_u32 m0, s40, 131072
    s_add_u32 s45, s42, 2359296
    buffer_load_dwordx4 v2, s[8:11], s45 offen offset:0 lds
    s_waitcnt lgkmcnt(10)
    v_mfma_f32_32x32x16_bf16 v[112:127], a[132:135], a[44:47], v[112:127]
    v_xor_b32 v13, 32960, v6
    ds_read_b64_tr_b16 a[124:125], v13 offset:0
    ds_read_b64_tr_b16 a[126:127], v13 offset:1024
    s_waitcnt lgkmcnt(10)
    v_mfma_f32_32x32x16_bf16 v[128:143], a[136:139], a[44:47], v[128:143]
    ds_read_b64_tr_b16 a[128:129], v10 offset:256
    ds_read_b64_tr_b16 a[130:131], v10 offset:1280
    buffer_load_dwordx4 v3, s[8:11], s45 offen offset:1024 lds
    s_waitcnt lgkmcnt(10)
    v_mfma_f32_32x32x16_bf16 v[144:159], a[140:143], a[44:47], v[144:159]
    ds_read_b64_tr_b16 a[132:133], v11 offset:256
    ds_read_b64_tr_b16 a[134:135], v11 offset:1280
    s_waitcnt lgkmcnt(10)
    v_mfma_f32_32x32x16_bf16 v[32:47], a[112:115], a[48:51], v[32:47]
    ds_read_b64_tr_b16 a[136:137], v12 offset:256
    ds_read_b64_tr_b16 a[138:139], v12 offset:1280
    buffer_load_dwordx4 v4, s[8:11], s45 offen offset:2048 lds
    s_waitcnt lgkmcnt(10)
    v_mfma_f32_32x32x16_bf16 v[48:63], a[116:119], a[48:51], v[48:63]
    ds_read_b64_tr_b16 a[140:141], v13 offset:256
    ds_read_b64_tr_b16 a[142:143], v13 offset:1280
    s_waitcnt lgkmcnt(10)
    v_mfma_f32_32x32x16_bf16 v[64:79], a[120:123], a[48:51], v[64:79]
    ds_read_b64_tr_b16 a[112:113], v10 offset:4096
    ds_read_b64_tr_b16 a[114:115], v10 offset:5120
    buffer_load_dwordx4 v5, s[8:11], s45 offen offset:3072 lds
    s_waitcnt lgkmcnt(10)
    v_mfma_f32_32x32x16_bf16 v[80:95], a[124:127], a[48:51], v[80:95]
    ds_read_b64_tr_b16 a[116:117], v11 offset:4096
    ds_read_b64_tr_b16 a[118:119], v11 offset:5120
    s_waitcnt lgkmcnt(10)
    v_mfma_f32_32x32x16_bf16 v[96:111], a[128:131], a[48:51], v[96:111]
    ds_read_b64_tr_b16 a[120:121], v12 offset:4096
    ds_read_b64_tr_b16 a[122:123], v12 offset:5120
    s_add_u32 m0, s40, 135168
    s_add_u32 s45, s42, 2490368
    buffer_load_dwordx4 v2, s[8:11], s45 offen offset:0 lds
    s_waitcnt lgkmcnt(10)
    v_mfma_f32_32x32x16_bf16 v[112:127], a[132:135], a[48:51], v[112:127]
    ds_read_b64_tr_b16 a[124:125], v13 offset:4096
    ds_read_b64_tr_b16 a[126:127], v13 offset:5120
    s_waitcnt lgkmcnt(10)
    v_mfma_f32_32x32x16_bf16 v[128:143], a[136:139], a[48:51], v[128:143]
    ds_read_b64_tr_b16 a[128:129], v10 offset:4352
    ds_read_b64_tr_b16 a[130:131], v10 offset:5376
    buffer_load_dwordx4 v3, s[8:11], s45 offen offset:1024 lds
    s_waitcnt lgkmcnt(10)
    v_mfma_f32_32x32x16_bf16 v[144:159], a[140:143], a[48:51], v[144:159]
    ds_read_b64_tr_b16 a[132:133], v11 offset:4352
    ds_read_b64_tr_b16 a[134:135], v11 offset:5376
    s_waitcnt lgkmcnt(10)
    v_mfma_f32_32x32x16_bf16 v[32:47], a[112:115], a[52:55], v[32:47]
    ds_read_b64_tr_b16 a[136:137], v12 offset:4352
    ds_read_b64_tr_b16 a[138:139], v12 offset:5376
    buffer_load_dwordx4 v4, s[8:11], s45 offen offset:2048 lds
    s_waitcnt lgkmcnt(10)
    v_mfma_f32_32x32x16_bf16 v[48:63], a[116:119], a[52:55], v[48:63]
    ds_read_b64_tr_b16 a[140:141], v13 offset:4352
    ds_read_b64_tr_b16 a[142:143], v13 offset:5376
    s_waitcnt lgkmcnt(10)
    v_mfma_f32_32x32x16_bf16 v[64:79], a[120:123], a[52:55], v[64:79]
    s_waitcnt vmcnt(15)
    s_barrier
    v_xor_b32 v10, 65536, v6
    ds_read_b64_tr_b16 a[112:113], v10 offset:0
    ds_read_b64_tr_b16 a[114:115], v10 offset:1024
    buffer_load_dwordx4 v5, s[8:11], s45 offen offset:3072 lds
    s_waitcnt lgkmcnt(10)
    v_mfma_f32_32x32x16_bf16 v[80:95], a[124:127], a[52:55], v[80:95]
    v_xor_b32 v11, 65600, v6
    ds_read_b64_tr_b16 a[116:117], v11 offset:0
    ds_read_b64_tr_b16 a[118:119], v11 offset:1024
    s_waitcnt lgkmcnt(10)
    v_mfma_f32_32x32x16_bf16 v[96:111], a[128:131], a[52:55], v[96:111]
    v_xor_b32 v12, 65664, v6
    ds_read_b64_tr_b16 a[120:121], v12 offset:0
    ds_read_b64_tr_b16 a[122:123], v12 offset:1024
    s_add_u32 m0, s40, 0
    s_add_u32 s45, s42, 2621440
    buffer_load_dwordx4 v2, s[8:11], s45 offen offset:0 lds
    s_waitcnt lgkmcnt(10)
    v_mfma_f32_32x32x16_bf16 v[112:127], a[132:135], a[52:55], v[112:127]
    v_xor_b32 v13, 65728, v6
    ds_read_b64_tr_b16 a[124:125], v13 offset:0
    ds_read_b64_tr_b16 a[126:127], v13 offset:1024
    s_waitcnt lgkmcnt(10)
    v_mfma_f32_32x32x16_bf16 v[128:143], a[136:139], a[52:55], v[128:143]
    ds_read_b64_tr_b16 a[128:129], v10 offset:256
    ds_read_b64_tr_b16 a[130:131], v10 offset:1280
    buffer_load_dwordx4 v3, s[8:11], s45 offen offset:1024 lds
    s_waitcnt lgkmcnt(10)
    v_mfma_f32_32x32x16_bf16 v[144:159], a[140:143], a[52:55], v[144:159]
    ds_read_b64_tr_b16 a[132:133], v11 offset:256
    ds_read_b64_tr_b16 a[134:135], v11 offset:1280
    s_waitcnt lgkmcnt(10)
    v_mfma_f32_32x32x16_bf16 v[32:47], a[112:115], a[56:59], v[32:47]
    ds_read_b64_tr_b16 a[136:137], v12 offset:256
    ds_read_b64_tr_b16 a[138:139], v12 offset:1280
    buffer_load_dwordx4 v4, s[8:11], s45 offen offset:2048 lds
    s_waitcnt lgkmcnt(10)
    v_mfma_f32_32x32x16_bf16 v[48:63], a[116:119], a[56:59], v[48:63]
    ds_read_b64_tr_b16 a[140:141], v13 offset:256
    ds_read_b64_tr_b16 a[142:143], v13 offset:1280
    s_waitcnt lgkmcnt(10)
    v_mfma_f32_32x32x16_bf16 v[64:79], a[120:123], a[56:59], v[64:79]
    ds_read_b64_tr_b16 a[112:113], v10 offset:4096
    ds_read_b64_tr_b16 a[114:115], v10 offset:5120
    buffer_load_dwordx4 v5, s[8:11], s45 offen offset:3072 lds
    s_waitcnt lgkmcnt(10)
    v_mfma_f32_32x32x16_bf16 v[80:95], a[124:127], a[56:59], v[80:95]
    ds_read_b64_tr_b16 a[116:117], v11 offset:4096
    ds_read_b64_tr_b16 a[118:119], v11 offset:5120
    s_waitcnt lgkmcnt(10)
    v_mfma_f32_32x32x16_bf16 v[96:111], a[128:131], a[56:59], v[96:111]
    ds_read_b64_tr_b16 a[120:121], v12 offset:4096
    ds_read_b64_tr_b16 a[122:123], v12 offset:5120
    s_add_u32 m0, s40, 4096
    s_add_u32 s45, s42, 2752512
    buffer_load_dwordx4 v2, s[8:11], s45 offen offset:0 lds
    s_waitcnt lgkmcnt(10)
    v_mfma_f32_32x32x16_bf16 v[112:127], a[132:135], a[56:59], v[112:127]
    ds_read_b64_tr_b16 a[124:125], v13 offset:4096
    ds_read_b64_tr_b16 a[126:127], v13 offset:5120
    s_waitcnt lgkmcnt(10)
    v_mfma_f32_32x32x16_bf16 v[128:143], a[136:139], a[56:59], v[128:143]
    ds_read_b64_tr_b16 a[128:129], v10 offset:4352
    ds_read_b64_tr_b16 a[130:131], v10 offset:5376
    buffer_load_dwordx4 v3, s[8:11], s45 offen offset:1024 lds
    s_waitcnt lgkmcnt(10)
    v_mfma_f32_32x32x16_bf16 v[144:159], a[140:143], a[56:59], v[144:159]
    ds_read_b64_tr_b16 a[132:133], v11 offset:4352
    ds_read_b64_tr_b16 a[134:135], v11 offset:5376
    s_waitcnt lgkmcnt(10)
    v_mfma_f32_32x32x16_bf16 v[32:47], a[112:115], a[60:63], v[32:47]
    ds_read_b64_tr_b16 a[136:137], v12 offset:4352
    ds_read_b64_tr_b16 a[138:139], v12 offset:5376
    buffer_load_dwordx4 v4, s[8:11], s45 offen offset:2048 lds
    s_waitcnt lgkmcnt(10)
    v_mfma_f32_32x32x16_bf16 v[48:63], a[116:119], a[60:63], v[48:63]
    ds_read_b64_tr_b16 a[140:141], v13 offset:4352
    ds_read_b64_tr_b16 a[142:143], v13 offset:5376
    s_waitcnt lgkmcnt(10)
    v_mfma_f32_32x32x16_bf16 v[64:79], a[120:123], a[60:63], v[64:79]
    s_waitcnt vmcnt(15)
    s_barrier
    v_xor_b32 v10, 98304, v6
    ds_read_b64_tr_b16 a[112:113], v10 offset:0
    ds_read_b64_tr_b16 a[114:115], v10 offset:1024
    buffer_load_dwordx4 v5, s[8:11], s45 offen offset:3072 lds
    s_waitcnt lgkmcnt(10)
    v_mfma_f32_32x32x16_bf16 v[80:95], a[124:127], a[60:63], v[80:95]
    v_xor_b32 v11, 98368, v6
    ds_read_b64_tr_b16 a[116:117], v11 offset:0
    ds_read_b64_tr_b16 a[118:119], v11 offset:1024
    s_waitcnt lgkmcnt(10)
    v_mfma_f32_32x32x16_bf16 v[96:111], a[128:131], a[60:63], v[96:111]
    v_xor_b32 v12, 98432, v6
    ds_read_b64_tr_b16 a[120:121], v12 offset:0
    ds_read_b64_tr_b16 a[122:123], v12 offset:1024
    s_add_u32 m0, s40, 32768
    s_add_u32 s45, s42, 2883584
    buffer_load_dwordx4 v2, s[8:11], s45 offen offset:0 lds
    s_waitcnt lgkmcnt(10)
    v_mfma_f32_32x32x16_bf16 v[112:127], a[132:135], a[60:63], v[112:127]
    v_xor_b32 v13, 98496, v6
    ds_read_b64_tr_b16 a[124:125], v13 offset:0
    ds_read_b64_tr_b16 a[126:127], v13 offset:1024
    s_waitcnt lgkmcnt(10)
    v_mfma_f32_32x32x16_bf16 v[128:143], a[136:139], a[60:63], v[128:143]
    ds_read_b64_tr_b16 a[128:129], v10 offset:256
    ds_read_b64_tr_b16 a[130:131], v10 offset:1280
    buffer_load_dwordx4 v3, s[8:11], s45 offen offset:1024 lds
    s_waitcnt lgkmcnt(10)
    v_mfma_f32_32x32x16_bf16 v[144:159], a[140:143], a[60:63], v[144:159]
    ds_read_b64_tr_b16 a[132:133], v11 offset:256
    ds_read_b64_tr_b16 a[134:135], v11 offset:1280
    s_waitcnt lgkmcnt(10)
    v_mfma_f32_32x32x16_bf16 v[32:47], a[112:115], a[64:67], v[32:47]
    ds_read_b64_tr_b16 a[136:137], v12 offset:256
    ds_read_b64_tr_b16 a[138:139], v12 offset:1280
    buffer_load_dwordx4 v4, s[8:11], s45 offen offset:2048 lds
    s_waitcnt lgkmcnt(10)
    v_mfma_f32_32x32x16_bf16 v[48:63], a[116:119], a[64:67], v[48:63]
    ds_read_b64_tr_b16 a[140:141], v13 offset:256
    ds_read_b64_tr_b16 a[142:143], v13 offset:1280
    s_waitcnt lgkmcnt(10)
    v_mfma_f32_32x32x16_bf16 v[64:79], a[120:123], a[64:67], v[64:79]
    ds_read_b64_tr_b16 a[112:113], v10 offset:4096
    ds_read_b64_tr_b16 a[114:115], v10 offset:5120
    buffer_load_dwordx4 v5, s[8:11], s45 offen offset:3072 lds
    s_waitcnt lgkmcnt(10)
    v_mfma_f32_32x32x16_bf16 v[80:95], a[124:127], a[64:67], v[80:95]
    ds_read_b64_tr_b16 a[116:117], v11 offset:4096
    ds_read_b64_tr_b16 a[118:119], v11 offset:5120
    s_waitcnt lgkmcnt(10)
    v_mfma_f32_32x32x16_bf16 v[96:111], a[128:131], a[64:67], v[96:111]
    ds_read_b64_tr_b16 a[120:121], v12 offset:4096
    ds_read_b64_tr_b16 a[122:123], v12 offset:5120
    s_add_u32 m0, s40, 36864
    s_add_u32 s45, s42, 3014656
    buffer_load_dwordx4 v2, s[8:11], s45 offen offset:0 lds
    s_waitcnt lgkmcnt(10)
    v_mfma_f32_32x32x16_bf16 v[112:127], a[132:135], a[64:67], v[112:127]
    ds_read_b64_tr_b16 a[124:125], v13 offset:4096
    ds_read_b64_tr_b16 a[126:127], v13 offset:5120
    s_waitcnt lgkmcnt(10)
    v_mfma_f32_32x32x16_bf16 v[128:143], a[136:139], a[64:67], v[128:143]
    ds_read_b64_tr_b16 a[128:129], v10 offset:4352
    ds_read_b64_tr_b16 a[130:131], v10 offset:5376
    buffer_load_dwordx4 v3, s[8:11], s45 offen offset:1024 lds
    s_waitcnt lgkmcnt(10)
    v_mfma_f32_32x32x16_bf16 v[144:159], a[140:143], a[64:67], v[144:159]
    ds_read_b64_tr_b16 a[132:133], v11 offset:4352
    ds_read_b64_tr_b16 a[134:135], v11 offset:5376
    s_waitcnt lgkmcnt(10)
    v_mfma_f32_32x32x16_bf16 v[32:47], a[112:115], a[68:71], v[32:47]
    ds_read_b64_tr_b16 a[136:137], v12 offset:4352
    ds_read_b64_tr_b16 a[138:139], v12 offset:5376
    buffer_load_dwordx4 v4, s[8:11], s45 offen offset:2048 lds
    s_waitcnt lgkmcnt(10)
    v_mfma_f32_32x32x16_bf16 v[48:63], a[116:119], a[68:71], v[48:63]
    ds_read_b64_tr_b16 a[140:141], v13 offset:4352
    ds_read_b64_tr_b16 a[142:143], v13 offset:5376
    s_waitcnt lgkmcnt(10)
    v_mfma_f32_32x32x16_bf16 v[64:79], a[120:123], a[68:71], v[64:79]
    s_waitcnt vmcnt(15)
    s_barrier
    v_xor_b32 v10, 131072, v6
    ds_read_b64_tr_b16 a[112:113], v10 offset:0
    ds_read_b64_tr_b16 a[114:115], v10 offset:1024
    buffer_load_dwordx4 v5, s[8:11], s45 offen offset:3072 lds
    s_waitcnt lgkmcnt(10)
    v_mfma_f32_32x32x16_bf16 v[80:95], a[124:127], a[68:71], v[80:95]
    v_xor_b32 v11, 131136, v6
    ds_read_b64_tr_b16 a[116:117], v11 offset:0
    ds_read_b64_tr_b16 a[118:119], v11 offset:1024
    s_waitcnt lgkmcnt(10)
    v_mfma_f32_32x32x16_bf16 v[96:111], a[128:131], a[68:71], v[96:111]
    v_xor_b32 v12, 131200, v6
    ds_read_b64_tr_b16 a[120:121], v12 offset:0
    ds_read_b64_tr_b16 a[122:123], v12 offset:1024
    s_add_u32 m0, s40, 65536
    s_add_u32 s45, s42, 3145728
    buffer_load_dwordx4 v2, s[8:11], s45 offen offset:0 lds
    s_waitcnt lgkmcnt(10)
    v_mfma_f32_32x32x16_bf16 v[112:127], a[132:135], a[68:71], v[112:127]
    v_xor_b32 v13, 131264, v6
    ds_read_b64_tr_b16 a[124:125], v13 offset:0
    ds_read_b64_tr_b16 a[126:127], v13 offset:1024
    s_waitcnt lgkmcnt(10)
    v_mfma_f32_32x32x16_bf16 v[128:143], a[136:139], a[68:71], v[128:143]
    ds_read_b64_tr_b16 a[128:129], v10 offset:256
    ds_read_b64_tr_b16 a[130:131], v10 offset:1280
    buffer_load_dwordx4 v3, s[8:11], s45 offen offset:1024 lds
    s_waitcnt lgkmcnt(10)
    v_mfma_f32_32x32x16_bf16 v[144:159], a[140:143], a[68:71], v[144:159]
    ds_read_b64_tr_b16 a[132:133], v11 offset:256
    ds_read_b64_tr_b16 a[134:135], v11 offset:1280
    s_waitcnt lgkmcnt(10)
    v_mfma_f32_32x32x16_bf16 v[32:47], a[112:115], a[72:75], v[32:47]
    ds_read_b64_tr_b16 a[136:137], v12 offset:256
    ds_read_b64_tr_b16 a[138:139], v12 offset:1280
    buffer_load_dwordx4 v4, s[8:11], s45 offen offset:2048 lds
    s_waitcnt lgkmcnt(10)
    v_mfma_f32_32x32x16_bf16 v[48:63], a[116:119], a[72:75], v[48:63]
    ds_read_b64_tr_b16 a[140:141], v13 offset:256
    ds_read_b64_tr_b16 a[142:143], v13 offset:1280
    s_waitcnt lgkmcnt(10)
    v_mfma_f32_32x32x16_bf16 v[64:79], a[120:123], a[72:75], v[64:79]
    ds_read_b64_tr_b16 a[112:113], v10 offset:4096
    ds_read_b64_tr_b16 a[114:115], v10 offset:5120
    buffer_load_dwordx4 v5, s[8:11], s45 offen offset:3072 lds
    s_waitcnt lgkmcnt(10)
    v_mfma_f32_32x32x16_bf16 v[80:95], a[124:127], a[72:75], v[80:95]
    ds_read_b64_tr_b16 a[116:117], v11 offset:4096
    ds_read_b64_tr_b16 a[118:119], v11 offset:5120
    s_waitcnt lgkmcnt(10)
    v_mfma_f32_32x32x16_bf16 v[96:111], a[128:131], a[72:75], v[96:111]
    ds_read_b64_tr_b16 a[120:121], v12 offset:4096
    ds_read_b64_tr_b16 a[122:123], v12 offset:5120
    s_add_u32 m0, s40, 69632
    s_add_u32 s45, s42, 3276800
    buffer_load_dwordx4 v2, s[8:11], s45 offen offset:0 lds
    s_waitcnt lgkmcnt(10)
    v_mfma_f32_32x32x16_bf16 v[112:127], a[132:135], a[72:75], v[112:127]
    ds_read_b64_tr_b16 a[124:125], v13 offset:4096
    ds_read_b64_tr_b16 a[126:127], v13 offset:5120
    s_waitcnt lgkmcnt(10)
    v_mfma_f32_32x32x16_bf16 v[128:143], a[136:139], a[72:75], v[128:143]
    ds_read_b64_tr_b16 a[128:129], v10 offset:4352
    ds_read_b64_tr_b16 a[130:131], v10 offset:5376
    buffer_load_dwordx4 v3, s[8:11], s45 offen offset:1024 lds
    s_waitcnt lgkmcnt(10)
    v_mfma_f32_32x32x16_bf16 v[144:159], a[140:143], a[72:75], v[144:159]
    ds_read_b64_tr_b16 a[132:133], v11 offset:4352
    ds_read_b64_tr_b16 a[134:135], v11 offset:5376
    s_waitcnt lgkmcnt(10)
    v_mfma_f32_32x32x16_bf16 v[32:47], a[112:115], a[76:79], v[32:47]
    ds_read_b64_tr_b16 a[136:137], v12 offset:4352
    ds_read_b64_tr_b16 a[138:139], v12 offset:5376
    buffer_load_dwordx4 v4, s[8:11], s45 offen offset:2048 lds
    s_waitcnt lgkmcnt(10)
    v_mfma_f32_32x32x16_bf16 v[48:63], a[116:119], a[76:79], v[48:63]
    ds_read_b64_tr_b16 a[140:141], v13 offset:4352
    ds_read_b64_tr_b16 a[142:143], v13 offset:5376
    s_waitcnt lgkmcnt(10)
    v_mfma_f32_32x32x16_bf16 v[64:79], a[120:123], a[76:79], v[64:79]
    s_waitcnt vmcnt(15)
    s_barrier
    v_xor_b32 v10, 0, v6
    ds_read_b64_tr_b16 a[112:113], v10 offset:0
    ds_read_b64_tr_b16 a[114:115], v10 offset:1024
    buffer_load_dwordx4 v5, s[8:11], s45 offen offset:3072 lds
    s_waitcnt lgkmcnt(10)
    v_mfma_f32_32x32x16_bf16 v[80:95], a[124:127], a[76:79], v[80:95]
    v_xor_b32 v11, 64, v6
    ds_read_b64_tr_b16 a[116:117], v11 offset:0
    ds_read_b64_tr_b16 a[118:119], v11 offset:1024
    s_waitcnt lgkmcnt(10)
    v_mfma_f32_32x32x16_bf16 v[96:111], a[128:131], a[76:79], v[96:111]
    v_xor_b32 v12, 128, v6
    ds_read_b64_tr_b16 a[120:121], v12 offset:0
    ds_read_b64_tr_b16 a[122:123], v12 offset:1024
    s_add_u32 m0, s40, 98304
    s_add_u32 s45, s42, 3407872
    buffer_load_dwordx4 v2, s[8:11], s45 offen offset:0 lds
    s_waitcnt lgkmcnt(10)
    v_mfma_f32_32x32x16_bf16 v[112:127], a[132:135], a[76:79], v[112:127]
    v_xor_b32 v13, 192, v6
    ds_read_b64_tr_b16 a[124:125], v13 offset:0
    ds_read_b64_tr_b16 a[126:127], v13 offset:1024
    s_waitcnt lgkmcnt(10)
    v_mfma_f32_32x32x16_bf16 v[128:143], a[136:139], a[76:79], v[128:143]
    ds_read_b64_tr_b16 a[128:129], v10 offset:256
    ds_read_b64_tr_b16 a[130:131], v10 offset:1280
    buffer_load_dwordx4 v3, s[8:11], s45 offen offset:1024 lds
    s_waitcnt lgkmcnt(10)
    v_mfma_f32_32x32x16_bf16 v[144:159], a[140:143], a[76:79], v[144:159]
    ds_read_b64_tr_b16 a[132:133], v11 offset:256
    ds_read_b64_tr_b16 a[134:135], v11 offset:1280
    s_waitcnt lgkmcnt(10)
    v_mfma_f32_32x32x16_bf16 v[32:47], a[112:115], a[80:83], v[32:47]
    ds_read_b64_tr_b16 a[136:137], v12 offset:256
    ds_read_b64_tr_b16 a[138:139], v12 offset:1280
    buffer_load_dwordx4 v4, s[8:11], s45 offen offset:2048 lds
    s_waitcnt lgkmcnt(10)
    v_mfma_f32_32x32x16_bf16 v[48:63], a[116:119], a[80:83], v[48:63]
    ds_read_b64_tr_b16 a[140:141], v13 offset:256
    ds_read_b64_tr_b16 a[142:143], v13 offset:1280
    s_waitcnt lgkmcnt(10)
    v_mfma_f32_32x32x16_bf16 v[64:79], a[120:123], a[80:83], v[64:79]
    ds_read_b64_tr_b16 a[112:113], v10 offset:4096
    ds_read_b64_tr_b16 a[114:115], v10 offset:5120
    buffer_load_dwordx4 v5, s[8:11], s45 offen offset:3072 lds
    s_waitcnt lgkmcnt(10)
    v_mfma_f32_32x32x16_bf16 v[80:95], a[124:127], a[80:83], v[80:95]
    ds_read_b64_tr_b16 a[116:117], v11 offset:4096
    ds_read_b64_tr_b16 a[118:119], v11 offset:5120
    s_waitcnt lgkmcnt(10)
    v_mfma_f32_32x32x16_bf16 v[96:111], a[128:131], a[80:83], v[96:111]
    ds_read_b64_tr_b16 a[120:121], v12 offset:4096
    ds_read_b64_tr_b16 a[122:123], v12 offset:5120
    s_add_u32 m0, s40, 102400
    s_add_u32 s45, s42, 3538944
    buffer_load_dwordx4 v2, s[8:11], s45 offen offset:0 lds
    s_waitcnt lgkmcnt(10)
    v_mfma_f32_32x32x16_bf16 v[112:127], a[132:135], a[80:83], v[112:127]
    ds_read_b64_tr_b16 a[124:125], v13 offset:4096
    ds_read_b64_tr_b16 a[126:127], v13 offset:5120
    s_waitcnt lgkmcnt(10)
    v_mfma_f32_32x32x16_bf16 v[128:143], a[136:139], a[80:83], v[128:143]
    ds_read_b64_tr_b16 a[128:129], v10 offset:4352
    ds_read_b64_tr_b16 a[130:131], v10 offset:5376
    buffer_load_dwordx4 v3, s[8:11], s45 offen offset:1024 lds
    s_waitcnt lgkmcnt(10)
    v_mfma_f32_32x32x16_bf16 v[144:159], a[140:143], a[80:83], v[144:159]
    ds_read_b64_tr_b16 a[132:133], v11 offset:4352
    ds_read_b64_tr_b16 a[134:135], v11 offset:5376
    s_waitcnt lgkmcnt(10)
    v_mfma_f32_32x32x16_bf16 v[32:47], a[112:115], a[84:87], v[32:47]
    ds_read_b64_tr_b16 a[136:137], v12 offset:4352
    ds_read_b64_tr_b16 a[138:139], v12 offset:5376
    buffer_load_dwordx4 v4, s[8:11], s45 offen offset:2048 lds
    s_waitcnt lgkmcnt(10)
    v_mfma_f32_32x32x16_bf16 v[48:63], a[116:119], a[84:87], v[48:63]
    ds_read_b64_tr_b16 a[140:141], v13 offset:4352
    ds_read_b64_tr_b16 a[142:143], v13 offset:5376
    s_waitcnt lgkmcnt(10)
    v_mfma_f32_32x32x16_bf16 v[64:79], a[120:123], a[84:87], v[64:79]
    s_waitcnt vmcnt(15)
    s_barrier
    v_xor_b32 v10, 32768, v6
    ds_read_b64_tr_b16 a[112:113], v10 offset:0
    ds_read_b64_tr_b16 a[114:115], v10 offset:1024
    buffer_load_dwordx4 v5, s[8:11], s45 offen offset:3072 lds
    s_waitcnt lgkmcnt(10)
    v_mfma_f32_32x32x16_bf16 v[80:95], a[124:127], a[84:87], v[80:95]
    v_xor_b32 v11, 32832, v6
    ds_read_b64_tr_b16 a[116:117], v11 offset:0
    ds_read_b64_tr_b16 a[118:119], v11 offset:1024
    s_waitcnt lgkmcnt(10)
    v_mfma_f32_32x32x16_bf16 v[96:111], a[128:131], a[84:87], v[96:111]
    v_xor_b32 v12, 32896, v6
    ds_read_b64_tr_b16 a[120:121], v12 offset:0
    ds_read_b64_tr_b16 a[122:123], v12 offset:1024
    v_accvgpr_read_b32 v2, a176
    v_xor_b32 v3, 32, v2
    v_xor_b32 v4, 64, v2
    v_xor_b32 v5, 96, v2
    s_add_u32 m0, s41, 131072
    s_add_u32 s45, s43, 0
    buffer_load_dwordx4 v2, s[12:15], s45 offen offset:0 lds
    s_waitcnt lgkmcnt(10)
    v_mfma_f32_32x32x16_bf16 v[112:127], a[132:135], a[84:87], v[112:127]
    v_xor_b32 v13, 32960, v6
    ds_read_b64_tr_b16 a[124:125], v13 offset:0
    ds_read_b64_tr_b16 a[126:127], v13 offset:1024
    s_waitcnt lgkmcnt(10)
    v_mfma_f32_32x32x16_bf16 v[128:143], a[136:139], a[84:87], v[128:143]
    ds_read_b64_tr_b16 a[128:129], v10 offset:256
    ds_read_b64_tr_b16 a[130:131], v10 offset:1280
    buffer_load_dwordx4 v3, s[12:15], s45 offen offset:1024 lds
    s_waitcnt lgkmcnt(10)
    v_mfma_f32_32x32x16_bf16 v[144:159], a[140:143], a[84:87], v[144:159]
    ds_read_b64_tr_b16 a[132:133], v11 offset:256
    ds_read_b64_tr_b16 a[134:135], v11 offset:1280
    s_waitcnt lgkmcnt(10)
    v_mfma_f32_32x32x16_bf16 v[32:47], a[112:115], a[88:91], v[32:47]
    ds_read_b64_tr_b16 a[136:137], v12 offset:256
    ds_read_b64_tr_b16 a[138:139], v12 offset:1280
    buffer_load_dwordx4 v4, s[12:15], s45 offen offset:2048 lds
    s_waitcnt lgkmcnt(10)
    v_mfma_f32_32x32x16_bf16 v[48:63], a[116:119], a[88:91], v[48:63]
    ds_read_b64_tr_b16 a[140:141], v13 offset:256
    ds_read_b64_tr_b16 a[142:143], v13 offset:1280
    s_waitcnt lgkmcnt(10)
    v_mfma_f32_32x32x16_bf16 v[64:79], a[120:123], a[88:91], v[64:79]
    ds_read_b64_tr_b16 a[112:113], v10 offset:4096
    ds_read_b64_tr_b16 a[114:115], v10 offset:5120
    buffer_load_dwordx4 v5, s[12:15], s45 offen offset:3072 lds
    s_waitcnt lgkmcnt(10)
    v_mfma_f32_32x32x16_bf16 v[80:95], a[124:127], a[88:91], v[80:95]
    ds_read_b64_tr_b16 a[116:117], v11 offset:4096
    ds_read_b64_tr_b16 a[118:119], v11 offset:5120
    s_waitcnt lgkmcnt(10)
    v_mfma_f32_32x32x16_bf16 v[96:111], a[128:131], a[88:91], v[96:111]
    ds_read_b64_tr_b16 a[120:121], v12 offset:4096
    ds_read_b64_tr_b16 a[122:123], v12 offset:5120
    s_add_u32 m0, s41, 147456
    s_add_u32 s45, s43, 16384
    buffer_load_dwordx4 v2, s[12:15], s45 offen offset:0 lds
    s_waitcnt lgkmcnt(10)
    v_mfma_f32_32x32x16_bf16 v[112:127], a[132:135], a[88:91], v[112:127]
    ds_read_b64_tr_b16 a[124:125], v13 offset:4096
    ds_read_b64_tr_b16 a[126:127], v13 offset:5120
    s_waitcnt lgkmcnt(10)
    v_mfma_f32_32x32x16_bf16 v[128:143], a[136:139], a[88:91], v[128:143]
    ds_read_b64_tr_b16 a[128:129], v10 offset:4352
    ds_read_b64_tr_b16 a[130:131], v10 offset:5376
    buffer_load_dwordx4 v3, s[12:15], s45 offen offset:1024 lds
    s_waitcnt lgkmcnt(10)
    v_mfma_f32_32x32x16_bf16 v[144:159], a[140:143], a[88:91], v[144:159]
    ds_read_b64_tr_b16 a[132:133], v11 offset:4352
    ds_read_b64_tr_b16 a[134:135], v11 offset:5376
    s_waitcnt lgkmcnt(10)
    v_mfma_f32_32x32x16_bf16 v[32:47], a[112:115], a[92:95], v[32:47]
    ds_read_b64_tr_b16 a[136:137], v12 offset:4352
    ds_read_b64_tr_b16 a[138:139], v12 offset:5376
    buffer_load_dwordx4 v4, s[12:15], s45 offen offset:2048 lds
    s_waitcnt lgkmcnt(10)
    v_mfma_f32_32x32x16_bf16 v[48:63], a[116:119], a[92:95], v[48:63]
    ds_read_b64_tr_b16 a[140:141], v13 offset:4352
    ds_read_b64_tr_b16 a[142:143], v13 offset:5376
    s_waitcnt lgkmcnt(10)
    v_mfma_f32_32x32x16_bf16 v[64:79], a[120:123], a[92:95], v[64:79]
    s_waitcnt vmcnt(15)
    s_barrier
    v_xor_b32 v10, 65536, v6
    ds_read_b64_tr_b16 a[112:113], v10 offset:0
    ds_read_b64_tr_b16 a[114:115], v10 offset:1024
    buffer_load_dwordx4 v5, s[12:15], s45 offen offset:3072 lds
    s_waitcnt lgkmcnt(10)
    v_mfma_f32_32x32x16_bf16 v[80:95], a[124:127], a[92:95], v[80:95]
    v_xor_b32 v11, 65600, v6
    ds_read_b64_tr_b16 a[116:117], v11 offset:0
    ds_read_b64_tr_b16 a[118:119], v11 offset:1024
    s_waitcnt lgkmcnt(10)
    v_mfma_f32_32x32x16_bf16 v[96:111], a[128:131], a[92:95], v[96:111]
    v_xor_b32 v12, 65664, v6
    ds_read_b64_tr_b16 a[120:121], v12 offset:0
    ds_read_b64_tr_b16 a[122:123], v12 offset:1024
    s_add_u32 m0, s41, 0
    s_add_u32 s45, s43, 32768
    buffer_load_dwordx4 v2, s[12:15], s45 offen offset:0 lds
    s_waitcnt lgkmcnt(10)
    v_mfma_f32_32x32x16_bf16 v[112:127], a[132:135], a[92:95], v[112:127]
    v_xor_b32 v13, 65728, v6
    ds_read_b64_tr_b16 a[124:125], v13 offset:0
    ds_read_b64_tr_b16 a[126:127], v13 offset:1024
    s_waitcnt lgkmcnt(10)
    v_mfma_f32_32x32x16_bf16 v[128:143], a[136:139], a[92:95], v[128:143]
    ds_read_b64_tr_b16 a[128:129], v10 offset:256
    ds_read_b64_tr_b16 a[130:131], v10 offset:1280
    buffer_load_dwordx4 v3, s[12:15], s45 offen offset:1024 lds
    s_waitcnt lgkmcnt(10)
    v_mfma_f32_32x32x16_bf16 v[144:159], a[140:143], a[92:95], v[144:159]
    ds_read_b64_tr_b16 a[132:133], v11 offset:256
    ds_read_b64_tr_b16 a[134:135], v11 offset:1280
    s_waitcnt lgkmcnt(10)
    v_mfma_f32_32x32x16_bf16 v[32:47], a[112:115], a[96:99], v[32:47]
    ds_read_b64_tr_b16 a[136:137], v12 offset:256
    ds_read_b64_tr_b16 a[138:139], v12 offset:1280
    buffer_load_dwordx4 v4, s[12:15], s45 offen offset:2048 lds
    s_waitcnt lgkmcnt(10)
    v_mfma_f32_32x32x16_bf16 v[48:63], a[116:119], a[96:99], v[48:63]
    ds_read_b64_tr_b16 a[140:141], v13 offset:256
    ds_read_b64_tr_b16 a[142:143], v13 offset:1280
    s_waitcnt lgkmcnt(10)
    v_mfma_f32_32x32x16_bf16 v[64:79], a[120:123], a[96:99], v[64:79]
    ds_read_b64_tr_b16 a[112:113], v10 offset:4096
    ds_read_b64_tr_b16 a[114:115], v10 offset:5120
    buffer_load_dwordx4 v5, s[12:15], s45 offen offset:3072 lds
    s_waitcnt lgkmcnt(10)
    v_mfma_f32_32x32x16_bf16 v[80:95], a[124:127], a[96:99], v[80:95]
    ds_read_b64_tr_b16 a[116:117], v11 offset:4096
    ds_read_b64_tr_b16 a[118:119], v11 offset:5120
    s_waitcnt lgkmcnt(10)
    v_mfma_f32_32x32x16_bf16 v[96:111], a[128:131], a[96:99], v[96:111]
    ds_read_b64_tr_b16 a[120:121], v12 offset:4096
    ds_read_b64_tr_b16 a[122:123], v12 offset:5120
    s_add_u32 m0, s41, 16384
    s_add_u32 s45, s43, 49152
    buffer_load_dwordx4 v2, s[12:15], s45 offen offset:0 lds
    s_waitcnt lgkmcnt(10)
    v_mfma_f32_32x32x16_bf16 v[112:127], a[132:135], a[96:99], v[112:127]
    ds_read_b64_tr_b16 a[124:125], v13 offset:4096
    ds_read_b64_tr_b16 a[126:127], v13 offset:5120
    s_waitcnt lgkmcnt(10)
    v_mfma_f32_32x32x16_bf16 v[128:143], a[136:139], a[96:99], v[128:143]
    ds_read_b64_tr_b16 a[128:129], v10 offset:4352
    ds_read_b64_tr_b16 a[130:131], v10 offset:5376
    buffer_load_dwordx4 v3, s[12:15], s45 offen offset:1024 lds
    s_waitcnt lgkmcnt(10)
    v_mfma_f32_32x32x16_bf16 v[144:159], a[140:143], a[96:99], v[144:159]
    ds_read_b64_tr_b16 a[132:133], v11 offset:4352
    ds_read_b64_tr_b16 a[134:135], v11 offset:5376
    s_waitcnt lgkmcnt(10)
    v_mfma_f32_32x32x16_bf16 v[32:47], a[112:115], a[100:103], v[32:47]
    ds_read_b64_tr_b16 a[136:137], v12 offset:4352
    ds_read_b64_tr_b16 a[138:139], v12 offset:5376
    buffer_load_dwordx4 v4, s[12:15], s45 offen offset:2048 lds
    s_waitcnt lgkmcnt(10)
    v_mfma_f32_32x32x16_bf16 v[48:63], a[116:119], a[100:103], v[48:63]
    ds_read_b64_tr_b16 a[140:141], v13 offset:4352
    ds_read_b64_tr_b16 a[142:143], v13 offset:5376
    s_waitcnt lgkmcnt(10)
    v_mfma_f32_32x32x16_bf16 v[64:79], a[120:123], a[100:103], v[64:79]
    s_waitcnt vmcnt(15)
    s_barrier
    v_xor_b32 v10, 98304, v6
    ds_read_b64_tr_b16 a[112:113], v10 offset:0
    ds_read_b64_tr_b16 a[114:115], v10 offset:1024
    buffer_load_dwordx4 v5, s[12:15], s45 offen offset:3072 lds
    s_waitcnt lgkmcnt(10)
    v_mfma_f32_32x32x16_bf16 v[80:95], a[124:127], a[100:103], v[80:95]
    v_xor_b32 v11, 98368, v6
    ds_read_b64_tr_b16 a[116:117], v11 offset:0
    ds_read_b64_tr_b16 a[118:119], v11 offset:1024
    s_waitcnt lgkmcnt(10)
    v_mfma_f32_32x32x16_bf16 v[96:111], a[128:131], a[100:103], v[96:111]
    v_xor_b32 v12, 98432, v6
    ds_read_b64_tr_b16 a[120:121], v12 offset:0
    ds_read_b64_tr_b16 a[122:123], v12 offset:1024
    s_add_u32 m0, s41, 32768
    s_add_u32 s45, s43, 65536
    buffer_load_dwordx4 v2, s[12:15], s45 offen offset:0 lds
    s_waitcnt lgkmcnt(10)
    v_mfma_f32_32x32x16_bf16 v[112:127], a[132:135], a[100:103], v[112:127]
    v_xor_b32 v13, 98496, v6
    ds_read_b64_tr_b16 a[124:125], v13 offset:0
    ds_read_b64_tr_b16 a[126:127], v13 offset:1024
    s_waitcnt lgkmcnt(10)
    v_mfma_f32_32x32x16_bf16 v[128:143], a[136:139], a[100:103], v[128:143]
    ds_read_b64_tr_b16 a[128:129], v10 offset:256
    ds_read_b64_tr_b16 a[130:131], v10 offset:1280
    buffer_load_dwordx4 v3, s[12:15], s45 offen offset:1024 lds
    s_waitcnt lgkmcnt(10)
    v_mfma_f32_32x32x16_bf16 v[144:159], a[140:143], a[100:103], v[144:159]
    ds_read_b64_tr_b16 a[132:133], v11 offset:256
    ds_read_b64_tr_b16 a[134:135], v11 offset:1280
    s_waitcnt lgkmcnt(10)
    v_mfma_f32_32x32x16_bf16 v[32:47], a[112:115], a[104:107], v[32:47]
    ds_read_b64_tr_b16 a[136:137], v12 offset:256
    ds_read_b64_tr_b16 a[138:139], v12 offset:1280
    buffer_load_dwordx4 v4, s[12:15], s45 offen offset:2048 lds
    s_waitcnt lgkmcnt(10)
    v_mfma_f32_32x32x16_bf16 v[48:63], a[116:119], a[104:107], v[48:63]
    ds_read_b64_tr_b16 a[140:141], v13 offset:256
    ds_read_b64_tr_b16 a[142:143], v13 offset:1280
    s_waitcnt lgkmcnt(10)
    v_mfma_f32_32x32x16_bf16 v[64:79], a[120:123], a[104:107], v[64:79]
    ds_read_b64_tr_b16 a[112:113], v10 offset:4096
    ds_read_b64_tr_b16 a[114:115], v10 offset:5120
    buffer_load_dwordx4 v5, s[12:15], s45 offen offset:3072 lds
    s_waitcnt lgkmcnt(10)
    v_mfma_f32_32x32x16_bf16 v[80:95], a[124:127], a[104:107], v[80:95]
    ds_read_b64_tr_b16 a[116:117], v11 offset:4096
    ds_read_b64_tr_b16 a[118:119], v11 offset:5120
    s_waitcnt lgkmcnt(10)
    v_mfma_f32_32x32x16_bf16 v[96:111], a[128:131], a[104:107], v[96:111]
    ds_read_b64_tr_b16 a[120:121], v12 offset:4096
    ds_read_b64_tr_b16 a[122:123], v12 offset:5120
    s_add_u32 m0, s41, 49152
    s_add_u32 s45, s43, 81920
    buffer_load_dwordx4 v2, s[12:15], s45 offen offset:0 lds
    s_waitcnt lgkmcnt(10)
    v_mfma_f32_32x32x16_bf16 v[112:127], a[132:135], a[104:107], v[112:127]
    ds_read_b64_tr_b16 a[124:125], v13 offset:4096
    ds_read_b64_tr_b16 a[126:127], v13 offset:5120
    s_waitcnt lgkmcnt(10)
    v_mfma_f32_32x32x16_bf16 v[128:143], a[136:139], a[104:107], v[128:143]
    ds_read_b64_tr_b16 a[128:129], v10 offset:4352
    ds_read_b64_tr_b16 a[130:131], v10 offset:5376
    buffer_load_dwordx4 v3, s[12:15], s45 offen offset:1024 lds
    s_waitcnt lgkmcnt(10)
    v_mfma_f32_32x32x16_bf16 v[144:159], a[140:143], a[104:107], v[144:159]
    ds_read_b64_tr_b16 a[132:133], v11 offset:4352
    ds_read_b64_tr_b16 a[134:135], v11 offset:5376
    s_waitcnt lgkmcnt(10)
    v_mfma_f32_32x32x16_bf16 v[32:47], a[112:115], a[108:111], v[32:47]
    ds_read_b64_tr_b16 a[136:137], v12 offset:4352
    ds_read_b64_tr_b16 a[138:139], v12 offset:5376
    buffer_load_dwordx4 v4, s[12:15], s45 offen offset:2048 lds
    s_waitcnt lgkmcnt(10)
    v_mfma_f32_32x32x16_bf16 v[48:63], a[116:119], a[108:111], v[48:63]
    ds_read_b64_tr_b16 a[140:141], v13 offset:4352
    ds_read_b64_tr_b16 a[142:143], v13 offset:5376
    s_waitcnt lgkmcnt(10)
    v_mfma_f32_32x32x16_bf16 v[64:79], a[120:123], a[108:111], v[64:79]
    s_waitcnt vmcnt(15)
    s_barrier
    v_xor_b32 v10, 131072, v7
    ds_read_b128 a[112:115], v10 offset:0
    buffer_load_dwordx4 v5, s[12:15], s45 offen offset:3072 lds
    s_waitcnt lgkmcnt(9)
    v_mfma_f32_32x32x16_bf16 v[80:95], a[124:127], a[108:111], v[80:95]
    v_xor_b32 v11, 131104, v7
    ds_read_b128 a[116:119], v11 offset:0
    v_cvt_pk_bf16_f32 v160, v32, v33
    v_cvt_pk_bf16_f32 v161, v34, v35
    v_cvt_pk_bf16_f32 v162, v36, v37
    v_cvt_pk_bf16_f32 v163, v38, v39
    s_waitcnt lgkmcnt(8)
    v_mfma_f32_32x32x16_bf16 v[96:111], a[128:131], a[108:111], v[96:111]
    v_xor_b32 v12, 131136, v7
    ds_read_b128 a[120:123], v12 offset:0
    v_cvt_pk_bf16_f32 v164, v40, v41
    v_cvt_pk_bf16_f32 v165, v42, v43
    v_cvt_pk_bf16_f32 v166, v44, v45
    v_cvt_pk_bf16_f32 v167, v46, v47
    s_add_u32 m0, s41, 65536
    s_add_u32 s45, s43, 98304
    buffer_load_dwordx4 v2, s[12:15], s45 offen offset:0 lds
    s_waitcnt lgkmcnt(7)
    v_mfma_f32_32x32x16_bf16 v[112:127], a[132:135], a[108:111], v[112:127]
    v_xor_b32 v13, 131168, v7
    ds_read_b128 a[124:127], v13 offset:0
    v_cvt_pk_bf16_f32 v168, v48, v49
    v_cvt_pk_bf16_f32 v169, v50, v51
    v_cvt_pk_bf16_f32 v170, v52, v53
    v_cvt_pk_bf16_f32 v171, v54, v55
    s_waitcnt lgkmcnt(6)
    v_mfma_f32_32x32x16_bf16 v[128:143], a[136:139], a[108:111], v[128:143]
    v_xor_b32 v14, 131200, v7
    ds_read_b128 a[128:131], v14 offset:0
    v_cvt_pk_bf16_f32 v172, v56, v57
    v_cvt_pk_bf16_f32 v173, v58, v59
    v_cvt_pk_bf16_f32 v174, v60, v61
    v_cvt_pk_bf16_f32 v175, v62, v63
    buffer_load_dwordx4 v3, s[12:15], s45 offen offset:1024 lds
    s_waitcnt lgkmcnt(5)
    v_mfma_f32_32x32x16_bf16 v[144:159], a[140:143], a[108:111], v[144:159]
    v_xor_b32 v15, 131232, v7
    ds_read_b128 a[132:135], v15 offset:0
    v_cvt_pk_bf16_f32 v176, v64, v65
    v_cvt_pk_bf16_f32 v177, v66, v67
    v_cvt_pk_bf16_f32 v178, v68, v69
    v_cvt_pk_bf16_f32 v179, v70, v71
    s_waitcnt lgkmcnt(5)
    v_mfma_f32_32x32x16_bf16 v[224:239], a[112:115], v[160:163], 0
    v_xor_b32 v16, 131264, v7
    ds_read_b128 a[136:139], v16 offset:0
    v_cvt_pk_bf16_f32 v180, v72, v73
    v_cvt_pk_bf16_f32 v181, v74, v75
    v_cvt_pk_bf16_f32 v182, v76, v77
    v_cvt_pk_bf16_f32 v183, v78, v79
    buffer_load_dwordx4 v4, s[12:15], s45 offen offset:2048 lds
    s_waitcnt lgkmcnt(5)
    v_mfma_f32_32x32x16_bf16 v[224:239], a[116:119], v[164:167], v[224:239]
    v_xor_b32 v17, 131296, v7
    ds_read_b128 a[140:143], v17 offset:0
    v_cvt_pk_bf16_f32 v184, v80, v81
    v_cvt_pk_bf16_f32 v185, v82, v83
    v_cvt_pk_bf16_f32 v186, v84, v85
    v_cvt_pk_bf16_f32 v187, v86, v87
    s_waitcnt lgkmcnt(5)
    v_mfma_f32_32x32x16_bf16 v[224:239], a[120:123], v[168:171], v[224:239]
    ds_read_b128 a[112:115], v10 offset:256
    v_cvt_pk_bf16_f32 v188, v88, v89
    v_cvt_pk_bf16_f32 v189, v90, v91
    v_cvt_pk_bf16_f32 v190, v92, v93
    v_cvt_pk_bf16_f32 v191, v94, v95
    s_waitcnt lgkmcnt(5)
    v_mfma_f32_32x32x16_bf16 v[224:239], a[124:127], v[172:175], v[224:239]
    ds_read_b128 a[116:119], v11 offset:256
    v_cvt_pk_bf16_f32 v192, v96, v97
    v_cvt_pk_bf16_f32 v193, v98, v99
    v_cvt_pk_bf16_f32 v194, v100, v101
    v_cvt_pk_bf16_f32 v195, v102, v103
    s_waitcnt lgkmcnt(5)
    v_mfma_f32_32x32x16_bf16 v[224:239], a[128:131], v[176:179], v[224:239]
    ds_read_b128 a[120:123], v12 offset:256
    v_cvt_pk_bf16_f32 v196, v104, v105
    v_cvt_pk_bf16_f32 v197, v106, v107
    v_cvt_pk_bf16_f32 v198, v108, v109
    v_cvt_pk_bf16_f32 v199, v110, v111
    buffer_load_dwordx4 v5, s[12:15], s45 offen offset:3072 lds
    s_waitcnt lgkmcnt(5)
    v_mfma_f32_32x32x16_bf16 v[224:239], a[132:135], v[180:183], v[224:239]
    ds_read_b128 a[124:127], v13 offset:256
    v_cvt_pk_bf16_f32 v200, v112, v113
    v_cvt_pk_bf16_f32 v201, v114, v115
    v_cvt_pk_bf16_f32 v202, v116, v117
    v_cvt_pk_bf16_f32 v203, v118, v119
    s_waitcnt lgkmcnt(5)
    v_mfma_f32_32x32x16_bf16 v[224:239], a[136:139], v[184:187], v[224:239]
    ds_read_b128 a[128:131], v14 offset:256
    v_cvt_pk_bf16_f32 v204, v120, v121
    v_cvt_pk_bf16_f32 v205, v122, v123
    v_cvt_pk_bf16_f32 v206, v124, v125
    v_cvt_pk_bf16_f32 v207, v126, v127
    s_waitcnt lgkmcnt(5)
    v_mfma_f32_32x32x16_bf16 v[224:239], a[140:143], v[188:191], v[224:239]
    ds_read_b128 a[132:135], v15 offset:256
    v_cvt_pk_bf16_f32 v208, v128, v129
    v_cvt_pk_bf16_f32 v209, v130, v131
    v_cvt_pk_bf16_f32 v210, v132, v133
    v_cvt_pk_bf16_f32 v211, v134, v135
    s_waitcnt lgkmcnt(5)
    v_mfma_f32_32x32x16_bf16 v[224:239], a[112:115], v[192:195], v[224:239]
    ds_read_b128 a[136:139], v16 offset:256
    v_cvt_pk_bf16_f32 v212, v136, v137
    v_cvt_pk_bf16_f32 v213, v138, v139
    v_cvt_pk_bf16_f32 v214, v140, v141
    v_cvt_pk_bf16_f32 v215, v142, v143
    s_add_u32 m0, s41, 81920
    s_add_u32 s45, s43, 114688
    buffer_load_dwordx4 v2, s[12:15], s45 offen offset:0 lds
    s_waitcnt lgkmcnt(5)
    v_mfma_f32_32x32x16_bf16 v[224:239], a[116:119], v[196:199], v[224:239]
    ds_read_b128 a[140:143], v17 offset:256
    v_cvt_pk_bf16_f32 v216, v144, v145
    v_cvt_pk_bf16_f32 v217, v146, v147
    v_cvt_pk_bf16_f32 v218, v148, v149
    v_cvt_pk_bf16_f32 v219, v150, v151
    s_waitcnt lgkmcnt(5)
    v_mfma_f32_32x32x16_bf16 v[224:239], a[120:123], v[200:203], v[224:239]
    ds_read_b128 a[112:115], v10 offset:16384
    v_cvt_pk_bf16_f32 v220, v152, v153
    v_cvt_pk_bf16_f32 v221, v154, v155
    v_cvt_pk_bf16_f32 v222, v156, v157
    v_cvt_pk_bf16_f32 v223, v158, v159
    s_waitcnt lgkmcnt(5)
    v_mfma_f32_32x32x16_bf16 v[224:239], a[124:127], v[204:207], v[224:239]
    ds_read_b128 a[116:119], v11 offset:16384
    s_waitcnt lgkmcnt(5)
    v_mfma_f32_32x32x16_bf16 v[224:239], a[128:131], v[208:211], v[224:239]
    ds_read_b128 a[120:123], v12 offset:16384
    buffer_load_dwordx4 v3, s[12:15], s45 offen offset:1024 lds
    s_waitcnt lgkmcnt(5)
    v_mfma_f32_32x32x16_bf16 v[224:239], a[132:135], v[212:215], v[224:239]
    ds_read_b128 a[124:127], v13 offset:16384
    s_waitcnt lgkmcnt(5)
    v_mfma_f32_32x32x16_bf16 v[224:239], a[136:139], v[216:219], v[224:239]
    ds_read_b128 a[128:131], v14 offset:16384
    s_waitcnt lgkmcnt(5)
    v_mfma_f32_32x32x16_bf16 v[224:239], a[140:143], v[220:223], v[224:239]
    ds_read_b128 a[132:135], v15 offset:16384
    s_waitcnt lgkmcnt(5)
    v_mfma_f32_32x32x16_bf16 v[240:255], a[112:115], v[160:163], 0
    ds_read_b128 a[136:139], v16 offset:16384
    buffer_load_dwordx4 v4, s[12:15], s45 offen offset:2048 lds
    s_waitcnt lgkmcnt(5)
    v_mfma_f32_32x32x16_bf16 v[240:255], a[116:119], v[164:167], v[240:255]
    ds_read_b128 a[140:143], v17 offset:16384
    s_waitcnt lgkmcnt(5)
    v_mfma_f32_32x32x16_bf16 v[240:255], a[120:123], v[168:171], v[240:255]
    ds_read_b128 a[112:115], v10 offset:16640
    s_waitcnt lgkmcnt(5)
    v_mfma_f32_32x32x16_bf16 v[240:255], a[124:127], v[172:175], v[240:255]
    ds_read_b128 a[116:119], v11 offset:16640
    s_mov_b32 s88, s20
    s_mov_b32 s89, s21
    s_mov_b32 s90, 3670016
    s_mov_b32 s91, 0x20000
    s_lshl_b32 s5, s2, 2
    s_add_u32 s5, s5, s48
    s_mul_i32 s52, s5, 3584
    v_lshlrev_b32 v27, 4, v1
    v_max_f32 v19, v224, v225
    v_cvt_pk_bf16_f32 v32, v224, v225
    s_waitcnt lgkmcnt(5)
    v_mfma_f32_32x32x16_bf16 v[240:255], a[128:131], v[176:179], v[240:255]
    ds_read_b128 a[120:123], v12 offset:16640
    buffer_load_dwordx4 v[28:31], v27, s[88:91], s52 offen
    s_add_u32 s52, s52, 1024
    v_max3_f32 v19, v19, v226, v227
    v_cvt_pk_bf16_f32 v33, v226, v227
    buffer_load_dwordx4 v5, s[12:15], s45 offen offset:3072 lds
    s_waitcnt lgkmcnt(5)
    v_mfma_f32_32x32x16_bf16 v[240:255], a[132:135], v[180:183], v[240:255]
    ds_read_b128 a[124:127], v13 offset:16640
    v_max3_f32 v19, v19, v228, v229
    v_cvt_pk_bf16_f32 v34, v228, v229
    s_waitcnt lgkmcnt(5)
    v_mfma_f32_32x32x16_bf16 v[240:255], a[136:139], v[184:187], v[240:255]
    ds_read_b128 a[128:131], v14 offset:16640
    v_max3_f32 v19, v19, v230, v231
    v_cvt_pk_bf16_f32 v35, v230, v231
    s_waitcnt lgkmcnt(5)
    v_mfma_f32_32x32x16_bf16 v[240:255], a[140:143], v[188:191], v[240:255]
    ds_read_b128 a[132:135], v15 offset:16640
    v_max3_f32 v19, v19, v232, v233
    v_cvt_pk_bf16_f32 v36, v232, v233
    s_waitcnt lgkmcnt(5)
    v_mfma_f32_32x32x16_bf16 v[240:255], a[112:115], v[192:195], v[240:255]
    ds_read_b128 a[136:139], v16 offset:16640
    v_max3_f32 v19, v19, v234, v235
    v_cvt_pk_bf16_f32 v37, v234, v235
    s_waitcnt lgkmcnt(5)
    v_mfma_f32_32x32x16_bf16 v[240:255], a[116:119], v[196:199], v[240:255]
    ds_read_b128 a[140:143], v17 offset:16640
    v_max3_f32 v19, v19, v236, v237
    v_cvt_pk_bf16_f32 v38, v236, v237
    s_waitcnt lgkmcnt(5)
    v_mfma_f32_32x32x16_bf16 v[240:255], a[120:123], v[200:203], v[240:255]
    s_waitcnt vmcnt(17)
    s_barrier
    v_xor_b32 v10, 0, v7
    ds_read_b128 a[112:115], v10 offset:0
    v_max3_f32 v19, v19, v238, v239
    v_cvt_pk_bf16_f32 v39, v238, v239
    s_waitcnt lgkmcnt(5)
    v_mfma_f32_32x32x16_bf16 v[240:255], a[124:127], v[204:207], v[240:255]
    v_xor_b32 v11, 32, v7
    ds_read_b128 a[116:119], v11 offset:0
    s_waitcnt lgkmcnt(5)
    v_mfma_f32_32x32x16_bf16 v[240:255], a[128:131], v[208:211], v[240:255]
    v_xor_b32 v12, 64, v7
    ds_read_b128 a[120:123], v12 offset:0
    s_add_u32 m0, s41, 98304
    s_add_u32 s45, s43, 131072
    buffer_load_dwordx4 v2, s[12:15], s45 offen offset:0 lds
    s_waitcnt lgkmcnt(5)
    v_mfma_f32_32x32x16_bf16 v[240:255], a[132:135], v[212:215], v[240:255]
    v_xor_b32 v13, 96, v7
    ds_read_b128 a[124:127], v13 offset:0
    s_waitcnt lgkmcnt(5)
    v_mfma_f32_32x32x16_bf16 v[240:255], a[136:139], v[216:219], v[240:255]
    v_xor_b32 v14, 128, v7
    ds_read_b128 a[128:131], v14 offset:0
    s_waitcnt lgkmcnt(5)
    v_mfma_f32_32x32x16_bf16 v[240:255], a[140:143], v[220:223], v[240:255]
    v_xor_b32 v15, 160, v7
    ds_read_b128 a[132:135], v15 offset:0
    s_waitcnt lgkmcnt(5)
    v_mfma_f32_32x32x16_bf16 v[224:239], a[112:115], v[160:163], 0
    v_xor_b32 v16, 192, v7
    ds_read_b128 a[136:139], v16 offset:0
    buffer_load_dwordx4 v3, s[12:15], s45 offen offset:1024 lds
    s_waitcnt lgkmcnt(5)
    v_mfma_f32_32x32x16_bf16 v[224:239], a[116:119], v[164:167], v[224:239]
    v_xor_b32 v17, 224, v7
    ds_read_b128 a[140:143], v17 offset:0
    s_waitcnt lgkmcnt(5)
    v_mfma_f32_32x32x16_bf16 v[224:239], a[120:123], v[168:171], v[224:239]
    ds_read_b128 a[112:115], v10 offset:256
    s_waitcnt lgkmcnt(5)
    v_mfma_f32_32x32x16_bf16 v[224:239], a[124:127], v[172:175], v[224:239]
    ds_read_b128 a[116:119], v11 offset:256
    v_max3_f32 v19, v19, v240, v241
    v_cvt_pk_bf16_f32 v40, v240, v241
    s_waitcnt lgkmcnt(5)
    v_mfma_f32_32x32x16_bf16 v[224:239], a[128:131], v[176:179], v[224:239]
    ds_read_b128 a[120:123], v12 offset:256
    v_max3_f32 v19, v19, v242, v243
    v_cvt_pk_bf16_f32 v41, v242, v243
    buffer_load_dwordx4 v4, s[12:15], s45 offen offset:2048 lds
    s_waitcnt lgkmcnt(5)
    v_mfma_f32_32x32x16_bf16 v[224:239], a[132:135], v[180:183], v[224:239]
    ds_read_b128 a[124:127], v13 offset:256
    v_max3_f32 v19, v19, v244, v245
    v_cvt_pk_bf16_f32 v42, v244, v245
    s_waitcnt lgkmcnt(5)
    v_mfma_f32_32x32x16_bf16 v[224:239], a[136:139], v[184:187], v[224:239]
    ds_read_b128 a[128:131], v14 offset:256
    v_max3_f32 v19, v19, v246, v247
    v_cvt_pk_bf16_f32 v43, v246, v247
    s_waitcnt lgkmcnt(5)
    v_mfma_f32_32x32x16_bf16 v[224:239], a[140:143], v[188:191], v[224:239]
    ds_read_b128 a[132:135], v15 offset:256
    v_max3_f32 v19, v19, v248, v249
    v_cvt_pk_bf16_f32 v44, v248, v249
    s_waitcnt lgkmcnt(5)
    v_mfma_f32_32x32x16_bf16 v[224:239], a[112:115], v[192:195], v[224:239]
    ds_read_b128 a[136:139], v16 offset:256
    v_max3_f32 v19, v19, v250, v251
    v_cvt_pk_bf16_f32 v45, v250, v251
    buffer_load_dwordx4 v5, s[12:15], s45 offen offset:3072 lds
    s_waitcnt lgkmcnt(5)
    v_mfma_f32_32x32x16_bf16 v[224:239], a[116:119], v[196:199], v[224:239]
    ds_read_b128 a[140:143], v17 offset:256
    v_max3_f32 v19, v19, v252, v253
    v_cvt_pk_bf16_f32 v46, v252, v253
    s_waitcnt lgkmcnt(5)
    v_mfma_f32_32x32x16_bf16 v[224:239], a[120:123], v[200:203], v[224:239]
    ds_read_b128 a[112:115], v10 offset:16384
    v_max3_f32 v19, v19, v254, v255
    v_cvt_pk_bf16_f32 v47, v254, v255
    s_waitcnt lgkmcnt(5)
    v_mfma_f32_32x32x16_bf16 v[224:239], a[124:127], v[204:207], v[224:239]
    ds_read_b128 a[116:119], v11 offset:16384
    s_waitcnt lgkmcnt(5)
    v_mfma_f32_32x32x16_bf16 v[224:239], a[128:131], v[208:211], v[224:239]
    ds_read_b128 a[120:123], v12 offset:16384
    s_add_u32 m0, s41, 114688
    s_add_u32 s45, s43, 147456
    buffer_load_dwordx4 v2, s[12:15], s45 offen offset:0 lds
    s_waitcnt lgkmcnt(5)
    v_mfma_f32_32x32x16_bf16 v[224:239], a[132:135], v[212:215], v[224:239]
    ds_read_b128 a[124:127], v13 offset:16384
    s_waitcnt lgkmcnt(5)
    v_mfma_f32_32x32x16_bf16 v[224:239], a[136:139], v[216:219], v[224:239]
    ds_read_b128 a[128:131], v14 offset:16384
    s_waitcnt lgkmcnt(5)
    v_mfma_f32_32x32x16_bf16 v[224:239], a[140:143], v[220:223], v[224:239]
    ds_read_b128 a[132:135], v15 offset:16384
    s_waitcnt lgkmcnt(5)
    v_mfma_f32_32x32x16_bf16 v[240:255], a[112:115], v[160:163], 0
    ds_read_b128 a[136:139], v16 offset:16384
    buffer_load_dwordx4 v3, s[12:15], s45 offen offset:1024 lds
    s_waitcnt lgkmcnt(5)
    v_mfma_f32_32x32x16_bf16 v[240:255], a[116:119], v[164:167], v[240:255]
    ds_read_b128 a[140:143], v17 offset:16384
    s_waitcnt lgkmcnt(5)
    v_mfma_f32_32x32x16_bf16 v[240:255], a[120:123], v[168:171], v[240:255]
    ds_read_b128 a[112:115], v10 offset:16640
    s_waitcnt lgkmcnt(5)
    v_mfma_f32_32x32x16_bf16 v[240:255], a[124:127], v[172:175], v[240:255]
    ds_read_b128 a[116:119], v11 offset:16640
    v_max3_f32 v19, v19, v224, v225
    v_cvt_pk_bf16_f32 v48, v224, v225
    s_waitcnt lgkmcnt(5)
    v_mfma_f32_32x32x16_bf16 v[240:255], a[128:131], v[176:179], v[240:255]
    ds_read_b128 a[120:123], v12 offset:16640
    buffer_load_dwordx4 v[28:31], v27, s[88:91], s52 offen
    s_add_u32 s52, s52, 1024
    v_max3_f32 v19, v19, v226, v227
    v_cvt_pk_bf16_f32 v49, v226, v227
    buffer_load_dwordx4 v4, s[12:15], s45 offen offset:2048 lds
    s_waitcnt lgkmcnt(5)
    v_mfma_f32_32x32x16_bf16 v[240:255], a[132:135], v[180:183], v[240:255]
    ds_read_b128 a[124:127], v13 offset:16640
    v_max3_f32 v19, v19, v228, v229
    v_cvt_pk_bf16_f32 v50, v228, v229
    s_waitcnt lgkmcnt(5)
    v_mfma_f32_32x32x16_bf16 v[240:255], a[136:139], v[184:187], v[240:255]
    ds_read_b128 a[128:131], v14 offset:16640
    v_max3_f32 v19, v19, v230, v231
    v_cvt_pk_bf16_f32 v51, v230, v231
    s_waitcnt lgkmcnt(5)
    v_mfma_f32_32x32x16_bf16 v[240:255], a[140:143], v[188:191], v[240:255]
    ds_read_b128 a[132:135], v15 offset:16640
    v_max3_f32 v19, v19, v232, v233
    v_cvt_pk_bf16_f32 v52, v232, v233
    s_waitcnt lgkmcnt(5)
    v_mfma_f32_32x32x16_bf16 v[240:255], a[112:115], v[192:195], v[240:255]
    ds_read_b128 a[136:139], v16 offset:16640
    v_max3_f32 v19, v19, v234, v235
    v_cvt_pk_bf16_f32 v53, v234, v235
    buffer_load_dwordx4 v5, s[12:15], s45 offen offset:3072 lds
    s_waitcnt lgkmcnt(5)
    v_mfma_f32_32x32x16_bf16 v[240:255], a[116:119], v[196:199], v[240:255]
    ds_read_b128 a[140:143], v17 offset:16640
    v_max3_f32 v19, v19, v236, v237
    v_cvt_pk_bf16_f32 v54, v236, v237
    s_waitcnt lgkmcnt(5)
    v_mfma_f32_32x32x16_bf16 v[240:255], a[120:123], v[200:203], v[240:255]
    s_waitcnt vmcnt(18)
    s_barrier
    v_xor_b32 v10, 32768, v7
    ds_read_b128 a[112:115], v10 offset:0
    v_max3_f32 v19, v19, v238, v239
    v_cvt_pk_bf16_f32 v55, v238, v239
    s_waitcnt lgkmcnt(5)
    v_mfma_f32_32x32x16_bf16 v[240:255], a[124:127], v[204:207], v[240:255]
    v_xor_b32 v11, 32800, v7
    ds_read_b128 a[116:119], v11 offset:0
    s_waitcnt lgkmcnt(5)
    v_mfma_f32_32x32x16_bf16 v[240:255], a[128:131], v[208:211], v[240:255]
    v_xor_b32 v12, 32832, v7
    ds_read_b128 a[120:123], v12 offset:0
    s_add_u32 m0, s41, 131072
    s_add_u32 s45, s43, 163840
    buffer_load_dwordx4 v2, s[12:15], s45 offen offset:0 lds
    s_waitcnt lgkmcnt(5)
    v_mfma_f32_32x32x16_bf16 v[240:255], a[132:135], v[212:215], v[240:255]
    v_xor_b32 v13, 32864, v7
    ds_read_b128 a[124:127], v13 offset:0
    s_waitcnt lgkmcnt(5)
    v_mfma_f32_32x32x16_bf16 v[240:255], a[136:139], v[216:219], v[240:255]
    v_xor_b32 v14, 32896, v7
    ds_read_b128 a[128:131], v14 offset:0
    s_waitcnt lgkmcnt(5)
    v_mfma_f32_32x32x16_bf16 v[240:255], a[140:143], v[220:223], v[240:255]
    v_xor_b32 v15, 32928, v7
    ds_read_b128 a[132:135], v15 offset:0
    s_waitcnt lgkmcnt(5)
    v_mfma_f32_32x32x16_bf16 v[224:239], a[112:115], v[160:163], 0
    v_xor_b32 v16, 32960, v7
    ds_read_b128 a[136:139], v16 offset:0
    buffer_load_dwordx4 v3, s[12:15], s45 offen offset:1024 lds
    s_waitcnt lgkmcnt(5)
    v_mfma_f32_32x32x16_bf16 v[224:239], a[116:119], v[164:167], v[224:239]
    v_xor_b32 v17, 32992, v7
    ds_read_b128 a[140:143], v17 offset:0
    s_waitcnt lgkmcnt(5)
    v_mfma_f32_32x32x16_bf16 v[224:239], a[120:123], v[168:171], v[224:239]
    ds_read_b128 a[112:115], v10 offset:256
    s_waitcnt lgkmcnt(5)
    v_mfma_f32_32x32x16_bf16 v[224:239], a[124:127], v[172:175], v[224:239]
    ds_read_b128 a[116:119], v11 offset:256
    v_max3_f32 v19, v19, v240, v241
    v_cvt_pk_bf16_f32 v56, v240, v241
    s_waitcnt lgkmcnt(5)
    v_mfma_f32_32x32x16_bf16 v[224:239], a[128:131], v[176:179], v[224:239]
    ds_read_b128 a[120:123], v12 offset:256
    v_max3_f32 v19, v19, v242, v243
    v_cvt_pk_bf16_f32 v57, v242, v243
    buffer_load_dwordx4 v4, s[12:15], s45 offen offset:2048 lds
    s_waitcnt lgkmcnt(5)
    v_mfma_f32_32x32x16_bf16 v[224:239], a[132:135], v[180:183], v[224:239]
    ds_read_b128 a[124:127], v13 offset:256
    v_max3_f32 v19, v19, v244, v245
    v_cvt_pk_bf16_f32 v58, v244, v245
    s_waitcnt lgkmcnt(5)
    v_mfma_f32_32x32x16_bf16 v[224:239], a[136:139], v[184:187], v[224:239]
    ds_read_b128 a[128:131], v14 offset:256
    v_max3_f32 v19, v19, v246, v247
    v_cvt_pk_bf16_f32 v59, v246, v247
    s_waitcnt lgkmcnt(5)
    v_mfma_f32_32x32x16_bf16 v[224:239], a[140:143], v[188:191], v[224:239]
    ds_read_b128 a[132:135], v15 offset:256
    v_max3_f32 v19, v19, v248, v249
    v_cvt_pk_bf16_f32 v60, v248, v249
    s_waitcnt lgkmcnt(5)
    v_mfma_f32_32x32x16_bf16 v[224:239], a[112:115], v[192:195], v[224:239]
    ds_read_b128 a[136:139], v16 offset:256
    v_max3_f32 v19, v19, v250, v251
    v_cvt_pk_bf16_f32 v61, v250, v251
    buffer_load_dwordx4 v5, s[12:15], s45 offen offset:3072 lds
    s_waitcnt lgkmcnt(5)
    v_mfma_f32_32x32x16_bf16 v[224:239], a[116:119], v[196:199], v[224:239]
    ds_read_b128 a[140:143], v17 offset:256
    v_max3_f32 v19, v19, v252, v253
    v_cvt_pk_bf16_f32 v62, v252, v253
    s_waitcnt lgkmcnt(5)
    v_mfma_f32_32x32x16_bf16 v[224:239], a[120:123], v[200:203], v[224:239]
    ds_read_b128 a[112:115], v10 offset:16384
    v_max3_f32 v19, v19, v254, v255
    v_cvt_pk_bf16_f32 v63, v254, v255
    s_waitcnt lgkmcnt(5)
    v_mfma_f32_32x32x16_bf16 v[224:239], a[124:127], v[204:207], v[224:239]
    ds_read_b128 a[116:119], v11 offset:16384
    s_waitcnt lgkmcnt(5)
    v_mfma_f32_32x32x16_bf16 v[224:239], a[128:131], v[208:211], v[224:239]
    ds_read_b128 a[120:123], v12 offset:16384
    s_add_u32 m0, s41, 147456
    s_add_u32 s45, s43, 180224
    buffer_load_dwordx4 v2, s[12:15], s45 offen offset:0 lds
    s_waitcnt lgkmcnt(5)
    v_mfma_f32_32x32x16_bf16 v[224:239], a[132:135], v[212:215], v[224:239]
    ds_read_b128 a[124:127], v13 offset:16384
    s_waitcnt lgkmcnt(5)
    v_mfma_f32_32x32x16_bf16 v[224:239], a[136:139], v[216:219], v[224:239]
    ds_read_b128 a[128:131], v14 offset:16384
    s_waitcnt lgkmcnt(5)
    v_mfma_f32_32x32x16_bf16 v[224:239], a[140:143], v[220:223], v[224:239]
    ds_read_b128 a[132:135], v15 offset:16384
    s_waitcnt lgkmcnt(5)
    v_mfma_f32_32x32x16_bf16 v[240:255], a[112:115], v[160:163], 0
    ds_read_b128 a[136:139], v16 offset:16384
    buffer_load_dwordx4 v3, s[12:15], s45 offen offset:1024 lds
    s_waitcnt lgkmcnt(5)
    v_mfma_f32_32x32x16_bf16 v[240:255], a[116:119], v[164:167], v[240:255]
    ds_read_b128 a[140:143], v17 offset:16384
    s_waitcnt lgkmcnt(5)
    v_mfma_f32_32x32x16_bf16 v[240:255], a[120:123], v[168:171], v[240:255]
    ds_read_b128 a[112:115], v10 offset:16640
    s_waitcnt lgkmcnt(5)
    v_mfma_f32_32x32x16_bf16 v[240:255], a[124:127], v[172:175], v[240:255]
    ds_read_b128 a[116:119], v11 offset:16640
    v_max3_f32 v19, v19, v224, v225
    v_cvt_pk_bf16_f32 v64, v224, v225
    s_waitcnt lgkmcnt(5)
    v_mfma_f32_32x32x16_bf16 v[240:255], a[128:131], v[176:179], v[240:255]
    ds_read_b128 a[120:123], v12 offset:16640
    buffer_load_dwordx4 v[28:31], v27, s[88:91], s52 offen
    s_add_u32 s52, s52, 1024
    v_max3_f32 v19, v19, v226, v227
    v_cvt_pk_bf16_f32 v65, v226, v227
    buffer_load_dwordx4 v4, s[12:15], s45 offen offset:2048 lds
    s_waitcnt lgkmcnt(5)
    v_mfma_f32_32x32x16_bf16 v[240:255], a[132:135], v[180:183], v[240:255]
    ds_read_b128 a[124:127], v13 offset:16640
    v_max3_f32 v19, v19, v228, v229
    v_cvt_pk_bf16_f32 v66, v228, v229
    s_waitcnt lgkmcnt(5)
    v_mfma_f32_32x32x16_bf16 v[240:255], a[136:139], v[184:187], v[240:255]
    ds_read_b128 a[128:131], v14 offset:16640
    v_max3_f32 v19, v19, v230, v231
    v_cvt_pk_bf16_f32 v67, v230, v231
    s_waitcnt lgkmcnt(5)
    v_mfma_f32_32x32x16_bf16 v[240:255], a[140:143], v[188:191], v[240:255]
    ds_read_b128 a[132:135], v15 offset:16640
    v_max3_f32 v19, v19, v232, v233
    v_cvt_pk_bf16_f32 v68, v232, v233
    s_waitcnt lgkmcnt(5)
    v_mfma_f32_32x32x16_bf16 v[240:255], a[112:115], v[192:195], v[240:255]
    ds_read_b128 a[136:139], v16 offset:16640
    v_max3_f32 v19, v19, v234, v235
    v_cvt_pk_bf16_f32 v69, v234, v235
    buffer_load_dwordx4 v5, s[12:15], s45 offen offset:3072 lds
    s_waitcnt lgkmcnt(5)
    v_mfma_f32_32x32x16_bf16 v[240:255], a[116:119], v[196:199], v[240:255]
    ds_read_b128 a[140:143], v17 offset:16640
    v_max3_f32 v19, v19, v236, v237
    v_cvt_pk_bf16_f32 v70, v236, v237
    s_waitcnt lgkmcnt(5)
    v_mfma_f32_32x32x16_bf16 v[240:255], a[120:123], v[200:203], v[240:255]
    s_waitcnt vmcnt(18)
    s_barrier
    v_xor_b32 v10, 65536, v7
    ds_read_b128 a[112:115], v10 offset:0
    v_max3_f32 v19, v19, v238, v239
    v_cvt_pk_bf16_f32 v71, v238, v239
    s_waitcnt lgkmcnt(5)
    v_mfma_f32_32x32x16_bf16 v[240:255], a[124:127], v[204:207], v[240:255]
    v_xor_b32 v11, 65568, v7
    ds_read_b128 a[116:119], v11 offset:0
    s_waitcnt lgkmcnt(5)
    v_mfma_f32_32x32x16_bf16 v[240:255], a[128:131], v[208:211], v[240:255]
    v_xor_b32 v12, 65600, v7
    ds_read_b128 a[120:123], v12 offset:0
    s_add_u32 m0, s41, 0
    s_add_u32 s45, s43, 196608
    buffer_load_dwordx4 v2, s[12:15], s45 offen offset:0 lds
    s_waitcnt lgkmcnt(5)
    v_mfma_f32_32x32x16_bf16 v[240:255], a[132:135], v[212:215], v[240:255]
    v_xor_b32 v13, 65632, v7
    ds_read_b128 a[124:127], v13 offset:0
    s_waitcnt lgkmcnt(5)
    v_mfma_f32_32x32x16_bf16 v[240:255], a[136:139], v[216:219], v[240:255]
    v_xor_b32 v14, 65664, v7
    ds_read_b128 a[128:131], v14 offset:0
    s_waitcnt lgkmcnt(5)
    v_mfma_f32_32x32x16_bf16 v[240:255], a[140:143], v[220:223], v[240:255]
    v_xor_b32 v15, 65696, v7
    ds_read_b128 a[132:135], v15 offset:0
    s_waitcnt lgkmcnt(5)
    v_mfma_f32_32x32x16_bf16 v[224:239], a[112:115], v[160:163], 0
    v_xor_b32 v16, 65728, v7
    ds_read_b128 a[136:139], v16 offset:0
    buffer_load_dwordx4 v3, s[12:15], s45 offen offset:1024 lds
    s_waitcnt lgkmcnt(5)
    v_mfma_f32_32x32x16_bf16 v[224:239], a[116:119], v[164:167], v[224:239]
    v_xor_b32 v17, 65760, v7
    ds_read_b128 a[140:143], v17 offset:0
    s_waitcnt lgkmcnt(5)
    v_mfma_f32_32x32x16_bf16 v[224:239], a[120:123], v[168:171], v[224:239]
    ds_read_b128 a[112:115], v10 offset:256
    s_waitcnt lgkmcnt(5)
    v_mfma_f32_32x32x16_bf16 v[224:239], a[124:127], v[172:175], v[224:239]
    ds_read_b128 a[116:119], v11 offset:256
    v_max3_f32 v19, v19, v240, v241
    v_cvt_pk_bf16_f32 v72, v240, v241
    s_waitcnt lgkmcnt(5)
    v_mfma_f32_32x32x16_bf16 v[224:239], a[128:131], v[176:179], v[224:239]
    ds_read_b128 a[120:123], v12 offset:256
    v_max3_f32 v19, v19, v242, v243
    v_cvt_pk_bf16_f32 v73, v242, v243
    buffer_load_dwordx4 v4, s[12:15], s45 offen offset:2048 lds
    s_waitcnt lgkmcnt(5)
    v_mfma_f32_32x32x16_bf16 v[224:239], a[132:135], v[180:183], v[224:239]
    ds_read_b128 a[124:127], v13 offset:256
    v_max3_f32 v19, v19, v244, v245
    v_cvt_pk_bf16_f32 v74, v244, v245
    s_waitcnt lgkmcnt(5)
    v_mfma_f32_32x32x16_bf16 v[224:239], a[136:139], v[184:187], v[224:239]
    ds_read_b128 a[128:131], v14 offset:256
    v_max3_f32 v19, v19, v246, v247
    v_cvt_pk_bf16_f32 v75, v246, v247
    s_waitcnt lgkmcnt(5)
    v_mfma_f32_32x32x16_bf16 v[224:239], a[140:143], v[188:191], v[224:239]
    ds_read_b128 a[132:135], v15 offset:256
    v_max3_f32 v19, v19, v248, v249
    v_cvt_pk_bf16_f32 v76, v248, v249
    s_waitcnt lgkmcnt(5)
    v_mfma_f32_32x32x16_bf16 v[224:239], a[112:115], v[192:195], v[224:239]
    ds_read_b128 a[136:139], v16 offset:256
    v_max3_f32 v19, v19, v250, v251
    v_cvt_pk_bf16_f32 v77, v250, v251
    buffer_load_dwordx4 v5, s[12:15], s45 offen offset:3072 lds
    s_waitcnt lgkmcnt(5)
    v_mfma_f32_32x32x16_bf16 v[224:239], a[116:119], v[196:199], v[224:239]
    ds_read_b128 a[140:143], v17 offset:256
    v_max3_f32 v19, v19, v252, v253
    v_cvt_pk_bf16_f32 v78, v252, v253
    s_waitcnt lgkmcnt(5)
    v_mfma_f32_32x32x16_bf16 v[224:239], a[120:123], v[200:203], v[224:239]
    ds_read_b128 a[112:115], v10 offset:16384
    v_max3_f32 v19, v19, v254, v255
    v_cvt_pk_bf16_f32 v79, v254, v255
    s_waitcnt lgkmcnt(5)
    v_mfma_f32_32x32x16_bf16 v[224:239], a[124:127], v[204:207], v[224:239]
    ds_read_b128 a[116:119], v11 offset:16384
    s_waitcnt lgkmcnt(5)
    v_mfma_f32_32x32x16_bf16 v[224:239], a[128:131], v[208:211], v[224:239]
    ds_read_b128 a[120:123], v12 offset:16384
    s_add_u32 m0, s41, 16384
    s_add_u32 s45, s43, 212992
    buffer_load_dwordx4 v2, s[12:15], s45 offen offset:0 lds
    s_waitcnt lgkmcnt(5)
    v_mfma_f32_32x32x16_bf16 v[224:239], a[132:135], v[212:215], v[224:239]
    ds_read_b128 a[124:127], v13 offset:16384
    s_waitcnt lgkmcnt(5)
    v_mfma_f32_32x32x16_bf16 v[224:239], a[136:139], v[216:219], v[224:239]
    ds_read_b128 a[128:131], v14 offset:16384
    s_waitcnt lgkmcnt(5)
    v_mfma_f32_32x32x16_bf16 v[224:239], a[140:143], v[220:223], v[224:239]
    ds_read_b128 a[132:135], v15 offset:16384
    s_waitcnt lgkmcnt(5)
    v_mfma_f32_32x32x16_bf16 v[240:255], a[112:115], v[160:163], 0
    ds_read_b128 a[136:139], v16 offset:16384
    buffer_load_dwordx4 v3, s[12:15], s45 offen offset:1024 lds
    s_waitcnt lgkmcnt(5)
    v_mfma_f32_32x32x16_bf16 v[240:255], a[116:119], v[164:167], v[240:255]
    ds_read_b128 a[140:143], v17 offset:16384
    s_waitcnt lgkmcnt(5)
    v_mfma_f32_32x32x16_bf16 v[240:255], a[120:123], v[168:171], v[240:255]
    ds_read_b128 a[112:115], v10 offset:16640
    s_waitcnt lgkmcnt(5)
    v_mfma_f32_32x32x16_bf16 v[240:255], a[124:127], v[172:175], v[240:255]
    ds_read_b128 a[116:119], v11 offset:16640
    v_max3_f32 v19, v19, v224, v225
    v_cvt_pk_bf16_f32 v80, v224, v225
    s_waitcnt lgkmcnt(5)
    v_mfma_f32_32x32x16_bf16 v[240:255], a[128:131], v[176:179], v[240:255]
    ds_read_b128 a[120:123], v12 offset:16640
    buffer_load_dwordx4 v[28:31], v27, s[88:91], s52 offen
    s_add_u32 s52, s52, 1024
    v_max3_f32 v19, v19, v226, v227
    v_cvt_pk_bf16_f32 v81, v226, v227
    buffer_load_dwordx4 v4, s[12:15], s45 offen offset:2048 lds
    s_waitcnt lgkmcnt(5)
    v_mfma_f32_32x32x16_bf16 v[240:255], a[132:135], v[180:183], v[240:255]
    ds_read_b128 a[124:127], v13 offset:16640
    v_max3_f32 v19, v19, v228, v229
    v_cvt_pk_bf16_f32 v82, v228, v229
    s_waitcnt lgkmcnt(5)
    v_mfma_f32_32x32x16_bf16 v[240:255], a[136:139], v[184:187], v[240:255]
    ds_read_b128 a[128:131], v14 offset:16640
    v_max3_f32 v19, v19, v230, v231
    v_cvt_pk_bf16_f32 v83, v230, v231
    s_waitcnt lgkmcnt(5)
    v_mfma_f32_32x32x16_bf16 v[240:255], a[140:143], v[188:191], v[240:255]
    ds_read_b128 a[132:135], v15 offset:16640
    v_max3_f32 v19, v19, v232, v233
    v_cvt_pk_bf16_f32 v84, v232, v233
    s_waitcnt lgkmcnt(5)
    v_mfma_f32_32x32x16_bf16 v[240:255], a[112:115], v[192:195], v[240:255]
    ds_read_b128 a[136:139], v16 offset:16640
    v_max3_f32 v19, v19, v234, v235
    v_cvt_pk_bf16_f32 v85, v234, v235
    buffer_load_dwordx4 v5, s[12:15], s45 offen offset:3072 lds
    s_waitcnt lgkmcnt(5)
    v_mfma_f32_32x32x16_bf16 v[240:255], a[116:119], v[196:199], v[240:255]
    ds_read_b128 a[140:143], v17 offset:16640
    v_max3_f32 v19, v19, v236, v237
    v_cvt_pk_bf16_f32 v86, v236, v237
    s_waitcnt lgkmcnt(5)
    v_mfma_f32_32x32x16_bf16 v[240:255], a[120:123], v[200:203], v[240:255]
    s_waitcnt vmcnt(18)
    s_barrier
    v_xor_b32 v10, 98304, v7
    ds_read_b128 a[112:115], v10 offset:0
    v_max3_f32 v19, v19, v238, v239
    v_cvt_pk_bf16_f32 v87, v238, v239
    s_waitcnt lgkmcnt(5)
    v_mfma_f32_32x32x16_bf16 v[240:255], a[124:127], v[204:207], v[240:255]
    v_xor_b32 v11, 98336, v7
    ds_read_b128 a[116:119], v11 offset:0
    s_waitcnt lgkmcnt(5)
    v_mfma_f32_32x32x16_bf16 v[240:255], a[128:131], v[208:211], v[240:255]
    v_xor_b32 v12, 98368, v7
    ds_read_b128 a[120:123], v12 offset:0
    s_add_u32 m0, s41, 32768
    s_add_u32 s45, s43, 229376
    buffer_load_dwordx4 v2, s[12:15], s45 offen offset:0 lds
    s_waitcnt lgkmcnt(5)
    v_mfma_f32_32x32x16_bf16 v[240:255], a[132:135], v[212:215], v[240:255]
    v_xor_b32 v13, 98400, v7
    ds_read_b128 a[124:127], v13 offset:0
    s_waitcnt lgkmcnt(5)
    v_mfma_f32_32x32x16_bf16 v[240:255], a[136:139], v[216:219], v[240:255]
    v_xor_b32 v14, 98432, v7
    ds_read_b128 a[128:131], v14 offset:0
    s_waitcnt lgkmcnt(5)
    v_mfma_f32_32x32x16_bf16 v[240:255], a[140:143], v[220:223], v[240:255]
    v_xor_b32 v15, 98464, v7
    ds_read_b128 a[132:135], v15 offset:0
    s_waitcnt lgkmcnt(5)
    v_mfma_f32_32x32x16_bf16 v[224:239], a[112:115], v[160:163], 0
    v_xor_b32 v16, 98496, v7
    ds_read_b128 a[136:139], v16 offset:0
    buffer_load_dwordx4 v3, s[12:15], s45 offen offset:1024 lds
    s_waitcnt lgkmcnt(5)
    v_mfma_f32_32x32x16_bf16 v[224:239], a[116:119], v[164:167], v[224:239]
    v_xor_b32 v17, 98528, v7
    ds_read_b128 a[140:143], v17 offset:0
    s_waitcnt lgkmcnt(5)
    v_mfma_f32_32x32x16_bf16 v[224:239], a[120:123], v[168:171], v[224:239]
    ds_read_b128 a[112:115], v10 offset:256
    s_waitcnt lgkmcnt(5)
    v_mfma_f32_32x32x16_bf16 v[224:239], a[124:127], v[172:175], v[224:239]
    ds_read_b128 a[116:119], v11 offset:256
    v_max3_f32 v19, v19, v240, v241
    v_cvt_pk_bf16_f32 v88, v240, v241
    s_waitcnt lgkmcnt(5)
    v_mfma_f32_32x32x16_bf16 v[224:239], a[128:131], v[176:179], v[224:239]
    ds_read_b128 a[120:123], v12 offset:256
    v_max3_f32 v19, v19, v242, v243
    v_cvt_pk_bf16_f32 v89, v242, v243
    buffer_load_dwordx4 v4, s[12:15], s45 offen offset:2048 lds
    s_waitcnt lgkmcnt(5)
    v_mfma_f32_32x32x16_bf16 v[224:239], a[132:135], v[180:183], v[224:239]
    ds_read_b128 a[124:127], v13 offset:256
    v_max3_f32 v19, v19, v244, v245
    v_cvt_pk_bf16_f32 v90, v244, v245
    s_waitcnt lgkmcnt(5)
    v_mfma_f32_32x32x16_bf16 v[224:239], a[136:139], v[184:187], v[224:239]
    ds_read_b128 a[128:131], v14 offset:256
    v_max3_f32 v19, v19, v246, v247
    v_cvt_pk_bf16_f32 v91, v246, v247
    s_waitcnt lgkmcnt(5)
    v_mfma_f32_32x32x16_bf16 v[224:239], a[140:143], v[188:191], v[224:239]
    ds_read_b128 a[132:135], v15 offset:256
    v_max3_f32 v19, v19, v248, v249
    v_cvt_pk_bf16_f32 v92, v248, v249
    s_waitcnt lgkmcnt(5)
    v_mfma_f32_32x32x16_bf16 v[224:239], a[112:115], v[192:195], v[224:239]
    ds_read_b128 a[136:139], v16 offset:256
    v_max3_f32 v19, v19, v250, v251
    v_cvt_pk_bf16_f32 v93, v250, v251
    buffer_load_dwordx4 v5, s[12:15], s45 offen offset:3072 lds
    s_waitcnt lgkmcnt(5)
    v_mfma_f32_32x32x16_bf16 v[224:239], a[116:119], v[196:199], v[224:239]
    ds_read_b128 a[140:143], v17 offset:256
    v_max3_f32 v19, v19, v252, v253
    v_cvt_pk_bf16_f32 v94, v252, v253
    s_waitcnt lgkmcnt(5)
    v_mfma_f32_32x32x16_bf16 v[224:239], a[120:123], v[200:203], v[224:239]
    ds_read_b128 a[112:115], v10 offset:16384
    v_max3_f32 v19, v19, v254, v255
    v_cvt_pk_bf16_f32 v95, v254, v255
    s_waitcnt lgkmcnt(5)
    v_mfma_f32_32x32x16_bf16 v[224:239], a[124:127], v[204:207], v[224:239]
    ds_read_b128 a[116:119], v11 offset:16384
    s_waitcnt lgkmcnt(5)
    v_mfma_f32_32x32x16_bf16 v[224:239], a[128:131], v[208:211], v[224:239]
    ds_read_b128 a[120:123], v12 offset:16384
    s_add_u32 m0, s41, 49152
    s_add_u32 s45, s43, 245760
    buffer_load_dwordx4 v2, s[12:15], s45 offen offset:0 lds
    s_waitcnt lgkmcnt(5)
    v_mfma_f32_32x32x16_bf16 v[224:239], a[132:135], v[212:215], v[224:239]
    ds_read_b128 a[124:127], v13 offset:16384
    s_waitcnt lgkmcnt(5)
    v_mfma_f32_32x32x16_bf16 v[224:239], a[136:139], v[216:219], v[224:239]
    ds_read_b128 a[128:131], v14 offset:16384
    s_waitcnt lgkmcnt(5)
    v_mfma_f32_32x32x16_bf16 v[224:239], a[140:143], v[220:223], v[224:239]
    ds_read_b128 a[132:135], v15 offset:16384
    s_waitcnt lgkmcnt(5)
    v_mfma_f32_32x32x16_bf16 v[240:255], a[112:115], v[160:163], 0
    ds_read_b128 a[136:139], v16 offset:16384
    buffer_load_dwordx4 v3, s[12:15], s45 offen offset:1024 lds
    s_waitcnt lgkmcnt(5)
    v_mfma_f32_32x32x16_bf16 v[240:255], a[116:119], v[164:167], v[240:255]
    ds_read_b128 a[140:143], v17 offset:16384
    s_waitcnt lgkmcnt(5)
    v_mfma_f32_32x32x16_bf16 v[240:255], a[120:123], v[168:171], v[240:255]
    ds_read_b128 a[112:115], v10 offset:16640
    s_waitcnt lgkmcnt(5)
    v_mfma_f32_32x32x16_bf16 v[240:255], a[124:127], v[172:175], v[240:255]
    ds_read_b128 a[116:119], v11 offset:16640
    s_mov_b32 s88, s98
    s_mov_b32 s89, s99
    s_mov_b32 s90, 8388608
    s_mov_b32 s91, 0x20000
    s_lshl_b32 s5, s2, 2
    s_add_u32 s5, s5, s48
    s_mul_i32 s52, s5, 8192
    v_lshlrev_b32 v27, 4, v1
    v_max3_f32 v19, v19, v224, v225
    v_cvt_pk_bf16_f32 v96, v224, v225
    s_waitcnt lgkmcnt(5)
    v_mfma_f32_32x32x16_bf16 v[240:255], a[128:131], v[176:179], v[240:255]
    ds_read_b128 a[120:123], v12 offset:16640
    buffer_load_dwordx4 v[28:31], v27, s[88:91], s52 offen
    s_add_u32 s52, s52, 1024
    v_max3_f32 v19, v19, v226, v227
    v_cvt_pk_bf16_f32 v97, v226, v227
    buffer_load_dwordx4 v4, s[12:15], s45 offen offset:2048 lds
    s_waitcnt lgkmcnt(5)
    v_mfma_f32_32x32x16_bf16 v[240:255], a[132:135], v[180:183], v[240:255]
    ds_read_b128 a[124:127], v13 offset:16640
    v_max3_f32 v19, v19, v228, v229
    v_cvt_pk_bf16_f32 v98, v228, v229
    s_waitcnt lgkmcnt(5)
    v_mfma_f32_32x32x16_bf16 v[240:255], a[136:139], v[184:187], v[240:255]
    ds_read_b128 a[128:131], v14 offset:16640
    v_max3_f32 v19, v19, v230, v231
    v_cvt_pk_bf16_f32 v99, v230, v231
    s_waitcnt lgkmcnt(5)
    v_mfma_f32_32x32x16_bf16 v[240:255], a[140:143], v[188:191], v[240:255]
    ds_read_b128 a[132:135], v15 offset:16640
    v_max3_f32 v19, v19, v232, v233
    v_cvt_pk_bf16_f32 v100, v232, v233
    s_waitcnt lgkmcnt(5)
    v_mfma_f32_32x32x16_bf16 v[240:255], a[112:115], v[192:195], v[240:255]
    ds_read_b128 a[136:139], v16 offset:16640
    v_max3_f32 v19, v19, v234, v235
    v_cvt_pk_bf16_f32 v101, v234, v235
    buffer_load_dwordx4 v5, s[12:15], s45 offen offset:3072 lds
    s_waitcnt lgkmcnt(5)
    v_mfma_f32_32x32x16_bf16 v[240:255], a[116:119], v[196:199], v[240:255]
    ds_read_b128 a[140:143], v17 offset:16640
    v_max3_f32 v19, v19, v236, v237
    v_cvt_pk_bf16_f32 v102, v236, v237
    s_waitcnt lgkmcnt(5)
    v_mfma_f32_32x32x16_bf16 v[240:255], a[120:123], v[200:203], v[240:255]
    s_waitcnt vmcnt(18)
    s_barrier
    v_xor_b32 v10, 131072, v7
    ds_read_b128 a[112:115], v10 offset:0
    v_max3_f32 v19, v19, v238, v239
    v_cvt_pk_bf16_f32 v103, v238, v239
    s_waitcnt lgkmcnt(5)
    v_mfma_f32_32x32x16_bf16 v[240:255], a[124:127], v[204:207], v[240:255]
    v_xor_b32 v11, 131104, v7
    ds_read_b128 a[116:119], v11 offset:0
    s_waitcnt lgkmcnt(5)
    v_mfma_f32_32x32x16_bf16 v[240:255], a[128:131], v[208:211], v[240:255]
    v_xor_b32 v12, 131136, v7
    ds_read_b128 a[120:123], v12 offset:0
    v_accvgpr_read_b32 v2, a177
    v_xor_b32 v3, 128, v2
    s_add_u32 m0, s41, 65536
    s_add_u32 s45, s43, 0
    buffer_load_dwordx4 v2, s[16:19], s45 offen offset:0 lds
    s_waitcnt lgkmcnt(5)
    v_mfma_f32_32x32x16_bf16 v[240:255], a[132:135], v[212:215], v[240:255]
    v_xor_b32 v13, 131168, v7
    ds_read_b128 a[124:127], v13 offset:0
    s_waitcnt lgkmcnt(5)
    v_mfma_f32_32x32x16_bf16 v[240:255], a[136:139], v[216:219], v[240:255]
    v_xor_b32 v14, 131200, v7
    ds_read_b128 a[128:131], v14 offset:0
    s_waitcnt lgkmcnt(5)
    v_mfma_f32_32x32x16_bf16 v[240:255], a[140:143], v[220:223], v[240:255]
    v_xor_b32 v15, 131232, v7
    ds_read_b128 a[132:135], v15 offset:0
    s_waitcnt lgkmcnt(5)
    v_mfma_f32_32x32x16_bf16 v[224:239], a[112:115], v[160:163], 0
    v_xor_b32 v16, 131264, v7
    ds_read_b128 a[136:139], v16 offset:0
    buffer_load_dwordx4 v3, s[16:19], s45 offen offset:1024 lds
    s_waitcnt lgkmcnt(5)
    v_mfma_f32_32x32x16_bf16 v[224:239], a[116:119], v[164:167], v[224:239]
    v_xor_b32 v17, 131296, v7
    ds_read_b128 a[140:143], v17 offset:0
    s_waitcnt lgkmcnt(5)
    v_mfma_f32_32x32x16_bf16 v[224:239], a[120:123], v[168:171], v[224:239]
    ds_read_b128 a[112:115], v10 offset:256
    s_waitcnt lgkmcnt(5)
    v_mfma_f32_32x32x16_bf16 v[224:239], a[124:127], v[172:175], v[224:239]
    ds_read_b128 a[116:119], v11 offset:256
    v_max3_f32 v19, v19, v240, v241
    v_cvt_pk_bf16_f32 v104, v240, v241
    s_waitcnt lgkmcnt(5)
    v_mfma_f32_32x32x16_bf16 v[224:239], a[128:131], v[176:179], v[224:239]
    ds_read_b128 a[120:123], v12 offset:256
    v_max3_f32 v19, v19, v242, v243
    v_cvt_pk_bf16_f32 v105, v242, v243
    buffer_load_dwordx4 v2, s[16:19], s45 offen offset:2048 lds
    s_waitcnt lgkmcnt(5)
    v_mfma_f32_32x32x16_bf16 v[224:239], a[132:135], v[180:183], v[224:239]
    ds_read_b128 a[124:127], v13 offset:256
    v_max3_f32 v19, v19, v244, v245
    v_cvt_pk_bf16_f32 v106, v244, v245
    s_waitcnt lgkmcnt(5)
    v_mfma_f32_32x32x16_bf16 v[224:239], a[136:139], v[184:187], v[224:239]
    ds_read_b128 a[128:131], v14 offset:256
    v_max3_f32 v19, v19, v246, v247
    v_cvt_pk_bf16_f32 v107, v246, v247
    s_waitcnt lgkmcnt(5)
    v_mfma_f32_32x32x16_bf16 v[224:239], a[140:143], v[188:191], v[224:239]
    ds_read_b128 a[132:135], v15 offset:256
    v_max3_f32 v19, v19, v248, v249
    v_cvt_pk_bf16_f32 v108, v248, v249
    s_waitcnt lgkmcnt(5)
    v_mfma_f32_32x32x16_bf16 v[224:239], a[112:115], v[192:195], v[224:239]
    ds_read_b128 a[136:139], v16 offset:256
    v_max3_f32 v19, v19, v250, v251
    v_cvt_pk_bf16_f32 v109, v250, v251
    buffer_load_dwordx4 v3, s[16:19], s45 offen offset:3072 lds
    s_waitcnt lgkmcnt(5)
    v_mfma_f32_32x32x16_bf16 v[224:239], a[116:119], v[196:199], v[224:239]
    ds_read_b128 a[140:143], v17 offset:256
    v_max3_f32 v19, v19, v252, v253
    v_cvt_pk_bf16_f32 v110, v252, v253
    s_waitcnt lgkmcnt(5)
    v_mfma_f32_32x32x16_bf16 v[224:239], a[120:123], v[200:203], v[224:239]
    ds_read_b128 a[112:115], v10 offset:16384
    v_max3_f32 v19, v19, v254, v255
    v_cvt_pk_bf16_f32 v111, v254, v255
    s_waitcnt lgkmcnt(5)
    v_mfma_f32_32x32x16_bf16 v[224:239], a[124:127], v[204:207], v[224:239]
    ds_read_b128 a[116:119], v11 offset:16384
    s_waitcnt lgkmcnt(5)
    v_mfma_f32_32x32x16_bf16 v[224:239], a[128:131], v[208:211], v[224:239]
    ds_read_b128 a[120:123], v12 offset:16384
    s_add_u32 m0, s41, 81920
    s_add_u32 s45, s43, 16384
    buffer_load_dwordx4 v2, s[16:19], s45 offen offset:0 lds
    s_waitcnt lgkmcnt(5)
    v_mfma_f32_32x32x16_bf16 v[224:239], a[132:135], v[212:215], v[224:239]
    ds_read_b128 a[124:127], v13 offset:16384
    s_waitcnt lgkmcnt(5)
    v_mfma_f32_32x32x16_bf16 v[224:239], a[136:139], v[216:219], v[224:239]
    ds_read_b128 a[128:131], v14 offset:16384
    s_waitcnt lgkmcnt(5)
    v_mfma_f32_32x32x16_bf16 v[224:239], a[140:143], v[220:223], v[224:239]
    ds_read_b128 a[132:135], v15 offset:16384
    s_waitcnt lgkmcnt(5)
    v_mfma_f32_32x32x16_bf16 v[240:255], a[112:115], v[160:163], 0
    ds_read_b128 a[136:139], v16 offset:16384
    buffer_load_dwordx4 v3, s[16:19], s45 offen offset:1024 lds
    s_waitcnt lgkmcnt(5)
    v_mfma_f32_32x32x16_bf16 v[240:255], a[116:119], v[164:167], v[240:255]
    ds_read_b128 a[140:143], v17 offset:16384
    s_waitcnt lgkmcnt(5)
    v_mfma_f32_32x32x16_bf16 v[240:255], a[120:123], v[168:171], v[240:255]
    ds_read_b128 a[112:115], v10 offset:16640
    s_waitcnt lgkmcnt(5)
    v_mfma_f32_32x32x16_bf16 v[240:255], a[124:127], v[172:175], v[240:255]
    ds_read_b128 a[116:119], v11 offset:16640
    v_max3_f32 v19, v19, v224, v225
    v_cvt_pk_bf16_f32 v112, v224, v225
    s_waitcnt lgkmcnt(5)
    v_mfma_f32_32x32x16_bf16 v[240:255], a[128:131], v[176:179], v[240:255]
    ds_read_b128 a[120:123], v12 offset:16640
    buffer_load_dwordx4 v[28:31], v27, s[88:91], s52 offen
    s_add_u32 s52, s52, 1024
    v_max3_f32 v19, v19, v226, v227
    v_cvt_pk_bf16_f32 v113, v226, v227
    buffer_load_dwordx4 v2, s[16:19], s45 offen offset:2048 lds
    s_waitcnt lgkmcnt(5)
    v_mfma_f32_32x32x16_bf16 v[240:255], a[132:135], v[180:183], v[240:255]
    ds_read_b128 a[124:127], v13 offset:16640
    v_max3_f32 v19, v19, v228, v229
    v_cvt_pk_bf16_f32 v114, v228, v229
    s_waitcnt lgkmcnt(5)
    v_mfma_f32_32x32x16_bf16 v[240:255], a[136:139], v[184:187], v[240:255]
    ds_read_b128 a[128:131], v14 offset:16640
    v_max3_f32 v19, v19, v230, v231
    v_cvt_pk_bf16_f32 v115, v230, v231
    s_waitcnt lgkmcnt(5)
    v_mfma_f32_32x32x16_bf16 v[240:255], a[140:143], v[188:191], v[240:255]
    ds_read_b128 a[132:135], v15 offset:16640
    v_max3_f32 v19, v19, v232, v233
    v_cvt_pk_bf16_f32 v116, v232, v233
    s_waitcnt lgkmcnt(5)
    v_mfma_f32_32x32x16_bf16 v[240:255], a[112:115], v[192:195], v[240:255]
    ds_read_b128 a[136:139], v16 offset:16640
    v_max3_f32 v19, v19, v234, v235
    v_cvt_pk_bf16_f32 v117, v234, v235
    buffer_load_dwordx4 v3, s[16:19], s45 offen offset:3072 lds
    s_waitcnt lgkmcnt(5)
    v_mfma_f32_32x32x16_bf16 v[240:255], a[116:119], v[196:199], v[240:255]
    ds_read_b128 a[140:143], v17 offset:16640
    v_max3_f32 v19, v19, v236, v237
    v_cvt_pk_bf16_f32 v118, v236, v237
    s_waitcnt lgkmcnt(5)
    v_mfma_f32_32x32x16_bf16 v[240:255], a[120:123], v[200:203], v[240:255]
    s_waitcnt vmcnt(18)
    s_barrier
    v_xor_b32 v10, 0, v7
    ds_read_b128 a[112:115], v10 offset:0
    v_max3_f32 v19, v19, v238, v239
    v_cvt_pk_bf16_f32 v119, v238, v239
    s_waitcnt lgkmcnt(5)
    v_mfma_f32_32x32x16_bf16 v[240:255], a[124:127], v[204:207], v[240:255]
    v_xor_b32 v11, 32, v7
    ds_read_b128 a[116:119], v11 offset:0
    s_waitcnt lgkmcnt(5)
    v_mfma_f32_32x32x16_bf16 v[240:255], a[128:131], v[208:211], v[240:255]
    v_xor_b32 v12, 64, v7
    ds_read_b128 a[120:123], v12 offset:0
    s_add_u32 m0, s41, 98304
    s_add_u32 s45, s43, 32768
    buffer_load_dwordx4 v2, s[16:19], s45 offen offset:0 lds
    s_waitcnt lgkmcnt(5)
    v_mfma_f32_32x32x16_bf16 v[240:255], a[132:135], v[212:215], v[240:255]
    v_xor_b32 v13, 96, v7
    ds_read_b128 a[124:127], v13 offset:0
    s_waitcnt lgkmcnt(5)
    v_mfma_f32_32x32x16_bf16 v[240:255], a[136:139], v[216:219], v[240:255]
    v_xor_b32 v14, 128, v7
    ds_read_b128 a[128:131], v14 offset:0
    s_waitcnt lgkmcnt(5)
    v_mfma_f32_32x32x16_bf16 v[240:255], a[140:143], v[220:223], v[240:255]
    v_xor_b32 v15, 160, v7
    ds_read_b128 a[132:135], v15 offset:0
    s_waitcnt lgkmcnt(5)
    v_mfma_f32_32x32x16_bf16 v[224:239], a[112:115], v[160:163], 0
    v_xor_b32 v16, 192, v7
    ds_read_b128 a[136:139], v16 offset:0
    buffer_load_dwordx4 v3, s[16:19], s45 offen offset:1024 lds
    s_waitcnt lgkmcnt(5)
    v_mfma_f32_32x32x16_bf16 v[224:239], a[116:119], v[164:167], v[224:239]
    v_xor_b32 v17, 224, v7
    ds_read_b128 a[140:143], v17 offset:0
    s_waitcnt lgkmcnt(5)
    v_mfma_f32_32x32x16_bf16 v[224:239], a[120:123], v[168:171], v[224:239]
    ds_read_b128 a[112:115], v10 offset:256
    s_waitcnt lgkmcnt(5)
    v_mfma_f32_32x32x16_bf16 v[224:239], a[124:127], v[172:175], v[224:239]
    ds_read_b128 a[116:119], v11 offset:256
    v_max3_f32 v19, v19, v240, v241
    v_cvt_pk_bf16_f32 v120, v240, v241
    s_waitcnt lgkmcnt(5)
    v_mfma_f32_32x32x16_bf16 v[224:239], a[128:131], v[176:179], v[224:239]
    ds_read_b128 a[120:123], v12 offset:256
    v_max3_f32 v19, v19, v242, v243
    v_cvt_pk_bf16_f32 v121, v242, v243
    buffer_load_dwordx4 v2, s[16:19], s45 offen offset:2048 lds
    s_waitcnt lgkmcnt(5)
    v_mfma_f32_32x32x16_bf16 v[224:239], a[132:135], v[180:183], v[224:239]
    ds_read_b128 a[124:127], v13 offset:256
    v_max3_f32 v19, v19, v244, v245
    v_cvt_pk_bf16_f32 v122, v244, v245
    s_waitcnt lgkmcnt(5)
    v_mfma_f32_32x32x16_bf16 v[224:239], a[136:139], v[184:187], v[224:239]
    ds_read_b128 a[128:131], v14 offset:256
    v_max3_f32 v19, v19, v246, v247
    v_cvt_pk_bf16_f32 v123, v246, v247
    s_waitcnt lgkmcnt(5)
    v_mfma_f32_32x32x16_bf16 v[224:239], a[140:143], v[188:191], v[224:239]
    ds_read_b128 a[132:135], v15 offset:256
    v_max3_f32 v19, v19, v248, v249
    v_cvt_pk_bf16_f32 v124, v248, v249
    s_waitcnt lgkmcnt(5)
    v_mfma_f32_32x32x16_bf16 v[224:239], a[112:115], v[192:195], v[224:239]
    ds_read_b128 a[136:139], v16 offset:256
    v_max3_f32 v19, v19, v250, v251
    v_cvt_pk_bf16_f32 v125, v250, v251
    buffer_load_dwordx4 v3, s[16:19], s45 offen offset:3072 lds
    s_waitcnt lgkmcnt(5)
    v_mfma_f32_32x32x16_bf16 v[224:239], a[116:119], v[196:199], v[224:239]
    ds_read_b128 a[140:143], v17 offset:256
    v_max3_f32 v19, v19, v252, v253
    v_cvt_pk_bf16_f32 v126, v252, v253
    s_waitcnt lgkmcnt(5)
    v_mfma_f32_32x32x16_bf16 v[224:239], a[120:123], v[200:203], v[224:239]
    ds_read_b128 a[112:115], v10 offset:16384
    v_max3_f32 v19, v19, v254, v255
    v_cvt_pk_bf16_f32 v127, v254, v255
    s_waitcnt lgkmcnt(5)
    v_mfma_f32_32x32x16_bf16 v[224:239], a[124:127], v[204:207], v[224:239]
    ds_read_b128 a[116:119], v11 offset:16384
    s_waitcnt lgkmcnt(5)
    v_mfma_f32_32x32x16_bf16 v[224:239], a[128:131], v[208:211], v[224:239]
    ds_read_b128 a[120:123], v12 offset:16384
    s_add_u32 m0, s41, 114688
    s_add_u32 s45, s43, 49152
    buffer_load_dwordx4 v2, s[16:19], s45 offen offset:0 lds
    s_waitcnt lgkmcnt(5)
    v_mfma_f32_32x32x16_bf16 v[224:239], a[132:135], v[212:215], v[224:239]
    ds_read_b128 a[124:127], v13 offset:16384
    s_waitcnt lgkmcnt(5)
    v_mfma_f32_32x32x16_bf16 v[224:239], a[136:139], v[216:219], v[224:239]
    ds_read_b128 a[128:131], v14 offset:16384
    s_waitcnt lgkmcnt(5)
    v_mfma_f32_32x32x16_bf16 v[224:239], a[140:143], v[220:223], v[224:239]
    ds_read_b128 a[132:135], v15 offset:16384
    s_waitcnt lgkmcnt(5)
    v_mfma_f32_32x32x16_bf16 v[240:255], a[112:115], v[160:163], 0
    ds_read_b128 a[136:139], v16 offset:16384
    buffer_load_dwordx4 v3, s[16:19], s45 offen offset:1024 lds
    s_waitcnt lgkmcnt(5)
    v_mfma_f32_32x32x16_bf16 v[240:255], a[116:119], v[164:167], v[240:255]
    ds_read_b128 a[140:143], v17 offset:16384
    s_waitcnt lgkmcnt(5)
    v_mfma_f32_32x32x16_bf16 v[240:255], a[120:123], v[168:171], v[240:255]
    ds_read_b128 a[112:115], v10 offset:16640
    s_waitcnt lgkmcnt(5)
    v_mfma_f32_32x32x16_bf16 v[240:255], a[124:127], v[172:175], v[240:255]
    ds_read_b128 a[116:119], v11 offset:16640
    v_max3_f32 v19, v19, v224, v225
    v_cvt_pk_bf16_f32 v128, v224, v225
    s_waitcnt lgkmcnt(5)
    v_mfma_f32_32x32x16_bf16 v[240:255], a[128:131], v[176:179], v[240:255]
    ds_read_b128 a[120:123], v12 offset:16640
    buffer_load_dwordx4 v[28:31], v27, s[88:91], s52 offen
    s_add_u32 s52, s52, 1024
    v_max3_f32 v19, v19, v226, v227
    v_cvt_pk_bf16_f32 v129, v226, v227
    buffer_load_dwordx4 v2, s[16:19], s45 offen offset:2048 lds
    s_waitcnt lgkmcnt(5)
    v_mfma_f32_32x32x16_bf16 v[240:255], a[132:135], v[180:183], v[240:255]
    ds_read_b128 a[124:127], v13 offset:16640
    v_max3_f32 v19, v19, v228, v229
    v_cvt_pk_bf16_f32 v130, v228, v229
    s_waitcnt lgkmcnt(5)
    v_mfma_f32_32x32x16_bf16 v[240:255], a[136:139], v[184:187], v[240:255]
    ds_read_b128 a[128:131], v14 offset:16640
    v_max3_f32 v19, v19, v230, v231
    v_cvt_pk_bf16_f32 v131, v230, v231
    s_waitcnt lgkmcnt(5)
    v_mfma_f32_32x32x16_bf16 v[240:255], a[140:143], v[188:191], v[240:255]
    ds_read_b128 a[132:135], v15 offset:16640
    v_max3_f32 v19, v19, v232, v233
    v_cvt_pk_bf16_f32 v132, v232, v233
    s_waitcnt lgkmcnt(5)
    v_mfma_f32_32x32x16_bf16 v[240:255], a[112:115], v[192:195], v[240:255]
    ds_read_b128 a[136:139], v16 offset:16640
    v_max3_f32 v19, v19, v234, v235
    v_cvt_pk_bf16_f32 v133, v234, v235
    buffer_load_dwordx4 v3, s[16:19], s45 offen offset:3072 lds
    s_waitcnt lgkmcnt(5)
    v_mfma_f32_32x32x16_bf16 v[240:255], a[116:119], v[196:199], v[240:255]
    ds_read_b128 a[140:143], v17 offset:16640
    v_max3_f32 v19, v19, v236, v237
    v_cvt_pk_bf16_f32 v134, v236, v237
    s_waitcnt lgkmcnt(5)
    v_mfma_f32_32x32x16_bf16 v[240:255], a[120:123], v[200:203], v[240:255]
    s_waitcnt vmcnt(18)
    s_barrier
    v_xor_b32 v10, 32768, v7
    ds_read_b128 a[112:115], v10 offset:0
    v_max3_f32 v19, v19, v238, v239
    v_cvt_pk_bf16_f32 v135, v238, v239
    s_waitcnt lgkmcnt(5)
    v_mfma_f32_32x32x16_bf16 v[240:255], a[124:127], v[204:207], v[240:255]
    v_xor_b32 v11, 32800, v7
    ds_read_b128 a[116:119], v11 offset:0
    s_waitcnt lgkmcnt(5)
    v_mfma_f32_32x32x16_bf16 v[240:255], a[128:131], v[208:211], v[240:255]
    v_xor_b32 v12, 32832, v7
    ds_read_b128 a[120:123], v12 offset:0
    s_add_u32 m0, s41, 131072
    s_add_u32 s45, s43, 65536
    buffer_load_dwordx4 v2, s[16:19], s45 offen offset:0 lds
    s_waitcnt lgkmcnt(5)
    v_mfma_f32_32x32x16_bf16 v[240:255], a[132:135], v[212:215], v[240:255]
    v_xor_b32 v13, 32864, v7
    ds_read_b128 a[124:127], v13 offset:0
    s_waitcnt lgkmcnt(5)
    v_mfma_f32_32x32x16_bf16 v[240:255], a[136:139], v[216:219], v[240:255]
    v_xor_b32 v14, 32896, v7
    ds_read_b128 a[128:131], v14 offset:0
    s_waitcnt lgkmcnt(5)
    v_mfma_f32_32x32x16_bf16 v[240:255], a[140:143], v[220:223], v[240:255]
    v_xor_b32 v15, 32928, v7
    ds_read_b128 a[132:135], v15 offset:0
    s_waitcnt lgkmcnt(5)
    v_mfma_f32_32x32x16_bf16 v[224:239], a[112:115], v[160:163], 0
    v_xor_b32 v16, 32960, v7
    ds_read_b128 a[136:139], v16 offset:0
    buffer_load_dwordx4 v3, s[16:19], s45 offen offset:1024 lds
    s_waitcnt lgkmcnt(5)
    v_mfma_f32_32x32x16_bf16 v[224:239], a[116:119], v[164:167], v[224:239]
    v_xor_b32 v17, 32992, v7
    ds_read_b128 a[140:143], v17 offset:0
    s_waitcnt lgkmcnt(5)
    v_mfma_f32_32x32x16_bf16 v[224:239], a[120:123], v[168:171], v[224:239]
    ds_read_b128 a[112:115], v10 offset:256
    s_waitcnt lgkmcnt(5)
    v_mfma_f32_32x32x16_bf16 v[224:239], a[124:127], v[172:175], v[224:239]
    ds_read_b128 a[116:119], v11 offset:256
    v_max3_f32 v19, v19, v240, v241
    v_cvt_pk_bf16_f32 v136, v240, v241
    s_waitcnt lgkmcnt(5)
    v_mfma_f32_32x32x16_bf16 v[224:239], a[128:131], v[176:179], v[224:239]
    ds_read_b128 a[120:123], v12 offset:256
    v_max3_f32 v19, v19, v242, v243
    v_cvt_pk_bf16_f32 v137, v242, v243
    buffer_load_dwordx4 v2, s[16:19], s45 offen offset:2048 lds
    s_waitcnt lgkmcnt(5)
    v_mfma_f32_32x32x16_bf16 v[224:239], a[132:135], v[180:183], v[224:239]
    ds_read_b128 a[124:127], v13 offset:256
    v_max3_f32 v19, v19, v244, v245
    v_cvt_pk_bf16_f32 v138, v244, v245
    s_waitcnt lgkmcnt(5)
    v_mfma_f32_32x32x16_bf16 v[224:239], a[136:139], v[184:187], v[224:239]
    ds_read_b128 a[128:131], v14 offset:256
    v_max3_f32 v19, v19, v246, v247
    v_cvt_pk_bf16_f32 v139, v246, v247
    s_waitcnt lgkmcnt(5)
    v_mfma_f32_32x32x16_bf16 v[224:239], a[140:143], v[188:191], v[224:239]
    ds_read_b128 a[132:135], v15 offset:256
    v_max3_f32 v19, v19, v248, v249
    v_cvt_pk_bf16_f32 v140, v248, v249
    s_waitcnt lgkmcnt(5)
    v_mfma_f32_32x32x16_bf16 v[224:239], a[112:115], v[192:195], v[224:239]
    ds_read_b128 a[136:139], v16 offset:256
    v_max3_f32 v19, v19, v250, v251
    v_cvt_pk_bf16_f32 v141, v250, v251
    buffer_load_dwordx4 v3, s[16:19], s45 offen offset:3072 lds
    s_waitcnt lgkmcnt(5)
    v_mfma_f32_32x32x16_bf16 v[224:239], a[116:119], v[196:199], v[224:239]
    ds_read_b128 a[140:143], v17 offset:256
    v_max3_f32 v19, v19, v252, v253
    v_cvt_pk_bf16_f32 v142, v252, v253
    s_waitcnt lgkmcnt(5)
    v_mfma_f32_32x32x16_bf16 v[224:239], a[120:123], v[200:203], v[224:239]
    ds_read_b128 a[112:115], v10 offset:16384
    v_max3_f32 v19, v19, v254, v255
    v_cvt_pk_bf16_f32 v143, v254, v255
    s_waitcnt lgkmcnt(5)
    v_mfma_f32_32x32x16_bf16 v[224:239], a[124:127], v[204:207], v[224:239]
    ds_read_b128 a[116:119], v11 offset:16384
    s_waitcnt lgkmcnt(5)
    v_mfma_f32_32x32x16_bf16 v[224:239], a[128:131], v[208:211], v[224:239]
    ds_read_b128 a[120:123], v12 offset:16384
    s_add_u32 m0, s41, 147456
    s_add_u32 s45, s43, 81920
    buffer_load_dwordx4 v2, s[16:19], s45 offen offset:0 lds
    s_waitcnt lgkmcnt(5)
    v_mfma_f32_32x32x16_bf16 v[224:239], a[132:135], v[212:215], v[224:239]
    ds_read_b128 a[124:127], v13 offset:16384
    s_waitcnt lgkmcnt(5)
    v_mfma_f32_32x32x16_bf16 v[224:239], a[136:139], v[216:219], v[224:239]
    ds_read_b128 a[128:131], v14 offset:16384
    s_waitcnt lgkmcnt(5)
    v_mfma_f32_32x32x16_bf16 v[224:239], a[140:143], v[220:223], v[224:239]
    ds_read_b128 a[132:135], v15 offset:16384
    s_waitcnt lgkmcnt(5)
    v_mfma_f32_32x32x16_bf16 v[240:255], a[112:115], v[160:163], 0
    ds_read_b128 a[136:139], v16 offset:16384
    buffer_load_dwordx4 v3, s[16:19], s45 offen offset:1024 lds
    s_waitcnt lgkmcnt(5)
    v_mfma_f32_32x32x16_bf16 v[240:255], a[116:119], v[164:167], v[240:255]
    ds_read_b128 a[140:143], v17 offset:16384
    s_waitcnt lgkmcnt(5)
    v_mfma_f32_32x32x16_bf16 v[240:255], a[120:123], v[168:171], v[240:255]
    ds_read_b128 a[112:115], v10 offset:16640
    s_waitcnt lgkmcnt(5)
    v_mfma_f32_32x32x16_bf16 v[240:255], a[124:127], v[172:175], v[240:255]
    ds_read_b128 a[116:119], v11 offset:16640
    v_max3_f32 v19, v19, v224, v225
    v_cvt_pk_bf16_f32 v144, v224, v225
    s_waitcnt lgkmcnt(5)
    v_mfma_f32_32x32x16_bf16 v[240:255], a[128:131], v[176:179], v[240:255]
    ds_read_b128 a[120:123], v12 offset:16640
    buffer_load_dwordx4 v[28:31], v27, s[88:91], s52 offen
    s_add_u32 s52, s52, 1024
    v_max3_f32 v19, v19, v226, v227
    v_cvt_pk_bf16_f32 v145, v226, v227
    buffer_load_dwordx4 v2, s[16:19], s45 offen offset:2048 lds
    s_waitcnt lgkmcnt(5)
    v_mfma_f32_32x32x16_bf16 v[240:255], a[132:135], v[180:183], v[240:255]
    ds_read_b128 a[124:127], v13 offset:16640
    v_max3_f32 v19, v19, v228, v229
    v_cvt_pk_bf16_f32 v146, v228, v229
    s_waitcnt lgkmcnt(5)
    v_mfma_f32_32x32x16_bf16 v[240:255], a[136:139], v[184:187], v[240:255]
    ds_read_b128 a[128:131], v14 offset:16640
    v_max3_f32 v19, v19, v230, v231
    v_cvt_pk_bf16_f32 v147, v230, v231
    s_waitcnt lgkmcnt(5)
    v_mfma_f32_32x32x16_bf16 v[240:255], a[140:143], v[188:191], v[240:255]
    ds_read_b128 a[132:135], v15 offset:16640
    v_max3_f32 v19, v19, v232, v233
    v_cvt_pk_bf16_f32 v148, v232, v233
    s_waitcnt lgkmcnt(5)
    v_mfma_f32_32x32x16_bf16 v[240:255], a[112:115], v[192:195], v[240:255]
    ds_read_b128 a[136:139], v16 offset:16640
    v_max3_f32 v19, v19, v234, v235
    v_cvt_pk_bf16_f32 v149, v234, v235
    buffer_load_dwordx4 v3, s[16:19], s45 offen offset:3072 lds
    s_waitcnt lgkmcnt(5)
    v_mfma_f32_32x32x16_bf16 v[240:255], a[116:119], v[196:199], v[240:255]
    ds_read_b128 a[140:143], v17 offset:16640
    v_max3_f32 v19, v19, v236, v237
    v_cvt_pk_bf16_f32 v150, v236, v237
    s_waitcnt lgkmcnt(5)
    v_mfma_f32_32x32x16_bf16 v[240:255], a[120:123], v[200:203], v[240:255]
    s_waitcnt vmcnt(18)
    s_barrier
    v_xor_b32 v10, 65536, v8
    ds_read_b64_tr_b16 a[112:113], v10 offset:0
    ds_read_b64_tr_b16 a[114:115], v10 offset:4096
    v_max3_f32 v19, v19, v238, v239
    v_cvt_pk_bf16_f32 v151, v238, v239
    s_waitcnt lgkmcnt(6)
    v_mfma_f32_32x32x16_bf16 v[240:255], a[124:127], v[204:207], v[240:255]
    v_xor_b32 v11, 65600, v8
    ds_read_b64_tr_b16 a[116:117], v11 offset:0
    ds_read_b64_tr_b16 a[118:119], v11 offset:4096
    s_waitcnt lgkmcnt(7)
    v_mfma_f32_32x32x16_bf16 v[240:255], a[128:131], v[208:211], v[240:255]
    v_xor_b32 v12, 65664, v8
    ds_read_b64_tr_b16 a[120:121], v12 offset:0
    ds_read_b64_tr_b16 a[122:123], v12 offset:4096
    s_add_u32 m0, s41, 0
    s_add_u32 s45, s43, 98304
    buffer_load_dwordx4 v2, s[16:19], s45 offen offset:0 lds
    s_waitcnt lgkmcnt(8)
    v_mfma_f32_32x32x16_bf16 v[240:255], a[132:135], v[212:215], v[240:255]
    v_xor_b32 v13, 65728, v8
    ds_read_b64_tr_b16 a[124:125], v13 offset:0
    ds_read_b64_tr_b16 a[126:127], v13 offset:4096
    s_waitcnt lgkmcnt(9)
    v_mfma_f32_32x32x16_bf16 v[240:255], a[136:139], v[216:219], v[240:255]
    ds_read_b64_tr_b16 a[128:129], v10 offset:256
    ds_read_b64_tr_b16 a[130:131], v10 offset:4352
    s_waitcnt lgkmcnt(10)
    v_mfma_f32_32x32x16_bf16 v[240:255], a[140:143], v[220:223], v[240:255]
    ds_read_b64_tr_b16 a[132:133], v11 offset:256
    ds_read_b64_tr_b16 a[134:135], v11 offset:4352
    s_nop 9
    v_max3_f32 v19, v19, v240, v241
    v_max3_f32 v19, v19, v242, v243
    v_max3_f32 v19, v19, v244, v245
    v_max3_f32 v19, v19, v246, v247
    v_max3_f32 v19, v19, v248, v249
    v_max3_f32 v19, v19, v250, v251
    v_max3_f32 v19, v19, v252, v253
    v_max3_f32 v19, v19, v254, v255
    v_mov_b32 v22, v19
    v_cvt_pk_bf16_f32 v152, v240, v241
    v_cvt_pk_bf16_f32 v153, v242, v243
    v_permlane32_swap_b32 v19, v22
    v_max_f32 v19, v19, v22
    v_cvt_pk_bf16_f32 v19, 0, v19
    v_mul_f32 v19, s49, v19
    v_sub_f32 v19, 0, v19
    v_lshlrev_b32 v22, 16, v32
    v_and_b32 v23, s47, v32
    v_fma_f32 v22, v22, s49, v19
    v_fma_f32 v23, v23, s49, v19
    v_exp_f32 v22, v22
    v_exp_f32 v23, v23
    v_add_f32 v20, 0, v22
    v_add_f32 v21, 0, v23
    v_cvt_pk_bf16_f32 v32, v22, v23
    v_lshlrev_b32 v24, 16, v33
    v_and_b32 v25, s47, v33
    v_fma_f32 v24, v24, s49, v19
    v_fma_f32 v25, v25, s49, v19
    v_exp_f32 v24, v24
    v_exp_f32 v25, v25
    v_add_f32 v20, v20, v24
    v_add_f32 v21, v21, v25
    v_cvt_pk_bf16_f32 v33, v24, v25
    v_lshlrev_b32 v22, 16, v34
    v_and_b32 v23, s47, v34
    v_fma_f32 v22, v22, s49, v19
    v_fma_f32 v23, v23, s49, v19
    v_exp_f32 v22, v22
    v_exp_f32 v23, v23
    v_add_f32 v20, v20, v22
    v_add_f32 v21, v21, v23
    v_cvt_pk_bf16_f32 v34, v22, v23
    v_lshlrev_b32 v24, 16, v35
    v_and_b32 v25, s47, v35
    v_fma_f32 v24, v24, s49, v19
    v_fma_f32 v25, v25, s49, v19
    v_exp_f32 v24, v24
    v_exp_f32 v25, v25
    v_add_f32 v20, v20, v24
    v_add_f32 v21, v21, v25
    v_cvt_pk_bf16_f32 v35, v24, v25
    v_cvt_pk_bf16_f32 v154, v244, v245
    v_cvt_pk_bf16_f32 v155, v246, v247
    v_cvt_pk_bf16_f32 v156, v248, v249
    v_cvt_pk_bf16_f32 v157, v250, v251
    v_cvt_pk_bf16_f32 v158, v252, v253
    v_cvt_pk_bf16_f32 v159, v254, v255
    s_waitcnt lgkmcnt(10)
    v_mfma_f32_32x32x16_bf16 v[160:175], a[112:115], v[32:35], 0
    ds_read_b64_tr_b16 a[136:137], v12 offset:256
    ds_read_b64_tr_b16 a[138:139], v12 offset:4352
    v_lshlrev_b32 v22, 16, v36
    v_and_b32 v23, s47, v36
    v_fma_f32 v22, v22, s49, v19
    v_fma_f32 v23, v23, s49, v19
    v_exp_f32 v22, v22
    buffer_load_dwordx4 v3, s[16:19], s45 offen offset:1024 lds
    s_waitcnt lgkmcnt(10)
    v_mfma_f32_32x32x16_bf16 v[176:191], a[116:119], v[32:35], 0
    ds_read_b64_tr_b16 a[140:141], v13 offset:256
    ds_read_b64_tr_b16 a[142:143], v13 offset:4352
    v_exp_f32 v23, v23
    v_add_f32 v20, v20, v22
    v_add_f32 v21, v21, v23
    v_cvt_pk_bf16_f32 v36, v22, v23
    s_waitcnt lgkmcnt(10)
    v_mfma_f32_32x32x16_bf16 v[192:207], a[120:123], v[32:35], 0
    ds_read_b64_tr_b16 a[112:113], v10 offset:8192
    ds_read_b64_tr_b16 a[114:115], v10 offset:12288
    v_lshlrev_b32 v24, 16, v37
    v_and_b32 v25, s47, v37
    v_fma_f32 v24, v24, s49, v19
    v_fma_f32 v25, v25, s49, v19
    v_exp_f32 v24, v24
    s_waitcnt lgkmcnt(10)
    v_mfma_f32_32x32x16_bf16 v[208:223], a[124:127], v[32:35], 0
    ds_read_b64_tr_b16 a[116:117], v11 offset:8192
    ds_read_b64_tr_b16 a[118:119], v11 offset:12288
    v_exp_f32 v25, v25
    v_add_f32 v20, v20, v24
    v_add_f32 v21, v21, v25
    v_cvt_pk_bf16_f32 v37, v24, v25
    s_waitcnt lgkmcnt(10)
    v_mfma_f32_32x32x16_bf16 a[144:159], a[128:131], v[32:35], 0
    ds_read_b64_tr_b16 a[120:121], v12 offset:8192
    ds_read_b64_tr_b16 a[122:123], v12 offset:12288
    v_lshlrev_b32 v22, 16, v38
    v_and_b32 v23, s47, v38
    v_fma_f32 v22, v22, s49, v19
    v_fma_f32 v23, v23, s49, v19
    v_exp_f32 v22, v22
    buffer_load_dwordx4 v2, s[16:19], s45 offen offset:2048 lds
    s_waitcnt lgkmcnt(10)
    v_mfma_f32_32x32x16_bf16 a[160:175], a[132:135], v[32:35], 0
    ds_read_b64_tr_b16 a[124:125], v13 offset:8192
    ds_read_b64_tr_b16 a[126:127], v13 offset:12288
    v_exp_f32 v23, v23
    v_add_f32 v20, v20, v22
    v_add_f32 v21, v21, v23
    v_cvt_pk_bf16_f32 v38, v22, v23
    s_waitcnt lgkmcnt(10)
    v_mfma_f32_32x32x16_bf16 v[224:239], a[136:139], v[32:35], 0
    ds_read_b64_tr_b16 a[128:129], v10 offset:8448
    ds_read_b64_tr_b16 a[130:131], v10 offset:12544
    v_lshlrev_b32 v24, 16, v39
    v_and_b32 v25, s47, v39
    v_fma_f32 v24, v24, s49, v19
    v_fma_f32 v25, v25, s49, v19
    v_exp_f32 v24, v24
    s_waitcnt lgkmcnt(10)
    v_mfma_f32_32x32x16_bf16 v[240:255], a[140:143], v[32:35], 0
    ds_read_b64_tr_b16 a[132:133], v11 offset:8448
    ds_read_b64_tr_b16 a[134:135], v11 offset:12544
    v_exp_f32 v25, v25
    v_add_f32 v20, v20, v24
    v_add_f32 v21, v21, v25
    v_cvt_pk_bf16_f32 v39, v24, v25
    s_waitcnt lgkmcnt(10)
    s_nop 0
    v_mfma_f32_32x32x16_bf16 v[160:175], a[112:115], v[36:39], v[160:175]
    ds_read_b64_tr_b16 a[136:137], v12 offset:8448
    ds_read_b64_tr_b16 a[138:139], v12 offset:12544
    v_lshlrev_b32 v22, 16, v40
    v_and_b32 v23, s47, v40
    v_fma_f32 v22, v22, s49, v19
    v_fma_f32 v23, v23, s49, v19
    v_exp_f32 v22, v22
    buffer_load_dwordx4 v3, s[16:19], s45 offen offset:3072 lds
    s_waitcnt lgkmcnt(10)
    v_mfma_f32_32x32x16_bf16 v[176:191], a[116:119], v[36:39], v[176:191]
    ds_read_b64_tr_b16 a[140:141], v13 offset:8448
    ds_read_b64_tr_b16 a[142:143], v13 offset:12544
    v_exp_f32 v23, v23
    v_add_f32 v20, v20, v22
    v_add_f32 v21, v21, v23
    v_cvt_pk_bf16_f32 v40, v22, v23
    s_waitcnt lgkmcnt(10)
    v_mfma_f32_32x32x16_bf16 v[192:207], a[120:123], v[36:39], v[192:207]
    ds_read_b64_tr_b16 a[112:113], v10 offset:16384
    ds_read_b64_tr_b16 a[114:115], v10 offset:20480
    v_lshlrev_b32 v24, 16, v41
    v_and_b32 v25, s47, v41
    v_fma_f32 v24, v24, s49, v19
    v_fma_f32 v25, v25, s49, v19
    v_exp_f32 v24, v24
    s_waitcnt lgkmcnt(10)
    v_mfma_f32_32x32x16_bf16 v[208:223], a[124:127], v[36:39], v[208:223]
    ds_read_b64_tr_b16 a[116:117], v11 offset:16384
    ds_read_b64_tr_b16 a[118:119], v11 offset:20480
    v_exp_f32 v25, v25
    v_add_f32 v20, v20, v24
    v_add_f32 v21, v21, v25
    v_cvt_pk_bf16_f32 v41, v24, v25
    s_waitcnt lgkmcnt(10)
    v_mfma_f32_32x32x16_bf16 a[144:159], a[128:131], v[36:39], a[144:159]
    ds_read_b64_tr_b16 a[120:121], v12 offset:16384
    ds_read_b64_tr_b16 a[122:123], v12 offset:20480
    v_lshlrev_b32 v22, 16, v42
    v_and_b32 v23, s47, v42
    v_fma_f32 v22, v22, s49, v19
    v_fma_f32 v23, v23, s49, v19
    v_exp_f32 v22, v22
    s_add_u32 m0, s41, 16384
    s_add_u32 s45, s43, 114688
    buffer_load_dwordx4 v2, s[16:19], s45 offen offset:0 lds
    s_waitcnt lgkmcnt(10)
    v_mfma_f32_32x32x16_bf16 a[160:175], a[132:135], v[36:39], a[160:175]
    ds_read_b64_tr_b16 a[124:125], v13 offset:16384
    ds_read_b64_tr_b16 a[126:127], v13 offset:20480
    v_exp_f32 v23, v23
    v_add_f32 v20, v20, v22
    v_add_f32 v21, v21, v23
    v_cvt_pk_bf16_f32 v42, v22, v23
    s_waitcnt lgkmcnt(10)
    v_mfma_f32_32x32x16_bf16 v[224:239], a[136:139], v[36:39], v[224:239]
    ds_read_b64_tr_b16 a[128:129], v10 offset:16640
    ds_read_b64_tr_b16 a[130:131], v10 offset:20736
    v_lshlrev_b32 v24, 16, v43
    v_and_b32 v25, s47, v43
    v_fma_f32 v24, v24, s49, v19
    v_fma_f32 v25, v25, s49, v19
    v_exp_f32 v24, v24
    s_waitcnt lgkmcnt(10)
    v_mfma_f32_32x32x16_bf16 v[240:255], a[140:143], v[36:39], v[240:255]
    ds_read_b64_tr_b16 a[132:133], v11 offset:16640
    ds_read_b64_tr_b16 a[134:135], v11 offset:20736
    v_exp_f32 v25, v25
    v_add_f32 v20, v20, v24
    v_add_f32 v21, v21, v25
    v_cvt_pk_bf16_f32 v43, v24, v25
    s_waitcnt lgkmcnt(10)
    s_nop 0
    v_mfma_f32_32x32x16_bf16 v[160:175], a[112:115], v[40:43], v[160:175]
    ds_read_b64_tr_b16 a[136:137], v12 offset:16640
    ds_read_b64_tr_b16 a[138:139], v12 offset:20736
    v_lshlrev_b32 v22, 16, v44
    v_and_b32 v23, s47, v44
    v_fma_f32 v22, v22, s49, v19
    v_fma_f32 v23, v23, s49, v19
    v_exp_f32 v22, v22
    buffer_load_dwordx4 v3, s[16:19], s45 offen offset:1024 lds
    s_waitcnt lgkmcnt(10)
    v_mfma_f32_32x32x16_bf16 v[176:191], a[116:119], v[40:43], v[176:191]
    ds_read_b64_tr_b16 a[140:141], v13 offset:16640
    ds_read_b64_tr_b16 a[142:143], v13 offset:20736
    v_exp_f32 v23, v23
    v_add_f32 v20, v20, v22
    v_add_f32 v21, v21, v23
    v_cvt_pk_bf16_f32 v44, v22, v23
    s_waitcnt lgkmcnt(10)
    v_mfma_f32_32x32x16_bf16 v[192:207], a[120:123], v[40:43], v[192:207]
    ds_read_b64_tr_b16 a[112:113], v10 offset:24576
    ds_read_b64_tr_b16 a[114:115], v10 offset:28672
    v_lshlrev_b32 v24, 16, v45
    v_and_b32 v25, s47, v45
    v_fma_f32 v24, v24, s49, v19
    v_fma_f32 v25, v25, s49, v19
    v_exp_f32 v24, v24
    s_waitcnt lgkmcnt(10)
    v_mfma_f32_32x32x16_bf16 v[208:223], a[124:127], v[40:43], v[208:223]
    ds_read_b64_tr_b16 a[116:117], v11 offset:24576
    ds_read_b64_tr_b16 a[118:119], v11 offset:28672
    v_exp_f32 v25, v25
    v_add_f32 v20, v20, v24
    v_add_f32 v21, v21, v25
    v_cvt_pk_bf16_f32 v45, v24, v25
    s_waitcnt lgkmcnt(10)
    v_mfma_f32_32x32x16_bf16 a[144:159], a[128:131], v[40:43], a[144:159]
    ds_read_b64_tr_b16 a[120:121], v12 offset:24576
    ds_read_b64_tr_b16 a[122:123], v12 offset:28672
    buffer_load_dwordx4 v[28:31], v27, s[88:91], s52 offen
    s_add_u32 s52, s52, 1024
    v_lshlrev_b32 v22, 16, v46
    v_and_b32 v23, s47, v46
    v_fma_f32 v22, v22, s49, v19
    v_fma_f32 v23, v23, s49, v19
    v_exp_f32 v22, v22
    buffer_load_dwordx4 v2, s[16:19], s45 offen offset:2048 lds
    s_waitcnt lgkmcnt(10)
    v_mfma_f32_32x32x16_bf16 a[160:175], a[132:135], v[40:43], a[160:175]
    ds_read_b64_tr_b16 a[124:125], v13 offset:24576
    ds_read_b64_tr_b16 a[126:127], v13 offset:28672
    v_exp_f32 v23, v23
    v_add_f32 v20, v20, v22
    v_add_f32 v21, v21, v23
    v_cvt_pk_bf16_f32 v46, v22, v23
    s_waitcnt lgkmcnt(10)
    v_mfma_f32_32x32x16_bf16 v[224:239], a[136:139], v[40:43], v[224:239]
    ds_read_b64_tr_b16 a[128:129], v10 offset:24832
    ds_read_b64_tr_b16 a[130:131], v10 offset:28928
    v_lshlrev_b32 v24, 16, v47
    v_and_b32 v25, s47, v47
    v_fma_f32 v24, v24, s49, v19
    v_fma_f32 v25, v25, s49, v19
    v_exp_f32 v24, v24
    s_waitcnt lgkmcnt(10)
    v_mfma_f32_32x32x16_bf16 v[240:255], a[140:143], v[40:43], v[240:255]
    ds_read_b64_tr_b16 a[132:133], v11 offset:24832
    ds_read_b64_tr_b16 a[134:135], v11 offset:28928
    v_exp_f32 v25, v25
    v_add_f32 v20, v20, v24
    v_add_f32 v21, v21, v25
    v_cvt_pk_bf16_f32 v47, v24, v25
    s_waitcnt lgkmcnt(10)
    s_nop 0
    v_mfma_f32_32x32x16_bf16 v[160:175], a[112:115], v[44:47], v[160:175]
    ds_read_b64_tr_b16 a[136:137], v12 offset:24832
    ds_read_b64_tr_b16 a[138:139], v12 offset:28928
    v_lshlrev_b32 v22, 16, v48
    v_and_b32 v23, s47, v48
    v_fma_f32 v22, v22, s49, v19
    v_fma_f32 v23, v23, s49, v19
    v_exp_f32 v22, v22
    buffer_load_dwordx4 v3, s[16:19], s45 offen offset:3072 lds
    s_waitcnt lgkmcnt(10)
    v_mfma_f32_32x32x16_bf16 v[176:191], a[116:119], v[44:47], v[176:191]
    ds_read_b64_tr_b16 a[140:141], v13 offset:24832
    ds_read_b64_tr_b16 a[142:143], v13 offset:28928
    v_exp_f32 v23, v23
    v_add_f32 v20, v20, v22
    v_add_f32 v21, v21, v23
    v_cvt_pk_bf16_f32 v48, v22, v23
    s_waitcnt lgkmcnt(10)
    v_mfma_f32_32x32x16_bf16 v[192:207], a[120:123], v[44:47], v[192:207]
    s_waitcnt vmcnt(18)
    s_barrier
    v_xor_b32 v10, 98304, v8
    ds_read_b64_tr_b16 a[112:113], v10 offset:0
    ds_read_b64_tr_b16 a[114:115], v10 offset:4096
    v_lshlrev_b32 v24, 16, v49
    v_and_b32 v25, s47, v49
    v_fma_f32 v24, v24, s49, v19
    v_fma_f32 v25, v25, s49, v19
    v_exp_f32 v24, v24
    s_waitcnt lgkmcnt(10)
    v_mfma_f32_32x32x16_bf16 v[208:223], a[124:127], v[44:47], v[208:223]
    v_xor_b32 v11, 98368, v8
    ds_read_b64_tr_b16 a[116:117], v11 offset:0
    ds_read_b64_tr_b16 a[118:119], v11 offset:4096
    v_exp_f32 v25, v25
    v_add_f32 v20, v20, v24
    v_add_f32 v21, v21, v25
    v_cvt_pk_bf16_f32 v49, v24, v25
    s_waitcnt lgkmcnt(10)
    v_mfma_f32_32x32x16_bf16 a[144:159], a[128:131], v[44:47], a[144:159]
    v_xor_b32 v12, 98432, v8
    ds_read_b64_tr_b16 a[120:121], v12 offset:0
    ds_read_b64_tr_b16 a[122:123], v12 offset:4096
    v_lshlrev_b32 v22, 16, v50
    v_and_b32 v23, s47, v50
    v_fma_f32 v22, v22, s49, v19
    v_fma_f32 v23, v23, s49, v19
    v_exp_f32 v22, v22
    s_add_u32 m0, s41, 32768
    s_add_u32 s45, s43, 131072
    buffer_load_dwordx4 v2, s[16:19], s45 offen offset:0 lds
    s_waitcnt lgkmcnt(10)
    v_mfma_f32_32x32x16_bf16 a[160:175], a[132:135], v[44:47], a[160:175]
    v_xor_b32 v13, 98496, v8
    ds_read_b64_tr_b16 a[124:125], v13 offset:0
    ds_read_b64_tr_b16 a[126:127], v13 offset:4096
    v_exp_f32 v23, v23
    v_add_f32 v20, v20, v22
    v_add_f32 v21, v21, v23
    v_cvt_pk_bf16_f32 v50, v22, v23
    s_waitcnt lgkmcnt(10)
    v_mfma_f32_32x32x16_bf16 v[224:239], a[136:139], v[44:47], v[224:239]
    ds_read_b64_tr_b16 a[128:129], v10 offset:256
    ds_read_b64_tr_b16 a[130:131], v10 offset:4352
    v_lshlrev_b32 v24, 16, v51
    v_and_b32 v25, s47, v51
    v_fma_f32 v24, v24, s49, v19
    v_fma_f32 v25, v25, s49, v19
    v_exp_f32 v24, v24
    s_waitcnt lgkmcnt(10)
    v_mfma_f32_32x32x16_bf16 v[240:255], a[140:143], v[44:47], v[240:255]
    ds_read_b64_tr_b16 a[132:133], v11 offset:256
    ds_read_b64_tr_b16 a[134:135], v11 offset:4352
    v_exp_f32 v25, v25
    v_add_f32 v20, v20, v24
    v_add_f32 v21, v21, v25
    v_cvt_pk_bf16_f32 v51, v24, v25
    s_waitcnt lgkmcnt(10)
    s_nop 0
    v_mfma_f32_32x32x16_bf16 v[160:175], a[112:115], v[48:51], v[160:175]
    ds_read_b64_tr_b16 a[136:137], v12 offset:256
    ds_read_b64_tr_b16 a[138:139], v12 offset:4352
    v_lshlrev_b32 v22, 16, v52
    v_and_b32 v23, s47, v52
    v_fma_f32 v22, v22, s49, v19
    v_fma_f32 v23, v23, s49, v19
    v_exp_f32 v22, v22
    buffer_load_dwordx4 v3, s[16:19], s45 offen offset:1024 lds
    s_waitcnt lgkmcnt(10)
    v_mfma_f32_32x32x16_bf16 v[176:191], a[116:119], v[48:51], v[176:191]
    ds_read_b64_tr_b16 a[140:141], v13 offset:256
    ds_read_b64_tr_b16 a[142:143], v13 offset:4352
    v_exp_f32 v23, v23
    v_add_f32 v20, v20, v22
    v_add_f32 v21, v21, v23
    v_cvt_pk_bf16_f32 v52, v22, v23
    s_waitcnt lgkmcnt(10)
    v_mfma_f32_32x32x16_bf16 v[192:207], a[120:123], v[48:51], v[192:207]
    ds_read_b64_tr_b16 a[112:113], v10 offset:8192
    ds_read_b64_tr_b16 a[114:115], v10 offset:12288
    v_lshlrev_b32 v24, 16, v53
    v_and_b32 v25, s47, v53
    v_fma_f32 v24, v24, s49, v19
    v_fma_f32 v25, v25, s49, v19
    v_exp_f32 v24, v24
    s_waitcnt lgkmcnt(10)
    v_mfma_f32_32x32x16_bf16 v[208:223], a[124:127], v[48:51], v[208:223]
    ds_read_b64_tr_b16 a[116:117], v11 offset:8192
    ds_read_b64_tr_b16 a[118:119], v11 offset:12288
    v_exp_f32 v25, v25
    v_add_f32 v20, v20, v24
    v_add_f32 v21, v21, v25
    v_cvt_pk_bf16_f32 v53, v24, v25
    s_waitcnt lgkmcnt(10)
    v_mfma_f32_32x32x16_bf16 a[144:159], a[128:131], v[48:51], a[144:159]
    ds_read_b64_tr_b16 a[120:121], v12 offset:8192
    ds_read_b64_tr_b16 a[122:123], v12 offset:12288
    v_lshlrev_b32 v22, 16, v54
    v_and_b32 v23, s47, v54
    v_fma_f32 v22, v22, s49, v19
    v_fma_f32 v23, v23, s49, v19
    v_exp_f32 v22, v22
    buffer_load_dwordx4 v2, s[16:19], s45 offen offset:2048 lds
    s_waitcnt lgkmcnt(10)
    v_mfma_f32_32x32x16_bf16 a[160:175], a[132:135], v[48:51], a[160:175]
    ds_read_b64_tr_b16 a[124:125], v13 offset:8192
    ds_read_b64_tr_b16 a[126:127], v13 offset:12288
    v_exp_f32 v23, v23
    v_add_f32 v20, v20, v22
    v_add_f32 v21, v21, v23
    v_cvt_pk_bf16_f32 v54, v22, v23
    s_waitcnt lgkmcnt(10)
    v_mfma_f32_32x32x16_bf16 v[224:239], a[136:139], v[48:51], v[224:239]
    ds_read_b64_tr_b16 a[128:129], v10 offset:8448
    ds_read_b64_tr_b16 a[130:131], v10 offset:12544
    v_lshlrev_b32 v24, 16, v55
    v_and_b32 v25, s47, v55
    v_fma_f32 v24, v24, s49, v19
    v_fma_f32 v25, v25, s49, v19
    v_exp_f32 v24, v24
    s_waitcnt lgkmcnt(10)
    v_mfma_f32_32x32x16_bf16 v[240:255], a[140:143], v[48:51], v[240:255]
    ds_read_b64_tr_b16 a[132:133], v11 offset:8448
    ds_read_b64_tr_b16 a[134:135], v11 offset:12544
    v_exp_f32 v25, v25
    v_add_f32 v20, v20, v24
    v_add_f32 v21, v21, v25
    v_cvt_pk_bf16_f32 v55, v24, v25
    s_waitcnt lgkmcnt(10)
    s_nop 0
    v_mfma_f32_32x32x16_bf16 v[160:175], a[112:115], v[52:55], v[160:175]
    ds_read_b64_tr_b16 a[136:137], v12 offset:8448
    ds_read_b64_tr_b16 a[138:139], v12 offset:12544
    v_lshlrev_b32 v22, 16, v56
    v_and_b32 v23, s47, v56
    v_fma_f32 v22, v22, s49, v19
    v_fma_f32 v23, v23, s49, v19
    v_exp_f32 v22, v22
    buffer_load_dwordx4 v3, s[16:19], s45 offen offset:3072 lds
    s_waitcnt lgkmcnt(10)
    v_mfma_f32_32x32x16_bf16 v[176:191], a[116:119], v[52:55], v[176:191]
    ds_read_b64_tr_b16 a[140:141], v13 offset:8448
    ds_read_b64_tr_b16 a[142:143], v13 offset:12544
    v_exp_f32 v23, v23
    v_add_f32 v20, v20, v22
    v_add_f32 v21, v21, v23
    v_cvt_pk_bf16_f32 v56, v22, v23
    s_waitcnt lgkmcnt(10)
    v_mfma_f32_32x32x16_bf16 v[192:207], a[120:123], v[52:55], v[192:207]
    ds_read_b64_tr_b16 a[112:113], v10 offset:16384
    ds_read_b64_tr_b16 a[114:115], v10 offset:20480
    v_lshlrev_b32 v24, 16, v57
    v_and_b32 v25, s47, v57
    v_fma_f32 v24, v24, s49, v19
    v_fma_f32 v25, v25, s49, v19
    v_exp_f32 v24, v24
    s_waitcnt lgkmcnt(10)
    v_mfma_f32_32x32x16_bf16 v[208:223], a[124:127], v[52:55], v[208:223]
    ds_read_b64_tr_b16 a[116:117], v11 offset:16384
    ds_read_b64_tr_b16 a[118:119], v11 offset:20480
    v_exp_f32 v25, v25
    v_add_f32 v20, v20, v24
    v_add_f32 v21, v21, v25
    v_cvt_pk_bf16_f32 v57, v24, v25
    s_waitcnt lgkmcnt(10)
    v_mfma_f32_32x32x16_bf16 a[144:159], a[128:131], v[52:55], a[144:159]
    ds_read_b64_tr_b16 a[120:121], v12 offset:16384
    ds_read_b64_tr_b16 a[122:123], v12 offset:20480
    v_lshlrev_b32 v22, 16, v58
    v_and_b32 v23, s47, v58
    v_fma_f32 v22, v22, s49, v19
    v_fma_f32 v23, v23, s49, v19
    v_exp_f32 v22, v22
    s_add_u32 m0, s41, 49152
    s_add_u32 s45, s43, 147456
    buffer_load_dwordx4 v2, s[16:19], s45 offen offset:0 lds
    s_waitcnt lgkmcnt(10)
    v_mfma_f32_32x32x16_bf16 a[160:175], a[132:135], v[52:55], a[160:175]
    ds_read_b64_tr_b16 a[124:125], v13 offset:16384
    ds_read_b64_tr_b16 a[126:127], v13 offset:20480
    v_exp_f32 v23, v23
    v_add_f32 v20, v20, v22
    v_add_f32 v21, v21, v23
    v_cvt_pk_bf16_f32 v58, v22, v23
    s_waitcnt lgkmcnt(10)
    v_mfma_f32_32x32x16_bf16 v[224:239], a[136:139], v[52:55], v[224:239]
    ds_read_b64_tr_b16 a[128:129], v10 offset:16640
    ds_read_b64_tr_b16 a[130:131], v10 offset:20736
    v_lshlrev_b32 v24, 16, v59
    v_and_b32 v25, s47, v59
    v_fma_f32 v24, v24, s49, v19
    v_fma_f32 v25, v25, s49, v19
    v_exp_f32 v24, v24
    s_waitcnt lgkmcnt(10)
    v_mfma_f32_32x32x16_bf16 v[240:255], a[140:143], v[52:55], v[240:255]
    ds_read_b64_tr_b16 a[132:133], v11 offset:16640
    ds_read_b64_tr_b16 a[134:135], v11 offset:20736
    v_exp_f32 v25, v25
    v_add_f32 v20, v20, v24
    v_add_f32 v21, v21, v25
    v_cvt_pk_bf16_f32 v59, v24, v25
    s_waitcnt lgkmcnt(10)
    s_nop 0
    v_mfma_f32_32x32x16_bf16 v[160:175], a[112:115], v[56:59], v[160:175]
    ds_read_b64_tr_b16 a[136:137], v12 offset:16640
    ds_read_b64_tr_b16 a[138:139], v12 offset:20736
    v_lshlrev_b32 v22, 16, v60
    v_and_b32 v23, s47, v60
    v_fma_f32 v22, v22, s49, v19
    v_fma_f32 v23, v23, s49, v19
    v_exp_f32 v22, v22
    buffer_load_dwordx4 v3, s[16:19], s45 offen offset:1024 lds
    s_waitcnt lgkmcnt(10)
    v_mfma_f32_32x32x16_bf16 v[176:191], a[116:119], v[56:59], v[176:191]
    ds_read_b64_tr_b16 a[140:141], v13 offset:16640
    ds_read_b64_tr_b16 a[142:143], v13 offset:20736
    v_exp_f32 v23, v23
    v_add_f32 v20, v20, v22
    v_add_f32 v21, v21, v23
    v_cvt_pk_bf16_f32 v60, v22, v23
    s_waitcnt lgkmcnt(10)
    v_mfma_f32_32x32x16_bf16 v[192:207], a[120:123], v[56:59], v[192:207]
    ds_read_b64_tr_b16 a[112:113], v10 offset:24576
    ds_read_b64_tr_b16 a[114:115], v10 offset:28672
    v_lshlrev_b32 v24, 16, v61
    v_and_b32 v25, s47, v61
    v_fma_f32 v24, v24, s49, v19
    v_fma_f32 v25, v25, s49, v19
    v_exp_f32 v24, v24
    s_waitcnt lgkmcnt(10)
    v_mfma_f32_32x32x16_bf16 v[208:223], a[124:127], v[56:59], v[208:223]
    ds_read_b64_tr_b16 a[116:117], v11 offset:24576
    ds_read_b64_tr_b16 a[118:119], v11 offset:28672
    v_exp_f32 v25, v25
    v_add_f32 v20, v20, v24
    v_add_f32 v21, v21, v25
    v_cvt_pk_bf16_f32 v61, v24, v25
    s_waitcnt lgkmcnt(10)
    v_mfma_f32_32x32x16_bf16 a[144:159], a[128:131], v[56:59], a[144:159]
    ds_read_b64_tr_b16 a[120:121], v12 offset:24576
    ds_read_b64_tr_b16 a[122:123], v12 offset:28672
    buffer_load_dwordx4 v[28:31], v27, s[88:91], s52 offen
    s_add_u32 s52, s52, 1024
    v_lshlrev_b32 v22, 16, v62
    v_and_b32 v23, s47, v62
    v_fma_f32 v22, v22, s49, v19
    v_fma_f32 v23, v23, s49, v19
    v_exp_f32 v22, v22
    buffer_load_dwordx4 v2, s[16:19], s45 offen offset:2048 lds
    s_waitcnt lgkmcnt(10)
    v_mfma_f32_32x32x16_bf16 a[160:175], a[132:135], v[56:59], a[160:175]
    ds_read_b64_tr_b16 a[124:125], v13 offset:24576
    ds_read_b64_tr_b16 a[126:127], v13 offset:28672
    v_exp_f32 v23, v23
    v_add_f32 v20, v20, v22
    v_add_f32 v21, v21, v23
    v_cvt_pk_bf16_f32 v62, v22, v23
    s_waitcnt lgkmcnt(10)
    v_mfma_f32_32x32x16_bf16 v[224:239], a[136:139], v[56:59], v[224:239]
    ds_read_b64_tr_b16 a[128:129], v10 offset:24832
    ds_read_b64_tr_b16 a[130:131], v10 offset:28928
    v_lshlrev_b32 v24, 16, v63
    v_and_b32 v25, s47, v63
    v_fma_f32 v24, v24, s49, v19
    v_fma_f32 v25, v25, s49, v19
    v_exp_f32 v24, v24
    s_waitcnt lgkmcnt(10)
    v_mfma_f32_32x32x16_bf16 v[240:255], a[140:143], v[56:59], v[240:255]
    ds_read_b64_tr_b16 a[132:133], v11 offset:24832
    ds_read_b64_tr_b16 a[134:135], v11 offset:28928
    v_exp_f32 v25, v25
    v_add_f32 v20, v20, v24
    v_add_f32 v21, v21, v25
    v_cvt_pk_bf16_f32 v63, v24, v25
    s_waitcnt lgkmcnt(10)
    s_nop 0
    v_mfma_f32_32x32x16_bf16 v[160:175], a[112:115], v[60:63], v[160:175]
    ds_read_b64_tr_b16 a[136:137], v12 offset:24832
    ds_read_b64_tr_b16 a[138:139], v12 offset:28928
    v_lshlrev_b32 v22, 16, v64
    v_and_b32 v23, s47, v64
    v_fma_f32 v22, v22, s49, v19
    v_fma_f32 v23, v23, s49, v19
    v_exp_f32 v22, v22
    buffer_load_dwordx4 v3, s[16:19], s45 offen offset:3072 lds
    s_waitcnt lgkmcnt(10)
    v_mfma_f32_32x32x16_bf16 v[176:191], a[116:119], v[60:63], v[176:191]
    ds_read_b64_tr_b16 a[140:141], v13 offset:24832
    ds_read_b64_tr_b16 a[142:143], v13 offset:28928
    v_exp_f32 v23, v23
    v_add_f32 v20, v20, v22
    v_add_f32 v21, v21, v23
    v_cvt_pk_bf16_f32 v64, v22, v23
    s_waitcnt lgkmcnt(10)
    v_mfma_f32_32x32x16_bf16 v[192:207], a[120:123], v[60:63], v[192:207]
    s_waitcnt vmcnt(18)
    s_barrier
    v_xor_b32 v10, 131072, v8
    ds_read_b64_tr_b16 a[112:113], v10 offset:0
    ds_read_b64_tr_b16 a[114:115], v10 offset:4096
    v_lshlrev_b32 v24, 16, v65
    v_and_b32 v25, s47, v65
    v_fma_f32 v24, v24, s49, v19
    v_fma_f32 v25, v25, s49, v19
    v_exp_f32 v24, v24
    s_waitcnt lgkmcnt(10)
    v_mfma_f32_32x32x16_bf16 v[208:223], a[124:127], v[60:63], v[208:223]
    v_xor_b32 v11, 131136, v8
    ds_read_b64_tr_b16 a[116:117], v11 offset:0
    ds_read_b64_tr_b16 a[118:119], v11 offset:4096
    v_exp_f32 v25, v25
    v_add_f32 v20, v20, v24
    v_add_f32 v21, v21, v25
    v_cvt_pk_bf16_f32 v65, v24, v25
    s_waitcnt lgkmcnt(10)
    v_mfma_f32_32x32x16_bf16 a[144:159], a[128:131], v[60:63], a[144:159]
    v_xor_b32 v12, 131200, v8
    ds_read_b64_tr_b16 a[120:121], v12 offset:0
    ds_read_b64_tr_b16 a[122:123], v12 offset:4096
    v_lshlrev_b32 v22, 16, v66
    v_and_b32 v23, s47, v66
    v_fma_f32 v22, v22, s49, v19
    v_fma_f32 v23, v23, s49, v19
    v_exp_f32 v22, v22
    s_add_u32 m0, s41, 65536
    s_add_u32 s45, s43, 163840
    buffer_load_dwordx4 v2, s[16:19], s45 offen offset:0 lds
    s_waitcnt lgkmcnt(10)
    v_mfma_f32_32x32x16_bf16 a[160:175], a[132:135], v[60:63], a[160:175]
    v_xor_b32 v13, 131264, v8
    ds_read_b64_tr_b16 a[124:125], v13 offset:0
    ds_read_b64_tr_b16 a[126:127], v13 offset:4096
    v_exp_f32 v23, v23
    v_add_f32 v20, v20, v22
    v_add_f32 v21, v21, v23
    v_cvt_pk_bf16_f32 v66, v22, v23
    s_waitcnt lgkmcnt(10)
    v_mfma_f32_32x32x16_bf16 v[224:239], a[136:139], v[60:63], v[224:239]
    ds_read_b64_tr_b16 a[128:129], v10 offset:256
    ds_read_b64_tr_b16 a[130:131], v10 offset:4352
    v_lshlrev_b32 v24, 16, v67
    v_and_b32 v25, s47, v67
    v_fma_f32 v24, v24, s49, v19
    v_fma_f32 v25, v25, s49, v19
    v_exp_f32 v24, v24
    s_waitcnt lgkmcnt(10)
    v_mfma_f32_32x32x16_bf16 v[240:255], a[140:143], v[60:63], v[240:255]
    ds_read_b64_tr_b16 a[132:133], v11 offset:256
    ds_read_b64_tr_b16 a[134:135], v11 offset:4352
    v_exp_f32 v25, v25
    v_add_f32 v20, v20, v24
    v_add_f32 v21, v21, v25
    v_cvt_pk_bf16_f32 v67, v24, v25
    s_waitcnt lgkmcnt(10)
    s_nop 0
    v_mfma_f32_32x32x16_bf16 v[160:175], a[112:115], v[64:67], v[160:175]
    ds_read_b64_tr_b16 a[136:137], v12 offset:256
    ds_read_b64_tr_b16 a[138:139], v12 offset:4352
    v_lshlrev_b32 v22, 16, v68
    v_and_b32 v23, s47, v68
    v_fma_f32 v22, v22, s49, v19
    v_fma_f32 v23, v23, s49, v19
    v_exp_f32 v22, v22
    buffer_load_dwordx4 v3, s[16:19], s45 offen offset:1024 lds
    s_waitcnt lgkmcnt(10)
    v_mfma_f32_32x32x16_bf16 v[176:191], a[116:119], v[64:67], v[176:191]
    ds_read_b64_tr_b16 a[140:141], v13 offset:256
    ds_read_b64_tr_b16 a[142:143], v13 offset:4352
    v_exp_f32 v23, v23
    v_add_f32 v20, v20, v22
    v_add_f32 v21, v21, v23
    v_cvt_pk_bf16_f32 v68, v22, v23
    s_waitcnt lgkmcnt(10)
    v_mfma_f32_32x32x16_bf16 v[192:207], a[120:123], v[64:67], v[192:207]
    ds_read_b64_tr_b16 a[112:113], v10 offset:8192
    ds_read_b64_tr_b16 a[114:115], v10 offset:12288
    v_lshlrev_b32 v24, 16, v69
    v_and_b32 v25, s47, v69
    v_fma_f32 v24, v24, s49, v19
    v_fma_f32 v25, v25, s49, v19
    v_exp_f32 v24, v24
    s_waitcnt lgkmcnt(10)
    v_mfma_f32_32x32x16_bf16 v[208:223], a[124:127], v[64:67], v[208:223]
    ds_read_b64_tr_b16 a[116:117], v11 offset:8192
    ds_read_b64_tr_b16 a[118:119], v11 offset:12288
    v_exp_f32 v25, v25
    v_add_f32 v20, v20, v24
    v_add_f32 v21, v21, v25
    v_cvt_pk_bf16_f32 v69, v24, v25
    s_waitcnt lgkmcnt(10)
    v_mfma_f32_32x32x16_bf16 a[144:159], a[128:131], v[64:67], a[144:159]
    ds_read_b64_tr_b16 a[120:121], v12 offset:8192
    ds_read_b64_tr_b16 a[122:123], v12 offset:12288
    v_lshlrev_b32 v22, 16, v70
    v_and_b32 v23, s47, v70
    v_fma_f32 v22, v22, s49, v19
    v_fma_f32 v23, v23, s49, v19
    v_exp_f32 v22, v22
    buffer_load_dwordx4 v2, s[16:19], s45 offen offset:2048 lds
    s_waitcnt lgkmcnt(10)
    v_mfma_f32_32x32x16_bf16 a[160:175], a[132:135], v[64:67], a[160:175]
    ds_read_b64_tr_b16 a[124:125], v13 offset:8192
    ds_read_b64_tr_b16 a[126:127], v13 offset:12288
    v_exp_f32 v23, v23
    v_add_f32 v20, v20, v22
    v_add_f32 v21, v21, v23
    v_cvt_pk_bf16_f32 v70, v22, v23
    s_waitcnt lgkmcnt(10)
    v_mfma_f32_32x32x16_bf16 v[224:239], a[136:139], v[64:67], v[224:239]
    ds_read_b64_tr_b16 a[128:129], v10 offset:8448
    ds_read_b64_tr_b16 a[130:131], v10 offset:12544
    v_lshlrev_b32 v24, 16, v71
    v_and_b32 v25, s47, v71
    v_fma_f32 v24, v24, s49, v19
    v_fma_f32 v25, v25, s49, v19
    v_exp_f32 v24, v24
    s_waitcnt lgkmcnt(10)
    v_mfma_f32_32x32x16_bf16 v[240:255], a[140:143], v[64:67], v[240:255]
    ds_read_b64_tr_b16 a[132:133], v11 offset:8448
    ds_read_b64_tr_b16 a[134:135], v11 offset:12544
    v_exp_f32 v25, v25
    v_add_f32 v20, v20, v24
    v_add_f32 v21, v21, v25
    v_cvt_pk_bf16_f32 v71, v24, v25
    s_waitcnt lgkmcnt(10)
    s_nop 0
    v_mfma_f32_32x32x16_bf16 v[160:175], a[112:115], v[68:71], v[160:175]
    ds_read_b64_tr_b16 a[136:137], v12 offset:8448
    ds_read_b64_tr_b16 a[138:139], v12 offset:12544
    v_lshlrev_b32 v22, 16, v72
    v_and_b32 v23, s47, v72
    v_fma_f32 v22, v22, s49, v19
    v_fma_f32 v23, v23, s49, v19
    v_exp_f32 v22, v22
    buffer_load_dwordx4 v3, s[16:19], s45 offen offset:3072 lds
    s_waitcnt lgkmcnt(10)
    v_mfma_f32_32x32x16_bf16 v[176:191], a[116:119], v[68:71], v[176:191]
    ds_read_b64_tr_b16 a[140:141], v13 offset:8448
    ds_read_b64_tr_b16 a[142:143], v13 offset:12544
    v_exp_f32 v23, v23
    v_add_f32 v20, v20, v22
    v_add_f32 v21, v21, v23
    v_cvt_pk_bf16_f32 v72, v22, v23
    s_waitcnt lgkmcnt(10)
    v_mfma_f32_32x32x16_bf16 v[192:207], a[120:123], v[68:71], v[192:207]
    ds_read_b64_tr_b16 a[112:113], v10 offset:16384
    ds_read_b64_tr_b16 a[114:115], v10 offset:20480
    v_lshlrev_b32 v24, 16, v73
    v_and_b32 v25, s47, v73
    v_fma_f32 v24, v24, s49, v19
    v_fma_f32 v25, v25, s49, v19
    v_exp_f32 v24, v24
    s_waitcnt lgkmcnt(10)
    v_mfma_f32_32x32x16_bf16 v[208:223], a[124:127], v[68:71], v[208:223]
    ds_read_b64_tr_b16 a[116:117], v11 offset:16384
    ds_read_b64_tr_b16 a[118:119], v11 offset:20480
    v_exp_f32 v25, v25
    v_add_f32 v20, v20, v24
    v_add_f32 v21, v21, v25
    v_cvt_pk_bf16_f32 v73, v24, v25
    s_waitcnt lgkmcnt(10)
    v_mfma_f32_32x32x16_bf16 a[144:159], a[128:131], v[68:71], a[144:159]
    ds_read_b64_tr_b16 a[120:121], v12 offset:16384
    ds_read_b64_tr_b16 a[122:123], v12 offset:20480
    v_lshlrev_b32 v22, 16, v74
    v_and_b32 v23, s47, v74
    v_fma_f32 v22, v22, s49, v19
    v_fma_f32 v23, v23, s49, v19
    v_exp_f32 v22, v22
    s_add_u32 m0, s41, 81920
    s_add_u32 s45, s43, 180224
    buffer_load_dwordx4 v2, s[16:19], s45 offen offset:0 lds
    s_waitcnt lgkmcnt(10)
    v_mfma_f32_32x32x16_bf16 a[160:175], a[132:135], v[68:71], a[160:175]
    ds_read_b64_tr_b16 a[124:125], v13 offset:16384
    ds_read_b64_tr_b16 a[126:127], v13 offset:20480
    v_exp_f32 v23, v23
    v_add_f32 v20, v20, v22
    v_add_f32 v21, v21, v23
    v_cvt_pk_bf16_f32 v74, v22, v23
    s_waitcnt lgkmcnt(10)
    v_mfma_f32_32x32x16_bf16 v[224:239], a[136:139], v[68:71], v[224:239]
    ds_read_b64_tr_b16 a[128:129], v10 offset:16640
    ds_read_b64_tr_b16 a[130:131], v10 offset:20736
    v_lshlrev_b32 v24, 16, v75
    v_and_b32 v25, s47, v75
    v_fma_f32 v24, v24, s49, v19
    v_fma_f32 v25, v25, s49, v19
    v_exp_f32 v24, v24
    s_waitcnt lgkmcnt(10)
    v_mfma_f32_32x32x16_bf16 v[240:255], a[140:143], v[68:71], v[240:255]
    ds_read_b64_tr_b16 a[132:133], v11 offset:16640
    ds_read_b64_tr_b16 a[134:135], v11 offset:20736
    v_exp_f32 v25, v25
    v_add_f32 v20, v20, v24
    v_add_f32 v21, v21, v25
    v_cvt_pk_bf16_f32 v75, v24, v25
    s_waitcnt lgkmcnt(10)
    s_nop 0
    v_mfma_f32_32x32x16_bf16 v[160:175], a[112:115], v[72:75], v[160:175]
    ds_read_b64_tr_b16 a[136:137], v12 offset:16640
    ds_read_b64_tr_b16 a[138:139], v12 offset:20736
    v_lshlrev_b32 v22, 16, v76
    v_and_b32 v23, s47, v76
    v_fma_f32 v22, v22, s49, v19
    v_fma_f32 v23, v23, s49, v19
    v_exp_f32 v22, v22
    buffer_load_dwordx4 v3, s[16:19], s45 offen offset:1024 lds
    s_waitcnt lgkmcnt(10)
    v_mfma_f32_32x32x16_bf16 v[176:191], a[116:119], v[72:75], v[176:191]
    ds_read_b64_tr_b16 a[140:141], v13 offset:16640
    ds_read_b64_tr_b16 a[142:143], v13 offset:20736
    v_exp_f32 v23, v23
    v_add_f32 v20, v20, v22
    v_add_f32 v21, v21, v23
    v_cvt_pk_bf16_f32 v76, v22, v23
    s_waitcnt lgkmcnt(10)
    v_mfma_f32_32x32x16_bf16 v[192:207], a[120:123], v[72:75], v[192:207]
    ds_read_b64_tr_b16 a[112:113], v10 offset:24576
    ds_read_b64_tr_b16 a[114:115], v10 offset:28672
    v_lshlrev_b32 v24, 16, v77
    v_and_b32 v25, s47, v77
    v_fma_f32 v24, v24, s49, v19
    v_fma_f32 v25, v25, s49, v19
    v_exp_f32 v24, v24
    s_waitcnt lgkmcnt(10)
    v_mfma_f32_32x32x16_bf16 v[208:223], a[124:127], v[72:75], v[208:223]
    ds_read_b64_tr_b16 a[116:117], v11 offset:24576
    ds_read_b64_tr_b16 a[118:119], v11 offset:28672
    v_exp_f32 v25, v25
    v_add_f32 v20, v20, v24
    v_add_f32 v21, v21, v25
    v_cvt_pk_bf16_f32 v77, v24, v25
    s_waitcnt lgkmcnt(10)
    v_mfma_f32_32x32x16_bf16 a[144:159], a[128:131], v[72:75], a[144:159]
    ds_read_b64_tr_b16 a[120:121], v12 offset:24576
    ds_read_b64_tr_b16 a[122:123], v12 offset:28672
    buffer_load_dwordx4 v[28:31], v27, s[88:91], s52 offen
    s_add_u32 s52, s52, 1024
    v_lshlrev_b32 v22, 16, v78
    v_and_b32 v23, s47, v78
    v_fma_f32 v22, v22, s49, v19
    v_fma_f32 v23, v23, s49, v19
    v_exp_f32 v22, v22
    buffer_load_dwordx4 v2, s[16:19], s45 offen offset:2048 lds
    s_waitcnt lgkmcnt(10)
    v_mfma_f32_32x32x16_bf16 a[160:175], a[132:135], v[72:75], a[160:175]
    ds_read_b64_tr_b16 a[124:125], v13 offset:24576
    ds_read_b64_tr_b16 a[126:127], v13 offset:28672
    v_exp_f32 v23, v23
    v_add_f32 v20, v20, v22
    v_add_f32 v21, v21, v23
    v_cvt_pk_bf16_f32 v78, v22, v23
    s_waitcnt lgkmcnt(10)
    v_mfma_f32_32x32x16_bf16 v[224:239], a[136:139], v[72:75], v[224:239]
    ds_read_b64_tr_b16 a[128:129], v10 offset:24832
    ds_read_b64_tr_b16 a[130:131], v10 offset:28928
    v_lshlrev_b32 v24, 16, v79
    v_and_b32 v25, s47, v79
    v_fma_f32 v24, v24, s49, v19
    v_fma_f32 v25, v25, s49, v19
    v_exp_f32 v24, v24
    s_waitcnt lgkmcnt(10)
    v_mfma_f32_32x32x16_bf16 v[240:255], a[140:143], v[72:75], v[240:255]
    ds_read_b64_tr_b16 a[132:133], v11 offset:24832
    ds_read_b64_tr_b16 a[134:135], v11 offset:28928
    v_exp_f32 v25, v25
    v_add_f32 v20, v20, v24
    v_add_f32 v21, v21, v25
    v_cvt_pk_bf16_f32 v79, v24, v25
    s_waitcnt lgkmcnt(10)
    s_nop 0
    v_mfma_f32_32x32x16_bf16 v[160:175], a[112:115], v[76:79], v[160:175]
    ds_read_b64_tr_b16 a[136:137], v12 offset:24832
    ds_read_b64_tr_b16 a[138:139], v12 offset:28928
    v_lshlrev_b32 v22, 16, v80
    v_and_b32 v23, s47, v80
    v_fma_f32 v22, v22, s49, v19
    v_fma_f32 v23, v23, s49, v19
    v_exp_f32 v22, v22
    buffer_load_dwordx4 v3, s[16:19], s45 offen offset:3072 lds
    s_waitcnt lgkmcnt(10)
    v_mfma_f32_32x32x16_bf16 v[176:191], a[116:119], v[76:79], v[176:191]
    ds_read_b64_tr_b16 a[140:141], v13 offset:24832
    ds_read_b64_tr_b16 a[142:143], v13 offset:28928
    v_exp_f32 v23, v23
    v_add_f32 v20, v20, v22
    v_add_f32 v21, v21, v23
    v_cvt_pk_bf16_f32 v80, v22, v23
    s_waitcnt lgkmcnt(10)
    v_mfma_f32_32x32x16_bf16 v[192:207], a[120:123], v[76:79], v[192:207]
    s_waitcnt vmcnt(18)
    s_barrier
    v_xor_b32 v10, 0, v8
    ds_read_b64_tr_b16 a[112:113], v10 offset:0
    ds_read_b64_tr_b16 a[114:115], v10 offset:4096
    v_lshlrev_b32 v24, 16, v81
    v_and_b32 v25, s47, v81
    v_fma_f32 v24, v24, s49, v19
    v_fma_f32 v25, v25, s49, v19
    v_exp_f32 v24, v24
    s_waitcnt lgkmcnt(10)
    v_mfma_f32_32x32x16_bf16 v[208:223], a[124:127], v[76:79], v[208:223]
    v_xor_b32 v11, 64, v8
    ds_read_b64_tr_b16 a[116:117], v11 offset:0
    ds_read_b64_tr_b16 a[118:119], v11 offset:4096
    v_exp_f32 v25, v25
    v_add_f32 v20, v20, v24
    v_add_f32 v21, v21, v25
    v_cvt_pk_bf16_f32 v81, v24, v25
    s_waitcnt lgkmcnt(10)
    v_mfma_f32_32x32x16_bf16 a[144:159], a[128:131], v[76:79], a[144:159]
    v_xor_b32 v12, 128, v8
    ds_read_b64_tr_b16 a[120:121], v12 offset:0
    ds_read_b64_tr_b16 a[122:123], v12 offset:4096
    v_lshlrev_b32 v22, 16, v82
    v_and_b32 v23, s47, v82
    v_fma_f32 v22, v22, s49, v19
    v_fma_f32 v23, v23, s49, v19
    v_exp_f32 v22, v22
    s_add_u32 m0, s41, 98304
    s_add_u32 s45, s43, 196608
    buffer_load_dwordx4 v2, s[16:19], s45 offen offset:0 lds
    s_waitcnt lgkmcnt(10)
    v_mfma_f32_32x32x16_bf16 a[160:175], a[132:135], v[76:79], a[160:175]
    v_xor_b32 v13, 192, v8
    ds_read_b64_tr_b16 a[124:125], v13 offset:0
    ds_read_b64_tr_b16 a[126:127], v13 offset:4096
    v_exp_f32 v23, v23
    v_add_f32 v20, v20, v22
    v_add_f32 v21, v21, v23
    v_cvt_pk_bf16_f32 v82, v22, v23
    s_waitcnt lgkmcnt(10)
    v_mfma_f32_32x32x16_bf16 v[224:239], a[136:139], v[76:79], v[224:239]
    ds_read_b64_tr_b16 a[128:129], v10 offset:256
    ds_read_b64_tr_b16 a[130:131], v10 offset:4352
    v_lshlrev_b32 v24, 16, v83
    v_and_b32 v25, s47, v83
    v_fma_f32 v24, v24, s49, v19
    v_fma_f32 v25, v25, s49, v19
    v_exp_f32 v24, v24
    s_waitcnt lgkmcnt(10)
    v_mfma_f32_32x32x16_bf16 v[240:255], a[140:143], v[76:79], v[240:255]
    ds_read_b64_tr_b16 a[132:133], v11 offset:256
    ds_read_b64_tr_b16 a[134:135], v11 offset:4352
    v_exp_f32 v25, v25
    v_add_f32 v20, v20, v24
    v_add_f32 v21, v21, v25
    v_cvt_pk_bf16_f32 v83, v24, v25
    s_waitcnt lgkmcnt(10)
    s_nop 0
    v_mfma_f32_32x32x16_bf16 v[160:175], a[112:115], v[80:83], v[160:175]
    ds_read_b64_tr_b16 a[136:137], v12 offset:256
    ds_read_b64_tr_b16 a[138:139], v12 offset:4352
    v_lshlrev_b32 v22, 16, v84
    v_and_b32 v23, s47, v84
    v_fma_f32 v22, v22, s49, v19
    v_fma_f32 v23, v23, s49, v19
    v_exp_f32 v22, v22
    buffer_load_dwordx4 v3, s[16:19], s45 offen offset:1024 lds
    s_waitcnt lgkmcnt(10)
    v_mfma_f32_32x32x16_bf16 v[176:191], a[116:119], v[80:83], v[176:191]
    ds_read_b64_tr_b16 a[140:141], v13 offset:256
    ds_read_b64_tr_b16 a[142:143], v13 offset:4352
    v_exp_f32 v23, v23
    v_add_f32 v20, v20, v22
    v_add_f32 v21, v21, v23
    v_cvt_pk_bf16_f32 v84, v22, v23
    s_waitcnt lgkmcnt(10)
    v_mfma_f32_32x32x16_bf16 v[192:207], a[120:123], v[80:83], v[192:207]
    ds_read_b64_tr_b16 a[112:113], v10 offset:8192
    ds_read_b64_tr_b16 a[114:115], v10 offset:12288
    v_lshlrev_b32 v24, 16, v85
    v_and_b32 v25, s47, v85
    v_fma_f32 v24, v24, s49, v19
    v_fma_f32 v25, v25, s49, v19
    v_exp_f32 v24, v24
    s_waitcnt lgkmcnt(10)
    v_mfma_f32_32x32x16_bf16 v[208:223], a[124:127], v[80:83], v[208:223]
    ds_read_b64_tr_b16 a[116:117], v11 offset:8192
    ds_read_b64_tr_b16 a[118:119], v11 offset:12288
    v_exp_f32 v25, v25
    v_add_f32 v20, v20, v24
    v_add_f32 v21, v21, v25
    v_cvt_pk_bf16_f32 v85, v24, v25
    s_waitcnt lgkmcnt(10)
    v_mfma_f32_32x32x16_bf16 a[144:159], a[128:131], v[80:83], a[144:159]
    ds_read_b64_tr_b16 a[120:121], v12 offset:8192
    ds_read_b64_tr_b16 a[122:123], v12 offset:12288
    v_lshlrev_b32 v22, 16, v86
    v_and_b32 v23, s47, v86
    v_fma_f32 v22, v22, s49, v19
    v_fma_f32 v23, v23, s49, v19
    v_exp_f32 v22, v22
    buffer_load_dwordx4 v2, s[16:19], s45 offen offset:2048 lds
    s_waitcnt lgkmcnt(10)
    v_mfma_f32_32x32x16_bf16 a[160:175], a[132:135], v[80:83], a[160:175]
    ds_read_b64_tr_b16 a[124:125], v13 offset:8192
    ds_read_b64_tr_b16 a[126:127], v13 offset:12288
    v_exp_f32 v23, v23
    v_add_f32 v20, v20, v22
    v_add_f32 v21, v21, v23
    v_cvt_pk_bf16_f32 v86, v22, v23
    s_waitcnt lgkmcnt(10)
    v_mfma_f32_32x32x16_bf16 v[224:239], a[136:139], v[80:83], v[224:239]
    ds_read_b64_tr_b16 a[128:129], v10 offset:8448
    ds_read_b64_tr_b16 a[130:131], v10 offset:12544
    v_lshlrev_b32 v24, 16, v87
    v_and_b32 v25, s47, v87
    v_fma_f32 v24, v24, s49, v19
    v_fma_f32 v25, v25, s49, v19
    v_exp_f32 v24, v24
    s_waitcnt lgkmcnt(10)
    v_mfma_f32_32x32x16_bf16 v[240:255], a[140:143], v[80:83], v[240:255]
    ds_read_b64_tr_b16 a[132:133], v11 offset:8448
    ds_read_b64_tr_b16 a[134:135], v11 offset:12544
    v_exp_f32 v25, v25
    v_add_f32 v20, v20, v24
    v_add_f32 v21, v21, v25
    v_cvt_pk_bf16_f32 v87, v24, v25
    s_waitcnt lgkmcnt(10)
    s_nop 0
    v_mfma_f32_32x32x16_bf16 v[160:175], a[112:115], v[84:87], v[160:175]
    ds_read_b64_tr_b16 a[136:137], v12 offset:8448
    ds_read_b64_tr_b16 a[138:139], v12 offset:12544
    v_lshlrev_b32 v22, 16, v88
    v_and_b32 v23, s47, v88
    v_fma_f32 v22, v22, s49, v19
    v_fma_f32 v23, v23, s49, v19
    v_exp_f32 v22, v22
    buffer_load_dwordx4 v3, s[16:19], s45 offen offset:3072 lds
    s_waitcnt lgkmcnt(10)
    v_mfma_f32_32x32x16_bf16 v[176:191], a[116:119], v[84:87], v[176:191]
    ds_read_b64_tr_b16 a[140:141], v13 offset:8448
    ds_read_b64_tr_b16 a[142:143], v13 offset:12544
    v_exp_f32 v23, v23
    v_add_f32 v20, v20, v22
    v_add_f32 v21, v21, v23
    v_cvt_pk_bf16_f32 v88, v22, v23
    s_waitcnt lgkmcnt(10)
    v_mfma_f32_32x32x16_bf16 v[192:207], a[120:123], v[84:87], v[192:207]
    ds_read_b64_tr_b16 a[112:113], v10 offset:16384
    ds_read_b64_tr_b16 a[114:115], v10 offset:20480
    v_lshlrev_b32 v24, 16, v89
    v_and_b32 v25, s47, v89
    v_fma_f32 v24, v24, s49, v19
    v_fma_f32 v25, v25, s49, v19
    v_exp_f32 v24, v24
    s_waitcnt lgkmcnt(10)
    v_mfma_f32_32x32x16_bf16 v[208:223], a[124:127], v[84:87], v[208:223]
    ds_read_b64_tr_b16 a[116:117], v11 offset:16384
    ds_read_b64_tr_b16 a[118:119], v11 offset:20480
    v_exp_f32 v25, v25
    v_add_f32 v20, v20, v24
    v_add_f32 v21, v21, v25
    v_cvt_pk_bf16_f32 v89, v24, v25
    s_waitcnt lgkmcnt(10)
    v_mfma_f32_32x32x16_bf16 a[144:159], a[128:131], v[84:87], a[144:159]
    ds_read_b64_tr_b16 a[120:121], v12 offset:16384
    ds_read_b64_tr_b16 a[122:123], v12 offset:20480
    v_lshlrev_b32 v22, 16, v90
    v_and_b32 v23, s47, v90
    v_fma_f32 v22, v22, s49, v19
    v_fma_f32 v23, v23, s49, v19
    v_exp_f32 v22, v22
    s_add_u32 m0, s41, 114688
    s_add_u32 s45, s43, 212992
    buffer_load_dwordx4 v2, s[16:19], s45 offen offset:0 lds
    s_waitcnt lgkmcnt(10)
    v_mfma_f32_32x32x16_bf16 a[160:175], a[132:135], v[84:87], a[160:175]
    ds_read_b64_tr_b16 a[124:125], v13 offset:16384
    ds_read_b64_tr_b16 a[126:127], v13 offset:20480
    v_exp_f32 v23, v23
    v_add_f32 v20, v20, v22
    v_add_f32 v21, v21, v23
    v_cvt_pk_bf16_f32 v90, v22, v23
    s_waitcnt lgkmcnt(10)
    v_mfma_f32_32x32x16_bf16 v[224:239], a[136:139], v[84:87], v[224:239]
    ds_read_b64_tr_b16 a[128:129], v10 offset:16640
    ds_read_b64_tr_b16 a[130:131], v10 offset:20736
    v_lshlrev_b32 v24, 16, v91
    v_and_b32 v25, s47, v91
    v_fma_f32 v24, v24, s49, v19
    v_fma_f32 v25, v25, s49, v19
    v_exp_f32 v24, v24
    s_waitcnt lgkmcnt(10)
    v_mfma_f32_32x32x16_bf16 v[240:255], a[140:143], v[84:87], v[240:255]
    ds_read_b64_tr_b16 a[132:133], v11 offset:16640
    ds_read_b64_tr_b16 a[134:135], v11 offset:20736
    v_exp_f32 v25, v25
    v_add_f32 v20, v20, v24
    v_add_f32 v21, v21, v25
    v_cvt_pk_bf16_f32 v91, v24, v25
    s_waitcnt lgkmcnt(10)
    s_nop 0
    v_mfma_f32_32x32x16_bf16 v[160:175], a[112:115], v[88:91], v[160:175]
    ds_read_b64_tr_b16 a[136:137], v12 offset:16640
    ds_read_b64_tr_b16 a[138:139], v12 offset:20736
    v_lshlrev_b32 v22, 16, v92
    v_and_b32 v23, s47, v92
    v_fma_f32 v22, v22, s49, v19
    v_fma_f32 v23, v23, s49, v19
    v_exp_f32 v22, v22
    buffer_load_dwordx4 v3, s[16:19], s45 offen offset:1024 lds
    s_waitcnt lgkmcnt(10)
    v_mfma_f32_32x32x16_bf16 v[176:191], a[116:119], v[88:91], v[176:191]
    ds_read_b64_tr_b16 a[140:141], v13 offset:16640
    ds_read_b64_tr_b16 a[142:143], v13 offset:20736
    v_exp_f32 v23, v23
    v_add_f32 v20, v20, v22
    v_add_f32 v21, v21, v23
    v_cvt_pk_bf16_f32 v92, v22, v23
    s_waitcnt lgkmcnt(10)
    v_mfma_f32_32x32x16_bf16 v[192:207], a[120:123], v[88:91], v[192:207]
    ds_read_b64_tr_b16 a[112:113], v10 offset:24576
    ds_read_b64_tr_b16 a[114:115], v10 offset:28672
    v_lshlrev_b32 v24, 16, v93
    v_and_b32 v25, s47, v93
    v_fma_f32 v24, v24, s49, v19
    v_fma_f32 v25, v25, s49, v19
    v_exp_f32 v24, v24
    s_waitcnt lgkmcnt(10)
    v_mfma_f32_32x32x16_bf16 v[208:223], a[124:127], v[88:91], v[208:223]
    ds_read_b64_tr_b16 a[116:117], v11 offset:24576
    ds_read_b64_tr_b16 a[118:119], v11 offset:28672
    v_exp_f32 v25, v25
    v_add_f32 v20, v20, v24
    v_add_f32 v21, v21, v25
    v_cvt_pk_bf16_f32 v93, v24, v25
    s_waitcnt lgkmcnt(10)
    v_mfma_f32_32x32x16_bf16 a[144:159], a[128:131], v[88:91], a[144:159]
    ds_read_b64_tr_b16 a[120:121], v12 offset:24576
    ds_read_b64_tr_b16 a[122:123], v12 offset:28672
    buffer_load_dwordx4 v[28:31], v27, s[88:91], s52 offen
    s_add_u32 s52, s52, 1024
    v_lshlrev_b32 v22, 16, v94
    v_and_b32 v23, s47, v94
    v_fma_f32 v22, v22, s49, v19
    v_fma_f32 v23, v23, s49, v19
    v_exp_f32 v22, v22
    buffer_load_dwordx4 v2, s[16:19], s45 offen offset:2048 lds
    s_waitcnt lgkmcnt(10)
    v_mfma_f32_32x32x16_bf16 a[160:175], a[132:135], v[88:91], a[160:175]
    ds_read_b64_tr_b16 a[124:125], v13 offset:24576
    ds_read_b64_tr_b16 a[126:127], v13 offset:28672
    v_exp_f32 v23, v23
    v_add_f32 v20, v20, v22
    v_add_f32 v21, v21, v23
    v_cvt_pk_bf16_f32 v94, v22, v23
    s_waitcnt lgkmcnt(10)
    v_mfma_f32_32x32x16_bf16 v[224:239], a[136:139], v[88:91], v[224:239]
    ds_read_b64_tr_b16 a[128:129], v10 offset:24832
    ds_read_b64_tr_b16 a[130:131], v10 offset:28928
    v_lshlrev_b32 v24, 16, v95
    v_and_b32 v25, s47, v95
    v_fma_f32 v24, v24, s49, v19
    v_fma_f32 v25, v25, s49, v19
    v_exp_f32 v24, v24
    s_waitcnt lgkmcnt(10)
    v_mfma_f32_32x32x16_bf16 v[240:255], a[140:143], v[88:91], v[240:255]
    ds_read_b64_tr_b16 a[132:133], v11 offset:24832
    ds_read_b64_tr_b16 a[134:135], v11 offset:28928
    v_exp_f32 v25, v25
    v_add_f32 v20, v20, v24
    v_add_f32 v21, v21, v25
    v_cvt_pk_bf16_f32 v95, v24, v25
    s_waitcnt lgkmcnt(10)
    s_nop 0
    v_mfma_f32_32x32x16_bf16 v[160:175], a[112:115], v[92:95], v[160:175]
    ds_read_b64_tr_b16 a[136:137], v12 offset:24832
    ds_read_b64_tr_b16 a[138:139], v12 offset:28928
    v_lshlrev_b32 v22, 16, v96
    v_and_b32 v23, s47, v96
    v_fma_f32 v22, v22, s49, v19
    v_fma_f32 v23, v23, s49, v19
    v_exp_f32 v22, v22
    buffer_load_dwordx4 v3, s[16:19], s45 offen offset:3072 lds
    s_waitcnt lgkmcnt(10)
    v_mfma_f32_32x32x16_bf16 v[176:191], a[116:119], v[92:95], v[176:191]
    ds_read_b64_tr_b16 a[140:141], v13 offset:24832
    ds_read_b64_tr_b16 a[142:143], v13 offset:28928
    v_exp_f32 v23, v23
    v_add_f32 v20, v20, v22
    v_add_f32 v21, v21, v23
    v_cvt_pk_bf16_f32 v96, v22, v23
    s_waitcnt lgkmcnt(10)
    v_mfma_f32_32x32x16_bf16 v[192:207], a[120:123], v[92:95], v[192:207]
    s_waitcnt vmcnt(18)
    s_barrier
    v_xor_b32 v10, 32768, v8
    ds_read_b64_tr_b16 a[112:113], v10 offset:0
    ds_read_b64_tr_b16 a[114:115], v10 offset:4096
    v_lshlrev_b32 v24, 16, v97
    v_and_b32 v25, s47, v97
    v_fma_f32 v24, v24, s49, v19
    v_fma_f32 v25, v25, s49, v19
    v_exp_f32 v24, v24
    s_waitcnt lgkmcnt(10)
    v_mfma_f32_32x32x16_bf16 v[208:223], a[124:127], v[92:95], v[208:223]
    v_xor_b32 v11, 32832, v8
    ds_read_b64_tr_b16 a[116:117], v11 offset:0
    ds_read_b64_tr_b16 a[118:119], v11 offset:4096
    v_exp_f32 v25, v25
    v_add_f32 v20, v20, v24
    v_add_f32 v21, v21, v25
    v_cvt_pk_bf16_f32 v97, v24, v25
    s_waitcnt lgkmcnt(10)
    v_mfma_f32_32x32x16_bf16 a[144:159], a[128:131], v[92:95], a[144:159]
    v_xor_b32 v12, 32896, v8
    ds_read_b64_tr_b16 a[120:121], v12 offset:0
    ds_read_b64_tr_b16 a[122:123], v12 offset:4096
    v_lshlrev_b32 v22, 16, v98
    v_and_b32 v23, s47, v98
    v_fma_f32 v22, v22, s49, v19
    v_fma_f32 v23, v23, s49, v19
    v_exp_f32 v22, v22
    s_add_u32 m0, s41, 131072
    s_add_u32 s45, s43, 229376
    buffer_load_dwordx4 v2, s[16:19], s45 offen offset:0 lds
    s_waitcnt lgkmcnt(10)
    v_mfma_f32_32x32x16_bf16 a[160:175], a[132:135], v[92:95], a[160:175]
    v_xor_b32 v13, 32960, v8
    ds_read_b64_tr_b16 a[124:125], v13 offset:0
    ds_read_b64_tr_b16 a[126:127], v13 offset:4096
    v_exp_f32 v23, v23
    v_add_f32 v20, v20, v22
    v_add_f32 v21, v21, v23
    v_cvt_pk_bf16_f32 v98, v22, v23
    s_waitcnt lgkmcnt(10)
    v_mfma_f32_32x32x16_bf16 v[224:239], a[136:139], v[92:95], v[224:239]
    ds_read_b64_tr_b16 a[128:129], v10 offset:256
    ds_read_b64_tr_b16 a[130:131], v10 offset:4352
    v_lshlrev_b32 v24, 16, v99
    v_and_b32 v25, s47, v99
    v_fma_f32 v24, v24, s49, v19
    v_fma_f32 v25, v25, s49, v19
    v_exp_f32 v24, v24
    s_waitcnt lgkmcnt(10)
    v_mfma_f32_32x32x16_bf16 v[240:255], a[140:143], v[92:95], v[240:255]
    ds_read_b64_tr_b16 a[132:133], v11 offset:256
    ds_read_b64_tr_b16 a[134:135], v11 offset:4352
    v_exp_f32 v25, v25
    v_add_f32 v20, v20, v24
    v_add_f32 v21, v21, v25
    v_cvt_pk_bf16_f32 v99, v24, v25
    s_waitcnt lgkmcnt(10)
    s_nop 0
    v_mfma_f32_32x32x16_bf16 v[160:175], a[112:115], v[96:99], v[160:175]
    ds_read_b64_tr_b16 a[136:137], v12 offset:256
    ds_read_b64_tr_b16 a[138:139], v12 offset:4352
    v_lshlrev_b32 v22, 16, v100
    v_and_b32 v23, s47, v100
    v_fma_f32 v22, v22, s49, v19
    v_fma_f32 v23, v23, s49, v19
    v_exp_f32 v22, v22
    buffer_load_dwordx4 v3, s[16:19], s45 offen offset:1024 lds
    s_waitcnt lgkmcnt(10)
    v_mfma_f32_32x32x16_bf16 v[176:191], a[116:119], v[96:99], v[176:191]
    ds_read_b64_tr_b16 a[140:141], v13 offset:256
    ds_read_b64_tr_b16 a[142:143], v13 offset:4352
    v_exp_f32 v23, v23
    v_add_f32 v20, v20, v22
    v_add_f32 v21, v21, v23
    v_cvt_pk_bf16_f32 v100, v22, v23
    s_waitcnt lgkmcnt(10)
    v_mfma_f32_32x32x16_bf16 v[192:207], a[120:123], v[96:99], v[192:207]
    ds_read_b64_tr_b16 a[112:113], v10 offset:8192
    ds_read_b64_tr_b16 a[114:115], v10 offset:12288
    v_lshlrev_b32 v24, 16, v101
    v_and_b32 v25, s47, v101
    v_fma_f32 v24, v24, s49, v19
    v_fma_f32 v25, v25, s49, v19
    v_exp_f32 v24, v24
    s_waitcnt lgkmcnt(10)
    v_mfma_f32_32x32x16_bf16 v[208:223], a[124:127], v[96:99], v[208:223]
    ds_read_b64_tr_b16 a[116:117], v11 offset:8192
    ds_read_b64_tr_b16 a[118:119], v11 offset:12288
    v_exp_f32 v25, v25
    v_add_f32 v20, v20, v24
    v_add_f32 v21, v21, v25
    v_cvt_pk_bf16_f32 v101, v24, v25
    s_waitcnt lgkmcnt(10)
    v_mfma_f32_32x32x16_bf16 a[144:159], a[128:131], v[96:99], a[144:159]
    ds_read_b64_tr_b16 a[120:121], v12 offset:8192
    ds_read_b64_tr_b16 a[122:123], v12 offset:12288
    v_lshlrev_b32 v22, 16, v102
    v_and_b32 v23, s47, v102
    v_fma_f32 v22, v22, s49, v19
    v_fma_f32 v23, v23, s49, v19
    v_exp_f32 v22, v22
    buffer_load_dwordx4 v2, s[16:19], s45 offen offset:2048 lds
    s_waitcnt lgkmcnt(10)
    v_mfma_f32_32x32x16_bf16 a[160:175], a[132:135], v[96:99], a[160:175]
    ds_read_b64_tr_b16 a[124:125], v13 offset:8192
    ds_read_b64_tr_b16 a[126:127], v13 offset:12288
    v_exp_f32 v23, v23
    v_add_f32 v20, v20, v22
    v_add_f32 v21, v21, v23
    v_cvt_pk_bf16_f32 v102, v22, v23
    s_waitcnt lgkmcnt(10)
    v_mfma_f32_32x32x16_bf16 v[224:239], a[136:139], v[96:99], v[224:239]
    ds_read_b64_tr_b16 a[128:129], v10 offset:8448
    ds_read_b64_tr_b16 a[130:131], v10 offset:12544
    v_lshlrev_b32 v24, 16, v103
    v_and_b32 v25, s47, v103
    v_fma_f32 v24, v24, s49, v19
    v_fma_f32 v25, v25, s49, v19
    v_exp_f32 v24, v24
    s_waitcnt lgkmcnt(10)
    v_mfma_f32_32x32x16_bf16 v[240:255], a[140:143], v[96:99], v[240:255]
    ds_read_b64_tr_b16 a[132:133], v11 offset:8448
    ds_read_b64_tr_b16 a[134:135], v11 offset:12544
    v_exp_f32 v25, v25
    v_add_f32 v20, v20, v24
    v_add_f32 v21, v21, v25
    v_cvt_pk_bf16_f32 v103, v24, v25
    s_waitcnt lgkmcnt(10)
    s_nop 0
    v_mfma_f32_32x32x16_bf16 v[160:175], a[112:115], v[100:103], v[160:175]
    ds_read_b64_tr_b16 a[136:137], v12 offset:8448
    ds_read_b64_tr_b16 a[138:139], v12 offset:12544
    v_lshlrev_b32 v22, 16, v104
    v_and_b32 v23, s47, v104
    v_fma_f32 v22, v22, s49, v19
    v_fma_f32 v23, v23, s49, v19
    v_exp_f32 v22, v22
    buffer_load_dwordx4 v3, s[16:19], s45 offen offset:3072 lds
    s_waitcnt lgkmcnt(10)
    v_mfma_f32_32x32x16_bf16 v[176:191], a[116:119], v[100:103], v[176:191]
    ds_read_b64_tr_b16 a[140:141], v13 offset:8448
    ds_read_b64_tr_b16 a[142:143], v13 offset:12544
    v_exp_f32 v23, v23
    v_add_f32 v20, v20, v22
    v_add_f32 v21, v21, v23
    v_cvt_pk_bf16_f32 v104, v22, v23
    s_waitcnt lgkmcnt(10)
    v_mfma_f32_32x32x16_bf16 v[192:207], a[120:123], v[100:103], v[192:207]
    ds_read_b64_tr_b16 a[112:113], v10 offset:16384
    ds_read_b64_tr_b16 a[114:115], v10 offset:20480
    v_lshlrev_b32 v24, 16, v105
    v_and_b32 v25, s47, v105
    v_fma_f32 v24, v24, s49, v19
    v_fma_f32 v25, v25, s49, v19
    v_exp_f32 v24, v24
    s_waitcnt lgkmcnt(10)
    v_mfma_f32_32x32x16_bf16 v[208:223], a[124:127], v[100:103], v[208:223]
    ds_read_b64_tr_b16 a[116:117], v11 offset:16384
    ds_read_b64_tr_b16 a[118:119], v11 offset:20480
    v_exp_f32 v25, v25
    v_add_f32 v20, v20, v24
    v_add_f32 v21, v21, v25
    v_cvt_pk_bf16_f32 v105, v24, v25
    s_waitcnt lgkmcnt(10)
    v_mfma_f32_32x32x16_bf16 a[144:159], a[128:131], v[100:103], a[144:159]
    ds_read_b64_tr_b16 a[120:121], v12 offset:16384
    ds_read_b64_tr_b16 a[122:123], v12 offset:20480
    v_lshlrev_b32 v22, 16, v106
    v_and_b32 v23, s47, v106
    v_fma_f32 v22, v22, s49, v19
    v_fma_f32 v23, v23, s49, v19
    v_exp_f32 v22, v22
    s_add_u32 m0, s41, 147456
    s_add_u32 s45, s43, 245760
    buffer_load_dwordx4 v2, s[16:19], s45 offen offset:0 lds
    s_waitcnt lgkmcnt(10)
    v_mfma_f32_32x32x16_bf16 a[160:175], a[132:135], v[100:103], a[160:175]
    ds_read_b64_tr_b16 a[124:125], v13 offset:16384
    ds_read_b64_tr_b16 a[126:127], v13 offset:20480
    v_exp_f32 v23, v23
    v_add_f32 v20, v20, v22
    v_add_f32 v21, v21, v23
    v_cvt_pk_bf16_f32 v106, v22, v23
    s_waitcnt lgkmcnt(10)
    v_mfma_f32_32x32x16_bf16 v[224:239], a[136:139], v[100:103], v[224:239]
    ds_read_b64_tr_b16 a[128:129], v10 offset:16640
    ds_read_b64_tr_b16 a[130:131], v10 offset:20736
    v_lshlrev_b32 v24, 16, v107
    v_and_b32 v25, s47, v107
    v_fma_f32 v24, v24, s49, v19
    v_fma_f32 v25, v25, s49, v19
    v_exp_f32 v24, v24
    s_waitcnt lgkmcnt(10)
    v_mfma_f32_32x32x16_bf16 v[240:255], a[140:143], v[100:103], v[240:255]
    ds_read_b64_tr_b16 a[132:133], v11 offset:16640
    ds_read_b64_tr_b16 a[134:135], v11 offset:20736
    v_exp_f32 v25, v25
    v_add_f32 v20, v20, v24
    v_add_f32 v21, v21, v25
    v_cvt_pk_bf16_f32 v107, v24, v25
    s_waitcnt lgkmcnt(10)
    s_nop 0
    v_mfma_f32_32x32x16_bf16 v[160:175], a[112:115], v[104:107], v[160:175]
    ds_read_b64_tr_b16 a[136:137], v12 offset:16640
    ds_read_b64_tr_b16 a[138:139], v12 offset:20736
    v_lshlrev_b32 v22, 16, v108
    v_and_b32 v23, s47, v108
    v_fma_f32 v22, v22, s49, v19
    v_fma_f32 v23, v23, s49, v19
    v_exp_f32 v22, v22
    buffer_load_dwordx4 v3, s[16:19], s45 offen offset:1024 lds
    s_waitcnt lgkmcnt(10)
    v_mfma_f32_32x32x16_bf16 v[176:191], a[116:119], v[104:107], v[176:191]
    ds_read_b64_tr_b16 a[140:141], v13 offset:16640
    ds_read_b64_tr_b16 a[142:143], v13 offset:20736
    v_exp_f32 v23, v23
    v_add_f32 v20, v20, v22
    v_add_f32 v21, v21, v23
    v_cvt_pk_bf16_f32 v108, v22, v23
    s_waitcnt lgkmcnt(10)
    v_mfma_f32_32x32x16_bf16 v[192:207], a[120:123], v[104:107], v[192:207]
    ds_read_b64_tr_b16 a[112:113], v10 offset:24576
    ds_read_b64_tr_b16 a[114:115], v10 offset:28672
    v_lshlrev_b32 v24, 16, v109
    v_and_b32 v25, s47, v109
    v_fma_f32 v24, v24, s49, v19
    v_fma_f32 v25, v25, s49, v19
    v_exp_f32 v24, v24
    s_waitcnt lgkmcnt(10)
    v_mfma_f32_32x32x16_bf16 v[208:223], a[124:127], v[104:107], v[208:223]
    ds_read_b64_tr_b16 a[116:117], v11 offset:24576
    ds_read_b64_tr_b16 a[118:119], v11 offset:28672
    s_mov_b32 s88, s96
    s_mov_b32 s89, s97
    s_mov_b32 s90, 1605632
    s_mov_b32 s91, 0x20000
    s_lshl_b32 s5, s2, 2
    s_add_u32 s5, s5, s48
    s_mul_i32 s52, s5, 1568
    v_lshlrev_b32 v27, 4, v1
    v_exp_f32 v25, v25
    v_add_f32 v20, v20, v24
    v_add_f32 v21, v21, v25
    v_cvt_pk_bf16_f32 v109, v24, v25
    s_waitcnt lgkmcnt(10)
    v_mfma_f32_32x32x16_bf16 a[144:159], a[128:131], v[104:107], a[144:159]
    ds_read_b64_tr_b16 a[120:121], v12 offset:24576
    ds_read_b64_tr_b16 a[122:123], v12 offset:28672
    buffer_load_dwordx4 v[28:31], v27, s[88:91], s52 offen
    s_add_u32 s52, s52, 1024
    v_lshlrev_b32 v22, 16, v110
    v_and_b32 v23, s47, v110
    v_fma_f32 v22, v22, s49, v19
    v_fma_f32 v23, v23, s49, v19
    v_exp_f32 v22, v22
    buffer_load_dwordx4 v2, s[16:19], s45 offen offset:2048 lds
    s_waitcnt lgkmcnt(10)
    v_mfma_f32_32x32x16_bf16 a[160:175], a[132:135], v[104:107], a[160:175]
    ds_read_b64_tr_b16 a[124:125], v13 offset:24576
    ds_read_b64_tr_b16 a[126:127], v13 offset:28672
    v_exp_f32 v23, v23
    v_add_f32 v20, v20, v22
    v_add_f32 v21, v21, v23
    v_cvt_pk_bf16_f32 v110, v22, v23
    s_waitcnt lgkmcnt(10)
    v_mfma_f32_32x32x16_bf16 v[224:239], a[136:139], v[104:107], v[224:239]
    ds_read_b64_tr_b16 a[128:129], v10 offset:24832
    ds_read_b64_tr_b16 a[130:131], v10 offset:28928
    v_lshlrev_b32 v24, 16, v111
    v_and_b32 v25, s47, v111
    v_fma_f32 v24, v24, s49, v19
    v_fma_f32 v25, v25, s49, v19
    v_exp_f32 v24, v24
    s_waitcnt lgkmcnt(10)
    v_mfma_f32_32x32x16_bf16 v[240:255], a[140:143], v[104:107], v[240:255]
    ds_read_b64_tr_b16 a[132:133], v11 offset:24832
    ds_read_b64_tr_b16 a[134:135], v11 offset:28928
    v_exp_f32 v25, v25
    v_add_f32 v20, v20, v24
    v_add_f32 v21, v21, v25
    v_cvt_pk_bf16_f32 v111, v24, v25
    s_waitcnt lgkmcnt(10)
    s_nop 0
    v_mfma_f32_32x32x16_bf16 v[160:175], a[112:115], v[108:111], v[160:175]
    ds_read_b64_tr_b16 a[136:137], v12 offset:24832
    ds_read_b64_tr_b16 a[138:139], v12 offset:28928
    v_lshlrev_b32 v22, 16, v112
    v_and_b32 v23, s47, v112
    v_fma_f32 v22, v22, s49, v19
    v_fma_f32 v23, v23, s49, v19
    v_exp_f32 v22, v22
    buffer_load_dwordx4 v3, s[16:19], s45 offen offset:3072 lds
    s_waitcnt lgkmcnt(10)
    v_mfma_f32_32x32x16_bf16 v[176:191], a[116:119], v[108:111], v[176:191]
    ds_read_b64_tr_b16 a[140:141], v13 offset:24832
    ds_read_b64_tr_b16 a[142:143], v13 offset:28928
    v_exp_f32 v23, v23
    v_add_f32 v20, v20, v22
    v_add_f32 v21, v21, v23
    v_cvt_pk_bf16_f32 v112, v22, v23
    s_waitcnt lgkmcnt(10)
    v_mfma_f32_32x32x16_bf16 v[192:207], a[120:123], v[108:111], v[192:207]
    s_waitcnt vmcnt(18)
    s_barrier
    v_xor_b32 v10, 65536, v8
    ds_read_b64_tr_b16 a[112:113], v10 offset:0
    ds_read_b64_tr_b16 a[114:115], v10 offset:4096
    v_lshlrev_b32 v24, 16, v113
    v_and_b32 v25, s47, v113
    v_fma_f32 v24, v24, s49, v19
    v_fma_f32 v25, v25, s49, v19
    v_exp_f32 v24, v24
    s_waitcnt lgkmcnt(10)
    v_mfma_f32_32x32x16_bf16 v[208:223], a[124:127], v[108:111], v[208:223]
    v_xor_b32 v11, 65600, v8
    ds_read_b64_tr_b16 a[116:117], v11 offset:0
    ds_read_b64_tr_b16 a[118:119], v11 offset:4096
    v_exp_f32 v25, v25
    v_add_f32 v20, v20, v24
    v_add_f32 v21, v21, v25
    v_cvt_pk_bf16_f32 v113, v24, v25
    s_waitcnt lgkmcnt(10)
    v_mfma_f32_32x32x16_bf16 a[144:159], a[128:131], v[108:111], a[144:159]
    v_xor_b32 v12, 65664, v8
    ds_read_b64_tr_b16 a[120:121], v12 offset:0
    ds_read_b64_tr_b16 a[122:123], v12 offset:4096
    v_lshlrev_b32 v22, 16, v114
    v_and_b32 v23, s47, v114
    v_fma_f32 v22, v22, s49, v19
    v_fma_f32 v23, v23, s49, v19
    v_exp_f32 v22, v22
    v_accvgpr_read_b32 v2, a178
    v_add_u32 v3, 6144, v2
    v_add_u32 v4, 12288, v2
    v_add_u32 v5, 18432, v2
    s_add_u32 m0, s40, 0
    s_add_u32 s45, s44, 0
    buffer_load_dwordx4 v2, s[20:23], s45 offen offset:0 lds
    s_waitcnt lgkmcnt(10)
    v_mfma_f32_32x32x16_bf16 a[160:175], a[132:135], v[108:111], a[160:175]
    v_xor_b32 v13, 65728, v8
    ds_read_b64_tr_b16 a[124:125], v13 offset:0
    ds_read_b64_tr_b16 a[126:127], v13 offset:4096
    v_exp_f32 v23, v23
    v_add_f32 v20, v20, v22
    v_add_f32 v21, v21, v23
    v_cvt_pk_bf16_f32 v114, v22, v23
    s_waitcnt lgkmcnt(10)
    v_mfma_f32_32x32x16_bf16 v[224:239], a[136:139], v[108:111], v[224:239]
    ds_read_b64_tr_b16 a[128:129], v10 offset:256
    ds_read_b64_tr_b16 a[130:131], v10 offset:4352
    v_lshlrev_b32 v24, 16, v115
    v_and_b32 v25, s47, v115
    v_fma_f32 v24, v24, s49, v19
    v_fma_f32 v25, v25, s49, v19
    v_exp_f32 v24, v24
    s_waitcnt lgkmcnt(10)
    v_mfma_f32_32x32x16_bf16 v[240:255], a[140:143], v[108:111], v[240:255]
    ds_read_b64_tr_b16 a[132:133], v11 offset:256
    ds_read_b64_tr_b16 a[134:135], v11 offset:4352
    v_exp_f32 v25, v25
    v_add_f32 v20, v20, v24
    v_add_f32 v21, v21, v25
    v_cvt_pk_bf16_f32 v115, v24, v25
    s_waitcnt lgkmcnt(10)
    s_nop 0
    v_mfma_f32_32x32x16_bf16 v[160:175], a[112:115], v[112:115], v[160:175]
    ds_read_b64_tr_b16 a[136:137], v12 offset:256
    ds_read_b64_tr_b16 a[138:139], v12 offset:4352
    v_lshlrev_b32 v22, 16, v116
    v_and_b32 v23, s47, v116
    v_fma_f32 v22, v22, s49, v19
    v_fma_f32 v23, v23, s49, v19
    v_exp_f32 v22, v22
    buffer_load_dwordx4 v3, s[20:23], s45 offen offset:1024 lds
    s_waitcnt lgkmcnt(10)
    v_mfma_f32_32x32x16_bf16 v[176:191], a[116:119], v[112:115], v[176:191]
    ds_read_b64_tr_b16 a[140:141], v13 offset:256
    ds_read_b64_tr_b16 a[142:143], v13 offset:4352
    v_exp_f32 v23, v23
    v_add_f32 v20, v20, v22
    v_add_f32 v21, v21, v23
    v_cvt_pk_bf16_f32 v116, v22, v23
    s_waitcnt lgkmcnt(10)
    v_mfma_f32_32x32x16_bf16 v[192:207], a[120:123], v[112:115], v[192:207]
    ds_read_b64_tr_b16 a[112:113], v10 offset:8192
    ds_read_b64_tr_b16 a[114:115], v10 offset:12288
    v_lshlrev_b32 v24, 16, v117
    v_and_b32 v25, s47, v117
    v_fma_f32 v24, v24, s49, v19
    v_fma_f32 v25, v25, s49, v19
    v_exp_f32 v24, v24
    s_waitcnt lgkmcnt(10)
    v_mfma_f32_32x32x16_bf16 v[208:223], a[124:127], v[112:115], v[208:223]
    ds_read_b64_tr_b16 a[116:117], v11 offset:8192
    ds_read_b64_tr_b16 a[118:119], v11 offset:12288
    v_exp_f32 v25, v25
    v_add_f32 v20, v20, v24
    v_add_f32 v21, v21, v25
    v_cvt_pk_bf16_f32 v117, v24, v25
    s_waitcnt lgkmcnt(10)
    v_mfma_f32_32x32x16_bf16 a[144:159], a[128:131], v[112:115], a[144:159]
    ds_read_b64_tr_b16 a[120:121], v12 offset:8192
    ds_read_b64_tr_b16 a[122:123], v12 offset:12288
    v_lshlrev_b32 v22, 16, v118
    v_and_b32 v23, s47, v118
    v_fma_f32 v22, v22, s49, v19
    v_fma_f32 v23, v23, s49, v19
    v_exp_f32 v22, v22
    buffer_load_dwordx4 v4, s[20:23], s45 offen offset:2048 lds
    s_waitcnt lgkmcnt(10)
    v_mfma_f32_32x32x16_bf16 a[160:175], a[132:135], v[112:115], a[160:175]
    ds_read_b64_tr_b16 a[124:125], v13 offset:8192
    ds_read_b64_tr_b16 a[126:127], v13 offset:12288
    v_exp_f32 v23, v23
    v_add_f32 v20, v20, v22
    v_add_f32 v21, v21, v23
    v_cvt_pk_bf16_f32 v118, v22, v23
    s_waitcnt lgkmcnt(10)
    v_mfma_f32_32x32x16_bf16 v[224:239], a[136:139], v[112:115], v[224:239]
    ds_read_b64_tr_b16 a[128:129], v10 offset:8448
    ds_read_b64_tr_b16 a[130:131], v10 offset:12544
    v_lshlrev_b32 v24, 16, v119
    v_and_b32 v25, s47, v119
    v_fma_f32 v24, v24, s49, v19
    v_fma_f32 v25, v25, s49, v19
    v_exp_f32 v24, v24
    s_waitcnt lgkmcnt(10)
    v_mfma_f32_32x32x16_bf16 v[240:255], a[140:143], v[112:115], v[240:255]
    ds_read_b64_tr_b16 a[132:133], v11 offset:8448
    ds_read_b64_tr_b16 a[134:135], v11 offset:12544
    v_exp_f32 v25, v25
    v_add_f32 v20, v20, v24
    v_add_f32 v21, v21, v25
    v_cvt_pk_bf16_f32 v119, v24, v25
    s_waitcnt lgkmcnt(10)
    s_nop 0
    v_mfma_f32_32x32x16_bf16 v[160:175], a[112:115], v[116:119], v[160:175]
    ds_read_b64_tr_b16 a[136:137], v12 offset:8448
    ds_read_b64_tr_b16 a[138:139], v12 offset:12544
    v_lshlrev_b32 v22, 16, v120
    v_and_b32 v23, s47, v120
    v_fma_f32 v22, v22, s49, v19
    v_fma_f32 v23, v23, s49, v19
    v_exp_f32 v22, v22
    buffer_load_dwordx4 v5, s[20:23], s45 offen offset:3072 lds
    s_waitcnt lgkmcnt(10)
    v_mfma_f32_32x32x16_bf16 v[176:191], a[116:119], v[116:119], v[176:191]
    ds_read_b64_tr_b16 a[140:141], v13 offset:8448
    ds_read_b64_tr_b16 a[142:143], v13 offset:12544
    v_exp_f32 v23, v23
    v_add_f32 v20, v20, v22
    v_add_f32 v21, v21, v23
    v_cvt_pk_bf16_f32 v120, v22, v23
    s_waitcnt lgkmcnt(10)
    v_mfma_f32_32x32x16_bf16 v[192:207], a[120:123], v[116:119], v[192:207]
    ds_read_b64_tr_b16 a[112:113], v10 offset:16384
    ds_read_b64_tr_b16 a[114:115], v10 offset:20480
    v_lshlrev_b32 v24, 16, v121
    v_and_b32 v25, s47, v121
    v_fma_f32 v24, v24, s49, v19
    v_fma_f32 v25, v25, s49, v19
    v_exp_f32 v24, v24
    s_waitcnt lgkmcnt(10)
    v_mfma_f32_32x32x16_bf16 v[208:223], a[124:127], v[116:119], v[208:223]
    ds_read_b64_tr_b16 a[116:117], v11 offset:16384
    ds_read_b64_tr_b16 a[118:119], v11 offset:20480
    v_exp_f32 v25, v25
    v_add_f32 v20, v20, v24
    v_add_f32 v21, v21, v25
    v_cvt_pk_bf16_f32 v121, v24, v25
    s_waitcnt lgkmcnt(10)
    v_mfma_f32_32x32x16_bf16 a[144:159], a[128:131], v[116:119], a[144:159]
    ds_read_b64_tr_b16 a[120:121], v12 offset:16384
    ds_read_b64_tr_b16 a[122:123], v12 offset:20480
    v_lshlrev_b32 v22, 16, v122
    v_and_b32 v23, s47, v122
    v_fma_f32 v22, v22, s49, v19
    v_fma_f32 v23, v23, s49, v19
    v_exp_f32 v22, v22
    s_add_u32 m0, s40, 4096
    s_add_u32 s45, s44, 28672
    buffer_load_dwordx4 v2, s[20:23], s45 offen offset:0 lds
    s_waitcnt lgkmcnt(10)
    v_mfma_f32_32x32x16_bf16 a[160:175], a[132:135], v[116:119], a[160:175]
    ds_read_b64_tr_b16 a[124:125], v13 offset:16384
    ds_read_b64_tr_b16 a[126:127], v13 offset:20480
    v_exp_f32 v23, v23
    v_add_f32 v20, v20, v22
    v_add_f32 v21, v21, v23
    v_cvt_pk_bf16_f32 v122, v22, v23
    s_waitcnt lgkmcnt(10)
    v_mfma_f32_32x32x16_bf16 v[224:239], a[136:139], v[116:119], v[224:239]
    ds_read_b64_tr_b16 a[128:129], v10 offset:16640
    ds_read_b64_tr_b16 a[130:131], v10 offset:20736
    v_lshlrev_b32 v24, 16, v123
    v_and_b32 v25, s47, v123
    v_fma_f32 v24, v24, s49, v19
    v_fma_f32 v25, v25, s49, v19
    v_exp_f32 v24, v24
    s_waitcnt lgkmcnt(10)
    v_mfma_f32_32x32x16_bf16 v[240:255], a[140:143], v[116:119], v[240:255]
    ds_read_b64_tr_b16 a[132:133], v11 offset:16640
    ds_read_b64_tr_b16 a[134:135], v11 offset:20736
    v_exp_f32 v25, v25
    v_add_f32 v20, v20, v24
    v_add_f32 v21, v21, v25
    v_cvt_pk_bf16_f32 v123, v24, v25
    s_waitcnt lgkmcnt(10)
    s_nop 0
    v_mfma_f32_32x32x16_bf16 v[160:175], a[112:115], v[120:123], v[160:175]
    ds_read_b64_tr_b16 a[136:137], v12 offset:16640
    ds_read_b64_tr_b16 a[138:139], v12 offset:20736
    v_lshlrev_b32 v22, 16, v124
    v_and_b32 v23, s47, v124
    v_fma_f32 v22, v22, s49, v19
    v_fma_f32 v23, v23, s49, v19
    v_exp_f32 v22, v22
    buffer_load_dwordx4 v3, s[20:23], s45 offen offset:1024 lds
    s_waitcnt lgkmcnt(10)
    v_mfma_f32_32x32x16_bf16 v[176:191], a[116:119], v[120:123], v[176:191]
    ds_read_b64_tr_b16 a[140:141], v13 offset:16640
    ds_read_b64_tr_b16 a[142:143], v13 offset:20736
    v_exp_f32 v23, v23
    v_add_f32 v20, v20, v22
    v_add_f32 v21, v21, v23
    v_cvt_pk_bf16_f32 v124, v22, v23
    s_waitcnt lgkmcnt(10)
    v_mfma_f32_32x32x16_bf16 v[192:207], a[120:123], v[120:123], v[192:207]
    ds_read_b64_tr_b16 a[112:113], v10 offset:24576
    ds_read_b64_tr_b16 a[114:115], v10 offset:28672
    v_lshlrev_b32 v24, 16, v125
    v_and_b32 v25, s47, v125
    v_fma_f32 v24, v24, s49, v19
    v_fma_f32 v25, v25, s49, v19
    v_exp_f32 v24, v24
    s_waitcnt lgkmcnt(10)
    v_mfma_f32_32x32x16_bf16 v[208:223], a[124:127], v[120:123], v[208:223]
    ds_read_b64_tr_b16 a[116:117], v11 offset:24576
    ds_read_b64_tr_b16 a[118:119], v11 offset:28672
    v_exp_f32 v25, v25
    v_add_f32 v20, v20, v24
    v_add_f32 v21, v21, v25
    v_cvt_pk_bf16_f32 v125, v24, v25
    s_waitcnt lgkmcnt(10)
    v_mfma_f32_32x32x16_bf16 a[144:159], a[128:131], v[120:123], a[144:159]
    ds_read_b64_tr_b16 a[120:121], v12 offset:24576
    ds_read_b64_tr_b16 a[122:123], v12 offset:28672
    buffer_load_dwordx4 v[28:31], v27, s[88:91], s52 offen
    s_add_u32 s52, s52, 1024
    v_lshlrev_b32 v22, 16, v126
    v_and_b32 v23, s47, v126
    v_fma_f32 v22, v22, s49, v19
    v_fma_f32 v23, v23, s49, v19
    v_exp_f32 v22, v22
    buffer_load_dwordx4 v4, s[20:23], s45 offen offset:2048 lds
    s_waitcnt lgkmcnt(10)
    v_mfma_f32_32x32x16_bf16 a[160:175], a[132:135], v[120:123], a[160:175]
    ds_read_b64_tr_b16 a[124:125], v13 offset:24576
    ds_read_b64_tr_b16 a[126:127], v13 offset:28672
    v_exp_f32 v23, v23
    v_add_f32 v20, v20, v22
    v_add_f32 v21, v21, v23
    v_cvt_pk_bf16_f32 v126, v22, v23
    s_waitcnt lgkmcnt(10)
    v_mfma_f32_32x32x16_bf16 v[224:239], a[136:139], v[120:123], v[224:239]
    ds_read_b64_tr_b16 a[128:129], v10 offset:24832
    ds_read_b64_tr_b16 a[130:131], v10 offset:28928
    v_lshlrev_b32 v24, 16, v127
    v_and_b32 v25, s47, v127
    v_fma_f32 v24, v24, s49, v19
    v_fma_f32 v25, v25, s49, v19
    v_exp_f32 v24, v24
    s_waitcnt lgkmcnt(10)
    v_mfma_f32_32x32x16_bf16 v[240:255], a[140:143], v[120:123], v[240:255]
    ds_read_b64_tr_b16 a[132:133], v11 offset:24832
    ds_read_b64_tr_b16 a[134:135], v11 offset:28928
    v_exp_f32 v25, v25
    v_add_f32 v20, v20, v24
    v_add_f32 v21, v21, v25
    v_cvt_pk_bf16_f32 v127, v24, v25
    s_waitcnt lgkmcnt(10)
    s_nop 0
    v_mfma_f32_32x32x16_bf16 v[160:175], a[112:115], v[124:127], v[160:175]
    ds_read_b64_tr_b16 a[136:137], v12 offset:24832
    ds_read_b64_tr_b16 a[138:139], v12 offset:28928
    v_lshlrev_b32 v22, 16, v128
    v_and_b32 v23, s47, v128
    v_fma_f32 v22, v22, s49, v19
    v_fma_f32 v23, v23, s49, v19
    v_exp_f32 v22, v22
    buffer_load_dwordx4 v5, s[20:23], s45 offen offset:3072 lds
    s_waitcnt lgkmcnt(10)
    v_mfma_f32_32x32x16_bf16 v[176:191], a[116:119], v[124:127], v[176:191]
    ds_read_b64_tr_b16 a[140:141], v13 offset:24832
    ds_read_b64_tr_b16 a[142:143], v13 offset:28928
    v_exp_f32 v23, v23
    v_add_f32 v20, v20, v22
    v_add_f32 v21, v21, v23
    v_cvt_pk_bf16_f32 v128, v22, v23
    s_waitcnt lgkmcnt(10)
    v_mfma_f32_32x32x16_bf16 v[192:207], a[120:123], v[124:127], v[192:207]
    s_waitcnt vmcnt(18)
    s_barrier
    v_xor_b32 v10, 98304, v8
    ds_read_b64_tr_b16 a[112:113], v10 offset:0
    ds_read_b64_tr_b16 a[114:115], v10 offset:4096
    v_lshlrev_b32 v24, 16, v129
    v_and_b32 v25, s47, v129
    v_fma_f32 v24, v24, s49, v19
    v_fma_f32 v25, v25, s49, v19
    v_exp_f32 v24, v24
    s_waitcnt lgkmcnt(10)
    v_mfma_f32_32x32x16_bf16 v[208:223], a[124:127], v[124:127], v[208:223]
    v_xor_b32 v11, 98368, v8
    ds_read_b64_tr_b16 a[116:117], v11 offset:0
    ds_read_b64_tr_b16 a[118:119], v11 offset:4096
    v_exp_f32 v25, v25
    v_add_f32 v20, v20, v24
    v_add_f32 v21, v21, v25
    v_cvt_pk_bf16_f32 v129, v24, v25
    s_waitcnt lgkmcnt(10)
    v_mfma_f32_32x32x16_bf16 a[144:159], a[128:131], v[124:127], a[144:159]
    v_xor_b32 v12, 98432, v8
    ds_read_b64_tr_b16 a[120:121], v12 offset:0
    ds_read_b64_tr_b16 a[122:123], v12 offset:4096
    v_lshlrev_b32 v22, 16, v130
    v_and_b32 v23, s47, v130
    v_fma_f32 v22, v22, s49, v19
    v_fma_f32 v23, v23, s49, v19
    v_exp_f32 v22, v22
    s_add_u32 m0, s40, 32768
    s_add_u32 s45, s44, 114688
    buffer_load_dwordx4 v2, s[20:23], s45 offen offset:0 lds
    s_waitcnt lgkmcnt(10)
    v_mfma_f32_32x32x16_bf16 a[160:175], a[132:135], v[124:127], a[160:175]
    v_xor_b32 v13, 98496, v8
    ds_read_b64_tr_b16 a[124:125], v13 offset:0
    ds_read_b64_tr_b16 a[126:127], v13 offset:4096
    v_exp_f32 v23, v23
    v_add_f32 v20, v20, v22
    v_add_f32 v21, v21, v23
    v_cvt_pk_bf16_f32 v130, v22, v23
    s_waitcnt lgkmcnt(10)
    v_mfma_f32_32x32x16_bf16 v[224:239], a[136:139], v[124:127], v[224:239]
    ds_read_b64_tr_b16 a[128:129], v10 offset:256
    ds_read_b64_tr_b16 a[130:131], v10 offset:4352
    v_lshlrev_b32 v24, 16, v131
    v_and_b32 v25, s47, v131
    v_fma_f32 v24, v24, s49, v19
    v_fma_f32 v25, v25, s49, v19
    v_exp_f32 v24, v24
    s_waitcnt lgkmcnt(10)
    v_mfma_f32_32x32x16_bf16 v[240:255], a[140:143], v[124:127], v[240:255]
    ds_read_b64_tr_b16 a[132:133], v11 offset:256
    ds_read_b64_tr_b16 a[134:135], v11 offset:4352
    v_exp_f32 v25, v25
    v_add_f32 v20, v20, v24
    v_add_f32 v21, v21, v25
    v_cvt_pk_bf16_f32 v131, v24, v25
    s_waitcnt lgkmcnt(10)
    s_nop 0
    v_mfma_f32_32x32x16_bf16 v[160:175], a[112:115], v[128:131], v[160:175]
    ds_read_b64_tr_b16 a[136:137], v12 offset:256
    ds_read_b64_tr_b16 a[138:139], v12 offset:4352
    v_lshlrev_b32 v22, 16, v132
    v_and_b32 v23, s47, v132
    v_fma_f32 v22, v22, s49, v19
    v_fma_f32 v23, v23, s49, v19
    v_exp_f32 v22, v22
    buffer_load_dwordx4 v3, s[20:23], s45 offen offset:1024 lds
    s_waitcnt lgkmcnt(10)
    v_mfma_f32_32x32x16_bf16 v[176:191], a[116:119], v[128:131], v[176:191]
    ds_read_b64_tr_b16 a[140:141], v13 offset:256
    ds_read_b64_tr_b16 a[142:143], v13 offset:4352
    v_exp_f32 v23, v23
    v_add_f32 v20, v20, v22
    v_add_f32 v21, v21, v23
    v_cvt_pk_bf16_f32 v132, v22, v23
    s_waitcnt lgkmcnt(10)
    v_mfma_f32_32x32x16_bf16 v[192:207], a[120:123], v[128:131], v[192:207]
    ds_read_b64_tr_b16 a[112:113], v10 offset:8192
    ds_read_b64_tr_b16 a[114:115], v10 offset:12288
    v_lshlrev_b32 v24, 16, v133
    v_and_b32 v25, s47, v133
    v_fma_f32 v24, v24, s49, v19
    v_fma_f32 v25, v25, s49, v19
    v_exp_f32 v24, v24
    s_waitcnt lgkmcnt(10)
    v_mfma_f32_32x32x16_bf16 v[208:223], a[124:127], v[128:131], v[208:223]
    ds_read_b64_tr_b16 a[116:117], v11 offset:8192
    ds_read_b64_tr_b16 a[118:119], v11 offset:12288
    v_exp_f32 v25, v25
    v_add_f32 v20, v20, v24
    v_add_f32 v21, v21, v25
    v_cvt_pk_bf16_f32 v133, v24, v25
    s_waitcnt lgkmcnt(10)
    v_mfma_f32_32x32x16_bf16 a[144:159], a[128:131], v[128:131], a[144:159]
    ds_read_b64_tr_b16 a[120:121], v12 offset:8192
    ds_read_b64_tr_b16 a[122:123], v12 offset:12288
    v_lshlrev_b32 v22, 16, v134
    v_and_b32 v23, s47, v134
    v_fma_f32 v22, v22, s49, v19
    v_fma_f32 v23, v23, s49, v19
    v_exp_f32 v22, v22
    buffer_load_dwordx4 v4, s[20:23], s45 offen offset:2048 lds
    s_waitcnt lgkmcnt(10)
    v_mfma_f32_32x32x16_bf16 a[160:175], a[132:135], v[128:131], a[160:175]
    ds_read_b64_tr_b16 a[124:125], v13 offset:8192
    ds_read_b64_tr_b16 a[126:127], v13 offset:12288
    v_exp_f32 v23, v23
    v_add_f32 v20, v20, v22
    v_add_f32 v21, v21, v23
    v_cvt_pk_bf16_f32 v134, v22, v23
    s_waitcnt lgkmcnt(10)
    v_mfma_f32_32x32x16_bf16 v[224:239], a[136:139], v[128:131], v[224:239]
    ds_read_b64_tr_b16 a[128:129], v10 offset:8448
    ds_read_b64_tr_b16 a[130:131], v10 offset:12544
    v_lshlrev_b32 v24, 16, v135
    v_and_b32 v25, s47, v135
    v_fma_f32 v24, v24, s49, v19
    v_fma_f32 v25, v25, s49, v19
    v_exp_f32 v24, v24
    s_waitcnt lgkmcnt(10)
    v_mfma_f32_32x32x16_bf16 v[240:255], a[140:143], v[128:131], v[240:255]
    ds_read_b64_tr_b16 a[132:133], v11 offset:8448
    ds_read_b64_tr_b16 a[134:135], v11 offset:12544
    v_exp_f32 v25, v25
    v_add_f32 v20, v20, v24
    v_add_f32 v21, v21, v25
    v_cvt_pk_bf16_f32 v135, v24, v25
    s_waitcnt lgkmcnt(10)
    s_nop 0
    v_mfma_f32_32x32x16_bf16 v[160:175], a[112:115], v[132:135], v[160:175]
    ds_read_b64_tr_b16 a[136:137], v12 offset:8448
    ds_read_b64_tr_b16 a[138:139], v12 offset:12544
    v_lshlrev_b32 v22, 16, v136
    v_and_b32 v23, s47, v136
    v_fma_f32 v22, v22, s49, v19
    v_fma_f32 v23, v23, s49, v19
    v_exp_f32 v22, v22
    buffer_load_dwordx4 v5, s[20:23], s45 offen offset:3072 lds
    s_waitcnt lgkmcnt(10)
    v_mfma_f32_32x32x16_bf16 v[176:191], a[116:119], v[132:135], v[176:191]
    ds_read_b64_tr_b16 a[140:141], v13 offset:8448
    ds_read_b64_tr_b16 a[142:143], v13 offset:12544
    v_exp_f32 v23, v23
    v_add_f32 v20, v20, v22
    v_add_f32 v21, v21, v23
    v_cvt_pk_bf16_f32 v136, v22, v23
    s_waitcnt lgkmcnt(10)
    v_mfma_f32_32x32x16_bf16 v[192:207], a[120:123], v[132:135], v[192:207]
    ds_read_b64_tr_b16 a[112:113], v10 offset:16384
    ds_read_b64_tr_b16 a[114:115], v10 offset:20480
    v_lshlrev_b32 v24, 16, v137
    v_and_b32 v25, s47, v137
    v_fma_f32 v24, v24, s49, v19
    v_fma_f32 v25, v25, s49, v19
    v_exp_f32 v24, v24
    s_waitcnt lgkmcnt(10)
    v_mfma_f32_32x32x16_bf16 v[208:223], a[124:127], v[132:135], v[208:223]
    ds_read_b64_tr_b16 a[116:117], v11 offset:16384
    ds_read_b64_tr_b16 a[118:119], v11 offset:20480
    v_exp_f32 v25, v25
    v_add_f32 v20, v20, v24
    v_add_f32 v21, v21, v25
    v_cvt_pk_bf16_f32 v137, v24, v25
    s_waitcnt lgkmcnt(10)
    v_mfma_f32_32x32x16_bf16 a[144:159], a[128:131], v[132:135], a[144:159]
    ds_read_b64_tr_b16 a[120:121], v12 offset:16384
    ds_read_b64_tr_b16 a[122:123], v12 offset:20480
    v_lshlrev_b32 v22, 16, v138
    v_and_b32 v23, s47, v138
    v_fma_f32 v22, v22, s49, v19
    v_fma_f32 v23, v23, s49, v19
    v_exp_f32 v22, v22
    s_add_u32 m0, s40, 36864
    s_add_u32 s45, s44, 143360
    buffer_load_dwordx4 v2, s[20:23], s45 offen offset:0 lds
    s_waitcnt lgkmcnt(10)
    v_mfma_f32_32x32x16_bf16 a[160:175], a[132:135], v[132:135], a[160:175]
    ds_read_b64_tr_b16 a[124:125], v13 offset:16384
    ds_read_b64_tr_b16 a[126:127], v13 offset:20480
    v_exp_f32 v23, v23
    v_add_f32 v20, v20, v22
    v_add_f32 v21, v21, v23
    v_cvt_pk_bf16_f32 v138, v22, v23
    s_waitcnt lgkmcnt(10)
    v_mfma_f32_32x32x16_bf16 v[224:239], a[136:139], v[132:135], v[224:239]
    ds_read_b64_tr_b16 a[128:129], v10 offset:16640
    ds_read_b64_tr_b16 a[130:131], v10 offset:20736
    v_lshlrev_b32 v24, 16, v139
    v_and_b32 v25, s47, v139
    v_fma_f32 v24, v24, s49, v19
    v_fma_f32 v25, v25, s49, v19
    v_exp_f32 v24, v24
    s_waitcnt lgkmcnt(10)
    v_mfma_f32_32x32x16_bf16 v[240:255], a[140:143], v[132:135], v[240:255]
    ds_read_b64_tr_b16 a[132:133], v11 offset:16640
    ds_read_b64_tr_b16 a[134:135], v11 offset:20736
    v_exp_f32 v25, v25
    v_add_f32 v20, v20, v24
    v_add_f32 v21, v21, v25
    v_cvt_pk_bf16_f32 v139, v24, v25
    s_waitcnt lgkmcnt(10)
    s_nop 0
    v_mfma_f32_32x32x16_bf16 v[160:175], a[112:115], v[136:139], v[160:175]
    ds_read_b64_tr_b16 a[136:137], v12 offset:16640
    ds_read_b64_tr_b16 a[138:139], v12 offset:20736
    v_lshlrev_b32 v22, 16, v140
    v_and_b32 v23, s47, v140
    v_fma_f32 v22, v22, s49, v19
    v_fma_f32 v23, v23, s49, v19
    v_exp_f32 v22, v22
    buffer_load_dwordx4 v3, s[20:23], s45 offen offset:1024 lds
    s_waitcnt lgkmcnt(10)
    v_mfma_f32_32x32x16_bf16 v[176:191], a[116:119], v[136:139], v[176:191]
    ds_read_b64_tr_b16 a[140:141], v13 offset:16640
    ds_read_b64_tr_b16 a[142:143], v13 offset:20736
    v_exp_f32 v23, v23
    v_add_f32 v20, v20, v22
    v_add_f32 v21, v21, v23
    v_cvt_pk_bf16_f32 v140, v22, v23
    s_waitcnt lgkmcnt(10)
    v_mfma_f32_32x32x16_bf16 v[192:207], a[120:123], v[136:139], v[192:207]
    ds_read_b64_tr_b16 a[112:113], v10 offset:24576
    ds_read_b64_tr_b16 a[114:115], v10 offset:28672
    v_lshlrev_b32 v24, 16, v141
    v_and_b32 v25, s47, v141
    v_fma_f32 v24, v24, s49, v19
    v_fma_f32 v25, v25, s49, v19
    v_exp_f32 v24, v24
    s_waitcnt lgkmcnt(10)
    v_mfma_f32_32x32x16_bf16 v[208:223], a[124:127], v[136:139], v[208:223]
    ds_read_b64_tr_b16 a[116:117], v11 offset:24576
    ds_read_b64_tr_b16 a[118:119], v11 offset:28672
    s_mov_b32 s88, s100
    s_mov_b32 s89, s101
    s_mov_b32 s90, 802816
    s_mov_b32 s91, 0x20000
    s_lshl_b32 s5, s2, 2
    s_add_u32 s5, s5, s48
    s_mul_i32 s52, s5, 784
    v_lshlrev_b32 v27, 4, v1
    v_exp_f32 v25, v25
    v_add_f32 v20, v20, v24
    v_add_f32 v21, v21, v25
    v_cvt_pk_bf16_f32 v141, v24, v25
    s_waitcnt lgkmcnt(10)
    v_mfma_f32_32x32x16_bf16 a[144:159], a[128:131], v[136:139], a[144:159]
    ds_read_b64_tr_b16 a[120:121], v12 offset:24576
    ds_read_b64_tr_b16 a[122:123], v12 offset:28672
    buffer_load_dwordx4 v[28:31], v27, s[88:91], s52 offen
    s_add_u32 s52, s52, 1024
    v_lshlrev_b32 v22, 16, v142
    v_and_b32 v23, s47, v142
    v_fma_f32 v22, v22, s49, v19
    v_fma_f32 v23, v23, s49, v19
    v_exp_f32 v22, v22
    buffer_load_dwordx4 v4, s[20:23], s45 offen offset:2048 lds
    s_waitcnt lgkmcnt(10)
    v_mfma_f32_32x32x16_bf16 a[160:175], a[132:135], v[136:139], a[160:175]
    ds_read_b64_tr_b16 a[124:125], v13 offset:24576
    ds_read_b64_tr_b16 a[126:127], v13 offset:28672
    v_exp_f32 v23, v23
    v_add_f32 v20, v20, v22
    v_add_f32 v21, v21, v23
    v_cvt_pk_bf16_f32 v142, v22, v23
    s_waitcnt lgkmcnt(10)
    v_mfma_f32_32x32x16_bf16 v[224:239], a[136:139], v[136:139], v[224:239]
    ds_read_b64_tr_b16 a[128:129], v10 offset:24832
    ds_read_b64_tr_b16 a[130:131], v10 offset:28928
    v_lshlrev_b32 v24, 16, v143
    v_and_b32 v25, s47, v143
    v_fma_f32 v24, v24, s49, v19
    v_fma_f32 v25, v25, s49, v19
    v_exp_f32 v24, v24
    s_waitcnt lgkmcnt(10)
    v_mfma_f32_32x32x16_bf16 v[240:255], a[140:143], v[136:139], v[240:255]
    ds_read_b64_tr_b16 a[132:133], v11 offset:24832
    ds_read_b64_tr_b16 a[134:135], v11 offset:28928
    v_exp_f32 v25, v25
    v_add_f32 v20, v20, v24
    v_add_f32 v21, v21, v25
    v_cvt_pk_bf16_f32 v143, v24, v25
    s_waitcnt lgkmcnt(10)
    s_nop 0
    v_mfma_f32_32x32x16_bf16 v[160:175], a[112:115], v[140:143], v[160:175]
    ds_read_b64_tr_b16 a[136:137], v12 offset:24832
    ds_read_b64_tr_b16 a[138:139], v12 offset:28928
    v_lshlrev_b32 v22, 16, v144
    v_and_b32 v23, s47, v144
    v_fma_f32 v22, v22, s49, v19
    v_fma_f32 v23, v23, s49, v19
    v_exp_f32 v22, v22
    buffer_load_dwordx4 v5, s[20:23], s45 offen offset:3072 lds
    s_waitcnt lgkmcnt(10)
    v_mfma_f32_32x32x16_bf16 v[176:191], a[116:119], v[140:143], v[176:191]
    ds_read_b64_tr_b16 a[140:141], v13 offset:24832
    ds_read_b64_tr_b16 a[142:143], v13 offset:28928
    v_exp_f32 v23, v23
    v_add_f32 v20, v20, v22
    v_add_f32 v21, v21, v23
    v_cvt_pk_bf16_f32 v144, v22, v23
    s_waitcnt lgkmcnt(10)
    v_mfma_f32_32x32x16_bf16 v[192:207], a[120:123], v[140:143], v[192:207]
    s_waitcnt vmcnt(18)
    s_barrier
    v_xor_b32 v10, 131072, v8
    ds_read_b64_tr_b16 a[112:113], v10 offset:0
    ds_read_b64_tr_b16 a[114:115], v10 offset:4096
    v_lshlrev_b32 v24, 16, v145
    v_and_b32 v25, s47, v145
    v_fma_f32 v24, v24, s49, v19
    v_fma_f32 v25, v25, s49, v19
    v_exp_f32 v24, v24
    s_waitcnt lgkmcnt(10)
    v_mfma_f32_32x32x16_bf16 v[208:223], a[124:127], v[140:143], v[208:223]
    v_xor_b32 v11, 131136, v8
    ds_read_b64_tr_b16 a[116:117], v11 offset:0
    ds_read_b64_tr_b16 a[118:119], v11 offset:4096
    v_exp_f32 v25, v25
    v_add_f32 v20, v20, v24
    v_add_f32 v21, v21, v25
    v_cvt_pk_bf16_f32 v145, v24, v25
    s_waitcnt lgkmcnt(10)
    v_mfma_f32_32x32x16_bf16 a[144:159], a[128:131], v[140:143], a[144:159]
    v_xor_b32 v12, 131200, v8
    ds_read_b64_tr_b16 a[120:121], v12 offset:0
    ds_read_b64_tr_b16 a[122:123], v12 offset:4096
    v_lshlrev_b32 v22, 16, v146
    v_and_b32 v23, s47, v146
    v_fma_f32 v22, v22, s49, v19
    v_fma_f32 v23, v23, s49, v19
    v_exp_f32 v22, v22
    s_add_u32 m0, s40, 65536
    s_add_u32 s45, s44, 128
    buffer_load_dwordx4 v2, s[20:23], s45 offen offset:0 lds
    s_waitcnt lgkmcnt(10)
    v_mfma_f32_32x32x16_bf16 a[160:175], a[132:135], v[140:143], a[160:175]
    v_xor_b32 v13, 131264, v8
    ds_read_b64_tr_b16 a[124:125], v13 offset:0
    ds_read_b64_tr_b16 a[126:127], v13 offset:4096
    v_exp_f32 v23, v23
    v_add_f32 v20, v20, v22
    v_add_f32 v21, v21, v23
    v_cvt_pk_bf16_f32 v146, v22, v23
    s_waitcnt lgkmcnt(10)
    v_mfma_f32_32x32x16_bf16 v[224:239], a[136:139], v[140:143], v[224:239]
    ds_read_b64_tr_b16 a[128:129], v10 offset:256
    ds_read_b64_tr_b16 a[130:131], v10 offset:4352
    v_lshlrev_b32 v24, 16, v147
    v_and_b32 v25, s47, v147
    v_fma_f32 v24, v24, s49, v19
    v_fma_f32 v25, v25, s49, v19
    v_exp_f32 v24, v24
    s_waitcnt lgkmcnt(10)
    v_mfma_f32_32x32x16_bf16 v[240:255], a[140:143], v[140:143], v[240:255]
    ds_read_b64_tr_b16 a[132:133], v11 offset:256
    ds_read_b64_tr_b16 a[134:135], v11 offset:4352
    v_exp_f32 v25, v25
    v_add_f32 v20, v20, v24
    v_add_f32 v21, v21, v25
    v_cvt_pk_bf16_f32 v147, v24, v25
    s_waitcnt lgkmcnt(10)
    s_nop 0
    v_mfma_f32_32x32x16_bf16 v[160:175], a[112:115], v[144:147], v[160:175]
    ds_read_b64_tr_b16 a[136:137], v12 offset:256
    ds_read_b64_tr_b16 a[138:139], v12 offset:4352
    v_lshlrev_b32 v22, 16, v148
    v_and_b32 v23, s47, v148
    v_fma_f32 v22, v22, s49, v19
    v_fma_f32 v23, v23, s49, v19
    v_exp_f32 v22, v22
    buffer_load_dwordx4 v3, s[20:23], s45 offen offset:1024 lds
    s_waitcnt lgkmcnt(10)
    v_mfma_f32_32x32x16_bf16 v[176:191], a[116:119], v[144:147], v[176:191]
    ds_read_b64_tr_b16 a[140:141], v13 offset:256
    ds_read_b64_tr_b16 a[142:143], v13 offset:4352
    v_exp_f32 v23, v23
    v_add_f32 v20, v20, v22
    v_add_f32 v21, v21, v23
    v_cvt_pk_bf16_f32 v148, v22, v23
    s_waitcnt lgkmcnt(10)
    v_mfma_f32_32x32x16_bf16 v[192:207], a[120:123], v[144:147], v[192:207]
    ds_read_b64_tr_b16 a[112:113], v10 offset:8192
    ds_read_b64_tr_b16 a[114:115], v10 offset:12288
    v_lshlrev_b32 v24, 16, v149
    v_and_b32 v25, s47, v149
    v_fma_f32 v24, v24, s49, v19
    v_fma_f32 v25, v25, s49, v19
    v_exp_f32 v24, v24
    s_waitcnt lgkmcnt(10)
    v_mfma_f32_32x32x16_bf16 v[208:223], a[124:127], v[144:147], v[208:223]
    ds_read_b64_tr_b16 a[116:117], v11 offset:8192
    ds_read_b64_tr_b16 a[118:119], v11 offset:12288
    v_exp_f32 v25, v25
    v_add_f32 v20, v20, v24
    v_add_f32 v21, v21, v25
    v_cvt_pk_bf16_f32 v149, v24, v25
    s_waitcnt lgkmcnt(10)
    v_mfma_f32_32x32x16_bf16 a[144:159], a[128:131], v[144:147], a[144:159]
    ds_read_b64_tr_b16 a[120:121], v12 offset:8192
    ds_read_b64_tr_b16 a[122:123], v12 offset:12288
    v_lshlrev_b32 v22, 16, v150
    v_and_b32 v23, s47, v150
    v_fma_f32 v22, v22, s49, v19
    v_fma_f32 v23, v23, s49, v19
    v_exp_f32 v22, v22
    buffer_load_dwordx4 v4, s[20:23], s45 offen offset:2048 lds
    s_waitcnt lgkmcnt(10)
    v_mfma_f32_32x32x16_bf16 a[160:175], a[132:135], v[144:147], a[160:175]
    ds_read_b64_tr_b16 a[124:125], v13 offset:8192
    ds_read_b64_tr_b16 a[126:127], v13 offset:12288
    v_exp_f32 v23, v23
    v_add_f32 v20, v20, v22
    v_add_f32 v21, v21, v23
    v_cvt_pk_bf16_f32 v150, v22, v23
    s_waitcnt lgkmcnt(10)
    v_mfma_f32_32x32x16_bf16 v[224:239], a[136:139], v[144:147], v[224:239]
    ds_read_b64_tr_b16 a[128:129], v10 offset:8448
    ds_read_b64_tr_b16 a[130:131], v10 offset:12544
    v_lshlrev_b32 v24, 16, v151
    v_and_b32 v25, s47, v151
    v_fma_f32 v24, v24, s49, v19
    v_fma_f32 v25, v25, s49, v19
    v_exp_f32 v24, v24
    s_waitcnt lgkmcnt(10)
    v_mfma_f32_32x32x16_bf16 v[240:255], a[140:143], v[144:147], v[240:255]
    ds_read_b64_tr_b16 a[132:133], v11 offset:8448
    ds_read_b64_tr_b16 a[134:135], v11 offset:12544
    v_exp_f32 v25, v25
    v_add_f32 v20, v20, v24
    v_add_f32 v21, v21, v25
    v_cvt_pk_bf16_f32 v151, v24, v25
    s_waitcnt lgkmcnt(10)
    s_nop 0
    v_mfma_f32_32x32x16_bf16 v[160:175], a[112:115], v[148:151], v[160:175]
    ds_read_b64_tr_b16 a[136:137], v12 offset:8448
    ds_read_b64_tr_b16 a[138:139], v12 offset:12544
    v_lshlrev_b32 v22, 16, v152
    v_and_b32 v23, s47, v152
    v_fma_f32 v22, v22, s49, v19
    v_fma_f32 v23, v23, s49, v19
    v_exp_f32 v22, v22
    buffer_load_dwordx4 v5, s[20:23], s45 offen offset:3072 lds
    s_waitcnt lgkmcnt(10)
    v_mfma_f32_32x32x16_bf16 v[176:191], a[116:119], v[148:151], v[176:191]
    ds_read_b64_tr_b16 a[140:141], v13 offset:8448
    ds_read_b64_tr_b16 a[142:143], v13 offset:12544
    v_exp_f32 v23, v23
    v_add_f32 v20, v20, v22
    v_add_f32 v21, v21, v23
    v_cvt_pk_bf16_f32 v152, v22, v23
    s_waitcnt lgkmcnt(10)
    v_mfma_f32_32x32x16_bf16 v[192:207], a[120:123], v[148:151], v[192:207]
    ds_read_b64_tr_b16 a[112:113], v10 offset:16384
    ds_read_b64_tr_b16 a[114:115], v10 offset:20480
    v_lshlrev_b32 v24, 16, v153
    v_and_b32 v25, s47, v153
    v_fma_f32 v24, v24, s49, v19
    v_fma_f32 v25, v25, s49, v19
    v_exp_f32 v24, v24
    s_waitcnt lgkmcnt(10)
    v_mfma_f32_32x32x16_bf16 v[208:223], a[124:127], v[148:151], v[208:223]
    ds_read_b64_tr_b16 a[116:117], v11 offset:16384
    ds_read_b64_tr_b16 a[118:119], v11 offset:20480
    v_exp_f32 v25, v25
    v_add_f32 v20, v20, v24
    v_add_f32 v21, v21, v25
    v_cvt_pk_bf16_f32 v153, v24, v25
    s_waitcnt lgkmcnt(10)
    v_mfma_f32_32x32x16_bf16 a[144:159], a[128:131], v[148:151], a[144:159]
    ds_read_b64_tr_b16 a[120:121], v12 offset:16384
    ds_read_b64_tr_b16 a[122:123], v12 offset:20480
    v_lshlrev_b32 v22, 16, v154
    v_and_b32 v23, s47, v154
    v_fma_f32 v22, v22, s49, v19
    v_fma_f32 v23, v23, s49, v19
    v_exp_f32 v22, v22
    s_add_u32 m0, s40, 69632
    s_add_u32 s45, s44, 28800
    buffer_load_dwordx4 v2, s[20:23], s45 offen offset:0 lds
    s_waitcnt lgkmcnt(10)
    v_mfma_f32_32x32x16_bf16 a[160:175], a[132:135], v[148:151], a[160:175]
    ds_read_b64_tr_b16 a[124:125], v13 offset:16384
    ds_read_b64_tr_b16 a[126:127], v13 offset:20480
    v_exp_f32 v23, v23
    v_add_f32 v20, v20, v22
    v_add_f32 v21, v21, v23
    v_cvt_pk_bf16_f32 v154, v22, v23
    s_waitcnt lgkmcnt(10)
    v_mfma_f32_32x32x16_bf16 v[224:239], a[136:139], v[148:151], v[224:239]
    ds_read_b64_tr_b16 a[128:129], v10 offset:16640
    ds_read_b64_tr_b16 a[130:131], v10 offset:20736
    v_lshlrev_b32 v24, 16, v155
    v_and_b32 v25, s47, v155
    v_fma_f32 v24, v24, s49, v19
    v_fma_f32 v25, v25, s49, v19
    v_exp_f32 v24, v24
    s_waitcnt lgkmcnt(10)
    v_mfma_f32_32x32x16_bf16 v[240:255], a[140:143], v[148:151], v[240:255]
    ds_read_b64_tr_b16 a[132:133], v11 offset:16640
    ds_read_b64_tr_b16 a[134:135], v11 offset:20736
    v_exp_f32 v25, v25
    v_add_f32 v20, v20, v24
    v_add_f32 v21, v21, v25
    v_cvt_pk_bf16_f32 v155, v24, v25
    s_waitcnt lgkmcnt(10)
    s_nop 0
    v_mfma_f32_32x32x16_bf16 v[160:175], a[112:115], v[152:155], v[160:175]
    ds_read_b64_tr_b16 a[136:137], v12 offset:16640
    ds_read_b64_tr_b16 a[138:139], v12 offset:20736
    v_lshlrev_b32 v22, 16, v156
    v_and_b32 v23, s47, v156
    v_fma_f32 v22, v22, s49, v19
    v_fma_f32 v23, v23, s49, v19
    v_exp_f32 v22, v22
    buffer_load_dwordx4 v3, s[20:23], s45 offen offset:1024 lds
    s_waitcnt lgkmcnt(10)
    v_mfma_f32_32x32x16_bf16 v[176:191], a[116:119], v[152:155], v[176:191]
    ds_read_b64_tr_b16 a[140:141], v13 offset:16640
    ds_read_b64_tr_b16 a[142:143], v13 offset:20736
    v_exp_f32 v23, v23
    v_add_f32 v20, v20, v22
    v_add_f32 v21, v21, v23
    v_cvt_pk_bf16_f32 v156, v22, v23
    s_waitcnt lgkmcnt(10)
    v_mfma_f32_32x32x16_bf16 v[192:207], a[120:123], v[152:155], v[192:207]
    ds_read_b64_tr_b16 a[112:113], v10 offset:24576
    ds_read_b64_tr_b16 a[114:115], v10 offset:28672
    v_lshlrev_b32 v24, 16, v157
    v_and_b32 v25, s47, v157
    v_fma_f32 v24, v24, s49, v19
    v_fma_f32 v25, v25, s49, v19
    v_exp_f32 v24, v24
    s_waitcnt lgkmcnt(10)
    v_mfma_f32_32x32x16_bf16 v[208:223], a[124:127], v[152:155], v[208:223]
    ds_read_b64_tr_b16 a[116:117], v11 offset:24576
    ds_read_b64_tr_b16 a[118:119], v11 offset:28672
    v_exp_f32 v25, v25
    v_add_f32 v20, v20, v24
    v_add_f32 v21, v21, v25
    v_cvt_pk_bf16_f32 v157, v24, v25
    s_waitcnt lgkmcnt(10)
    v_mfma_f32_32x32x16_bf16 a[144:159], a[128:131], v[152:155], a[144:159]
    ds_read_b64_tr_b16 a[120:121], v12 offset:24576
    ds_read_b64_tr_b16 a[122:123], v12 offset:28672
    v_lshlrev_b32 v22, 16, v158
    v_and_b32 v23, s47, v158
    v_fma_f32 v22, v22, s49, v19
    v_fma_f32 v23, v23, s49, v19
    v_exp_f32 v22, v22
    buffer_load_dwordx4 v4, s[20:23], s45 offen offset:2048 lds
    s_waitcnt lgkmcnt(10)
    v_mfma_f32_32x32x16_bf16 a[160:175], a[132:135], v[152:155], a[160:175]
    ds_read_b64_tr_b16 a[124:125], v13 offset:24576
    ds_read_b64_tr_b16 a[126:127], v13 offset:28672
    v_exp_f32 v23, v23
    v_add_f32 v20, v20, v22
    v_add_f32 v21, v21, v23
    v_cvt_pk_bf16_f32 v158, v22, v23
    s_waitcnt lgkmcnt(10)
    v_mfma_f32_32x32x16_bf16 v[224:239], a[136:139], v[152:155], v[224:239]
    ds_read_b64_tr_b16 a[128:129], v10 offset:24832
    ds_read_b64_tr_b16 a[130:131], v10 offset:28928
    v_lshlrev_b32 v24, 16, v159
    v_and_b32 v25, s47, v159
    v_fma_f32 v24, v24, s49, v19
    v_fma_f32 v25, v25, s49, v19
    v_exp_f32 v24, v24
    s_waitcnt lgkmcnt(10)
    v_mfma_f32_32x32x16_bf16 v[240:255], a[140:143], v[152:155], v[240:255]
    ds_read_b64_tr_b16 a[132:133], v11 offset:24832
    ds_read_b64_tr_b16 a[134:135], v11 offset:28928
    v_exp_f32 v25, v25
    v_add_f32 v20, v20, v24
    v_add_f32 v21, v21, v25
    v_cvt_pk_bf16_f32 v159, v24, v25
    s_waitcnt lgkmcnt(10)
    s_nop 0
    v_mfma_f32_32x32x16_bf16 v[160:175], a[112:115], v[156:159], v[160:175]
    ds_read_b64_tr_b16 a[136:137], v12 offset:24832
    ds_read_b64_tr_b16 a[138:139], v12 offset:28928
    buffer_load_dwordx4 v5, s[20:23], s45 offen offset:3072 lds
    s_waitcnt lgkmcnt(10)
    v_mfma_f32_32x32x16_bf16 v[176:191], a[116:119], v[156:159], v[176:191]
    ds_read_b64_tr_b16 a[140:141], v13 offset:24832
    ds_read_b64_tr_b16 a[142:143], v13 offset:28928
    v_add_f32 v20, v20, v21
    v_mov_b32 v21, v20
    s_waitcnt lgkmcnt(10)
    v_mfma_f32_32x32x16_bf16 v[192:207], a[120:123], v[156:159], v[192:207]
    s_waitcnt vmcnt(17) lgkmcnt(0)
    s_barrier
    v_xor_b32 v10, 0, v9
    ds_read_b64_tr_b16 a[112:113], v10 offset:0
    ds_read_b64_tr_b16 a[114:115], v10 offset:1024
    v_permlane32_swap_b32 v20, v21
    v_add_f32 v20, v20, v21
    v_rcp_f32 v20, v20
    s_lshl_b32 s5, s48, 14
    s_add_u32 s5, s5, 98304
    v_lshlrev_b32 v14, 4, v1
    v_add_u32 v14, s5, v14
    s_xor_b32 s5, s48, 2
    s_lshl_b32 s5, s5, 14
    s_add_u32 s5, s5, 98304
    v_lshlrev_b32 v15, 4, v1
    v_add_u32 v15, s5, v15
    v_mfma_f32_32x32x16_bf16 v[208:223], a[124:127], v[156:159], v[208:223]
    ds_read_b64_tr_b16 a[116:117], v10 offset:2048
    ds_read_b64_tr_b16 a[118:119], v10 offset:3072
    v_mfma_f32_32x32x16_bf16 a[144:159], a[128:131], v[156:159], a[144:159]
    ds_read_b64_tr_b16 a[120:121], v10 offset:4096
    ds_read_b64_tr_b16 a[122:123], v10 offset:5120
    v_mfma_f32_32x32x16_bf16 a[160:175], a[132:135], v[156:159], a[160:175]
    ds_read_b64_tr_b16 a[124:125], v10 offset:6144
    ds_read_b64_tr_b16 a[126:127], v10 offset:7168
    v_mul_f32 v160, v160, v20
    v_mul_f32 v161, v161, v20
    v_mul_f32 v162, v162, v20
    v_mul_f32 v163, v163, v20
    v_mul_f32 v164, v164, v20
    v_mul_f32 v165, v165, v20
    v_mul_f32 v166, v166, v20
    v_mul_f32 v167, v167, v20
    v_cvt_pk_bf16_f32 v32, v160, v161
    v_cvt_pk_bf16_f32 v33, v162, v163
    v_cvt_pk_bf16_f32 v34, v164, v165
    v_cvt_pk_bf16_f32 v35, v166, v167
    ds_write_b128 v14, v[32:35] offset:0
    v_mfma_f32_32x32x16_bf16 v[224:239], a[136:139], v[156:159], v[224:239]
    ds_read_b64_tr_b16 a[128:129], v10 offset:8192
    ds_read_b64_tr_b16 a[130:131], v10 offset:9216
    v_mul_f32 v168, v168, v20
    v_mul_f32 v169, v169, v20
    v_mul_f32 v170, v170, v20
    v_mul_f32 v171, v171, v20
    v_mul_f32 v172, v172, v20
    v_mul_f32 v173, v173, v20
    v_mul_f32 v174, v174, v20
    v_mul_f32 v175, v175, v20
    v_cvt_pk_bf16_f32 v36, v168, v169
    v_cvt_pk_bf16_f32 v37, v170, v171
    v_cvt_pk_bf16_f32 v38, v172, v173
    v_cvt_pk_bf16_f32 v39, v174, v175
    ds_write_b128 v14, v[36:39] offset:1024
    v_mfma_f32_32x32x16_bf16 v[240:255], a[140:143], v[156:159], v[240:255]
    ds_read_b64_tr_b16 a[132:133], v10 offset:10240
    ds_read_b64_tr_b16 a[134:135], v10 offset:11264
    v_mul_f32 v176, v176, v20
    v_mul_f32 v177, v177, v20
    v_mul_f32 v178, v178, v20
    v_mul_f32 v179, v179, v20
    v_mul_f32 v180, v180, v20
    v_mul_f32 v181, v181, v20
    v_mul_f32 v182, v182, v20
    v_mul_f32 v183, v183, v20
    v_cvt_pk_bf16_f32 v40, v176, v177
    v_cvt_pk_bf16_f32 v41, v178, v179
    v_cvt_pk_bf16_f32 v42, v180, v181
    v_cvt_pk_bf16_f32 v43, v182, v183
    ds_write_b128 v14, v[40:43] offset:2048
    v_mul_f32 v184, v184, v20
    v_mul_f32 v185, v185, v20
    v_mul_f32 v186, v186, v20
    v_mul_f32 v187, v187, v20
    v_mul_f32 v188, v188, v20
    v_mul_f32 v189, v189, v20
    v_mul_f32 v190, v190, v20
    v_mul_f32 v191, v191, v20
    v_cvt_pk_bf16_f32 v44, v184, v185
    v_cvt_pk_bf16_f32 v45, v186, v187
    v_cvt_pk_bf16_f32 v46, v188, v189
    v_cvt_pk_bf16_f32 v47, v190, v191
    ds_write_b128 v14, v[44:47] offset:3072
    v_pk_mul_f32 v[192:193], v[192:193], v[20:21] op_sel_hi:[1,0]
    v_pk_mul_f32 v[194:195], v[194:195], v[20:21] op_sel_hi:[1,0]
    v_pk_mul_f32 v[196:197], v[196:197], v[20:21] op_sel_hi:[1,0]
    v_pk_mul_f32 v[198:199], v[198:199], v[20:21] op_sel_hi:[1,0]
    v_cvt_pk_bf16_f32 v48, v192, v193
    v_cvt_pk_bf16_f32 v49, v194, v195
    v_cvt_pk_bf16_f32 v50, v196, v197
    v_cvt_pk_bf16_f32 v51, v198, v199
    ds_write_b128 v14, v[48:51] offset:4096
    v_pk_mul_f32 v[200:201], v[200:201], v[20:21] op_sel_hi:[1,0]
    v_pk_mul_f32 v[202:203], v[202:203], v[20:21] op_sel_hi:[1,0]
    v_pk_mul_f32 v[204:205], v[204:205], v[20:21] op_sel_hi:[1,0]
    v_pk_mul_f32 v[206:207], v[206:207], v[20:21] op_sel_hi:[1,0]
    v_cvt_pk_bf16_f32 v52, v200, v201
    v_cvt_pk_bf16_f32 v53, v202, v203
    v_cvt_pk_bf16_f32 v54, v204, v205
    v_cvt_pk_bf16_f32 v55, v206, v207
    ds_write_b128 v14, v[52:55] offset:5120
    v_pk_mul_f32 v[208:209], v[208:209], v[20:21] op_sel_hi:[1,0]
    v_pk_mul_f32 v[210:211], v[210:211], v[20:21] op_sel_hi:[1,0]
    v_pk_mul_f32 v[212:213], v[212:213], v[20:21] op_sel_hi:[1,0]
    v_pk_mul_f32 v[214:215], v[214:215], v[20:21] op_sel_hi:[1,0]
    v_cvt_pk_bf16_f32 v56, v208, v209
    v_cvt_pk_bf16_f32 v57, v210, v211
    v_cvt_pk_bf16_f32 v58, v212, v213
    v_cvt_pk_bf16_f32 v59, v214, v215
    ds_write_b128 v14, v[56:59] offset:6144
    v_pk_mul_f32 v[216:217], v[216:217], v[20:21] op_sel_hi:[1,0]
    v_pk_mul_f32 v[218:219], v[218:219], v[20:21] op_sel_hi:[1,0]
    v_pk_mul_f32 v[220:221], v[220:221], v[20:21] op_sel_hi:[1,0]
    v_pk_mul_f32 v[222:223], v[222:223], v[20:21] op_sel_hi:[1,0]
    v_cvt_pk_bf16_f32 v60, v216, v217
    v_cvt_pk_bf16_f32 v61, v218, v219
    v_cvt_pk_bf16_f32 v62, v220, v221
    v_cvt_pk_bf16_f32 v63, v222, v223
    ds_write_b128 v14, v[60:63] offset:7168
    s_waitcnt lgkmcnt(15)
    v_mfma_f32_32x32x16_bf16 v[160:175], a[112:115], v[32:35], 0
    ds_read_b64_tr_b16 a[136:137], v10 offset:12288
    ds_read_b64_tr_b16 a[138:139], v10 offset:13312
    v_accvgpr_read_b32 v22, a144
    v_accvgpr_read_b32 v23, a145
    v_accvgpr_read_b32 v24, a146
    v_accvgpr_read_b32 v25, a147
    v_accvgpr_read_b32 v26, a148
    v_accvgpr_read_b32 v27, a149
    v_accvgpr_read_b32 v28, a150
    v_accvgpr_read_b32 v29, a151
    v_mul_f32 v22, v22, v20
    v_mul_f32 v23, v23, v20
    v_mul_f32 v24, v24, v20
    v_mul_f32 v25, v25, v20
    v_mul_f32 v26, v26, v20
    v_mul_f32 v27, v27, v20
    v_mul_f32 v28, v28, v20
    v_mul_f32 v29, v29, v20
    v_cvt_pk_bf16_f32 v64, v22, v23
    v_mfma_f32_32x32x16_bf16 v[160:175], a[116:119], v[36:39], v[160:175]
    ds_read_b64_tr_b16 a[140:141], v10 offset:14336
    ds_read_b64_tr_b16 a[142:143], v10 offset:15360
    v_cvt_pk_bf16_f32 v65, v24, v25
    v_cvt_pk_bf16_f32 v66, v26, v27
    v_cvt_pk_bf16_f32 v67, v28, v29
    ds_write_b128 v14, v[64:67] offset:8192
    v_accvgpr_read_b32 v22, a152
    v_accvgpr_read_b32 v23, a153
    v_accvgpr_read_b32 v24, a154
    v_accvgpr_read_b32 v25, a155
    v_accvgpr_read_b32 v26, a156
    v_accvgpr_read_b32 v27, a157
    v_accvgpr_read_b32 v28, a158
    v_accvgpr_read_b32 v29, a159
    v_mul_f32 v22, v22, v20
    v_mul_f32 v23, v23, v20
    v_mul_f32 v24, v24, v20
    v_mul_f32 v25, v25, v20
    v_mul_f32 v26, v26, v20
    s_waitcnt lgkmcnt(15)
    v_mfma_f32_32x32x16_bf16 v[160:175], a[120:123], v[40:43], v[160:175]
    s_waitcnt vmcnt(8)
    s_barrier
    v_xor_b32 v11, 32768, v9
    ds_read_b64_tr_b16 a[112:113], v11 offset:0
    ds_read_b64_tr_b16 a[114:115], v11 offset:1024
    v_mul_f32 v27, v27, v20
    v_mul_f32 v28, v28, v20
    v_mul_f32 v29, v29, v20
    v_cvt_pk_bf16_f32 v68, v22, v23
    v_cvt_pk_bf16_f32 v69, v24, v25
    v_cvt_pk_bf16_f32 v70, v26, v27
    v_cvt_pk_bf16_f32 v71, v28, v29
    ds_write_b128 v14, v[68:71] offset:9216
    v_accvgpr_read_b32 v22, a160
    v_accvgpr_read_b32 v23, a161
    v_accvgpr_read_b32 v24, a162
    v_accvgpr_read_b32 v25, a163
    v_accvgpr_read_b32 v26, a164
    v_accvgpr_read_b32 v27, a165
    v_accvgpr_read_b32 v28, a166
    v_accvgpr_read_b32 v29, a167
    v_mul_f32 v22, v22, v20
    v_mfma_f32_32x32x16_bf16 v[160:175], a[124:127], v[44:47], v[160:175]
    ds_read_b64_tr_b16 a[116:117], v11 offset:2048
    ds_read_b64_tr_b16 a[118:119], v11 offset:3072
    v_mul_f32 v23, v23, v20
    v_mul_f32 v24, v24, v20
    v_mul_f32 v25, v25, v20
    v_mul_f32 v26, v26, v20
    v_mul_f32 v27, v27, v20
    v_mul_f32 v28, v28, v20
    v_mul_f32 v29, v29, v20
    v_cvt_pk_bf16_f32 v72, v22, v23
    v_cvt_pk_bf16_f32 v73, v24, v25
    v_cvt_pk_bf16_f32 v74, v26, v27
    v_cvt_pk_bf16_f32 v75, v28, v29
    ds_write_b128 v14, v[72:75] offset:10240
    v_accvgpr_read_b32 v22, a168
    v_accvgpr_read_b32 v23, a169
    v_accvgpr_read_b32 v24, a170
    v_accvgpr_read_b32 v25, a171
    v_accvgpr_read_b32 v26, a172
    s_waitcnt lgkmcnt(15)
    v_mfma_f32_32x32x16_bf16 v[160:175], a[128:131], v[48:51], v[160:175]
    ds_read_b64_tr_b16 a[120:121], v11 offset:4096
    ds_read_b64_tr_b16 a[122:123], v11 offset:5120
    v_accvgpr_read_b32 v27, a173
    v_accvgpr_read_b32 v28, a174
    v_accvgpr_read_b32 v29, a175
    v_mul_f32 v22, v22, v20
    v_mul_f32 v23, v23, v20
    v_mul_f32 v24, v24, v20
    v_mul_f32 v25, v25, v20
    v_mul_f32 v26, v26, v20
    v_mul_f32 v27, v27, v20
    v_mul_f32 v28, v28, v20
    v_mul_f32 v29, v29, v20
    v_cvt_pk_bf16_f32 v76, v22, v23
    v_cvt_pk_bf16_f32 v77, v24, v25
    v_cvt_pk_bf16_f32 v78, v26, v27
    v_cvt_pk_bf16_f32 v79, v28, v29
    ds_write_b128 v14, v[76:79] offset:11264
    v_mul_f32 v224, v224, v20
    v_mfma_f32_32x32x16_bf16 v[160:175], a[132:135], v[52:55], v[160:175]
    ds_read_b64_tr_b16 a[124:125], v11 offset:6144
    ds_read_b64_tr_b16 a[126:127], v11 offset:7168
    v_mul_f32 v225, v225, v20
    v_mul_f32 v226, v226, v20
    v_mul_f32 v227, v227, v20
    v_mul_f32 v228, v228, v20
    v_mul_f32 v229, v229, v20
    v_mul_f32 v230, v230, v20
    v_mul_f32 v231, v231, v20
    v_cvt_pk_bf16_f32 v80, v224, v225
    v_cvt_pk_bf16_f32 v81, v226, v227
    v_cvt_pk_bf16_f32 v82, v228, v229
    v_cvt_pk_bf16_f32 v83, v230, v231
    ds_write_b128 v14, v[80:83] offset:12288
    v_mul_f32 v232, v232, v20
    v_mul_f32 v233, v233, v20
    v_mul_f32 v234, v234, v20
    v_mul_f32 v235, v235, v20
    v_mul_f32 v236, v236, v20
    s_waitcnt lgkmcnt(15)
    v_mfma_f32_32x32x16_bf16 v[160:175], a[136:139], v[56:59], v[160:175]
    ds_read_b64_tr_b16 a[128:129], v11 offset:8192
    ds_read_b64_tr_b16 a[130:131], v11 offset:9216
    v_mul_f32 v237, v237, v20
    v_mul_f32 v238, v238, v20
    v_mul_f32 v239, v239, v20
    v_cvt_pk_bf16_f32 v84, v232, v233
    v_cvt_pk_bf16_f32 v85, v234, v235
    v_cvt_pk_bf16_f32 v86, v236, v237
    v_cvt_pk_bf16_f32 v87, v238, v239
    ds_write_b128 v14, v[84:87] offset:13312
    v_mul_f32 v240, v240, v20
    v_mul_f32 v241, v241, v20
    v_mul_f32 v242, v242, v20
    v_mul_f32 v243, v243, v20
    v_mul_f32 v244, v244, v20
    v_mul_f32 v245, v245, v20
    v_mul_f32 v246, v246, v20
    v_mul_f32 v247, v247, v20
    v_cvt_pk_bf16_f32 v88, v240, v241
    s_waitcnt lgkmcnt(15)
    v_mfma_f32_32x32x16_bf16 v[160:175], a[140:143], v[60:63], v[160:175]
    ds_read_b64_tr_b16 a[132:133], v11 offset:10240
    ds_read_b64_tr_b16 a[134:135], v11 offset:11264
    v_cvt_pk_bf16_f32 v89, v242, v243
    v_cvt_pk_bf16_f32 v90, v244, v245
    v_cvt_pk_bf16_f32 v91, v246, v247
    ds_write_b128 v14, v[88:91] offset:14336
    v_mul_f32 v248, v248, v20
    v_mul_f32 v249, v249, v20
    v_mul_f32 v250, v250, v20
    v_mul_f32 v251, v251, v20
    v_mul_f32 v252, v252, v20
    v_mul_f32 v253, v253, v20
    v_mul_f32 v254, v254, v20
    v_mul_f32 v255, v255, v20
    v_cvt_pk_bf16_f32 v92, v248, v249
    v_cvt_pk_bf16_f32 v93, v250, v251
    v_cvt_pk_bf16_f32 v94, v252, v253
    v_cvt_pk_bf16_f32 v95, v254, v255
    ds_write_b128 v14, v[92:95] offset:15360
    s_waitcnt lgkmcnt(15)
    v_mfma_f32_32x32x16_bf16 v[160:175], a[112:115], v[64:67], v[160:175]
    s_waitcnt lgkmcnt(0)
    s_barrier
    ds_read_b64_tr_b16 a[136:137], v11 offset:12288
    ds_read_b64_tr_b16 a[138:139], v11 offset:13312
    v_mfma_f32_32x32x16_bf16 v[160:175], a[116:119], v[68:71], v[160:175]
    ds_read_b64_tr_b16 a[140:141], v11 offset:14336
    ds_read_b64_tr_b16 a[142:143], v11 offset:15360
    ds_read_b128 v[96:99], v15 offset:0
    ds_read_b128 v[100:103], v15 offset:1024
    ds_read_b128 v[104:107], v15 offset:2048
    ds_read_b128 v[108:111], v15 offset:3072
    v_mfma_f32_32x32x16_bf16 v[160:175], a[120:123], v[72:75], v[160:175]
    v_xor_b32 v10, 16384, v9
    ds_read_b64_tr_b16 a[112:113], v10 offset:0
    ds_read_b64_tr_b16 a[114:115], v10 offset:1024
    ds_read_b128 v[112:115], v15 offset:4096
    ds_read_b128 v[116:119], v15 offset:5120
    ds_read_b128 v[120:123], v15 offset:6144
    ds_read_b128 v[124:127], v15 offset:7168
    v_mfma_f32_32x32x16_bf16 v[160:175], a[124:127], v[76:79], v[160:175]
    ds_read_b64_tr_b16 a[116:117], v10 offset:2048
    ds_read_b64_tr_b16 a[118:119], v10 offset:3072
    ds_read_b128 v[128:131], v15 offset:8192
    ds_read_b128 v[132:135], v15 offset:9216
    ds_read_b128 v[136:139], v15 offset:10240
    ds_read_b128 v[140:143], v15 offset:11264
    v_mfma_f32_32x32x16_bf16 v[160:175], a[128:131], v[80:83], v[160:175]
    ds_read_b64_tr_b16 a[120:121], v10 offset:4096
    ds_read_b64_tr_b16 a[122:123], v10 offset:5120
    ds_read_b128 v[144:147], v15 offset:12288
    ds_read_b128 v[148:151], v15 offset:13312
    ds_read_b128 v[152:155], v15 offset:14336
    ds_read_b128 v[156:159], v15 offset:15360
    v_mfma_f32_32x32x16_bf16 v[160:175], a[132:135], v[84:87], v[160:175]
    ds_read_b64_tr_b16 a[124:125], v10 offset:6144
    ds_read_b64_tr_b16 a[126:127], v10 offset:7168
    s_waitcnt lgkmcnt(15)
    v_mfma_f32_32x32x16_bf16 v[160:175], a[136:139], v[88:91], v[160:175]
    s_waitcnt lgkmcnt(2)
    s_barrier
    ds_read_b64_tr_b16 a[128:129], v10 offset:8192
    ds_read_b64_tr_b16 a[130:131], v10 offset:9216
    s_add_u32 m0, s40, 98304
    s_add_u32 s45, s44, 114816
    buffer_load_dwordx4 v2, s[20:23], s45 offen offset:0 lds
    v_mfma_f32_32x32x16_bf16 v[160:175], a[140:143], v[92:95], v[160:175]
    ds_read_b64_tr_b16 a[132:133], v10 offset:10240
    ds_read_b64_tr_b16 a[134:135], v10 offset:11264
    buffer_load_dwordx4 v3, s[20:23], s45 offen offset:1024 lds
    v_mfma_f32_32x32x16_bf16 v[160:175], a[112:115], v[96:99], v[160:175]
    ds_read_b64_tr_b16 a[136:137], v10 offset:12288
    ds_read_b64_tr_b16 a[138:139], v10 offset:13312
    buffer_load_dwordx4 v4, s[20:23], s45 offen offset:2048 lds
    v_mfma_f32_32x32x16_bf16 v[160:175], a[116:119], v[100:103], v[160:175]
    ds_read_b64_tr_b16 a[140:141], v10 offset:14336
    ds_read_b64_tr_b16 a[142:143], v10 offset:15360
    buffer_load_dwordx4 v5, s[20:23], s45 offen offset:3072 lds
    v_mfma_f32_32x32x16_bf16 v[160:175], a[120:123], v[104:107], v[160:175]
    v_xor_b32 v11, 49152, v9
    ds_read_b64_tr_b16 a[112:113], v11 offset:0
    ds_read_b64_tr_b16 a[114:115], v11 offset:1024
    s_add_u32 m0, s40, 102400
    s_add_u32 s45, s44, 143488
    buffer_load_dwordx4 v2, s[20:23], s45 offen offset:0 lds
    s_waitcnt lgkmcnt(10)
    v_mfma_f32_32x32x16_bf16 v[160:175], a[124:127], v[108:111], v[160:175]
    ds_read_b64_tr_b16 a[116:117], v11 offset:2048
    ds_read_b64_tr_b16 a[118:119], v11 offset:3072
    buffer_load_dwordx4 v3, s[20:23], s45 offen offset:1024 lds
    s_waitcnt lgkmcnt(10)
    v_mfma_f32_32x32x16_bf16 v[160:175], a[128:131], v[112:115], v[160:175]
    ds_read_b64_tr_b16 a[120:121], v11 offset:4096
    ds_read_b64_tr_b16 a[122:123], v11 offset:5120
    v_mov_b32 v30, 252
    buffer_load_dword v30, v30, s[92:95], 0 offen sc1
    buffer_load_dwordx4 v4, s[20:23], s45 offen offset:2048 lds
    s_waitcnt lgkmcnt(10)
    v_mfma_f32_32x32x16_bf16 v[160:175], a[132:135], v[116:119], v[160:175]
    ds_read_b64_tr_b16 a[124:125], v11 offset:6144
    ds_read_b64_tr_b16 a[126:127], v11 offset:7168
    buffer_load_dwordx4 v5, s[20:23], s45 offen offset:3072 lds
    s_waitcnt lgkmcnt(10)
    v_mfma_f32_32x32x16_bf16 v[160:175], a[136:139], v[120:123], v[160:175]
    ds_read_b64_tr_b16 a[128:129], v11 offset:8192
    ds_read_b64_tr_b16 a[130:131], v11 offset:9216
    s_add_u32 m0, s40, 131072
    s_add_u32 s45, s44, 256
    buffer_load_dwordx4 v2, s[20:23], s45 offen offset:0 lds
    s_waitcnt lgkmcnt(10)
    v_mfma_f32_32x32x16_bf16 v[160:175], a[140:143], v[124:127], v[160:175]
    ds_read_b64_tr_b16 a[132:133], v11 offset:10240
    ds_read_b64_tr_b16 a[134:135], v11 offset:11264
    s_waitcnt lgkmcnt(10)
    v_mfma_f32_32x32x16_bf16 v[160:175], a[112:115], v[128:131], v[160:175]
    ds_read_b64_tr_b16 a[136:137], v11 offset:12288
    ds_read_b64_tr_b16 a[138:139], v11 offset:13312
    buffer_load_dwordx4 v3, s[20:23], s45 offen offset:1024 lds
    s_waitcnt lgkmcnt(10)
    v_mfma_f32_32x32x16_bf16 v[160:175], a[116:119], v[132:135], v[160:175]
    ds_read_b64_tr_b16 a[140:141], v11 offset:14336
    ds_read_b64_tr_b16 a[142:143], v11 offset:15360
    s_waitcnt lgkmcnt(10)
    v_mfma_f32_32x32x16_bf16 v[160:175], a[120:123], v[136:139], v[160:175]
    s_waitcnt vmcnt(11)
    s_barrier
    v_xor_b32 v10, 65536, v9
    ds_read_b64_tr_b16 a[112:113], v10 offset:0
    ds_read_b64_tr_b16 a[114:115], v10 offset:1024
    buffer_load_dwordx4 v4, s[20:23], s45 offen offset:2048 lds
    s_waitcnt lgkmcnt(10)
    v_mfma_f32_32x32x16_bf16 v[160:175], a[124:127], v[140:143], v[160:175]
    ds_read_b64_tr_b16 a[116:117], v10 offset:2048
    ds_read_b64_tr_b16 a[118:119], v10 offset:3072
    buffer_load_dwordx4 v5, s[20:23], s45 offen offset:3072 lds
    s_waitcnt lgkmcnt(10)
    v_mfma_f32_32x32x16_bf16 v[160:175], a[128:131], v[144:147], v[160:175]
    ds_read_b64_tr_b16 a[120:121], v10 offset:4096
    ds_read_b64_tr_b16 a[122:123], v10 offset:5120
    s_add_u32 m0, s40, 135168
    s_add_u32 s45, s44, 28928
    buffer_load_dwordx4 v2, s[20:23], s45 offen offset:0 lds
    s_waitcnt lgkmcnt(10)
    v_mfma_f32_32x32x16_bf16 v[160:175], a[132:135], v[148:151], v[160:175]
    ds_read_b64_tr_b16 a[124:125], v10 offset:6144
    ds_read_b64_tr_b16 a[126:127], v10 offset:7168
    buffer_load_dwordx4 v3, s[20:23], s45 offen offset:1024 lds
    s_waitcnt lgkmcnt(10)
    v_mfma_f32_32x32x16_bf16 v[160:175], a[136:139], v[152:155], v[160:175]
    ds_read_b64_tr_b16 a[128:129], v10 offset:8192
    ds_read_b64_tr_b16 a[130:131], v10 offset:9216
    buffer_load_dwordx4 v4, s[20:23], s45 offen offset:2048 lds
    s_waitcnt lgkmcnt(10)
    v_mfma_f32_32x32x16_bf16 v[160:175], a[140:143], v[156:159], v[160:175]
    ds_read_b64_tr_b16 a[132:133], v10 offset:10240
    ds_read_b64_tr_b16 a[134:135], v10 offset:11264
    buffer_load_dwordx4 v5, s[20:23], s45 offen offset:3072 lds
    s_waitcnt lgkmcnt(10)
    v_mfma_f32_32x32x16_bf16 v[176:191], a[112:115], v[32:35], 0
    ds_read_b64_tr_b16 a[136:137], v10 offset:12288
    ds_read_b64_tr_b16 a[138:139], v10 offset:13312
    s_add_u32 m0, s40, 0
    s_add_u32 s45, s44, 114944
    buffer_load_dwordx4 v2, s[20:23], s45 offen offset:0 lds
    s_waitcnt lgkmcnt(10)
    v_mfma_f32_32x32x16_bf16 v[176:191], a[116:119], v[36:39], v[176:191]
    ds_read_b64_tr_b16 a[140:141], v10 offset:14336
    ds_read_b64_tr_b16 a[142:143], v10 offset:15360
    s_waitcnt lgkmcnt(10)
    v_mfma_f32_32x32x16_bf16 v[176:191], a[120:123], v[40:43], v[176:191]
    v_xor_b32 v11, 81920, v9
    ds_read_b64_tr_b16 a[112:113], v11 offset:0
    ds_read_b64_tr_b16 a[114:115], v11 offset:1024
    buffer_load_dwordx4 v3, s[20:23], s45 offen offset:1024 lds
    s_waitcnt lgkmcnt(10)
    v_mfma_f32_32x32x16_bf16 v[176:191], a[124:127], v[44:47], v[176:191]
    ds_read_b64_tr_b16 a[116:117], v11 offset:2048
    ds_read_b64_tr_b16 a[118:119], v11 offset:3072
    v_cvt_pk_bf16_f32 v192, v160, v161
    v_cvt_pk_bf16_f32 v193, v162, v163
    s_waitcnt lgkmcnt(10)
    v_mfma_f32_32x32x16_bf16 v[176:191], a[128:131], v[48:51], v[176:191]
    ds_read_b64_tr_b16 a[120:121], v11 offset:4096
    ds_read_b64_tr_b16 a[122:123], v11 offset:5120
    v_cvt_pk_bf16_f32 v194, v164, v165
    v_cvt_pk_bf16_f32 v195, v166, v167
    buffer_store_dwordx4 v[192:195], v18, s[24:27], s46 offen offset:0 sc1
    buffer_load_dwordx4 v4, s[20:23], s45 offen offset:2048 lds
    s_waitcnt lgkmcnt(10)
    v_mfma_f32_32x32x16_bf16 v[176:191], a[132:135], v[52:55], v[176:191]
    ds_read_b64_tr_b16 a[124:125], v11 offset:6144
    ds_read_b64_tr_b16 a[126:127], v11 offset:7168
    v_cvt_pk_bf16_f32 v196, v168, v169
    v_cvt_pk_bf16_f32 v197, v170, v171
    s_waitcnt lgkmcnt(10)
    v_mfma_f32_32x32x16_bf16 v[176:191], a[136:139], v[56:59], v[176:191]
    ds_read_b64_tr_b16 a[128:129], v11 offset:8192
    ds_read_b64_tr_b16 a[130:131], v11 offset:9216
    v_cvt_pk_bf16_f32 v198, v172, v173
    v_cvt_pk_bf16_f32 v199, v174, v175
    buffer_store_dwordx4 v[196:199], v18, s[24:27], s46 offen offset:1024 sc1
    s_add_u32 s46, s46, 4096
    buffer_load_dwordx4 v5, s[20:23], s45 offen offset:3072 lds
    s_waitcnt lgkmcnt(10)
    v_mfma_f32_32x32x16_bf16 v[176:191], a[140:143], v[60:63], v[176:191]
    ds_read_b64_tr_b16 a[132:133], v11 offset:10240
    ds_read_b64_tr_b16 a[134:135], v11 offset:11264
    s_waitcnt vmcnt(16)
    v_cmp_eq_u32 vcc, 28, v30
    s_mov_b32 s5, 0
    s_nop 3
    s_cbranch_vccnz k1_kernel_L2_ok
k1_kernel_L2:
    v_mov_b32 v30, 252
    buffer_load_dword v30, v30, s[92:95], 0 offen sc1
    s_add_u32 s5, s5, 1
    s_waitcnt vmcnt(0)
    v_cmp_eq_u32 vcc, 28, v30
    s_nop 4
    s_cbranch_vccnz k1_kernel_L2_ok
    s_cmp_lt_u32 s5, 0x20000
    s_cbranch_scc1 k1_kernel_L2
k1_kernel_L2_ok:
    s_waitcnt lgkmcnt(10)
    v_mfma_f32_32x32x16_bf16 v[176:191], a[112:115], v[96:99], v[176:191]
    ds_read_b64_tr_b16 a[136:137], v11 offset:12288
    ds_read_b64_tr_b16 a[138:139], v11 offset:13312
    s_mov_b32 s8, s54
    s_mov_b32 s9, s55
    s_mov_b32 s10, 1835008
    s_mul_i32 s5, s48, 14
    v_lshrrev_b32 v26, 3, v1
    v_add_u32 v26, s5, v26
    s_add_u32 m0, s40, 4096
    s_add_u32 s45, s44, 143616
    buffer_load_dwordx4 v2, s[20:23], s45 offen offset:0 lds
    s_waitcnt lgkmcnt(10)
    v_mfma_f32_32x32x16_bf16 v[176:191], a[116:119], v[100:103], v[176:191]
    ds_read_b64_tr_b16 a[140:141], v11 offset:14336
    ds_read_b64_tr_b16 a[142:143], v11 offset:15360
    v_and_b32 v27, 7, v1
    v_cmp_gt_u32 vcc, 56, v1
    v_mov_b32 v31, 0x7ffffff0
    v_lshlrev_b32 v28, 9, v26
    v_lshl_add_u32 v28, v27, 4, v28
    s_waitcnt lgkmcnt(10)
    v_mfma_f32_32x32x16_bf16 v[176:191], a[120:123], v[104:107], v[176:191]
    s_waitcnt vmcnt(15)
    s_barrier
    v_xor_b32 v10, 98304, v9
    ds_read_b64_tr_b16 a[112:113], v10 offset:0
    ds_read_b64_tr_b16 a[114:115], v10 offset:1024
    v_lshlrev_b32 v26, 4, v26
    v_mul_u32_u24 v27, 896, v27
    v_add_u32 v27, v27, v26
    v_cndmask_b32 v26, v31, v26, vcc
    v_cndmask_b32 v27, v31, v27, vcc
    v_cndmask_b32 v28, v31, v28, vcc
    buffer_load_dwordx4 v3, s[20:23], s45 offen offset:1024 lds
    s_waitcnt lgkmcnt(10)
    v_mfma_f32_32x32x16_bf16 v[176:191], a[124:127], v[108:111], v[176:191]
    ds_read_b64_tr_b16 a[116:117], v10 offset:2048
    ds_read_b64_tr_b16 a[118:119], v10 offset:3072
    s_lshl_b32 s5, s4, 3
    s_add_u32 s52, s5, s3
    s_mul_i32 s5, s52, 7168
    buffer_load_dwordx4 v4, s[20:23], s45 offen offset:2048 lds
    s_waitcnt lgkmcnt(10)
    v_mfma_f32_32x32x16_bf16 v[176:191], a[128:131], v[112:115], v[176:191]
    ds_read_b64_tr_b16 a[120:121], v10 offset:4096
    ds_read_b64_tr_b16 a[122:123], v10 offset:5120
    buffer_load_dwordx4 v[224:227], v27, s[8:11], s5 offen offset:0
    buffer_load_dwordx4 v5, s[20:23], s45 offen offset:3072 lds
    s_waitcnt lgkmcnt(10)
    v_mfma_f32_32x32x16_bf16 v[176:191], a[132:135], v[116:119], v[176:191]
    ds_read_b64_tr_b16 a[124:125], v10 offset:6144
    ds_read_b64_tr_b16 a[126:127], v10 offset:7168
    buffer_load_dwordx4 v[228:231], v27, s[8:11], s5 offen offset:112
    s_waitcnt lgkmcnt(10)
    v_mfma_f32_32x32x16_bf16 v[176:191], a[136:139], v[120:123], v[176:191]
    ds_read_b64_tr_b16 a[128:129], v10 offset:8192
    ds_read_b64_tr_b16 a[130:131], v10 offset:9216
    buffer_load_dwordx4 v[232:235], v26, s[24:27], 0 offen offset:1792
    s_add_u32 m0, s40, 32768
    s_add_u32 s45, s44, 384
    buffer_load_dwordx4 v2, s[20:23], s45 offen offset:0 lds
    s_waitcnt lgkmcnt(10)
    v_mfma_f32_32x32x16_bf16 v[176:191], a[140:143], v[124:127], v[176:191]
    ds_read_b64_tr_b16 a[132:133], v10 offset:10240
    ds_read_b64_tr_b16 a[134:135], v10 offset:11264
    buffer_load_dwordx4 v[240:243], v26, s[24:27], 0 offen offset:2688
    s_waitcnt lgkmcnt(10)
    v_mfma_f32_32x32x16_bf16 v[176:191], a[112:115], v[64:67], v[176:191]
    ds_read_b64_tr_b16 a[136:137], v10 offset:12288
    ds_read_b64_tr_b16 a[138:139], v10 offset:13312
    buffer_load_dwordx4 v[248:251], v26, s[24:27], 0 offen offset:3584
    buffer_load_dwordx4 v3, s[20:23], s45 offen offset:1024 lds
    s_waitcnt lgkmcnt(10)
    v_mfma_f32_32x32x16_bf16 v[176:191], a[116:119], v[68:71], v[176:191]
    ds_read_b64_tr_b16 a[140:141], v10 offset:14336
    ds_read_b64_tr_b16 a[142:143], v10 offset:15360
    buffer_load_dwordx4 v[236:239], v26, s[24:27], 0 offen offset:1904
    s_waitcnt lgkmcnt(10)
    v_mfma_f32_32x32x16_bf16 v[176:191], a[120:123], v[72:75], v[176:191]
    v_xor_b32 v11, 114688, v9
    ds_read_b64_tr_b16 a[112:113], v11 offset:0
    ds_read_b64_tr_b16 a[114:115], v11 offset:1024
    buffer_load_dwordx4 v[244:247], v26, s[24:27], 0 offen offset:2800
    buffer_load_dwordx4 v4, s[20:23], s45 offen offset:2048 lds
    s_waitcnt lgkmcnt(10)
    v_mfma_f32_32x32x16_bf16 v[176:191], a[124:127], v[76:79], v[176:191]
    ds_read_b64_tr_b16 a[116:117], v11 offset:2048
    ds_read_b64_tr_b16 a[118:119], v11 offset:3072
    buffer_load_dwordx4 v[252:255], v26, s[24:27], 0 offen offset:3696
    s_waitcnt lgkmcnt(10)
    v_mfma_f32_32x32x16_bf16 v[176:191], a[128:131], v[80:83], v[176:191]
    ds_read_b64_tr_b16 a[120:121], v11 offset:4096
    ds_read_b64_tr_b16 a[122:123], v11 offset:5120
    buffer_load_dwordx4 v5, s[20:23], s45 offen offset:3072 lds
    s_waitcnt lgkmcnt(10)
    v_mfma_f32_32x32x16_bf16 v[176:191], a[132:135], v[84:87], v[176:191]
    ds_read_b64_tr_b16 a[124:125], v11 offset:6144
    ds_read_b64_tr_b16 a[126:127], v11 offset:7168
    s_waitcnt lgkmcnt(10)
    v_mfma_f32_32x32x16_bf16 v[176:191], a[136:139], v[88:91], v[176:191]
    ds_read_b64_tr_b16 a[128:129], v11 offset:8192
    ds_read_b64_tr_b16 a[130:131], v11 offset:9216
    s_add_u32 m0, s40, 36864
    s_add_u32 s45, s44, 29056
    buffer_load_dwordx4 v2, s[20:23], s45 offen offset:0 lds
    s_waitcnt lgkmcnt(10)
    v_mfma_f32_32x32x16_bf16 v[176:191], a[140:143], v[92:95], v[176:191]
    ds_read_b64_tr_b16 a[132:133], v11 offset:10240
    ds_read_b64_tr_b16 a[134:135], v11 offset:11264
    s_waitcnt lgkmcnt(10)
    v_mfma_f32_32x32x16_bf16 v[176:191], a[112:115], v[128:131], v[176:191]
    ds_read_b64_tr_b16 a[136:137], v11 offset:12288
    ds_read_b64_tr_b16 a[138:139], v11 offset:13312
    buffer_load_dwordx4 v3, s[20:23], s45 offen offset:1024 lds
    s_waitcnt lgkmcnt(10)
    v_mfma_f32_32x32x16_bf16 v[176:191], a[116:119], v[132:135], v[176:191]
    ds_read_b64_tr_b16 a[140:141], v11 offset:14336
    ds_read_b64_tr_b16 a[142:143], v11 offset:15360
    s_waitcnt lgkmcnt(10)
    v_mfma_f32_32x32x16_bf16 v[176:191], a[120:123], v[136:139], v[176:191]
    s_waitcnt vmcnt(24)
    s_barrier
    v_xor_b32 v10, 131072, v9
    ds_read_b64_tr_b16 a[112:113], v10 offset:0
    ds_read_b64_tr_b16 a[114:115], v10 offset:1024
    buffer_load_dwordx4 v4, s[20:23], s45 offen offset:2048 lds
    s_waitcnt lgkmcnt(10)
    v_mfma_f32_32x32x16_bf16 v[176:191], a[124:127], v[140:143], v[176:191]
    ds_read_b64_tr_b16 a[116:117], v10 offset:2048
    ds_read_b64_tr_b16 a[118:119], v10 offset:3072
    buffer_load_dwordx4 v5, s[20:23], s45 offen offset:3072 lds
    s_waitcnt lgkmcnt(10)
    v_mfma_f32_32x32x16_bf16 v[176:191], a[128:131], v[144:147], v[176:191]
    ds_read_b64_tr_b16 a[120:121], v10 offset:4096
    ds_read_b64_tr_b16 a[122:123], v10 offset:5120
    s_add_u32 m0, s40, 65536
    s_add_u32 s45, s44, 115072
    buffer_load_dwordx4 v2, s[20:23], s45 offen offset:0 lds
    s_waitcnt lgkmcnt(10)
    v_mfma_f32_32x32x16_bf16 v[176:191], a[132:135], v[148:151], v[176:191]
    ds_read_b64_tr_b16 a[124:125], v10 offset:6144
    ds_read_b64_tr_b16 a[126:127], v10 offset:7168
    s_waitcnt lgkmcnt(10)
    v_mfma_f32_32x32x16_bf16 v[176:191], a[136:139], v[152:155], v[176:191]
    ds_read_b64_tr_b16 a[128:129], v10 offset:8192
    ds_read_b64_tr_b16 a[130:131], v10 offset:9216
    buffer_load_dwordx4 v3, s[20:23], s45 offen offset:1024 lds
    s_waitcnt lgkmcnt(10)
    v_mfma_f32_32x32x16_bf16 v[176:191], a[140:143], v[156:159], v[176:191]
    ds_read_b64_tr_b16 a[132:133], v10 offset:10240
    ds_read_b64_tr_b16 a[134:135], v10 offset:11264
    s_waitcnt lgkmcnt(10)
    v_mfma_f32_32x32x16_bf16 v[160:175], a[112:115], v[32:35], 0
    ds_read_b64_tr_b16 a[136:137], v10 offset:12288
    ds_read_b64_tr_b16 a[138:139], v10 offset:13312
    buffer_load_dwordx4 v4, s[20:23], s45 offen offset:2048 lds
    s_waitcnt lgkmcnt(10)
    v_mfma_f32_32x32x16_bf16 v[160:175], a[116:119], v[36:39], v[160:175]
    ds_read_b64_tr_b16 a[140:141], v10 offset:14336
    ds_read_b64_tr_b16 a[142:143], v10 offset:15360
    s_waitcnt lgkmcnt(10)
    v_mfma_f32_32x32x16_bf16 v[160:175], a[120:123], v[40:43], v[160:175]
    v_xor_b32 v11, 147456, v9
    ds_read_b64_tr_b16 a[112:113], v11 offset:0
    ds_read_b64_tr_b16 a[114:115], v11 offset:1024
    buffer_load_dwordx4 v5, s[20:23], s45 offen offset:3072 lds
    s_waitcnt lgkmcnt(10)
    v_mfma_f32_32x32x16_bf16 v[160:175], a[124:127], v[44:47], v[160:175]
    ds_read_b64_tr_b16 a[116:117], v11 offset:2048
    ds_read_b64_tr_b16 a[118:119], v11 offset:3072
    v_cvt_pk_bf16_f32 v192, v176, v177
    v_cvt_pk_bf16_f32 v193, v178, v179
    s_waitcnt lgkmcnt(10)
    v_mfma_f32_32x32x16_bf16 v[160:175], a[128:131], v[48:51], v[160:175]
    ds_read_b64_tr_b16 a[120:121], v11 offset:4096
    ds_read_b64_tr_b16 a[122:123], v11 offset:5120
    v_cvt_pk_bf16_f32 v194, v180, v181
    v_cvt_pk_bf16_f32 v195, v182, v183
    buffer_store_dwordx4 v[192:195], v18, s[24:27], s46 offen offset:0 sc1
    s_add_u32 m0, s40, 69632
    s_add_u32 s45, s44, 143744
    buffer_load_dwordx4 v2, s[20:23], s45 offen offset:0 lds
    s_waitcnt lgkmcnt(10)
    v_mfma_f32_32x32x16_bf16 v[160:175], a[132:135], v[52:55], v[160:175]
    ds_read_b64_tr_b16 a[124:125], v11 offset:6144
    ds_read_b64_tr_b16 a[126:127], v11 offset:7168
    v_cvt_pk_bf16_f32 v196, v184, v185
    v_cvt_pk_bf16_f32 v197, v186, v187
    s_waitcnt lgkmcnt(10)
    v_mfma_f32_32x32x16_bf16 v[160:175], a[136:139], v[56:59], v[160:175]
    ds_read_b64_tr_b16 a[128:129], v11 offset:8192
    ds_read_b64_tr_b16 a[130:131], v11 offset:9216
    v_cvt_pk_bf16_f32 v198, v188, v189
    v_cvt_pk_bf16_f32 v199, v190, v191
    buffer_store_dwordx4 v[196:199], v18, s[24:27], s46 offen offset:1024 sc1
    s_add_u32 s46, s46, 4096
    buffer_load_dwordx4 v3, s[20:23], s45 offen offset:1024 lds
    s_waitcnt lgkmcnt(10)
    v_mfma_f32_32x32x16_bf16 v[160:175], a[140:143], v[60:63], v[160:175]
    ds_read_b64_tr_b16 a[132:133], v11 offset:10240
    ds_read_b64_tr_b16 a[134:135], v11 offset:11264
    s_waitcnt lgkmcnt(10)
    v_mfma_f32_32x32x16_bf16 v[160:175], a[112:115], v[96:99], v[160:175]
    ds_read_b64_tr_b16 a[136:137], v11 offset:12288
    ds_read_b64_tr_b16 a[138:139], v11 offset:13312
    buffer_load_dwordx4 v4, s[20:23], s45 offen offset:2048 lds
    s_waitcnt lgkmcnt(10)
    v_mfma_f32_32x32x16_bf16 v[160:175], a[116:119], v[100:103], v[160:175]
    ds_read_b64_tr_b16 a[140:141], v11 offset:14336
    ds_read_b64_tr_b16 a[142:143], v11 offset:15360
    s_waitcnt lgkmcnt(10)
    v_mfma_f32_32x32x16_bf16 v[160:175], a[120:123], v[104:107], v[160:175]
    s_waitcnt vmcnt(24)
    s_barrier
    v_xor_b32 v10, 0, v9
    ds_read_b64_tr_b16 a[112:113], v10 offset:0
    ds_read_b64_tr_b16 a[114:115], v10 offset:1024
    buffer_load_dwordx4 v5, s[20:23], s45 offen offset:3072 lds
    s_waitcnt lgkmcnt(10)
    v_mfma_f32_32x32x16_bf16 v[160:175], a[124:127], v[108:111], v[160:175]
    ds_read_b64_tr_b16 a[116:117], v10 offset:2048
    ds_read_b64_tr_b16 a[118:119], v10 offset:3072
    s_waitcnt lgkmcnt(10)
    v_mfma_f32_32x32x16_bf16 v[160:175], a[128:131], v[112:115], v[160:175]
    ds_read_b64_tr_b16 a[120:121], v10 offset:4096
    ds_read_b64_tr_b16 a[122:123], v10 offset:5120
    s_add_u32 m0, s40, 98304
    s_add_u32 s45, s44, 512
    buffer_load_dwordx4 v2, s[20:23], s45 offen offset:0 lds
    s_waitcnt lgkmcnt(10)
    v_mfma_f32_32x32x16_bf16 v[160:175], a[132:135], v[116:119], v[160:175]
    ds_read_b64_tr_b16 a[124:125], v10 offset:6144
    ds_read_b64_tr_b16 a[126:127], v10 offset:7168
    s_waitcnt lgkmcnt(10)
    v_mfma_f32_32x32x16_bf16 v[160:175], a[136:139], v[120:123], v[160:175]
    ds_read_b64_tr_b16 a[128:129], v10 offset:8192
    ds_read_b64_tr_b16 a[130:131], v10 offset:9216
    buffer_load_dwordx4 v3, s[20:23], s45 offen offset:1024 lds
    s_waitcnt lgkmcnt(10)
    v_mfma_f32_32x32x16_bf16 v[160:175], a[140:143], v[124:127], v[160:175]
    ds_read_b64_tr_b16 a[132:133], v10 offset:10240
    ds_read_b64_tr_b16 a[134:135], v10 offset:11264
    s_waitcnt lgkmcnt(10)
    v_mfma_f32_32x32x16_bf16 v[160:175], a[112:115], v[64:67], v[160:175]
    ds_read_b64_tr_b16 a[136:137], v10 offset:12288
    ds_read_b64_tr_b16 a[138:139], v10 offset:13312
    buffer_load_dwordx4 v4, s[20:23], s45 offen offset:2048 lds
    s_waitcnt lgkmcnt(10)
    v_mfma_f32_32x32x16_bf16 v[160:175], a[116:119], v[68:71], v[160:175]
    ds_read_b64_tr_b16 a[140:141], v10 offset:14336
    ds_read_b64_tr_b16 a[142:143], v10 offset:15360
    s_waitcnt lgkmcnt(10)
    v_mfma_f32_32x32x16_bf16 v[160:175], a[120:123], v[72:75], v[160:175]
    v_xor_b32 v11, 16384, v9
    ds_read_b64_tr_b16 a[112:113], v11 offset:0
    ds_read_b64_tr_b16 a[114:115], v11 offset:1024
    buffer_load_dwordx4 v5, s[20:23], s45 offen offset:3072 lds
    s_waitcnt lgkmcnt(10)
    v_mfma_f32_32x32x16_bf16 v[160:175], a[124:127], v[76:79], v[160:175]
    ds_read_b64_tr_b16 a[116:117], v11 offset:2048
    ds_read_b64_tr_b16 a[118:119], v11 offset:3072
    s_waitcnt lgkmcnt(10)
    v_mfma_f32_32x32x16_bf16 v[160:175], a[128:131], v[80:83], v[160:175]
    ds_read_b64_tr_b16 a[120:121], v11 offset:4096
    ds_read_b64_tr_b16 a[122:123], v11 offset:5120
    s_add_u32 m0, s40, 102400
    s_add_u32 s45, s44, 29184
    buffer_load_dwordx4 v2, s[20:23], s45 offen offset:0 lds
    s_waitcnt lgkmcnt(10)
    v_mfma_f32_32x32x16_bf16 v[160:175], a[132:135], v[84:87], v[160:175]
    ds_read_b64_tr_b16 a[124:125], v11 offset:6144
    ds_read_b64_tr_b16 a[126:127], v11 offset:7168
    s_waitcnt lgkmcnt(10)
    v_mfma_f32_32x32x16_bf16 v[160:175], a[136:139], v[88:91], v[160:175]
    ds_read_b64_tr_b16 a[128:129], v11 offset:8192
    ds_read_b64_tr_b16 a[130:131], v11 offset:9216
    buffer_load_dwordx4 v3, s[20:23], s45 offen offset:1024 lds
    s_waitcnt lgkmcnt(10)
    v_mfma_f32_32x32x16_bf16 v[160:175], a[140:143], v[92:95], v[160:175]
    ds_read_b64_tr_b16 a[132:133], v11 offset:10240
    ds_read_b64_tr_b16 a[134:135], v11 offset:11264
    s_waitcnt lgkmcnt(10)
    v_mfma_f32_32x32x16_bf16 v[160:175], a[112:115], v[128:131], v[160:175]
    ds_read_b64_tr_b16 a[136:137], v11 offset:12288
    ds_read_b64_tr_b16 a[138:139], v11 offset:13312
    buffer_load_dwordx4 v4, s[20:23], s45 offen offset:2048 lds
    s_waitcnt lgkmcnt(10)
    v_mfma_f32_32x32x16_bf16 v[160:175], a[116:119], v[132:135], v[160:175]
    ds_read_b64_tr_b16 a[140:141], v11 offset:14336
    ds_read_b64_tr_b16 a[142:143], v11 offset:15360
    s_waitcnt lgkmcnt(10)
    v_mfma_f32_32x32x16_bf16 v[160:175], a[120:123], v[136:139], v[160:175]
    s_waitcnt vmcnt(17)
    s_barrier
    v_xor_b32 v10, 32768, v9
    ds_read_b64_tr_b16 a[112:113], v10 offset:0
    ds_read_b64_tr_b16 a[114:115], v10 offset:1024
    buffer_load_dwordx4 v5, s[20:23], s45 offen offset:3072 lds
    s_waitcnt lgkmcnt(10)
    v_mfma_f32_32x32x16_bf16 v[160:175], a[124:127], v[140:143], v[160:175]
    ds_read_b64_tr_b16 a[116:117], v10 offset:2048
    ds_read_b64_tr_b16 a[118:119], v10 offset:3072
    s_waitcnt lgkmcnt(10)
    v_mfma_f32_32x32x16_bf16 v[160:175], a[128:131], v[144:147], v[160:175]
    ds_read_b64_tr_b16 a[120:121], v10 offset:4096
    ds_read_b64_tr_b16 a[122:123], v10 offset:5120
    s_add_u32 m0, s40, 131072
    s_add_u32 s45, s44, 115200
    buffer_load_dwordx4 v2, s[20:23], s45 offen offset:0 lds
    s_waitcnt lgkmcnt(10)
    v_mfma_f32_32x32x16_bf16 v[160:175], a[132:135], v[148:151], v[160:175]
    ds_read_b64_tr_b16 a[124:125], v10 offset:6144
    ds_read_b64_tr_b16 a[126:127], v10 offset:7168
    s_waitcnt lgkmcnt(10)
    v_mfma_f32_32x32x16_bf16 v[160:175], a[136:139], v[152:155], v[160:175]
    ds_read_b64_tr_b16 a[128:129], v10 offset:8192
    ds_read_b64_tr_b16 a[130:131], v10 offset:9216
    buffer_load_dwordx4 v3, s[20:23], s45 offen offset:1024 lds
    s_waitcnt lgkmcnt(10)
    v_mfma_f32_32x32x16_bf16 v[160:175], a[140:143], v[156:159], v[160:175]
    ds_read_b64_tr_b16 a[132:133], v10 offset:10240
    ds_read_b64_tr_b16 a[134:135], v10 offset:11264
    s_waitcnt lgkmcnt(10)
    v_mfma_f32_32x32x16_bf16 v[176:191], a[112:115], v[32:35], 0
    ds_read_b64_tr_b16 a[136:137], v10 offset:12288
    ds_read_b64_tr_b16 a[138:139], v10 offset:13312
    buffer_load_dwordx4 v4, s[20:23], s45 offen offset:2048 lds
    s_waitcnt lgkmcnt(10)
    v_mfma_f32_32x32x16_bf16 v[176:191], a[116:119], v[36:39], v[176:191]
    ds_read_b64_tr_b16 a[140:141], v10 offset:14336
    ds_read_b64_tr_b16 a[142:143], v10 offset:15360
    s_waitcnt lgkmcnt(10)
    v_mfma_f32_32x32x16_bf16 v[176:191], a[120:123], v[40:43], v[176:191]
    v_xor_b32 v11, 49152, v9
    ds_read_b64_tr_b16 a[112:113], v11 offset:0
    ds_read_b64_tr_b16 a[114:115], v11 offset:1024
    buffer_load_dwordx4 v5, s[20:23], s45 offen offset:3072 lds
    s_waitcnt lgkmcnt(10)
    v_mfma_f32_32x32x16_bf16 v[176:191], a[124:127], v[44:47], v[176:191]
    ds_read_b64_tr_b16 a[116:117], v11 offset:2048
    ds_read_b64_tr_b16 a[118:119], v11 offset:3072
    v_cvt_pk_bf16_f32 v192, v160, v161
    v_cvt_pk_bf16_f32 v193, v162, v163
    s_waitcnt lgkmcnt(10)
    v_mfma_f32_32x32x16_bf16 v[176:191], a[128:131], v[48:51], v[176:191]
    ds_read_b64_tr_b16 a[120:121], v11 offset:4096
    ds_read_b64_tr_b16 a[122:123], v11 offset:5120
    v_cvt_pk_bf16_f32 v194, v164, v165
    v_cvt_pk_bf16_f32 v195, v166, v167
    buffer_store_dwordx4 v[192:195], v18, s[24:27], s46 offen offset:0 sc1
    s_add_u32 m0, s40, 135168
    s_add_u32 s45, s44, 143872
    buffer_load_dwordx4 v2, s[20:23], s45 offen offset:0 lds
    s_waitcnt lgkmcnt(10)
    v_mfma_f32_32x32x16_bf16 v[176:191], a[132:135], v[52:55], v[176:191]
    ds_read_b64_tr_b16 a[124:125], v11 offset:6144
    ds_read_b64_tr_b16 a[126:127], v11 offset:7168
    v_cvt_pk_bf16_f32 v196, v168, v169
    v_cvt_pk_bf16_f32 v197, v170, v171
    s_waitcnt lgkmcnt(10)
    v_mfma_f32_32x32x16_bf16 v[176:191], a[136:139], v[56:59], v[176:191]
    ds_read_b64_tr_b16 a[128:129], v11 offset:8192
    ds_read_b64_tr_b16 a[130:131], v11 offset:9216
    v_cvt_pk_bf16_f32 v198, v172, v173
    v_cvt_pk_bf16_f32 v199, v174, v175
    buffer_store_dwordx4 v[196:199], v18, s[24:27], s46 offen offset:1024 sc1
    s_add_u32 s46, s46, 4096
    buffer_load_dwordx4 v3, s[20:23], s45 offen offset:1024 lds
    s_waitcnt lgkmcnt(10)
    v_mfma_f32_32x32x16_bf16 v[176:191], a[140:143], v[60:63], v[176:191]
    ds_read_b64_tr_b16 a[132:133], v11 offset:10240
    ds_read_b64_tr_b16 a[134:135], v11 offset:11264
    s_waitcnt lgkmcnt(10)
    v_mfma_f32_32x32x16_bf16 v[176:191], a[112:115], v[96:99], v[176:191]
    ds_read_b64_tr_b16 a[136:137], v11 offset:12288
    ds_read_b64_tr_b16 a[138:139], v11 offset:13312
    buffer_load_dwordx4 v4, s[20:23], s45 offen offset:2048 lds
    s_waitcnt lgkmcnt(10)
    v_mfma_f32_32x32x16_bf16 v[176:191], a[116:119], v[100:103], v[176:191]
    ds_read_b64_tr_b16 a[140:141], v11 offset:14336
    ds_read_b64_tr_b16 a[142:143], v11 offset:15360
    s_waitcnt lgkmcnt(10)
    v_mfma_f32_32x32x16_bf16 v[176:191], a[120:123], v[104:107], v[176:191]
    s_waitcnt vmcnt(17)
    s_barrier
    v_xor_b32 v10, 65536, v9
    ds_read_b64_tr_b16 a[112:113], v10 offset:0
    ds_read_b64_tr_b16 a[114:115], v10 offset:1024
    buffer_load_dwordx4 v5, s[20:23], s45 offen offset:3072 lds
    s_waitcnt lgkmcnt(10)
    v_mfma_f32_32x32x16_bf16 v[176:191], a[124:127], v[108:111], v[176:191]
    ds_read_b64_tr_b16 a[116:117], v10 offset:2048
    ds_read_b64_tr_b16 a[118:119], v10 offset:3072
    s_waitcnt lgkmcnt(10)
    v_mfma_f32_32x32x16_bf16 v[176:191], a[128:131], v[112:115], v[176:191]
    ds_read_b64_tr_b16 a[120:121], v10 offset:4096
    ds_read_b64_tr_b16 a[122:123], v10 offset:5120
    s_add_u32 m0, s40, 0
    s_add_u32 s45, s44, 640
    buffer_load_dwordx4 v2, s[20:23], s45 offen offset:0 lds
    s_waitcnt lgkmcnt(10)
    v_mfma_f32_32x32x16_bf16 v[176:191], a[132:135], v[116:119], v[176:191]
    ds_read_b64_tr_b16 a[124:125], v10 offset:6144
    ds_read_b64_tr_b16 a[126:127], v10 offset:7168
    s_waitcnt lgkmcnt(10)
    v_mfma_f32_32x32x16_bf16 v[176:191], a[136:139], v[120:123], v[176:191]
    ds_read_b64_tr_b16 a[128:129], v10 offset:8192
    ds_read_b64_tr_b16 a[130:131], v10 offset:9216
    buffer_load_dwordx4 v3, s[20:23], s45 offen offset:1024 lds
    s_waitcnt lgkmcnt(10)
    v_mfma_f32_32x32x16_bf16 v[176:191], a[140:143], v[124:127], v[176:191]
    ds_read_b64_tr_b16 a[132:133], v10 offset:10240
    ds_read_b64_tr_b16 a[134:135], v10 offset:11264
    s_waitcnt lgkmcnt(10)
    v_mfma_f32_32x32x16_bf16 v[176:191], a[112:115], v[64:67], v[176:191]
    ds_read_b64_tr_b16 a[136:137], v10 offset:12288
    ds_read_b64_tr_b16 a[138:139], v10 offset:13312
    buffer_load_dwordx4 v4, s[20:23], s45 offen offset:2048 lds
    s_waitcnt lgkmcnt(10)
    v_mfma_f32_32x32x16_bf16 v[176:191], a[116:119], v[68:71], v[176:191]
    ds_read_b64_tr_b16 a[140:141], v10 offset:14336
    ds_read_b64_tr_b16 a[142:143], v10 offset:15360
    s_waitcnt lgkmcnt(10)
    v_mfma_f32_32x32x16_bf16 v[176:191], a[120:123], v[72:75], v[176:191]
    v_xor_b32 v11, 81920, v9
    ds_read_b64_tr_b16 a[112:113], v11 offset:0
    ds_read_b64_tr_b16 a[114:115], v11 offset:1024
    buffer_load_dwordx4 v5, s[20:23], s45 offen offset:3072 lds
    s_waitcnt lgkmcnt(10)
    v_mfma_f32_32x32x16_bf16 v[176:191], a[124:127], v[76:79], v[176:191]
    ds_read_b64_tr_b16 a[116:117], v11 offset:2048
    ds_read_b64_tr_b16 a[118:119], v11 offset:3072
    s_waitcnt lgkmcnt(10)
    v_mfma_f32_32x32x16_bf16 v[176:191], a[128:131], v[80:83], v[176:191]
    ds_read_b64_tr_b16 a[120:121], v11 offset:4096
    ds_read_b64_tr_b16 a[122:123], v11 offset:5120
    s_add_u32 m0, s40, 4096
    s_add_u32 s45, s44, 29312
    buffer_load_dwordx4 v2, s[20:23], s45 offen offset:0 lds
    s_waitcnt lgkmcnt(10)
    v_mfma_f32_32x32x16_bf16 v[176:191], a[132:135], v[84:87], v[176:191]
    ds_read_b64_tr_b16 a[124:125], v11 offset:6144
    ds_read_b64_tr_b16 a[126:127], v11 offset:7168
    s_waitcnt lgkmcnt(10)
    v_mfma_f32_32x32x16_bf16 v[176:191], a[136:139], v[88:91], v[176:191]
    ds_read_b64_tr_b16 a[128:129], v11 offset:8192
    ds_read_b64_tr_b16 a[130:131], v11 offset:9216
    buffer_load_dwordx4 v3, s[20:23], s45 offen offset:1024 lds
    s_waitcnt lgkmcnt(10)
    v_mfma_f32_32x32x16_bf16 v[176:191], a[140:143], v[92:95], v[176:191]
    ds_read_b64_tr_b16 a[132:133], v11 offset:10240
    ds_read_b64_tr_b16 a[134:135], v11 offset:11264
    s_waitcnt lgkmcnt(10)
    v_mfma_f32_32x32x16_bf16 v[176:191], a[112:115], v[128:131], v[176:191]
    ds_read_b64_tr_b16 a[136:137], v11 offset:12288
    ds_read_b64_tr_b16 a[138:139], v11 offset:13312
    buffer_load_dwordx4 v4, s[20:23], s45 offen offset:2048 lds
    s_waitcnt lgkmcnt(10)
    v_mfma_f32_32x32x16_bf16 v[176:191], a[116:119], v[132:135], v[176:191]
    ds_read_b64_tr_b16 a[140:141], v11 offset:14336
    ds_read_b64_tr_b16 a[142:143], v11 offset:15360
    s_waitcnt lgkmcnt(10)
    v_mfma_f32_32x32x16_bf16 v[176:191], a[120:123], v[136:139], v[176:191]
    s_waitcnt vmcnt(17)
    s_barrier
    v_xor_b32 v10, 98304, v9
    ds_read_b64_tr_b16 a[112:113], v10 offset:0
    ds_read_b64_tr_b16 a[114:115], v10 offset:1024
    buffer_load_dwordx4 v5, s[20:23], s45 offen offset:3072 lds
    s_waitcnt lgkmcnt(10)
    v_mfma_f32_32x32x16_bf16 v[176:191], a[124:127], v[140:143], v[176:191]
    ds_read_b64_tr_b16 a[116:117], v10 offset:2048
    ds_read_b64_tr_b16 a[118:119], v10 offset:3072
    s_waitcnt lgkmcnt(10)
    v_mfma_f32_32x32x16_bf16 v[176:191], a[128:131], v[144:147], v[176:191]
    ds_read_b64_tr_b16 a[120:121], v10 offset:4096
    ds_read_b64_tr_b16 a[122:123], v10 offset:5120
    s_add_u32 m0, s40, 32768
    s_add_u32 s45, s44, 115328
    buffer_load_dwordx4 v2, s[20:23], s45 offen offset:0 lds
    s_waitcnt lgkmcnt(10)
    v_mfma_f32_32x32x16_bf16 v[176:191], a[132:135], v[148:151], v[176:191]
    ds_read_b64_tr_b16 a[124:125], v10 offset:6144
    ds_read_b64_tr_b16 a[126:127], v10 offset:7168
    s_waitcnt lgkmcnt(10)
    v_mfma_f32_32x32x16_bf16 v[176:191], a[136:139], v[152:155], v[176:191]
    ds_read_b64_tr_b16 a[128:129], v10 offset:8192
    ds_read_b64_tr_b16 a[130:131], v10 offset:9216
    buffer_load_dwordx4 v3, s[20:23], s45 offen offset:1024 lds
    s_waitcnt lgkmcnt(10)
    v_mfma_f32_32x32x16_bf16 v[176:191], a[140:143], v[156:159], v[176:191]
    ds_read_b64_tr_b16 a[132:133], v10 offset:10240
    ds_read_b64_tr_b16 a[134:135], v10 offset:11264
    s_waitcnt lgkmcnt(10)
    v_mfma_f32_32x32x16_bf16 v[160:175], a[112:115], v[32:35], 0
    ds_read_b64_tr_b16 a[136:137], v10 offset:12288
    ds_read_b64_tr_b16 a[138:139], v10 offset:13312
    buffer_load_dwordx4 v4, s[20:23], s45 offen offset:2048 lds
    s_waitcnt lgkmcnt(10)
    v_mfma_f32_32x32x16_bf16 v[160:175], a[116:119], v[36:39], v[160:175]
    ds_read_b64_tr_b16 a[140:141], v10 offset:14336
    ds_read_b64_tr_b16 a[142:143], v10 offset:15360
    s_waitcnt lgkmcnt(10)
    v_mfma_f32_32x32x16_bf16 v[160:175], a[120:123], v[40:43], v[160:175]
    v_xor_b32 v11, 114688, v9
    ds_read_b64_tr_b16 a[112:113], v11 offset:0
    ds_read_b64_tr_b16 a[114:115], v11 offset:1024
    buffer_load_dwordx4 v5, s[20:23], s45 offen offset:3072 lds
    s_waitcnt lgkmcnt(10)
    v_mfma_f32_32x32x16_bf16 v[160:175], a[124:127], v[44:47], v[160:175]
    ds_read_b64_tr_b16 a[116:117], v11 offset:2048
    ds_read_b64_tr_b16 a[118:119], v11 offset:3072
    v_cvt_pk_bf16_f32 v192, v176, v177
    v_cvt_pk_bf16_f32 v193, v178, v179
    s_waitcnt lgkmcnt(10)
    v_mfma_f32_32x32x16_bf16 v[160:175], a[128:131], v[48:51], v[160:175]
    ds_read_b64_tr_b16 a[120:121], v11 offset:4096
    ds_read_b64_tr_b16 a[122:123], v11 offset:5120
    v_cvt_pk_bf16_f32 v194, v180, v181
    v_cvt_pk_bf16_f32 v195, v182, v183
    buffer_store_dwordx4 v[192:195], v18, s[24:27], s46 offen offset:0 sc1
    s_add_u32 m0, s40, 36864
    s_add_u32 s45, s44, 144000
    buffer_load_dwordx4 v2, s[20:23], s45 offen offset:0 lds
    s_waitcnt lgkmcnt(10)
    v_mfma_f32_32x32x16_bf16 v[160:175], a[132:135], v[52:55], v[160:175]
    ds_read_b64_tr_b16 a[124:125], v11 offset:6144
    ds_read_b64_tr_b16 a[126:127], v11 offset:7168
    v_cvt_pk_bf16_f32 v196, v184, v185
    v_cvt_pk_bf16_f32 v197, v186, v187
    s_waitcnt lgkmcnt(10)
    v_mfma_f32_32x32x16_bf16 v[160:175], a[136:139], v[56:59], v[160:175]
    ds_read_b64_tr_b16 a[128:129], v11 offset:8192
    ds_read_b64_tr_b16 a[130:131], v11 offset:9216
    v_cvt_pk_bf16_f32 v198, v188, v189
    v_cvt_pk_bf16_f32 v199, v190, v191
    buffer_store_dwordx4 v[196:199], v18, s[24:27], s46 offen offset:1024 sc1
    s_add_u32 s46, s46, 4096
    buffer_load_dwordx4 v3, s[20:23], s45 offen offset:1024 lds
    s_waitcnt lgkmcnt(10)
    v_mfma_f32_32x32x16_bf16 v[160:175], a[140:143], v[60:63], v[160:175]
    ds_read_b64_tr_b16 a[132:133], v11 offset:10240
    ds_read_b64_tr_b16 a[134:135], v11 offset:11264
    s_waitcnt lgkmcnt(10)
    v_mfma_f32_32x32x16_bf16 v[160:175], a[112:115], v[96:99], v[160:175]
    ds_read_b64_tr_b16 a[136:137], v11 offset:12288
    ds_read_b64_tr_b16 a[138:139], v11 offset:13312
    buffer_load_dwordx4 v4, s[20:23], s45 offen offset:2048 lds
    s_waitcnt lgkmcnt(10)
    v_mfma_f32_32x32x16_bf16 v[160:175], a[116:119], v[100:103], v[160:175]
    ds_read_b64_tr_b16 a[140:141], v11 offset:14336
    ds_read_b64_tr_b16 a[142:143], v11 offset:15360
    s_waitcnt lgkmcnt(10)
    v_mfma_f32_32x32x16_bf16 v[160:175], a[120:123], v[104:107], v[160:175]
    s_waitcnt vmcnt(17)
    s_barrier
    v_xor_b32 v10, 131072, v9
    ds_read_b64_tr_b16 a[112:113], v10 offset:0
    ds_read_b64_tr_b16 a[114:115], v10 offset:1024
    buffer_load_dwordx4 v5, s[20:23], s45 offen offset:3072 lds
    s_waitcnt lgkmcnt(10)
    v_mfma_f32_32x32x16_bf16 v[160:175], a[124:127], v[108:111], v[160:175]
    ds_read_b64_tr_b16 a[116:117], v10 offset:2048
    ds_read_b64_tr_b16 a[118:119], v10 offset:3072
    s_waitcnt lgkmcnt(10)
    v_mfma_f32_32x32x16_bf16 v[160:175], a[128:131], v[112:115], v[160:175]
    ds_read_b64_tr_b16 a[120:121], v10 offset:4096
    ds_read_b64_tr_b16 a[122:123], v10 offset:5120
    s_add_u32 m0, s40, 65536
    s_add_u32 s45, s44, 768
    buffer_load_dwordx4 v2, s[20:23], s45 offen offset:0 lds
    s_waitcnt lgkmcnt(10)
    v_mfma_f32_32x32x16_bf16 v[160:175], a[132:135], v[116:119], v[160:175]
    ds_read_b64_tr_b16 a[124:125], v10 offset:6144
    ds_read_b64_tr_b16 a[126:127], v10 offset:7168
    s_waitcnt lgkmcnt(10)
    v_mfma_f32_32x32x16_bf16 v[160:175], a[136:139], v[120:123], v[160:175]
    ds_read_b64_tr_b16 a[128:129], v10 offset:8192
    ds_read_b64_tr_b16 a[130:131], v10 offset:9216
    buffer_load_dwordx4 v3, s[20:23], s45 offen offset:1024 lds
    s_waitcnt lgkmcnt(10)
    v_mfma_f32_32x32x16_bf16 v[160:175], a[140:143], v[124:127], v[160:175]
    ds_read_b64_tr_b16 a[132:133], v10 offset:10240
    ds_read_b64_tr_b16 a[134:135], v10 offset:11264
    s_waitcnt lgkmcnt(10)
    v_mfma_f32_32x32x16_bf16 v[160:175], a[112:115], v[64:67], v[160:175]
    ds_read_b64_tr_b16 a[136:137], v10 offset:12288
    ds_read_b64_tr_b16 a[138:139], v10 offset:13312
    buffer_load_dwordx4 v4, s[20:23], s45 offen offset:2048 lds
    s_waitcnt lgkmcnt(10)
    v_mfma_f32_32x32x16_bf16 v[160:175], a[116:119], v[68:71], v[160:175]
    ds_read_b64_tr_b16 a[140:141], v10 offset:14336
    ds_read_b64_tr_b16 a[142:143], v10 offset:15360
    s_waitcnt lgkmcnt(10)
    v_mfma_f32_32x32x16_bf16 v[160:175], a[120:123], v[72:75], v[160:175]
    v_xor_b32 v11, 147456, v9
    ds_read_b64_tr_b16 a[112:113], v11 offset:0
    ds_read_b64_tr_b16 a[114:115], v11 offset:1024
    buffer_load_dwordx4 v5, s[20:23], s45 offen offset:3072 lds
    s_waitcnt lgkmcnt(10)
    v_mfma_f32_32x32x16_bf16 v[160:175], a[124:127], v[76:79], v[160:175]
    ds_read_b64_tr_b16 a[116:117], v11 offset:2048
    ds_read_b64_tr_b16 a[118:119], v11 offset:3072
    s_waitcnt lgkmcnt(10)
    v_mfma_f32_32x32x16_bf16 v[160:175], a[128:131], v[80:83], v[160:175]
    ds_read_b64_tr_b16 a[120:121], v11 offset:4096
    ds_read_b64_tr_b16 a[122:123], v11 offset:5120
    s_add_u32 m0, s40, 69632
    s_add_u32 s45, s44, 29440
    buffer_load_dwordx4 v2, s[20:23], s45 offen offset:0 lds
    s_waitcnt lgkmcnt(10)
    v_mfma_f32_32x32x16_bf16 v[160:175], a[132:135], v[84:87], v[160:175]
    ds_read_b64_tr_b16 a[124:125], v11 offset:6144
    ds_read_b64_tr_b16 a[126:127], v11 offset:7168
    s_waitcnt lgkmcnt(10)
    v_mfma_f32_32x32x16_bf16 v[160:175], a[136:139], v[88:91], v[160:175]
    ds_read_b64_tr_b16 a[128:129], v11 offset:8192
    ds_read_b64_tr_b16 a[130:131], v11 offset:9216
    buffer_load_dwordx4 v3, s[20:23], s45 offen offset:1024 lds
    s_waitcnt lgkmcnt(10)
    v_mfma_f32_32x32x16_bf16 v[160:175], a[140:143], v[92:95], v[160:175]
    ds_read_b64_tr_b16 a[132:133], v11 offset:10240
    ds_read_b64_tr_b16 a[134:135], v11 offset:11264
    s_waitcnt lgkmcnt(10)
    v_mfma_f32_32x32x16_bf16 v[160:175], a[112:115], v[128:131], v[160:175]
    ds_read_b64_tr_b16 a[136:137], v11 offset:12288
    ds_read_b64_tr_b16 a[138:139], v11 offset:13312
    buffer_load_dwordx4 v4, s[20:23], s45 offen offset:2048 lds
    s_waitcnt lgkmcnt(10)
    v_mfma_f32_32x32x16_bf16 v[160:175], a[116:119], v[132:135], v[160:175]
    ds_read_b64_tr_b16 a[140:141], v11 offset:14336
    ds_read_b64_tr_b16 a[142:143], v11 offset:15360
    s_waitcnt lgkmcnt(10)
    v_mfma_f32_32x32x16_bf16 v[160:175], a[120:123], v[136:139], v[160:175]
    s_waitcnt vmcnt(17)
    s_barrier
    v_xor_b32 v10, 0, v9
    ds_read_b64_tr_b16 a[112:113], v10 offset:0
    ds_read_b64_tr_b16 a[114:115], v10 offset:1024
    buffer_load_dwordx4 v5, s[20:23], s45 offen offset:3072 lds
    s_waitcnt lgkmcnt(10)
    v_mfma_f32_32x32x16_bf16 v[160:175], a[124:127], v[140:143], v[160:175]
    ds_read_b64_tr_b16 a[116:117], v10 offset:2048
    ds_read_b64_tr_b16 a[118:119], v10 offset:3072
    s_waitcnt lgkmcnt(10)
    v_mfma_f32_32x32x16_bf16 v[160:175], a[128:131], v[144:147], v[160:175]
    ds_read_b64_tr_b16 a[120:121], v10 offset:4096
    ds_read_b64_tr_b16 a[122:123], v10 offset:5120
    s_add_u32 m0, s40, 98304
    s_add_u32 s45, s44, 115456
    buffer_load_dwordx4 v2, s[20:23], s45 offen offset:0 lds
    s_waitcnt lgkmcnt(10)
    v_mfma_f32_32x32x16_bf16 v[160:175], a[132:135], v[148:151], v[160:175]
    ds_read_b64_tr_b16 a[124:125], v10 offset:6144
    ds_read_b64_tr_b16 a[126:127], v10 offset:7168
    s_waitcnt lgkmcnt(10)
    v_mfma_f32_32x32x16_bf16 v[160:175], a[136:139], v[152:155], v[160:175]
    ds_read_b64_tr_b16 a[128:129], v10 offset:8192
    ds_read_b64_tr_b16 a[130:131], v10 offset:9216
    buffer_load_dwordx4 v3, s[20:23], s45 offen offset:1024 lds
    s_waitcnt lgkmcnt(10)
    v_mfma_f32_32x32x16_bf16 v[160:175], a[140:143], v[156:159], v[160:175]
    ds_read_b64_tr_b16 a[132:133], v10 offset:10240
    ds_read_b64_tr_b16 a[134:135], v10 offset:11264
    s_waitcnt lgkmcnt(10)
    v_mfma_f32_32x32x16_bf16 v[176:191], a[112:115], v[32:35], 0
    ds_read_b64_tr_b16 a[136:137], v10 offset:12288
    ds_read_b64_tr_b16 a[138:139], v10 offset:13312
    buffer_load_dwordx4 v4, s[20:23], s45 offen offset:2048 lds
    s_waitcnt lgkmcnt(10)
    v_mfma_f32_32x32x16_bf16 v[176:191], a[116:119], v[36:39], v[176:191]
    ds_read_b64_tr_b16 a[140:141], v10 offset:14336
    ds_read_b64_tr_b16 a[142:143], v10 offset:15360
    s_waitcnt lgkmcnt(10)
    v_mfma_f32_32x32x16_bf16 v[176:191], a[120:123], v[40:43], v[176:191]
    v_xor_b32 v11, 16384, v9
    ds_read_b64_tr_b16 a[112:113], v11 offset:0
    ds_read_b64_tr_b16 a[114:115], v11 offset:1024
    buffer_load_dwordx4 v5, s[20:23], s45 offen offset:3072 lds
    s_waitcnt lgkmcnt(10)
    v_mfma_f32_32x32x16_bf16 v[176:191], a[124:127], v[44:47], v[176:191]
    ds_read_b64_tr_b16 a[116:117], v11 offset:2048
    ds_read_b64_tr_b16 a[118:119], v11 offset:3072
    v_cvt_pk_bf16_f32 v192, v160, v161
    v_cvt_pk_bf16_f32 v193, v162, v163
    s_waitcnt lgkmcnt(10)
    v_mfma_f32_32x32x16_bf16 v[176:191], a[128:131], v[48:51], v[176:191]
    ds_read_b64_tr_b16 a[120:121], v11 offset:4096
    ds_read_b64_tr_b16 a[122:123], v11 offset:5120
    v_cvt_pk_bf16_f32 v194, v164, v165
    v_cvt_pk_bf16_f32 v195, v166, v167
    buffer_store_dwordx4 v[192:195], v18, s[24:27], s46 offen offset:0 sc1
    s_add_u32 m0, s40, 102400
    s_add_u32 s45, s44, 144128
    buffer_load_dwordx4 v2, s[20:23], s45 offen offset:0 lds
    s_waitcnt lgkmcnt(10)
    v_mfma_f32_32x32x16_bf16 v[176:191], a[132:135], v[52:55], v[176:191]
    ds_read_b64_tr_b16 a[124:125], v11 offset:6144
    ds_read_b64_tr_b16 a[126:127], v11 offset:7168
    v_cvt_pk_bf16_f32 v196, v168, v169
    v_cvt_pk_bf16_f32 v197, v170, v171
    s_waitcnt lgkmcnt(10)
    v_mfma_f32_32x32x16_bf16 v[176:191], a[136:139], v[56:59], v[176:191]
    ds_read_b64_tr_b16 a[128:129], v11 offset:8192
    ds_read_b64_tr_b16 a[130:131], v11 offset:9216
    v_cvt_pk_bf16_f32 v198, v172, v173
    v_cvt_pk_bf16_f32 v199, v174, v175
    buffer_store_dwordx4 v[196:199], v18, s[24:27], s46 offen offset:1024 sc1
    s_add_u32 s46, s46, 4096
    buffer_load_dwordx4 v3, s[20:23], s45 offen offset:1024 lds
    s_waitcnt lgkmcnt(10)
    v_mfma_f32_32x32x16_bf16 v[176:191], a[140:143], v[60:63], v[176:191]
    ds_read_b64_tr_b16 a[132:133], v11 offset:10240
    ds_read_b64_tr_b16 a[134:135], v11 offset:11264
    s_waitcnt lgkmcnt(10)
    v_mfma_f32_32x32x16_bf16 v[176:191], a[112:115], v[96:99], v[176:191]
    ds_read_b64_tr_b16 a[136:137], v11 offset:12288
    ds_read_b64_tr_b16 a[138:139], v11 offset:13312
    buffer_load_dwordx4 v4, s[20:23], s45 offen offset:2048 lds
    s_waitcnt lgkmcnt(10)
    v_mfma_f32_32x32x16_bf16 v[176:191], a[116:119], v[100:103], v[176:191]
    ds_read_b64_tr_b16 a[140:141], v11 offset:14336
    ds_read_b64_tr_b16 a[142:143], v11 offset:15360
    s_waitcnt lgkmcnt(10)
    v_mfma_f32_32x32x16_bf16 v[176:191], a[120:123], v[104:107], v[176:191]
    s_waitcnt vmcnt(17)
    s_barrier
    v_xor_b32 v10, 32768, v9
    ds_read_b64_tr_b16 a[112:113], v10 offset:0
    ds_read_b64_tr_b16 a[114:115], v10 offset:1024
    buffer_load_dwordx4 v5, s[20:23], s45 offen offset:3072 lds
    s_waitcnt lgkmcnt(10)
    v_mfma_f32_32x32x16_bf16 v[176:191], a[124:127], v[108:111], v[176:191]
    ds_read_b64_tr_b16 a[116:117], v10 offset:2048
    ds_read_b64_tr_b16 a[118:119], v10 offset:3072
    s_waitcnt lgkmcnt(10)
    v_mfma_f32_32x32x16_bf16 v[176:191], a[128:131], v[112:115], v[176:191]
    ds_read_b64_tr_b16 a[120:121], v10 offset:4096
    ds_read_b64_tr_b16 a[122:123], v10 offset:5120
    v_lshrrev_b32 v2, 3, v1
    v_mul_u32_u24 v2, 3584, v2
    v_bfe_u32 v3, v1, 4, 1
    v_lshlrev_b32 v3, 2, v3
    v_and_b32 v4, 7, v1
    v_xor_b32 v3, v3, v4
    v_lshl_add_u32 v2, v3, 4, v2
    s_mov_b32 s12, s96
    s_mov_b32 s13, s97
    s_mov_b32 s14, 1605632
    s_lshr_b32 s41, s41, 2
    s_add_u32 m0, s41, 131072
    s_add_u32 s45, s53, 1792
    buffer_load_dwordx4 v2, s[12:15], s45 offen lds
    s_waitcnt lgkmcnt(10)
    v_mfma_f32_32x32x16_bf16 v[176:191], a[132:135], v[116:119], v[176:191]
    ds_read_b64_tr_b16 a[124:125], v10 offset:6144
    ds_read_b64_tr_b16 a[126:127], v10 offset:7168
    s_waitcnt lgkmcnt(10)
    v_mfma_f32_32x32x16_bf16 v[176:191], a[136:139], v[120:123], v[176:191]
    ds_read_b64_tr_b16 a[128:129], v10 offset:8192
    ds_read_b64_tr_b16 a[130:131], v10 offset:9216
    s_add_u32 m0, s41, 135168
    s_add_u32 s45, s53, 116480
    buffer_load_dwordx4 v2, s[12:15], s45 offen lds
    s_waitcnt lgkmcnt(10)
    v_mfma_f32_32x32x16_bf16 v[176:191], a[140:143], v[124:127], v[176:191]
    ds_read_b64_tr_b16 a[132:133], v10 offset:10240
    ds_read_b64_tr_b16 a[134:135], v10 offset:11264
    s_waitcnt lgkmcnt(10)
    v_mfma_f32_32x32x16_bf16 v[176:191], a[112:115], v[64:67], v[176:191]
    ds_read_b64_tr_b16 a[136:137], v10 offset:12288
    ds_read_b64_tr_b16 a[138:139], v10 offset:13312
    s_add_u32 m0, s41, 139264
    s_add_u32 s45, s53, 231168
    buffer_load_dwordx4 v2, s[12:15], s45 offen lds
    s_waitcnt lgkmcnt(10)
    v_mfma_f32_32x32x16_bf16 v[176:191], a[116:119], v[68:71], v[176:191]
    ds_read_b64_tr_b16 a[140:141], v10 offset:14336
    ds_read_b64_tr_b16 a[142:143], v10 offset:15360
    s_waitcnt lgkmcnt(10)
    v_mfma_f32_32x32x16_bf16 v[176:191], a[120:123], v[72:75], v[176:191]
    v_xor_b32 v11, 49152, v9
    ds_read_b64_tr_b16 a[112:113], v11 offset:0
    ds_read_b64_tr_b16 a[114:115], v11 offset:1024
    s_add_u32 m0, s41, 143360
    s_add_u32 s45, s53, 345856
    buffer_load_dwordx4 v2, s[12:15], s45 offen lds
    s_waitcnt lgkmcnt(10)
    v_mfma_f32_32x32x16_bf16 v[176:191], a[124:127], v[76:79], v[176:191]
    ds_read_b64_tr_b16 a[116:117], v11 offset:2048
    ds_read_b64_tr_b16 a[118:119], v11 offset:3072
    s_waitcnt lgkmcnt(10)
    v_mfma_f32_32x32x16_bf16 v[176:191], a[128:131], v[80:83], v[176:191]
    ds_read_b64_tr_b16 a[120:121], v11 offset:4096
    ds_read_b64_tr_b16 a[122:123], v11 offset:5120
    s_add_u32 m0, s41, 147456
    s_add_u32 s45, s53, 460544
    buffer_load_dwordx4 v2, s[12:15], s45 offen lds
    s_waitcnt lgkmcnt(10)
    v_mfma_f32_32x32x16_bf16 v[176:191], a[132:135], v[84:87], v[176:191]
    ds_read_b64_tr_b16 a[124:125], v11 offset:6144
    ds_read_b64_tr_b16 a[126:127], v11 offset:7168
    s_waitcnt lgkmcnt(10)
    v_mfma_f32_32x32x16_bf16 v[176:191], a[136:139], v[88:91], v[176:191]
    ds_read_b64_tr_b16 a[128:129], v11 offset:8192
    ds_read_b64_tr_b16 a[130:131], v11 offset:9216
    s_add_u32 m0, s41, 151552
    s_add_u32 s45, s53, 575232
    buffer_load_dwordx4 v2, s[12:15], s45 offen lds
    s_waitcnt lgkmcnt(10)
    v_mfma_f32_32x32x16_bf16 v[176:191], a[140:143], v[92:95], v[176:191]
    ds_read_b64_tr_b16 a[132:133], v11 offset:10240
    ds_read_b64_tr_b16 a[134:135], v11 offset:11264
    s_waitcnt lgkmcnt(10)
    v_mfma_f32_32x32x16_bf16 v[176:191], a[112:115], v[128:131], v[176:191]
    ds_read_b64_tr_b16 a[136:137], v11 offset:12288
    ds_read_b64_tr_b16 a[138:139], v11 offset:13312
    s_add_u32 m0, s41, 155648
    s_add_u32 s45, s53, 689920
    buffer_load_dwordx4 v2, s[12:15], s45 offen lds
    s_waitcnt lgkmcnt(10)
    v_mfma_f32_32x32x16_bf16 v[176:191], a[116:119], v[132:135], v[176:191]
    ds_read_b64_tr_b16 a[140:141], v11 offset:14336
    ds_read_b64_tr_b16 a[142:143], v11 offset:15360
    s_waitcnt lgkmcnt(10)
    v_mfma_f32_32x32x16_bf16 v[176:191], a[120:123], v[136:139], v[176:191]
    s_waitcnt vmcnt(17)
    s_barrier
    v_xor_b32 v10, 65536, v9
    ds_read_b64_tr_b16 a[112:113], v10 offset:0
    ds_read_b64_tr_b16 a[114:115], v10 offset:1024
    s_add_u32 m0, s41, 0
    s_add_u32 s45, s53, 804608
    buffer_load_dwordx4 v2, s[12:15], s45 offen lds
    s_waitcnt lgkmcnt(10)
    v_mfma_f32_32x32x16_bf16 v[176:191], a[124:127], v[140:143], v[176:191]
    ds_read_b64_tr_b16 a[116:117], v10 offset:2048
    ds_read_b64_tr_b16 a[118:119], v10 offset:3072
    s_waitcnt lgkmcnt(10)
    v_mfma_f32_32x32x16_bf16 v[176:191], a[128:131], v[144:147], v[176:191]
    ds_read_b64_tr_b16 a[120:121], v10 offset:4096
    ds_read_b64_tr_b16 a[122:123], v10 offset:5120
    s_add_u32 m0, s41, 4096
    s_add_u32 s45, s53, 919296
    buffer_load_dwordx4 v2, s[12:15], s45 offen lds
    s_waitcnt lgkmcnt(10)
    v_mfma_f32_32x32x16_bf16 v[176:191], a[132:135], v[148:151], v[176:191]
    ds_read_b64_tr_b16 a[124:125], v10 offset:6144
    ds_read_b64_tr_b16 a[126:127], v10 offset:7168
    s_waitcnt lgkmcnt(10)
    v_mfma_f32_32x32x16_bf16 v[176:191], a[136:139], v[152:155], v[176:191]
    ds_read_b64_tr_b16 a[128:129], v10 offset:8192
    ds_read_b64_tr_b16 a[130:131], v10 offset:9216
    s_add_u32 m0, s41, 8192
    s_add_u32 s45, s53, 1033984
    buffer_load_dwordx4 v2, s[12:15], s45 offen lds
    s_waitcnt lgkmcnt(10)
    v_mfma_f32_32x32x16_bf16 v[176:191], a[140:143], v[156:159], v[176:191]
    ds_read_b64_tr_b16 a[132:133], v10 offset:10240
    ds_read_b64_tr_b16 a[134:135], v10 offset:11264
    s_waitcnt lgkmcnt(10)
    v_mfma_f32_32x32x16_bf16 v[160:175], a[112:115], v[32:35], 0
    ds_read_b64_tr_b16 a[136:137], v10 offset:12288
    ds_read_b64_tr_b16 a[138:139], v10 offset:13312
    s_add_u32 m0, s41, 12288
    s_add_u32 s45, s53, 1148672
    buffer_load_dwordx4 v2, s[12:15], s45 offen lds
    s_waitcnt lgkmcnt(10)
    v_mfma_f32_32x32x16_bf16 v[160:175], a[116:119], v[36:39], v[160:175]
    ds_read_b64_tr_b16 a[140:141], v10 offset:14336
    ds_read_b64_tr_b16 a[142:143], v10 offset:15360
    s_waitcnt lgkmcnt(10)
    v_mfma_f32_32x32x16_bf16 v[160:175], a[120:123], v[40:43], v[160:175]
    v_xor_b32 v11, 81920, v9
    ds_read_b64_tr_b16 a[112:113], v11 offset:0
    ds_read_b64_tr_b16 a[114:115], v11 offset:1024
    s_add_u32 m0, s41, 16384
    s_add_u32 s45, s53, 1263360
    buffer_load_dwordx4 v2, s[12:15], s45 offen lds
    s_waitcnt lgkmcnt(10)
    v_mfma_f32_32x32x16_bf16 v[160:175], a[124:127], v[44:47], v[160:175]
    ds_read_b64_tr_b16 a[116:117], v11 offset:2048
    ds_read_b64_tr_b16 a[118:119], v11 offset:3072
    v_cvt_pk_bf16_f32 v192, v176, v177
    v_cvt_pk_bf16_f32 v193, v178, v179
    s_waitcnt lgkmcnt(10)
    v_mfma_f32_32x32x16_bf16 v[160:175], a[128:131], v[48:51], v[160:175]
    ds_read_b64_tr_b16 a[120:121], v11 offset:4096
    ds_read_b64_tr_b16 a[122:123], v11 offset:5120
    v_cvt_pk_bf16_f32 v194, v180, v181
    v_cvt_pk_bf16_f32 v195, v182, v183
    buffer_store_dwordx4 v[192:195], v18, s[24:27], s46 offen offset:0 sc1
    s_add_u32 m0, s41, 20480
    s_add_u32 s45, s53, 1378048
    buffer_load_dwordx4 v2, s[12:15], s45 offen lds
    s_waitcnt lgkmcnt(10)
    v_mfma_f32_32x32x16_bf16 v[160:175], a[132:135], v[52:55], v[160:175]
    ds_read_b64_tr_b16 a[124:125], v11 offset:6144
    ds_read_b64_tr_b16 a[126:127], v11 offset:7168
    v_cvt_pk_bf16_f32 v196, v184, v185
    v_cvt_pk_bf16_f32 v197, v186, v187
    s_waitcnt lgkmcnt(10)
    v_mfma_f32_32x32x16_bf16 v[160:175], a[136:139], v[56:59], v[160:175]
    ds_read_b64_tr_b16 a[128:129], v11 offset:8192
    ds_read_b64_tr_b16 a[130:131], v11 offset:9216
    v_cvt_pk_bf16_f32 v198, v188, v189
    v_cvt_pk_bf16_f32 v199, v190, v191
    buffer_store_dwordx4 v[196:199], v18, s[24:27], s46 offen offset:1024 sc1
    s_add_u32 s46, s46, 4096
    s_add_u32 m0, s41, 24576
    s_add_u32 s45, s53, 1492736
    buffer_load_dwordx4 v2, s[12:15], s45 offen lds
    s_waitcnt lgkmcnt(10)
    v_mfma_f32_32x32x16_bf16 v[160:175], a[140:143], v[60:63], v[160:175]
    ds_read_b64_tr_b16 a[132:133], v11 offset:10240
    ds_read_b64_tr_b16 a[134:135], v11 offset:11264
    s_waitcnt lgkmcnt(10)
    v_mfma_f32_32x32x16_bf16 v[160:175], a[112:115], v[96:99], v[160:175]
    ds_read_b64_tr_b16 a[136:137], v11 offset:12288
    ds_read_b64_tr_b16 a[138:139], v11 offset:13312
    s_waitcnt lgkmcnt(10)
    v_mfma_f32_32x32x16_bf16 v[160:175], a[116:119], v[100:103], v[160:175]
    ds_read_b64_tr_b16 a[140:141], v11 offset:14336
    ds_read_b64_tr_b16 a[142:143], v11 offset:15360
    s_waitcnt lgkmcnt(10)
    v_mfma_f32_32x32x16_bf16 v[160:175], a[120:123], v[104:107], v[160:175]
    s_waitcnt vmcnt(16)
    s_barrier
    v_xor_b32 v10, 98304, v9
    ds_read_b64_tr_b16 a[112:113], v10 offset:0
    ds_read_b64_tr_b16 a[114:115], v10 offset:1024
    s_add_u32 m0, s41, 32768
    s_add_u32 s45, s53, 0
    buffer_load_dwordx4 v2, s[12:15], s45 offen lds
    s_waitcnt lgkmcnt(10)
    v_mfma_f32_32x32x16_bf16 v[160:175], a[124:127], v[108:111], v[160:175]
    ds_read_b64_tr_b16 a[116:117], v10 offset:2048
    ds_read_b64_tr_b16 a[118:119], v10 offset:3072
    s_waitcnt lgkmcnt(10)
    v_mfma_f32_32x32x16_bf16 v[160:175], a[128:131], v[112:115], v[160:175]
    ds_read_b64_tr_b16 a[120:121], v10 offset:4096
    ds_read_b64_tr_b16 a[122:123], v10 offset:5120
    s_add_u32 m0, s41, 36864
    s_add_u32 s45, s53, 114688
    buffer_load_dwordx4 v2, s[12:15], s45 offen lds
    s_waitcnt lgkmcnt(10)
    v_mfma_f32_32x32x16_bf16 v[160:175], a[132:135], v[116:119], v[160:175]
    ds_read_b64_tr_b16 a[124:125], v10 offset:6144
    ds_read_b64_tr_b16 a[126:127], v10 offset:7168
    s_waitcnt lgkmcnt(10)
    v_mfma_f32_32x32x16_bf16 v[160:175], a[136:139], v[120:123], v[160:175]
    ds_read_b64_tr_b16 a[128:129], v10 offset:8192
    ds_read_b64_tr_b16 a[130:131], v10 offset:9216
    s_add_u32 m0, s41, 40960
    s_add_u32 s45, s53, 229376
    buffer_load_dwordx4 v2, s[12:15], s45 offen lds
    s_waitcnt lgkmcnt(10)
    v_mfma_f32_32x32x16_bf16 v[160:175], a[140:143], v[124:127], v[160:175]
    ds_read_b64_tr_b16 a[132:133], v10 offset:10240
    ds_read_b64_tr_b16 a[134:135], v10 offset:11264
    s_waitcnt lgkmcnt(10)
    v_mfma_f32_32x32x16_bf16 v[160:175], a[112:115], v[64:67], v[160:175]
    ds_read_b64_tr_b16 a[136:137], v10 offset:12288
    ds_read_b64_tr_b16 a[138:139], v10 offset:13312
    s_add_u32 m0, s41, 45056
    s_add_u32 s45, s53, 344064
    buffer_load_dwordx4 v2, s[12:15], s45 offen lds
    s_waitcnt lgkmcnt(10)
    v_mfma_f32_32x32x16_bf16 v[160:175], a[116:119], v[68:71], v[160:175]
    ds_read_b64_tr_b16 a[140:141], v10 offset:14336
    ds_read_b64_tr_b16 a[142:143], v10 offset:15360
    s_waitcnt lgkmcnt(10)
    v_mfma_f32_32x32x16_bf16 v[160:175], a[120:123], v[72:75], v[160:175]
    v_xor_b32 v11, 114688, v9
    ds_read_b64_tr_b16 a[112:113], v11 offset:0
    ds_read_b64_tr_b16 a[114:115], v11 offset:1024
    s_add_u32 m0, s41, 49152
    s_add_u32 s45, s53, 458752
    buffer_load_dwordx4 v2, s[12:15], s45 offen lds
    s_waitcnt lgkmcnt(10)
    v_mfma_f32_32x32x16_bf16 v[160:175], a[124:127], v[76:79], v[160:175]
    ds_read_b64_tr_b16 a[116:117], v11 offset:2048
    ds_read_b64_tr_b16 a[118:119], v11 offset:3072
    s_waitcnt lgkmcnt(10)
    v_mfma_f32_32x32x16_bf16 v[160:175], a[128:131], v[80:83], v[160:175]
    ds_read_b64_tr_b16 a[120:121], v11 offset:4096
    ds_read_b64_tr_b16 a[122:123], v11 offset:5120
    s_add_u32 m0, s41, 53248
    s_add_u32 s45, s53, 573440
    buffer_load_dwordx4 v2, s[12:15], s45 offen lds
    s_waitcnt lgkmcnt(10)
    v_mfma_f32_32x32x16_bf16 v[160:175], a[132:135], v[84:87], v[160:175]
    ds_read_b64_tr_b16 a[124:125], v11 offset:6144
    ds_read_b64_tr_b16 a[126:127], v11 offset:7168
    s_waitcnt lgkmcnt(10)
    v_mfma_f32_32x32x16_bf16 v[160:175], a[136:139], v[88:91], v[160:175]
    ds_read_b64_tr_b16 a[128:129], v11 offset:8192
    ds_read_b64_tr_b16 a[130:131], v11 offset:9216
    s_add_u32 m0, s41, 57344
    s_add_u32 s45, s53, 688128
    buffer_load_dwordx4 v2, s[12:15], s45 offen lds
    s_waitcnt lgkmcnt(10)
    v_mfma_f32_32x32x16_bf16 v[160:175], a[140:143], v[92:95], v[160:175]
    ds_read_b64_tr_b16 a[132:133], v11 offset:10240
    ds_read_b64_tr_b16 a[134:135], v11 offset:11264
    s_waitcnt lgkmcnt(10)
    v_mfma_f32_32x32x16_bf16 v[160:175], a[112:115], v[128:131], v[160:175]
    ds_read_b64_tr_b16 a[136:137], v11 offset:12288
    ds_read_b64_tr_b16 a[138:139], v11 offset:13312
    s_waitcnt lgkmcnt(10)
    v_mfma_f32_32x32x16_bf16 v[160:175], a[116:119], v[132:135], v[160:175]
    ds_read_b64_tr_b16 a[140:141], v11 offset:14336
    ds_read_b64_tr_b16 a[142:143], v11 offset:15360
    s_waitcnt lgkmcnt(10)
    v_mfma_f32_32x32x16_bf16 v[160:175], a[120:123], v[136:139], v[160:175]
    s_waitcnt lgkmcnt(8)
    v_mfma_f32_32x32x16_bf16 v[160:175], a[124:127], v[140:143], v[160:175]
    s_waitcnt lgkmcnt(6)
    v_mfma_f32_32x32x16_bf16 v[160:175], a[128:131], v[144:147], v[160:175]
    s_waitcnt lgkmcnt(4)
    v_mfma_f32_32x32x16_bf16 v[160:175], a[132:135], v[148:151], v[160:175]
    s_waitcnt lgkmcnt(2)
    v_mfma_f32_32x32x16_bf16 v[160:175], a[136:139], v[152:155], v[160:175]
    s_waitcnt lgkmcnt(0)
    v_mfma_f32_32x32x16_bf16 v[160:175], a[140:143], v[156:159], v[160:175]
    s_waitcnt lgkmcnt(0)
    s_barrier
    s_nop 9
    v_cvt_pk_bf16_f32 v192, v160, v161
    v_cvt_pk_bf16_f32 v193, v162, v163
    v_cvt_pk_bf16_f32 v194, v164, v165
    v_cvt_pk_bf16_f32 v195, v166, v167
    buffer_store_dwordx4 v[192:195], v18, s[24:27], s46 offen offset:0 sc1
    v_cvt_pk_bf16_f32 v196, v168, v169
    v_cvt_pk_bf16_f32 v197, v170, v171
    v_cvt_pk_bf16_f32 v198, v172, v173
    v_cvt_pk_bf16_f32 v199, v174, v175
    buffer_store_dwordx4 v[196:199], v18, s[24:27], s46 offen offset:1024 sc1
    s_lshl_b32 s5, s4, 1
    s_add_u32 s5, s5, s37
    s_lshl_b32 s5, s5, 3
    s_add_u32 s5, s5, s3
    s_lshl_b32 s5, s5, 1
    s_add_u32 s5, s5, s36
    s_lshl_b32 s5, s5, 2
    s_add_u32 s40, s5, 29589504
    v_mov_b32 v22, 0
    s_waitcnt vmcnt(0)
    buffer_store_dword v22, v22, s[24:27], s40 offen sc1
    s_lshr_b32 s40, s52, 2
    s_mul_i32 s32, s40, 28672
    s_and_b32 s5, s52, 3
    s_lshl_b32 s5, s5, 7
    s_add_u32 s32, s32, s5
    s_lshl_b32 s40, s40, 6
    s_add_u32 s40, s40, 29589504
    s_add_u32 s42, s32, 2097152
    s_add_u32 s43, s32, 16777216
    s_add_u32 s44, s32, 18874368
    s_lshl_b32 s46, s52, 2
    s_add_u32 s46, s46, s48
    s_lshl_b32 s46, s46, 2
    s_add_u32 s46, s46, 29593600
    v_and_b32 v29, 15, v1
    v_lshlrev_b32 v29, 2, v29
    v_and_b32 v7, 7, v1
    v_lshlrev_b32 v7, 3, v7
    v_add_u32 v7, 94208, v7
    s_lshl_b32 s5, s48, 6
    v_add_u32 v6, s5, v7
    v_lshlrev_b32 v128, 16, v224
    v_and_b32 v129, s47, v224
    v_lshlrev_b32 v130, 16, v225
    v_and_b32 v131, s47, v225
    v_lshlrev_b32 v132, 16, v226
    v_and_b32 v133, s47, v226
    v_lshlrev_b32 v134, 16, v227
    v_and_b32 v135, s47, v227
    v_lshlrev_b32 v136, 16, v228
    v_and_b32 v137, s47, v228
    v_lshlrev_b32 v138, 16, v229
    v_and_b32 v139, s47, v229
    v_lshlrev_b32 v140, 16, v230
    v_and_b32 v141, s47, v230
    v_lshlrev_b32 v142, 16, v231
    v_and_b32 v143, s47, v231
    v_lshlrev_b32 v144, 16, v232
    v_and_b32 v145, s47, v232
    v_lshlrev_b32 v146, 16, v233
    v_and_b32 v147, s47, v233
    v_lshlrev_b32 v148, 16, v234
    v_and_b32 v149, s47, v234
    v_lshlrev_b32 v150, 16, v235
    v_and_b32 v151, s47, v235
    v_lshlrev_b32 v152, 16, v236
    v_and_b32 v153, s47, v236
    v_lshlrev_b32 v154, 16, v237
    v_and_b32 v155, s47, v237
    v_lshlrev_b32 v156, 16, v238
    v_and_b32 v157, s47, v238
    v_lshlrev_b32 v158, 16, v239
    v_and_b32 v159, s47, v239
    v_lshlrev_b32 v176, 16, v240
    v_and_b32 v177, s47, v240
    v_lshlrev_b32 v178, 16, v241
    v_and_b32 v179, s47, v241
    v_lshlrev_b32 v180, 16, v242
    v_and_b32 v181, s47, v242
    v_lshlrev_b32 v182, 16, v243
    v_and_b32 v183, s47, v243
    v_lshlrev_b32 v184, 16, v244
    v_and_b32 v185, s47, v244
    v_lshlrev_b32 v186, 16, v245
    v_and_b32 v187, s47, v245
    v_lshlrev_b32 v188, 16, v246
    v_and_b32 v189, s47, v246
    v_lshlrev_b32 v190, 16, v247
    v_and_b32 v191, s47, v247
    v_lshlrev_b32 v160, 16, v248
    v_and_b32 v161, s47, v248
    v_lshlrev_b32 v162, 16, v249
    v_and_b32 v163, s47, v249
    v_lshlrev_b32 v164, 16, v250
    v_and_b32 v165, s47, v250
    v_lshlrev_b32 v166, 16, v251
    v_and_b32 v167, s47, v251
    v_lshlrev_b32 v168, 16, v252
    v_and_b32 v169, s47, v252
    v_lshlrev_b32 v170, 16, v253
    v_and_b32 v171, s47, v253
    v_lshlrev_b32 v172, 16, v254
    v_and_b32 v173, s47, v254
    v_lshlrev_b32 v174, 16, v255
    v_and_b32 v175, s47, v255
    v_add_f32 v160, 1.0, v160
    v_cvt_pk_bf16_f32 v160, 0, v160
    v_add_f32 v161, 1.0, v161
    v_cvt_pk_bf16_f32 v161, 0, v161
    v_add_f32 v162, 1.0, v162
    v_cvt_pk_bf16_f32 v162, 0, v162
    v_add_f32 v163, 1.0, v163
    v_cvt_pk_bf16_f32 v163, 0, v163
    v_add_f32 v164, 1.0, v164
    v_cvt_pk_bf16_f32 v164, 0, v164
    v_add_f32 v165, 1.0, v165
    v_cvt_pk_bf16_f32 v165, 0, v165
    v_add_f32 v166, 1.0, v166
    v_cvt_pk_bf16_f32 v166, 0, v166
    v_add_f32 v167, 1.0, v167
    v_cvt_pk_bf16_f32 v167, 0, v167
    v_add_f32 v168, 1.0, v168
    v_cvt_pk_bf16_f32 v168, 0, v168
    v_add_f32 v169, 1.0, v169
    v_cvt_pk_bf16_f32 v169, 0, v169
    v_add_f32 v170, 1.0, v170
    v_cvt_pk_bf16_f32 v170, 0, v170
    v_add_f32 v171, 1.0, v171
    v_cvt_pk_bf16_f32 v171, 0, v171
    v_add_f32 v172, 1.0, v172
    v_cvt_pk_bf16_f32 v172, 0, v172
    v_add_f32 v173, 1.0, v173
    v_cvt_pk_bf16_f32 v173, 0, v173
    v_add_f32 v174, 1.0, v174
    v_cvt_pk_bf16_f32 v174, 0, v174
    v_add_f32 v175, 1.0, v175
    v_cvt_pk_bf16_f32 v175, 0, v175
    s_mov_b32 s5, 0
k1_kernel_L3:
    buffer_load_dword v22, v29, s[24:27], s40 offen sc1
    s_add_u32 s5, s5, 1
    s_waitcnt vmcnt(0)
    v_cmp_eq_u32 vcc, -1, v22
    s_nop 4
    s_cbranch_vccz k1_kernel_L3_ok
    s_cmp_lt_u32 s5, 0x20000
    s_cbranch_scc1 k1_kernel_L3
k1_kernel_L3_ok:
    buffer_load_dwordx4 v[32:35], v28, s[24:27], s42 offen offset:0 sc1
    buffer_load_dwordx4 v[36:39], v28, s[24:27], s42 offen offset:3584 sc1
    s_add_u32 s42, s42, 1835008
    buffer_load_dwordx4 v[40:43], v28, s[24:27], s42 offen offset:0 sc1
    buffer_load_dwordx4 v[44:47], v28, s[24:27], s42 offen offset:3584 sc1
    s_add_u32 s42, s42, 1835008
    buffer_load_dwordx4 v[48:51], v28, s[24:27], s42 offen offset:0 sc1
    buffer_load_dwordx4 v[52:55], v28, s[24:27], s42 offen offset:3584 sc1
    s_add_u32 s42, s42, 1835008
    buffer_load_dwordx4 v[56:59], v28, s[24:27], s42 offen offset:0 sc1
    buffer_load_dwordx4 v[60:63], v28, s[24:27], s42 offen offset:3584 sc1
    s_add_u32 s42, s42, 1835008
    buffer_load_dwordx4 v[64:67], v28, s[24:27], s42 offen offset:0 sc1
    buffer_load_dwordx4 v[68:71], v28, s[24:27], s42 offen offset:3584 sc1
    s_add_u32 s42, s42, 1835008
    buffer_load_dwordx4 v[72:75], v28, s[24:27], s42 offen offset:0 sc1
    buffer_load_dwordx4 v[76:79], v28, s[24:27], s42 offen offset:3584 sc1
    s_add_u32 s42, s42, 1835008
    buffer_load_dwordx4 v[80:83], v28, s[24:27], s42 offen offset:0 sc1
    buffer_load_dwordx4 v[84:87], v28, s[24:27], s42 offen offset:3584 sc1
    s_add_u32 s42, s42, 1835008
    buffer_load_dwordx4 v[88:91], v28, s[24:27], s42 offen offset:0 sc1
    buffer_load_dwordx4 v[92:95], v28, s[24:27], s42 offen offset:3584 sc1
    s_add_u32 m0, s41, 65536
    s_add_u32 s45, s53, 802816
    buffer_load_dwordx4 v2, s[12:15], s45 offen lds
    s_add_u32 m0, s41, 69632
    s_add_u32 s45, s53, 917504
    buffer_load_dwordx4 v2, s[12:15], s45 offen lds
    s_add_u32 m0, s41, 73728
    s_add_u32 s45, s53, 1032192
    buffer_load_dwordx4 v2, s[12:15], s45 offen lds
    s_add_u32 m0, s41, 77824
    s_add_u32 s45, s53, 1146880
    buffer_load_dwordx4 v2, s[12:15], s45 offen lds
    s_add_u32 m0, s41, 81920
    s_add_u32 s45, s53, 1261568
    buffer_load_dwordx4 v2, s[12:15], s45 offen lds
    s_add_u32 m0, s41, 86016
    s_add_u32 s45, s53, 1376256
    buffer_load_dwordx4 v2, s[12:15], s45 offen lds
    s_add_u32 m0, s41, 90112
    s_add_u32 s45, s53, 1490944
    buffer_load_dwordx4 v2, s[12:15], s45 offen lds
    s_waitcnt vmcnt(22)
    v_lshlrev_b32 v96, 16, v32
    v_and_b32 v97, s47, v32
    v_lshlrev_b32 v98, 16, v33
    v_and_b32 v99, s47, v33
    v_lshlrev_b32 v100, 16, v34
    v_and_b32 v101, s47, v34
    v_lshlrev_b32 v102, 16, v35
    v_and_b32 v103, s47, v35
    s_waitcnt vmcnt(21)
    v_lshlrev_b32 v104, 16, v36
    v_and_b32 v105, s47, v36
    v_lshlrev_b32 v106, 16, v37
    v_and_b32 v107, s47, v37
    v_lshlrev_b32 v108, 16, v38
    v_and_b32 v109, s47, v38
    v_lshlrev_b32 v110, 16, v39
    v_and_b32 v111, s47, v39
    s_waitcnt vmcnt(20)
    v_lshlrev_b32 v112, 16, v40
    v_and_b32 v113, s47, v40
    v_lshlrev_b32 v114, 16, v41
    v_and_b32 v115, s47, v41
    v_lshlrev_b32 v116, 16, v42
    v_and_b32 v117, s47, v42
    v_lshlrev_b32 v118, 16, v43
    v_and_b32 v119, s47, v43
    s_waitcnt vmcnt(19)
    v_lshlrev_b32 v120, 16, v44
    v_and_b32 v121, s47, v44
    v_lshlrev_b32 v122, 16, v45
    v_and_b32 v123, s47, v45
    v_lshlrev_b32 v124, 16, v46
    v_and_b32 v125, s47, v46
    v_lshlrev_b32 v126, 16, v47
    v_and_b32 v127, s47, v47
    v_pk_add_f32 v[96:97], v[96:97], v[112:113]
    v_pk_add_f32 v[98:99], v[98:99], v[114:115]
    v_pk_add_f32 v[100:101], v[100:101], v[116:117]
    v_pk_add_f32 v[102:103], v[102:103], v[118:119]
    v_pk_add_f32 v[104:105], v[104:105], v[120:121]
    v_pk_add_f32 v[106:107], v[106:107], v[122:123]
    v_pk_add_f32 v[108:109], v[108:109], v[124:125]
    v_pk_add_f32 v[110:111], v[110:111], v[126:127]
    s_waitcnt vmcnt(18)
    v_lshlrev_b32 v112, 16, v48
    v_and_b32 v113, s47, v48
    v_lshlrev_b32 v114, 16, v49
    v_and_b32 v115, s47, v49
    v_lshlrev_b32 v116, 16, v50
    v_and_b32 v117, s47, v50
    v_lshlrev_b32 v118, 16, v51
    v_and_b32 v119, s47, v51
    s_waitcnt vmcnt(17)
    v_lshlrev_b32 v120, 16, v52
    v_and_b32 v121, s47, v52
    v_lshlrev_b32 v122, 16, v53
    v_and_b32 v123, s47, v53
    v_lshlrev_b32 v124, 16, v54
    v_and_b32 v125, s47, v54
    v_lshlrev_b32 v126, 16, v55
    v_and_b32 v127, s47, v55
    v_pk_add_f32 v[96:97], v[96:97], v[112:113]
    v_pk_add_f32 v[98:99], v[98:99], v[114:115]
    v_pk_add_f32 v[100:101], v[100:101], v[116:117]
    v_pk_add_f32 v[102:103], v[102:103], v[118:119]
    v_pk_add_f32 v[104:105], v[104:105], v[120:121]
    v_pk_add_f32 v[106:107], v[106:107], v[122:123]
    v_pk_add_f32 v[108:109], v[108:109], v[124:125]
    v_pk_add_f32 v[110:111], v[110:111], v[126:127]
    s_waitcnt vmcnt(16)
    v_lshlrev_b32 v112, 16, v56
    v_and_b32 v113, s47, v56
    v_lshlrev_b32 v114, 16, v57
    v_and_b32 v115, s47, v57
    v_lshlrev_b32 v116, 16, v58
    v_and_b32 v117, s47, v58
    v_lshlrev_b32 v118, 16, v59
    v_and_b32 v119, s47, v59
    s_waitcnt vmcnt(15)
    v_lshlrev_b32 v120, 16, v60
    v_and_b32 v121, s47, v60
    v_lshlrev_b32 v122, 16, v61
    v_and_b32 v123, s47, v61
    v_lshlrev_b32 v124, 16, v62
    v_and_b32 v125, s47, v62
    v_lshlrev_b32 v126, 16, v63
    v_and_b32 v127, s47, v63
    v_pk_add_f32 v[96:97], v[96:97], v[112:113]
    v_pk_add_f32 v[98:99], v[98:99], v[114:115]
    v_pk_add_f32 v[100:101], v[100:101], v[116:117]
    v_pk_add_f32 v[102:103], v[102:103], v[118:119]
    v_pk_add_f32 v[104:105], v[104:105], v[120:121]
    v_pk_add_f32 v[106:107], v[106:107], v[122:123]
    v_pk_add_f32 v[108:109], v[108:109], v[124:125]
    v_pk_add_f32 v[110:111], v[110:111], v[126:127]
    s_waitcnt vmcnt(14)
    v_lshlrev_b32 v112, 16, v64
    v_and_b32 v113, s47, v64
    v_lshlrev_b32 v114, 16, v65
    v_and_b32 v115, s47, v65
    v_lshlrev_b32 v116, 16, v66
    v_and_b32 v117, s47, v66
    v_lshlrev_b32 v118, 16, v67
    v_and_b32 v119, s47, v67
    s_waitcnt vmcnt(13)
    v_lshlrev_b32 v120, 16, v68
    v_and_b32 v121, s47, v68
    v_lshlrev_b32 v122, 16, v69
    v_and_b32 v123, s47, v69
    v_lshlrev_b32 v124, 16, v70
    v_and_b32 v125, s47, v70
    v_lshlrev_b32 v126, 16, v71
    v_and_b32 v127, s47, v71
    v_pk_add_f32 v[96:97], v[96:97], v[112:113]
    v_pk_add_f32 v[98:99], v[98:99], v[114:115]
    v_pk_add_f32 v[100:101], v[100:101], v[116:117]
    v_pk_add_f32 v[102:103], v[102:103], v[118:119]
    v_pk_add_f32 v[104:105], v[104:105], v[120:121]
    v_pk_add_f32 v[106:107], v[106:107], v[122:123]
    v_pk_add_f32 v[108:109], v[108:109], v[124:125]
    v_pk_add_f32 v[110:111], v[110:111], v[126:127]
    s_waitcnt vmcnt(12)
    v_lshlrev_b32 v112, 16, v72
    v_and_b32 v113, s47, v72
    v_lshlrev_b32 v114, 16, v73
    v_and_b32 v115, s47, v73
    v_lshlrev_b32 v116, 16, v74
    v_and_b32 v117, s47, v74
    v_lshlrev_b32 v118, 16, v75
    v_and_b32 v119, s47, v75
    s_waitcnt vmcnt(11)
    v_lshlrev_b32 v120, 16, v76
    v_and_b32 v121, s47, v76
    v_lshlrev_b32 v122, 16, v77
    v_and_b32 v123, s47, v77
    v_lshlrev_b32 v124, 16, v78
    v_and_b32 v125, s47, v78
    v_lshlrev_b32 v126, 16, v79
    v_and_b32 v127, s47, v79
    v_pk_add_f32 v[96:97], v[96:97], v[112:113]
    v_pk_add_f32 v[98:99], v[98:99], v[114:115]
    v_pk_add_f32 v[100:101], v[100:101], v[116:117]
    v_pk_add_f32 v[102:103], v[102:103], v[118:119]
    v_pk_add_f32 v[104:105], v[104:105], v[120:121]
    v_pk_add_f32 v[106:107], v[106:107], v[122:123]
    v_pk_add_f32 v[108:109], v[108:109], v[124:125]
    v_pk_add_f32 v[110:111], v[110:111], v[126:127]
    s_waitcnt vmcnt(10)
    v_lshlrev_b32 v112, 16, v80
    v_and_b32 v113, s47, v80
    v_lshlrev_b32 v114, 16, v81
    v_and_b32 v115, s47, v81
    v_lshlrev_b32 v116, 16, v82
    v_and_b32 v117, s47, v82
    v_lshlrev_b32 v118, 16, v83
    v_and_b32 v119, s47, v83
    s_waitcnt vmcnt(9)
    v_lshlrev_b32 v120, 16, v84
    v_and_b32 v121, s47, v84
    v_lshlrev_b32 v122, 16, v85
    v_and_b32 v123, s47, v85
    v_lshlrev_b32 v124, 16, v86
    v_and_b32 v125, s47, v86
    v_lshlrev_b32 v126, 16, v87
    v_and_b32 v127, s47, v87
    v_pk_add_f32 v[96:97], v[96:97], v[112:113]
    v_pk_add_f32 v[98:99], v[98:99], v[114:115]
    v_pk_add_f32 v[100:101], v[100:101], v[116:117]
    v_pk_add_f32 v[102:103], v[102:103], v[118:119]
    v_pk_add_f32 v[104:105], v[104:105], v[120:121]
    v_pk_add_f32 v[106:107], v[106:107], v[122:123]
    v_pk_add_f32 v[108:109], v[108:109], v[124:125]
    v_pk_add_f32 v[110:111], v[110:111], v[126:127]
    s_waitcnt vmcnt(8)
    v_lshlrev_b32 v112, 16, v88
    v_and_b32 v113, s47, v88
    v_lshlrev_b32 v114, 16, v89
    v_and_b32 v115, s47, v89
    v_lshlrev_b32 v116, 16, v90
    v_and_b32 v117, s47, v90
    v_lshlrev_b32 v118, 16, v91
    v_and_b32 v119, s47, v91
    s_waitcnt vmcnt(7)
    v_lshlrev_b32 v120, 16, v92
    v_and_b32 v121, s47, v92
    v_lshlrev_b32 v122, 16, v93
    v_and_b32 v123, s47, v93
    v_lshlrev_b32 v124, 16, v94
    v_and_b32 v125, s47, v94
    v_lshlrev_b32 v126, 16, v95
    v_and_b32 v127, s47, v95
    v_pk_add_f32 v[96:97], v[96:97], v[112:113]
    v_pk_add_f32 v[98:99], v[98:99], v[114:115]
    v_pk_add_f32 v[100:101], v[100:101], v[116:117]
    v_pk_add_f32 v[102:103], v[102:103], v[118:119]
    v_pk_add_f32 v[104:105], v[104:105], v[120:121]
    v_pk_add_f32 v[106:107], v[106:107], v[122:123]
    v_pk_add_f32 v[108:109], v[108:109], v[124:125]
    v_pk_add_f32 v[110:111], v[110:111], v[126:127]
    v_cvt_pk_bf16_f32 v96, 0, v96
    v_cvt_pk_bf16_f32 v97, 0, v97
    v_cvt_pk_bf16_f32 v98, 0, v98
    v_cvt_pk_bf16_f32 v99, 0, v99
    v_cvt_pk_bf16_f32 v100, 0, v100
    v_cvt_pk_bf16_f32 v101, 0, v101
    v_cvt_pk_bf16_f32 v102, 0, v102
    v_cvt_pk_bf16_f32 v103, 0, v103
    v_cvt_pk_bf16_f32 v104, 0, v104
    v_cvt_pk_bf16_f32 v105, 0, v105
    v_cvt_pk_bf16_f32 v106, 0, v106
    v_cvt_pk_bf16_f32 v107, 0, v107
    v_cvt_pk_bf16_f32 v108, 0, v108
    v_cvt_pk_bf16_f32 v109, 0, v109
    v_cvt_pk_bf16_f32 v110, 0, v110
    v_cvt_pk_bf16_f32 v111, 0, v111
    v_pk_mul_f32 v[96:97], v[96:97], v[144:145]
    v_pk_mul_f32 v[98:99], v[98:99], v[146:147]
    v_pk_mul_f32 v[100:101], v[100:101], v[148:149]
    v_pk_mul_f32 v[102:103], v[102:103], v[150:151]
    v_pk_mul_f32 v[104:105], v[104:105], v[152:153]
    v_pk_mul_f32 v[106:107], v[106:107], v[154:155]
    v_pk_mul_f32 v[108:109], v[108:109], v[156:157]
    v_pk_mul_f32 v[110:111], v[110:111], v[158:159]
    v_cvt_pk_bf16_f32 v96, 0, v96
    v_cvt_pk_bf16_f32 v97, 0, v97
    v_cvt_pk_bf16_f32 v98, 0, v98
    v_cvt_pk_bf16_f32 v99, 0, v99
    v_cvt_pk_bf16_f32 v100, 0, v100
    v_cvt_pk_bf16_f32 v101, 0, v101
    v_cvt_pk_bf16_f32 v102, 0, v102
    v_cvt_pk_bf16_f32 v103, 0, v103
    v_cvt_pk_bf16_f32 v104, 0, v104
    v_cvt_pk_bf16_f32 v105, 0, v105
    v_cvt_pk_bf16_f32 v106, 0, v106
    v_cvt_pk_bf16_f32 v107, 0, v107
    v_cvt_pk_bf16_f32 v108, 0, v108
    v_cvt_pk_bf16_f32 v109, 0, v109
    v_cvt_pk_bf16_f32 v110, 0, v110
    v_cvt_pk_bf16_f32 v111, 0, v111
    v_pk_add_f32 v[96:97], v[96:97], v[128:129]
    v_pk_add_f32 v[98:99], v[98:99], v[130:131]
    v_pk_add_f32 v[100:101], v[100:101], v[132:133]
    v_pk_add_f32 v[102:103], v[102:103], v[134:135]
    v_pk_add_f32 v[104:105], v[104:105], v[136:137]
    v_pk_add_f32 v[106:107], v[106:107], v[138:139]
    v_pk_add_f32 v[108:109], v[108:109], v[140:141]
    v_pk_add_f32 v[110:111], v[110:111], v[142:143]
    v_cvt_pk_bf16_f32 v32, v96, v97
    v_cvt_pk_bf16_f32 v33, v98, v99
    v_cvt_pk_bf16_f32 v34, v100, v101
    v_cvt_pk_bf16_f32 v35, v102, v103
    v_cvt_pk_bf16_f32 v36, v104, v105
    v_cvt_pk_bf16_f32 v37, v106, v107
    v_cvt_pk_bf16_f32 v38, v108, v109
    v_cvt_pk_bf16_f32 v39, v110, v111
    buffer_store_dwordx4 v[32:35], v28, s[24:27], s43 offen offset:0 sc1
    buffer_store_dwordx4 v[36:39], v28, s[24:27], s43 offen offset:3584 sc1
    v_lshlrev_b32 v96, 16, v32
    v_and_b32 v97, s47, v32
    v_lshlrev_b32 v98, 16, v33
    v_and_b32 v99, s47, v33
    v_lshlrev_b32 v100, 16, v34
    v_and_b32 v101, s47, v34
    v_lshlrev_b32 v102, 16, v35
    v_and_b32 v103, s47, v35
    v_lshlrev_b32 v104, 16, v36
    v_and_b32 v105, s47, v36
    v_lshlrev_b32 v106, 16, v37
    v_and_b32 v107, s47, v37
    v_lshlrev_b32 v108, 16, v38
    v_and_b32 v109, s47, v38
    v_lshlrev_b32 v110, 16, v39
    v_and_b32 v111, s47, v39
    v_pk_add_f32 v[20:21], v[96:97], v[98:99]
    v_pk_add_f32 v[20:21], v[20:21], v[100:101]
    v_pk_add_f32 v[20:21], v[20:21], v[102:103]
    v_pk_add_f32 v[20:21], v[20:21], v[104:105]
    v_pk_add_f32 v[20:21], v[20:21], v[106:107]
    v_pk_add_f32 v[20:21], v[20:21], v[108:109]
    v_pk_add_f32 v[20:21], v[20:21], v[110:111]
    v_add_f32 v20, v20, v21
    s_nop 1
    v_add_f32_dpp v20, v20, v20 row_ror:8 row_mask:0xf bank_mask:0xf
    v_mov_b32 v22, v20
    s_nop 1
    v_permlane16_swap_b32 v20, v22
    v_add_f32 v20, v20, v22
    v_mov_b32 v22, v20
    s_nop 1
    v_permlane32_swap_b32 v20, v22
    v_add_f32 v20, v20, v22
    v_mul_f32 v20, 0x3c124925, v20
    v_cmp_gt_u32 vcc, 56, v1
    v_pk_add_f32 v[22:23], v[96:97], v[20:21] op_sel_hi:[1,0] neg_lo:[0,1] neg_hi:[0,1]
    v_pk_mul_f32 v[24:25], v[22:23], v[22:23]
    v_pk_add_f32 v[22:23], v[98:99], v[20:21] op_sel_hi:[1,0] neg_lo:[0,1] neg_hi:[0,1]
    v_pk_fma_f32 v[24:25], v[22:23], v[22:23], v[24:25]
    v_pk_add_f32 v[22:23], v[100:101], v[20:21] op_sel_hi:[1,0] neg_lo:[0,1] neg_hi:[0,1]
    v_pk_fma_f32 v[24:25], v[22:23], v[22:23], v[24:25]
    v_pk_add_f32 v[22:23], v[102:103], v[20:21] op_sel_hi:[1,0] neg_lo:[0,1] neg_hi:[0,1]
    v_pk_fma_f32 v[24:25], v[22:23], v[22:23], v[24:25]
    v_pk_add_f32 v[22:23], v[104:105], v[20:21] op_sel_hi:[1,0] neg_lo:[0,1] neg_hi:[0,1]
    v_pk_fma_f32 v[24:25], v[22:23], v[22:23], v[24:25]
    v_pk_add_f32 v[22:23], v[106:107], v[20:21] op_sel_hi:[1,0] neg_lo:[0,1] neg_hi:[0,1]
    v_pk_fma_f32 v[24:25], v[22:23], v[22:23], v[24:25]
    v_pk_add_f32 v[22:23], v[108:109], v[20:21] op_sel_hi:[1,0] neg_lo:[0,1] neg_hi:[0,1]
    v_pk_fma_f32 v[24:25], v[22:23], v[22:23], v[24:25]
    v_pk_add_f32 v[22:23], v[110:111], v[20:21] op_sel_hi:[1,0] neg_lo:[0,1] neg_hi:[0,1]
    v_pk_fma_f32 v[24:25], v[22:23], v[22:23], v[24:25]
    v_add_f32 v21, v24, v25
    v_cndmask_b32 v21, 0, v21, vcc
    s_nop 1
    v_add_f32_dpp v21, v21, v21 row_ror:8 row_mask:0xf bank_mask:0xf
    v_mov_b32 v22, v21
    s_nop 1
    v_permlane16_swap_b32 v21, v22
    v_add_f32 v21, v21, v22
    v_mov_b32 v22, v21
    s_nop 1
    v_permlane32_swap_b32 v21, v22
    v_add_f32 v21, v21, v22
    ds_write_b64 v6, v[20:21]
    s_waitcnt lgkmcnt(0)
    s_barrier
    ds_read_b64 v[112:113], v7 offset:0
    ds_read_b64 v[114:115], v7 offset:64
    ds_read_b64 v[116:117], v7 offset:128
    ds_read_b64 v[118:119], v7 offset:192
    s_waitcnt lgkmcnt(2)
    v_pk_add_f32 v[20:21], v[112:113], v[114:115]
    s_waitcnt lgkmcnt(0)
    v_pk_add_f32 v[22:23], v[116:117], v[118:119]
    v_pk_add_f32 v[20:21], v[20:21], v[22:23]
    v_mul_f32 v20, 0x3e800000, v20
    v_sub_f32 v22, v112, v20
    v_mul_f32 v23, v22, v22
    v_sub_f32 v22, v114, v20
    v_fmac_f32 v23, v22, v22
    v_sub_f32 v22, v116, v20
    v_fmac_f32 v23, v22, v22
    v_sub_f32 v22, v118, v20
    v_fmac_f32 v23, v22, v22
    v_fmac_f32 v21, 0x42e00000, v23
    v_mul_f32 v21, 0x3b124925, v21
    v_cvt_pk_bf16_f32 v21, 0, v21
    v_cvt_pk_bf16_f32 v20, 0, v20
    v_add_f32 v21, 0x3727c5ac, v21
    v_cvt_pk_bf16_f32 v21, 0, v21
    v_sqrt_f32 v21, v21
    s_nop 0
    v_cvt_pk_bf16_f32 v21, 0, v21
    v_rcp_f32 v21, v21
    s_nop 0
    v_pk_add_f32 v[96:97], v[96:97], v[20:21] op_sel_hi:[1,0] neg_lo:[0,1] neg_hi:[0,1]
    v_pk_add_f32 v[98:99], v[98:99], v[20:21] op_sel_hi:[1,0] neg_lo:[0,1] neg_hi:[0,1]
    v_pk_add_f32 v[100:101], v[100:101], v[20:21] op_sel_hi:[1,0] neg_lo:[0,1] neg_hi:[0,1]
    v_pk_add_f32 v[102:103], v[102:103], v[20:21] op_sel_hi:[1,0] neg_lo:[0,1] neg_hi:[0,1]
    v_pk_add_f32 v[104:105], v[104:105], v[20:21] op_sel_hi:[1,0] neg_lo:[0,1] neg_hi:[0,1]
    v_pk_add_f32 v[106:107], v[106:107], v[20:21] op_sel_hi:[1,0] neg_lo:[0,1] neg_hi:[0,1]
    v_pk_add_f32 v[108:109], v[108:109], v[20:21] op_sel_hi:[1,0] neg_lo:[0,1] neg_hi:[0,1]
    v_pk_add_f32 v[110:111], v[110:111], v[20:21] op_sel_hi:[1,0] neg_lo:[0,1] neg_hi:[0,1]
    v_cvt_pk_bf16_f32 v96, 0, v96
    v_cvt_pk_bf16_f32 v97, 0, v97
    v_cvt_pk_bf16_f32 v98, 0, v98
    v_cvt_pk_bf16_f32 v99, 0, v99
    v_cvt_pk_bf16_f32 v100, 0, v100
    v_cvt_pk_bf16_f32 v101, 0, v101
    v_cvt_pk_bf16_f32 v102, 0, v102
    v_cvt_pk_bf16_f32 v103, 0, v103
    v_cvt_pk_bf16_f32 v104, 0, v104
    v_cvt_pk_bf16_f32 v105, 0, v105
    v_cvt_pk_bf16_f32 v106, 0, v106
    v_cvt_pk_bf16_f32 v107, 0, v107
    v_cvt_pk_bf16_f32 v108, 0, v108
    v_cvt_pk_bf16_f32 v109, 0, v109
    v_cvt_pk_bf16_f32 v110, 0, v110
    v_cvt_pk_bf16_f32 v111, 0, v111
    v_pk_mul_f32 v[96:97], v[96:97], v[20:21] op_sel:[0,1] op_sel_hi:[1,1]
    v_pk_mul_f32 v[98:99], v[98:99], v[20:21] op_sel:[0,1] op_sel_hi:[1,1]
    v_pk_mul_f32 v[100:101], v[100:101], v[20:21] op_sel:[0,1] op_sel_hi:[1,1]
    v_pk_mul_f32 v[102:103], v[102:103], v[20:21] op_sel:[0,1] op_sel_hi:[1,1]
    v_pk_mul_f32 v[104:105], v[104:105], v[20:21] op_sel:[0,1] op_sel_hi:[1,1]
    v_pk_mul_f32 v[106:107], v[106:107], v[20:21] op_sel:[0,1] op_sel_hi:[1,1]
    v_pk_mul_f32 v[108:109], v[108:109], v[20:21] op_sel:[0,1] op_sel_hi:[1,1]
    v_pk_mul_f32 v[110:111], v[110:111], v[20:21] op_sel:[0,1] op_sel_hi:[1,1]
    v_cvt_pk_bf16_f32 v96, 0, v96
    v_cvt_pk_bf16_f32 v97, 0, v97
    v_cvt_pk_bf16_f32 v98, 0, v98
    v_cvt_pk_bf16_f32 v99, 0, v99
    v_cvt_pk_bf16_f32 v100, 0, v100
    v_cvt_pk_bf16_f32 v101, 0, v101
    v_cvt_pk_bf16_f32 v102, 0, v102
    v_cvt_pk_bf16_f32 v103, 0, v103
    v_cvt_pk_bf16_f32 v104, 0, v104
    v_cvt_pk_bf16_f32 v105, 0, v105
    v_cvt_pk_bf16_f32 v106, 0, v106
    v_cvt_pk_bf16_f32 v107, 0, v107
    v_cvt_pk_bf16_f32 v108, 0, v108
    v_cvt_pk_bf16_f32 v109, 0, v109
    v_cvt_pk_bf16_f32 v110, 0, v110
    v_cvt_pk_bf16_f32 v111, 0, v111
    v_pk_mul_f32 v[96:97], v[96:97], v[160:161]
    v_pk_mul_f32 v[98:99], v[98:99], v[162:163]
    v_pk_mul_f32 v[100:101], v[100:101], v[164:165]
    v_pk_mul_f32 v[102:103], v[102:103], v[166:167]
    v_pk_mul_f32 v[104:105], v[104:105], v[168:169]
    v_pk_mul_f32 v[106:107], v[106:107], v[170:171]
    v_pk_mul_f32 v[108:109], v[108:109], v[172:173]
    v_pk_mul_f32 v[110:111], v[110:111], v[174:175]
    v_cvt_pk_bf16_f32 v96, 0, v96
    v_cvt_pk_bf16_f32 v97, 0, v97
    v_cvt_pk_bf16_f32 v98, 0, v98
    v_cvt_pk_bf16_f32 v99, 0, v99
    v_cvt_pk_bf16_f32 v100, 0, v100
    v_cvt_pk_bf16_f32 v101, 0, v101
    v_cvt_pk_bf16_f32 v102, 0, v102
    v_cvt_pk_bf16_f32 v103, 0, v103
    v_cvt_pk_bf16_f32 v104, 0, v104
    v_cvt_pk_bf16_f32 v105, 0, v105
    v_cvt_pk_bf16_f32 v106, 0, v106
    v_cvt_pk_bf16_f32 v107, 0, v107
    v_cvt_pk_bf16_f32 v108, 0, v108
    v_cvt_pk_bf16_f32 v109, 0, v109
    v_cvt_pk_bf16_f32 v110, 0, v110
    v_cvt_pk_bf16_f32 v111, 0, v111
    v_pk_add_f32 v[96:97], v[96:97], v[176:177]
    v_pk_add_f32 v[98:99], v[98:99], v[178:179]
    v_pk_add_f32 v[100:101], v[100:101], v[180:181]
    v_pk_add_f32 v[102:103], v[102:103], v[182:183]
    v_pk_add_f32 v[104:105], v[104:105], v[184:185]
    v_pk_add_f32 v[106:107], v[106:107], v[186:187]
    v_pk_add_f32 v[108:109], v[108:109], v[188:189]
    v_pk_add_f32 v[110:111], v[110:111], v[190:191]
    v_cvt_pk_bf16_f32 v40, v96, v97
    v_cvt_pk_bf16_f32 v41, v98, v99
    v_cvt_pk_bf16_f32 v42, v100, v101
    v_cvt_pk_bf16_f32 v43, v102, v103
    v_cvt_pk_bf16_f32 v44, v104, v105
    v_cvt_pk_bf16_f32 v45, v106, v107
    v_cvt_pk_bf16_f32 v46, v108, v109
    v_cvt_pk_bf16_f32 v47, v110, v111
    buffer_store_dwordx4 v[40:43], v28, s[24:27], s44 offen offset:0 sc1
    buffer_store_dwordx4 v[44:47], v28, s[24:27], s44 offen offset:3584 sc1
    s_load_dwordx2 s[28:29], s[0:1], 64
    s_load_dwordx2 s[30:31], s[0:1], 96
    v_mov_b32 v22, 0
    s_waitcnt vmcnt(0)
    buffer_store_dword v22, v22, s[24:27], s46 offen sc1
    s_cmp_ge_u32 s2, 224
    s_cbranch_scc1 k1_kernel_fin
    s_barrier
    s_lshl_b32 s3, s39, 2
    s_add_u32 s3, s3, s48
    s_lshl_b32 s34, s3, 6
    s_add_u32 s34, s34, 29593600
    s_mul_i32 s35, s3, 28672
    s_add_u32 s35, s35, 18874368
    s_mul_i32 s49, s3, 57344
    s_lshl_b32 s5, s38, 12
    s_add_u32 s49, s49, s5
    s_mul_i32 s50, s3, 3584
    s_add_u32 s50, s50, 29360128
    s_lshl_b32 s5, s38, 8
    s_add_u32 s51, s50, s5
    v_lshlrev_b32 v2, 4, v1
    v_lshrrev_b32 v24, 5, v1
    v_and_b32 v25, 31, v1
    v_bfe_u32 v26, v1, 2, 2
    v_bfe_u32 v27, v1, 4, 1
    v_and_b32 v28, 3, v1
    v_and_b32 v31, 1, v28
    v_lshlrev_b32 v31, 1, v31
    v_lshrrev_b32 v28, 1, v28
    v_or_b32 v28, v28, v31
    v_lshlrev_b32 v29, 5, v27
    v_lshl_add_u32 v29, v28, 3, v29
    v_lshl_add_u32 v30, v24, 3, v26
    v_lshl_add_u32 v6, v30, 7, v29
    v_lshrrev_b32 v31, 1, v26
    v_lshl_add_u32 v6, v31, 6, v6
    v_xor_b32 v7, 64, v6
    v_add_u32 v8, 65536, v6
    v_add_u32 v9, 65536, v7
    v_add_u32 v10, 131072, v6
    v_add_u32 v11, 131072, v7
    v_lshlrev_b32 v18, 3, v25
    v_mul_u32_u24 v19, 1792, v24
    v_add_u32 v19, v19, v18
    v_mov_b32 v12, 0xc0135761
    v_mov_b32 v13, 0xc0135761
    v_and_b32 v23, 15, v1
    v_lshlrev_b32 v23, 2, v23
    ds_read_b64_tr_b16 a[112:113], v10 offset:0
    ds_read_b64_tr_b16 a[114:115], v10 offset:512
    ds_read_b64_tr_b16 a[116:117], v11 offset:0
    ds_read_b64_tr_b16 a[118:119], v11 offset:512
    ds_read_b64_tr_b16 a[120:121], v10 offset:2048
    ds_read_b64_tr_b16 a[122:123], v10 offset:2560
    ds_read_b64_tr_b16 a[124:125], v11 offset:2048
    ds_read_b64_tr_b16 a[126:127], v11 offset:2560
    ds_read_b64_tr_b16 a[128:129], v10 offset:4096
    ds_read_b64_tr_b16 a[130:131], v10 offset:4608
    ds_read_b64_tr_b16 a[132:133], v11 offset:4096
    ds_read_b64_tr_b16 a[134:135], v11 offset:4608
    s_mov_b32 s12, s98
    s_mov_b32 s13, s99
    s_mov_b32 s14, 8388608
    s_mov_b32 s15, 0x20000
    s_mov_b32 s20, s100
    s_mov_b32 s21, s101
    s_mov_b32 s22, 802816
    s_mov_b32 s23, 0x20000
    s_mov_b32 s40, 0xbdd2d3e8
    s_mov_b32 s41, s40
    s_mov_b32 s42, 1.0
    s_mov_b32 s43, 1.0
    s_lshl_b32 s44, s3, 17
    s_mul_i32 s45, s48, 57344
    s_lshl_b32 s5, s38, 12
    s_add_u32 s45, s45, s5
    s_add_u32 s45, s45, 25165824
    s_lshl_b32 s46, s48, 12
    s_lshl_b32 s53, s48, 13
    s_add_u32 s53, s53, 16384
    s_waitcnt lgkmcnt(0)
    s_mov_b32 s16, s28
    s_mov_b32 s17, s29
    s_mov_b32 s18, 4096
    s_mov_b32 s19, 0x20000
    s_mov_b32 s8, s30
    s_mov_b32 s9, s31
    s_mov_b32 s10, 1835008
    s_mov_b32 s11, 0x20000
    v_lshlrev_b32 v30, 2, v24
    v_xor_b32 v30, v30, v25
    v_lshlrev_b32 v30, 4, v30
    v_lshl_add_u32 v112, v24, 9, v30
    v_xor_b32 v113, 128, v112
    v_lshrrev_b32 v30, 4, v1
    v_and_b32 v31, 15, v1
    v_xor_b32 v31, v31, v30
    v_lshlrev_b32 v31, 4, v31
    v_lshl_add_u32 v114, v30, 12, v31
    v_xor_b32 v115, 64, v114
    v_xor_b32 v116, 128, v114
    v_xor_b32 v117, 192, v114
    v_add_u32 v115, 15360, v115
    v_add_u32 v116, 30720, v116
    v_add_u32 v117, 46080, v117
    v_lshrrev_b32 v30, 1, v28
    v_lshl_add_u32 v30, v27, 1, v30
    v_lshl_add_u32 v31, v24, 3, v26
    v_lshlrev_b32 v22, 2, v30
    v_xor_b32 v31, v31, v22
    v_lshlrev_b32 v31, 4, v31
    v_lshl_add_u32 v118, v30, 9, v31
    v_and_b32 v31, 1, v28
    v_lshl_add_u32 v118, v31, 3, v118
    v_and_b32 v31, 15, v25
    v_xor_b32 v31, v31, v24
    v_lshlrev_b32 v31, 4, v31
    v_lshl_add_u32 v119, v25, 8, v31
    v_add_u32 v119, s53, v119
    v_lshlrev_b32 v120, 1, v25
    s_lshl_b32 s5, s3, 6
    buffer_load_ushort v120, v120, s[16:19], s5 offen
    v_add_u32 v128, 81920, v119
    v_xor_b32 v129, 32, v128
    v_xor_b32 v130, 64, v128
    v_xor_b32 v131, 96, v128
    v_xor_b32 v132, 128, v128
    v_xor_b32 v133, 160, v128
    v_xor_b32 v134, 192, v128
    v_xor_b32 v135, 224, v128
    s_add_u32 m0, s53, 81920
    s_add_u32 s33, s44, 768
    buffer_load_dwordx4 v114, s[12:15], s33 offen offset:0 lds
    buffer_load_dwordx4 v115, s[12:15], s33 offen offset:1024 lds
    buffer_load_dwordx4 v116, s[12:15], s33 offen offset:2048 lds
    buffer_load_dwordx4 v117, s[12:15], s33 offen offset:3072 lds
    s_add_u32 m0, s53, 86016
    s_add_u32 s33, s44, 66304
    buffer_load_dwordx4 v114, s[12:15], s33 offen offset:0 lds
    buffer_load_dwordx4 v115, s[12:15], s33 offen offset:1024 lds
    buffer_load_dwordx4 v116, s[12:15], s33 offen offset:2048 lds
    buffer_load_dwordx4 v117, s[12:15], s33 offen offset:3072 lds
    s_mov_b32 s5, 0
k1_kernel_L4:
    buffer_load_dword v22, v23, s[24:27], s34 offen sc1
    s_add_u32 s5, s5, 1
    s_waitcnt vmcnt(0)
    v_cmp_eq_u32 vcc, -1, v22
    s_nop 4
    s_cbranch_vccz k1_kernel_L4_ok
    s_cmp_lt_u32 s5, 0x20000
    s_cbranch_scc1 k1_kernel_L4
k1_kernel_L4_ok:
    buffer_load_dwordx4 a[0:3], v2, s[24:27], s35 offen offset:0
    buffer_load_dwordx4 a[4:7], v2, s[24:27], s35 offen offset:1024
    buffer_load_dwordx4 a[8:11], v2, s[24:27], s35 offen offset:2048
    buffer_load_dwordx4 a[12:15], v2, s[24:27], s35 offen offset:3072
    s_add_u32 s35, s35, 4096
    buffer_load_dwordx4 a[16:19], v2, s[24:27], s35 offen offset:0
    buffer_load_dwordx4 a[20:23], v2, s[24:27], s35 offen offset:1024
    buffer_load_dwordx4 a[24:27], v2, s[24:27], s35 offen offset:2048
    buffer_load_dwordx4 a[28:31], v2, s[24:27], s35 offen offset:3072
    s_add_u32 s35, s35, 4096
    buffer_load_dwordx4 a[32:35], v2, s[24:27], s35 offen offset:0
    buffer_load_dwordx4 a[36:39], v2, s[24:27], s35 offen offset:1024
    buffer_load_dwordx4 a[40:43], v2, s[24:27], s35 offen offset:2048
    buffer_load_dwordx4 a[44:47], v2, s[24:27], s35 offen offset:3072
    s_add_u32 s35, s35, 4096
    buffer_load_dwordx4 a[48:51], v2, s[24:27], s35 offen offset:0
    buffer_load_dwordx4 a[52:55], v2, s[24:27], s35 offen offset:1024
    buffer_load_dwordx4 a[56:59], v2, s[24:27], s35 offen offset:2048
    buffer_load_dwordx4 a[60:63], v2, s[24:27], s35 offen offset:3072
    s_add_u32 s35, s35, 4096
    buffer_load_dwordx4 a[64:67], v2, s[24:27], s35 offen offset:0
    buffer_load_dwordx4 a[68:71], v2, s[24:27], s35 offen offset:1024
    buffer_load_dwordx4 a[72:75], v2, s[24:27], s35 offen offset:2048
    buffer_load_dwordx4 a[76:79], v2, s[24:27], s35 offen offset:3072
    s_add_u32 s35, s35, 4096
    buffer_load_dwordx4 a[80:83], v2, s[24:27], s35 offen offset:0
    buffer_load_dwordx4 a[84:87], v2, s[24:27], s35 offen offset:1024
    buffer_load_dwordx4 a[88:91], v2, s[24:27], s35 offen offset:2048
    buffer_load_dwordx4 a[92:95], v2, s[24:27], s35 offen offset:3072
    s_add_u32 s35, s35, 4096
    buffer_load_dwordx4 a[96:99], v2, s[24:27], s35 offen offset:0
    buffer_load_dwordx4 a[100:103], v2, s[24:27], s35 offen offset:1024
    buffer_load_dwordx4 a[104:107], v2, s[24:27], s35 offen offset:2048
    buffer_load_dwordx4 a[108:111], v2, s[24:27], s35 offen offset:3072
    ds_read_b128 a[144:147], v128
    ds_read_b128 a[148:151], v129
    ds_read_b128 a[152:155], v130
    ds_read_b128 a[156:159], v131
    ds_read_b128 a[160:163], v132
    ds_read_b128 a[164:167], v133
    ds_read_b128 a[168:171], v134
    ds_read_b128 a[172:175], v135
    s_waitcnt vmcnt(27)
    v_mfma_f32_32x32x16_bf16 v[32:47], a[112:115], a[0:3], 0
    ds_read_b64_tr_b16 a[136:137], v10 offset:6144
    ds_read_b64_tr_b16 a[138:139], v10 offset:6656
    v_mfma_f32_32x32x16_bf16 v[48:63], a[116:119], a[0:3], 0
    ds_read_b64_tr_b16 a[140:141], v11 offset:6144
    ds_read_b64_tr_b16 a[142:143], v11 offset:6656
    s_waitcnt vmcnt(26)
    v_mfma_f32_32x32x16_bf16 v[32:47], a[120:123], a[4:7], v[32:47]
    ds_read_b64_tr_b16 a[112:113], v10 offset:8192
    ds_read_b64_tr_b16 a[114:115], v10 offset:8704
    v_mfma_f32_32x32x16_bf16 v[48:63], a[124:127], a[4:7], v[48:63]
    ds_read_b64_tr_b16 a[116:117], v11 offset:8192
    ds_read_b64_tr_b16 a[118:119], v11 offset:8704
    s_waitcnt vmcnt(25)
    v_mfma_f32_32x32x16_bf16 v[32:47], a[128:131], a[8:11], v[32:47]
    ds_read_b64_tr_b16 a[120:121], v10 offset:10240
    ds_read_b64_tr_b16 a[122:123], v10 offset:10752
    v_mfma_f32_32x32x16_bf16 v[48:63], a[132:135], a[8:11], v[48:63]
    ds_read_b64_tr_b16 a[124:125], v11 offset:10240
    ds_read_b64_tr_b16 a[126:127], v11 offset:10752
    s_waitcnt vmcnt(24) lgkmcnt(10)
    v_mfma_f32_32x32x16_bf16 v[32:47], a[136:139], a[12:15], v[32:47]
    ds_read_b64_tr_b16 a[128:129], v10 offset:12288
    ds_read_b64_tr_b16 a[130:131], v10 offset:12800
    s_waitcnt lgkmcnt(10)
    v_mfma_f32_32x32x16_bf16 v[48:63], a[140:143], a[12:15], v[48:63]
    ds_read_b64_tr_b16 a[132:133], v11 offset:12288
    ds_read_b64_tr_b16 a[134:135], v11 offset:12800
    s_waitcnt vmcnt(23) lgkmcnt(10)
    v_mfma_f32_32x32x16_bf16 v[32:47], a[112:115], a[16:19], v[32:47]
    ds_read_b64_tr_b16 a[136:137], v10 offset:14336
    ds_read_b64_tr_b16 a[138:139], v10 offset:14848
    s_waitcnt lgkmcnt(10)
    v_mfma_f32_32x32x16_bf16 v[48:63], a[116:119], a[16:19], v[48:63]
    ds_read_b64_tr_b16 a[140:141], v11 offset:14336
    ds_read_b64_tr_b16 a[142:143], v11 offset:14848
    s_waitcnt vmcnt(22) lgkmcnt(10)
    v_mfma_f32_32x32x16_bf16 v[32:47], a[120:123], a[20:23], v[32:47]
    ds_read_b64_tr_b16 a[112:113], v10 offset:16384
    ds_read_b64_tr_b16 a[114:115], v10 offset:16896
    s_waitcnt lgkmcnt(10)
    v_mfma_f32_32x32x16_bf16 v[48:63], a[124:127], a[20:23], v[48:63]
    ds_read_b64_tr_b16 a[116:117], v11 offset:16384
    ds_read_b64_tr_b16 a[118:119], v11 offset:16896
    s_waitcnt vmcnt(21) lgkmcnt(10)
    v_mfma_f32_32x32x16_bf16 v[32:47], a[128:131], a[24:27], v[32:47]
    ds_read_b64_tr_b16 a[120:121], v10 offset:18432
    ds_read_b64_tr_b16 a[122:123], v10 offset:18944
    s_add_u32 m0, s53, 81920
    s_add_u32 s33, s44, 1024
    buffer_load_dwordx4 v114, s[12:15], s33 offen offset:0 lds
    s_waitcnt lgkmcnt(10)
    v_mfma_f32_32x32x16_bf16 v[48:63], a[132:135], a[24:27], v[48:63]
    ds_read_b64_tr_b16 a[124:125], v11 offset:18432
    ds_read_b64_tr_b16 a[126:127], v11 offset:18944
    buffer_load_dwordx4 v115, s[12:15], s33 offen offset:1024 lds
    s_waitcnt vmcnt(22) lgkmcnt(10)
    v_mfma_f32_32x32x16_bf16 v[32:47], a[136:139], a[28:31], v[32:47]
    ds_read_b64_tr_b16 a[128:129], v10 offset:20480
    ds_read_b64_tr_b16 a[130:131], v10 offset:20992
    buffer_load_dwordx4 v116, s[12:15], s33 offen offset:2048 lds
    s_waitcnt lgkmcnt(10)
    v_mfma_f32_32x32x16_bf16 v[48:63], a[140:143], a[28:31], v[48:63]
    ds_read_b64_tr_b16 a[132:133], v11 offset:20480
    ds_read_b64_tr_b16 a[134:135], v11 offset:20992
    buffer_load_dwordx4 v117, s[12:15], s33 offen offset:3072 lds
    s_waitcnt vmcnt(23) lgkmcnt(10)
    v_mfma_f32_32x32x16_bf16 v[32:47], a[112:115], a[32:35], v[32:47]
    ds_read_b64_tr_b16 a[136:137], v10 offset:22528
    ds_read_b64_tr_b16 a[138:139], v10 offset:23040
    s_add_u32 m0, s53, 86016
    s_add_u32 s33, s44, 66560
    buffer_load_dwordx4 v114, s[12:15], s33 offen offset:0 lds
    s_waitcnt lgkmcnt(10)
    v_mfma_f32_32x32x16_bf16 v[48:63], a[116:119], a[32:35], v[48:63]
    ds_read_b64_tr_b16 a[140:141], v11 offset:22528
    ds_read_b64_tr_b16 a[142:143], v11 offset:23040
    buffer_load_dwordx4 v115, s[12:15], s33 offen offset:1024 lds
    s_waitcnt vmcnt(24) lgkmcnt(10)
    v_mfma_f32_32x32x16_bf16 v[32:47], a[120:123], a[36:39], v[32:47]
    ds_read_b64_tr_b16 a[112:113], v10 offset:24576
    ds_read_b64_tr_b16 a[114:115], v10 offset:25088
    buffer_load_dwordx4 v116, s[12:15], s33 offen offset:2048 lds
    s_waitcnt lgkmcnt(10)
    v_mfma_f32_32x32x16_bf16 v[48:63], a[124:127], a[36:39], v[48:63]
    ds_read_b64_tr_b16 a[116:117], v11 offset:24576
    ds_read_b64_tr_b16 a[118:119], v11 offset:25088
    buffer_load_dwordx4 v117, s[12:15], s33 offen offset:3072 lds
    s_waitcnt vmcnt(25) lgkmcnt(10)
    v_mfma_f32_32x32x16_bf16 v[32:47], a[128:131], a[40:43], v[32:47]
    ds_read_b64_tr_b16 a[120:121], v10 offset:26624
    ds_read_b64_tr_b16 a[122:123], v10 offset:27136
    s_waitcnt lgkmcnt(10)
    v_mfma_f32_32x32x16_bf16 v[48:63], a[132:135], a[40:43], v[48:63]
    ds_read_b64_tr_b16 a[124:125], v11 offset:26624
    ds_read_b64_tr_b16 a[126:127], v11 offset:27136
    s_waitcnt vmcnt(24) lgkmcnt(10)
    v_mfma_f32_32x32x16_bf16 v[32:47], a[136:139], a[44:47], v[32:47]
    ds_read_b64_tr_b16 a[128:129], v6 offset:0
    ds_read_b64_tr_b16 a[130:131], v6 offset:512
    s_waitcnt lgkmcnt(10)
    v_mfma_f32_32x32x16_bf16 v[48:63], a[140:143], a[44:47], v[48:63]
    ds_read_b64_tr_b16 a[132:133], v7 offset:0
    ds_read_b64_tr_b16 a[134:135], v7 offset:512
    s_waitcnt vmcnt(23) lgkmcnt(10)
    v_mfma_f32_32x32x16_bf16 v[32:47], a[112:115], a[48:51], v[32:47]
    ds_read_b64_tr_b16 a[136:137], v6 offset:2048
    ds_read_b64_tr_b16 a[138:139], v6 offset:2560
    s_waitcnt lgkmcnt(10)
    v_mfma_f32_32x32x16_bf16 v[48:63], a[116:119], a[48:51], v[48:63]
    ds_read_b64_tr_b16 a[140:141], v7 offset:2048
    ds_read_b64_tr_b16 a[142:143], v7 offset:2560
    s_waitcnt vmcnt(22) lgkmcnt(10)
    v_mfma_f32_32x32x16_bf16 v[32:47], a[120:123], a[52:55], v[32:47]
    ds_read_b64_tr_b16 a[112:113], v6 offset:4096
    ds_read_b64_tr_b16 a[114:115], v6 offset:4608
    s_waitcnt lgkmcnt(10)
    v_mfma_f32_32x32x16_bf16 v[48:63], a[124:127], a[52:55], v[48:63]
    ds_read_b64_tr_b16 a[116:117], v7 offset:4096
    ds_read_b64_tr_b16 a[118:119], v7 offset:4608
    s_waitcnt vmcnt(21) lgkmcnt(10)
    v_mfma_f32_32x32x16_bf16 v[32:47], a[128:131], a[56:59], v[32:47]
    ds_read_b64_tr_b16 a[120:121], v6 offset:6144
    ds_read_b64_tr_b16 a[122:123], v6 offset:6656
    s_waitcnt lgkmcnt(10)
    v_mfma_f32_32x32x16_bf16 v[48:63], a[132:135], a[56:59], v[48:63]
    ds_read_b64_tr_b16 a[124:125], v7 offset:6144
    ds_read_b64_tr_b16 a[126:127], v7 offset:6656
    s_waitcnt vmcnt(20) lgkmcnt(10)
    v_mfma_f32_32x32x16_bf16 v[32:47], a[136:139], a[60:63], v[32:47]
    ds_read_b64_tr_b16 a[128:129], v6 offset:8192
    ds_read_b64_tr_b16 a[130:131], v6 offset:8704
    s_waitcnt lgkmcnt(10)
    v_mfma_f32_32x32x16_bf16 v[48:63], a[140:143], a[60:63], v[48:63]
    ds_read_b64_tr_b16 a[132:133], v7 offset:8192
    ds_read_b64_tr_b16 a[134:135], v7 offset:8704
    s_waitcnt vmcnt(19) lgkmcnt(10)
    v_mfma_f32_32x32x16_bf16 v[32:47], a[112:115], a[64:67], v[32:47]
    ds_read_b64_tr_b16 a[136:137], v6 offset:10240
    ds_read_b64_tr_b16 a[138:139], v6 offset:10752
    s_waitcnt lgkmcnt(10)
    v_mfma_f32_32x32x16_bf16 v[48:63], a[116:119], a[64:67], v[48:63]
    ds_read_b64_tr_b16 a[140:141], v7 offset:10240
    ds_read_b64_tr_b16 a[142:143], v7 offset:10752
    s_waitcnt vmcnt(18) lgkmcnt(10)
    v_mfma_f32_32x32x16_bf16 v[32:47], a[120:123], a[68:71], v[32:47]
    ds_read_b64_tr_b16 a[112:113], v6 offset:12288
    ds_read_b64_tr_b16 a[114:115], v6 offset:12800
    s_waitcnt lgkmcnt(10)
    v_mfma_f32_32x32x16_bf16 v[48:63], a[124:127], a[68:71], v[48:63]
    ds_read_b64_tr_b16 a[116:117], v7 offset:12288
    ds_read_b64_tr_b16 a[118:119], v7 offset:12800
    s_waitcnt vmcnt(17) lgkmcnt(10)
    v_mfma_f32_32x32x16_bf16 v[32:47], a[128:131], a[72:75], v[32:47]
    s_waitcnt vmcnt(0)
    ds_read_b128 a[176:179], v128
    ds_read_b128 a[180:183], v129
    ds_read_b128 a[184:187], v130
    ds_read_b128 a[188:191], v131
    ds_read_b128 a[192:195], v132
    ds_read_b128 a[196:199], v133
    ds_read_b128 a[200:203], v134
    ds_read_b128 a[204:207], v135
    ds_read_b64_tr_b16 a[120:121], v6 offset:14336
    ds_read_b64_tr_b16 a[122:123], v6 offset:14848
    s_waitcnt lgkmcnt(15)
    v_mfma_f32_32x32x16_bf16 v[48:63], a[132:135], a[72:75], v[48:63]
    ds_read_b64_tr_b16 a[124:125], v7 offset:14336
    ds_read_b64_tr_b16 a[126:127], v7 offset:14848
    v_mfma_f32_32x32x16_bf16 v[32:47], a[136:139], a[76:79], v[32:47]
    ds_read_b64_tr_b16 a[128:129], v6 offset:16384
    ds_read_b64_tr_b16 a[130:131], v6 offset:16896
    s_waitcnt lgkmcnt(15)
    v_mfma_f32_32x32x16_bf16 v[48:63], a[140:143], a[76:79], v[48:63]
    ds_read_b64_tr_b16 a[132:133], v7 offset:16384
    ds_read_b64_tr_b16 a[134:135], v7 offset:16896
    v_mfma_f32_32x32x16_bf16 v[32:47], a[112:115], a[80:83], v[32:47]
    ds_read_b64_tr_b16 a[136:137], v6 offset:18432
    ds_read_b64_tr_b16 a[138:139], v6 offset:18944
    s_waitcnt lgkmcnt(15)
    v_mfma_f32_32x32x16_bf16 v[48:63], a[116:119], a[80:83], v[48:63]
    ds_read_b64_tr_b16 a[140:141], v7 offset:18432
    ds_read_b64_tr_b16 a[142:143], v7 offset:18944
    s_waitcnt lgkmcnt(10)
    v_mfma_f32_32x32x16_bf16 v[32:47], a[120:123], a[84:87], v[32:47]
    ds_read_b64_tr_b16 a[112:113], v6 offset:20480
    ds_read_b64_tr_b16 a[114:115], v6 offset:20992
    s_waitcnt lgkmcnt(10)
    v_mfma_f32_32x32x16_bf16 v[48:63], a[124:127], a[84:87], v[48:63]
    ds_read_b64_tr_b16 a[116:117], v7 offset:20480
    ds_read_b64_tr_b16 a[118:119], v7 offset:20992
    s_add_u32 m0, s53, 81920
    s_add_u32 s33, s44, 1280
    buffer_load_dwordx4 v114, s[12:15], s33 offen offset:0 lds
    s_waitcnt lgkmcnt(10)
    v_mfma_f32_32x32x16_bf16 v[32:47], a[128:131], a[88:91], v[32:47]
    ds_read_b64_tr_b16 a[120:121], v6 offset:22528
    ds_read_b64_tr_b16 a[122:123], v6 offset:23040
    buffer_load_dwordx4 v115, s[12:15], s33 offen offset:1024 lds
    s_waitcnt lgkmcnt(10)
    v_mfma_f32_32x32x16_bf16 v[48:63], a[132:135], a[88:91], v[48:63]
    ds_read_b64_tr_b16 a[124:125], v7 offset:22528
    ds_read_b64_tr_b16 a[126:127], v7 offset:23040
    buffer_load_dwordx4 v116, s[12:15], s33 offen offset:2048 lds
    s_waitcnt lgkmcnt(10)
    v_mfma_f32_32x32x16_bf16 v[32:47], a[136:139], a[92:95], v[32:47]
    ds_read_b64_tr_b16 a[128:129], v6 offset:24576
    ds_read_b64_tr_b16 a[130:131], v6 offset:25088
    buffer_load_dwordx4 v117, s[12:15], s33 offen offset:3072 lds
    s_waitcnt lgkmcnt(10)
    v_mfma_f32_32x32x16_bf16 v[48:63], a[140:143], a[92:95], v[48:63]
    ds_read_b64_tr_b16 a[132:133], v7 offset:24576
    ds_read_b64_tr_b16 a[134:135], v7 offset:25088
    s_add_u32 m0, s53, 86016
    s_add_u32 s33, s44, 66816
    buffer_load_dwordx4 v114, s[12:15], s33 offen offset:0 lds
    s_waitcnt lgkmcnt(10)
    v_mfma_f32_32x32x16_bf16 v[32:47], a[112:115], a[96:99], v[32:47]
    ds_read_b64_tr_b16 a[136:137], v6 offset:26624
    ds_read_b64_tr_b16 a[138:139], v6 offset:27136
    buffer_load_dwordx4 v115, s[12:15], s33 offen offset:1024 lds
    s_waitcnt lgkmcnt(10)
    v_mfma_f32_32x32x16_bf16 v[48:63], a[116:119], a[96:99], v[48:63]
    ds_read_b64_tr_b16 a[140:141], v7 offset:26624
    ds_read_b64_tr_b16 a[142:143], v7 offset:27136
    buffer_load_dwordx4 v116, s[12:15], s33 offen offset:2048 lds
    s_waitcnt lgkmcnt(10)
    v_mfma_f32_32x32x16_bf16 v[32:47], a[120:123], a[100:103], v[32:47]
    ds_read_b64_tr_b16 a[112:113], v6 offset:32768
    ds_read_b64_tr_b16 a[114:115], v6 offset:33280
    buffer_load_dwordx4 v117, s[12:15], s33 offen offset:3072 lds
    s_waitcnt lgkmcnt(10)
    v_mfma_f32_32x32x16_bf16 v[48:63], a[124:127], a[100:103], v[48:63]
    ds_read_b64_tr_b16 a[116:117], v7 offset:32768
    ds_read_b64_tr_b16 a[118:119], v7 offset:33280
    s_waitcnt lgkmcnt(10)
    v_mfma_f32_32x32x16_bf16 v[32:47], a[128:131], a[104:107], v[32:47]
    ds_read_b64_tr_b16 a[120:121], v6 offset:34816
    ds_read_b64_tr_b16 a[122:123], v6 offset:35328
    s_waitcnt lgkmcnt(10)
    v_mfma_f32_32x32x16_bf16 v[48:63], a[132:135], a[104:107], v[48:63]
    ds_read_b64_tr_b16 a[124:125], v7 offset:34816
    ds_read_b64_tr_b16 a[126:127], v7 offset:35328
    s_waitcnt lgkmcnt(10)
    v_mfma_f32_32x32x16_bf16 v[32:47], a[136:139], a[108:111], v[32:47]
    ds_read_b64_tr_b16 a[128:129], v6 offset:36864
    ds_read_b64_tr_b16 a[130:131], v6 offset:37376
    s_waitcnt lgkmcnt(10)
    v_mfma_f32_32x32x16_bf16 v[48:63], a[140:143], a[108:111], v[48:63]
    ds_read_b64_tr_b16 a[132:133], v7 offset:36864
    ds_read_b64_tr_b16 a[134:135], v7 offset:37376
    s_waitcnt lgkmcnt(10)
    v_mfma_f32_32x32x16_bf16 v[64:79], a[112:115], a[0:3], 0
    ds_read_b64_tr_b16 a[136:137], v6 offset:38912
    ds_read_b64_tr_b16 a[138:139], v6 offset:39424
    s_waitcnt lgkmcnt(10)
    v_mfma_f32_32x32x16_bf16 v[80:95], a[116:119], a[0:3], 0
    ds_read_b64_tr_b16 a[140:141], v7 offset:38912
    ds_read_b64_tr_b16 a[142:143], v7 offset:39424
    s_waitcnt lgkmcnt(10)
    v_mfma_f32_32x32x16_bf16 v[64:79], a[120:123], a[4:7], v[64:79]
    ds_read_b64_tr_b16 a[112:113], v6 offset:40960
    ds_read_b64_tr_b16 a[114:115], v6 offset:41472
    v_cvt_pk_bf16_f32 v32, 0, v32
    v_cvt_pk_bf16_f32 v34, 0, v34
    v_cvt_pk_bf16_f32 v33, 0, v33
    v_cvt_pk_bf16_f32 v35, 0, v35
    v_pk_mul_f32 v[14:15], v[32:33], v[32:33]
    s_waitcnt lgkmcnt(10)
    v_mfma_f32_32x32x16_bf16 v[80:95], a[124:127], a[4:7], v[80:95]
    ds_read_b64_tr_b16 a[116:117], v7 offset:40960
    ds_read_b64_tr_b16 a[118:119], v7 offset:41472
    v_pk_mul_f32 v[20:21], v[34:35], v[34:35]
    v_pk_fma_f32 v[14:15], v[14:15], s[40:41], v[12:13]
    v_pk_fma_f32 v[20:21], v[20:21], s[40:41], v[12:13]
    v_pk_mul_f32 v[14:15], v[14:15], v[32:33]
    v_pk_mul_f32 v[20:21], v[20:21], v[34:35]
    s_waitcnt lgkmcnt(10)
    v_mfma_f32_32x32x16_bf16 v[64:79], a[128:131], a[8:11], v[64:79]
    ds_read_b64_tr_b16 a[120:121], v6 offset:43008
    ds_read_b64_tr_b16 a[122:123], v6 offset:43520
    v_exp_f32 v14, v14
    v_exp_f32 v20, v20
    v_exp_f32 v15, v15
    v_exp_f32 v21, v21
    v_pk_add_f32 v[14:15], v[14:15], s[42:43]
    s_waitcnt lgkmcnt(10)
    v_mfma_f32_32x32x16_bf16 v[80:95], a[132:135], a[8:11], v[80:95]
    ds_read_b64_tr_b16 a[124:125], v7 offset:43008
    ds_read_b64_tr_b16 a[126:127], v7 offset:43520
    v_pk_add_f32 v[20:21], v[20:21], s[42:43]
    v_rcp_f32 v14, v14
    v_rcp_f32 v20, v20
    v_rcp_f32 v15, v15
    v_rcp_f32 v21, v21
    s_waitcnt lgkmcnt(10)
    v_mfma_f32_32x32x16_bf16 v[64:79], a[136:139], a[12:15], v[64:79]
    ds_read_b64_tr_b16 a[128:129], v6 offset:45056
    ds_read_b64_tr_b16 a[130:131], v6 offset:45568
    v_pk_mul_f32 v[32:33], v[32:33], v[14:15]
    v_pk_mul_f32 v[34:35], v[34:35], v[20:21]
    v_cvt_pk_bf16_f32 v32, 0, v32
    v_cvt_pk_bf16_f32 v34, 0, v34
    v_cvt_pk_bf16_f32 v33, 0, v33
    s_waitcnt lgkmcnt(10)
    v_mfma_f32_32x32x16_bf16 v[80:95], a[140:143], a[12:15], v[80:95]
    ds_read_b64_tr_b16 a[132:133], v7 offset:45056
    ds_read_b64_tr_b16 a[134:135], v7 offset:45568
    v_cvt_pk_bf16_f32 v35, 0, v35
    v_cvt_pk_bf16_f32 v36, 0, v36
    v_cvt_pk_bf16_f32 v38, 0, v38
    v_cvt_pk_bf16_f32 v37, 0, v37
    v_cvt_pk_bf16_f32 v39, 0, v39
    s_waitcnt lgkmcnt(10)
    v_mfma_f32_32x32x16_bf16 v[64:79], a[112:115], a[16:19], v[64:79]
    ds_read_b64_tr_b16 a[136:137], v6 offset:47104
    ds_read_b64_tr_b16 a[138:139], v6 offset:47616
    v_pk_mul_f32 v[14:15], v[36:37], v[36:37]
    v_pk_mul_f32 v[20:21], v[38:39], v[38:39]
    v_pk_fma_f32 v[14:15], v[14:15], s[40:41], v[12:13]
    v_pk_fma_f32 v[20:21], v[20:21], s[40:41], v[12:13]
    v_pk_mul_f32 v[14:15], v[14:15], v[36:37]
    s_waitcnt lgkmcnt(10)
    v_mfma_f32_32x32x16_bf16 v[80:95], a[116:119], a[16:19], v[80:95]
    ds_read_b64_tr_b16 a[140:141], v7 offset:47104
    ds_read_b64_tr_b16 a[142:143], v7 offset:47616
    v_pk_mul_f32 v[20:21], v[20:21], v[38:39]
    v_exp_f32 v14, v14
    v_exp_f32 v20, v20
    v_exp_f32 v15, v15
    v_exp_f32 v21, v21
    s_waitcnt lgkmcnt(10)
    v_mfma_f32_32x32x16_bf16 v[64:79], a[120:123], a[20:23], v[64:79]
    ds_read_b64_tr_b16 a[112:113], v6 offset:49152
    ds_read_b64_tr_b16 a[114:115], v6 offset:49664
    v_pk_add_f32 v[14:15], v[14:15], s[42:43]
    v_pk_add_f32 v[20:21], v[20:21], s[42:43]
    v_rcp_f32 v14, v14
    v_rcp_f32 v20, v20
    v_rcp_f32 v15, v15
    s_waitcnt lgkmcnt(10)
    v_mfma_f32_32x32x16_bf16 v[80:95], a[124:127], a[20:23], v[80:95]
    s_waitcnt vmcnt(0)
    ds_read_b128 a[208:211], v128
    ds_read_b128 a[212:215], v129
    ds_read_b128 a[216:219], v130
    ds_read_b128 a[220:223], v131
    ds_read_b128 a[224:227], v132
    ds_read_b128 a[228:231], v133
    ds_read_b128 a[232:235], v134
    ds_read_b128 a[236:239], v135
    ds_read_b64_tr_b16 a[116:117], v7 offset:49152
    ds_read_b64_tr_b16 a[118:119], v7 offset:49664
    v_rcp_f32 v21, v21
    v_pk_mul_f32 v[36:37], v[36:37], v[14:15]
    v_pk_mul_f32 v[38:39], v[38:39], v[20:21]
    v_cvt_pk_bf16_f32 v36, 0, v36
    v_cvt_pk_bf16_f32 v38, 0, v38
    s_waitcnt lgkmcnt(15)
    v_mfma_f32_32x32x16_bf16 v[64:79], a[128:131], a[24:27], v[64:79]
    ds_read_b64_tr_b16 a[120:121], v6 offset:51200
    ds_read_b64_tr_b16 a[122:123], v6 offset:51712
    v_cvt_pk_bf16_f32 v37, 0, v37
    v_cvt_pk_bf16_f32 v39, 0, v39
    v_cvt_pk_bf16_f32 v40, 0, v40
    v_cvt_pk_bf16_f32 v42, 0, v42
    v_cvt_pk_bf16_f32 v41, 0, v41
    v_mfma_f32_32x32x16_bf16 v[80:95], a[132:135], a[24:27], v[80:95]
    ds_read_b64_tr_b16 a[124:125], v7 offset:51200
    ds_read_b64_tr_b16 a[126:127], v7 offset:51712
    v_cvt_pk_bf16_f32 v43, 0, v43
    v_pk_mul_f32 v[14:15], v[40:41], v[40:41]
    v_pk_mul_f32 v[20:21], v[42:43], v[42:43]
    v_pk_fma_f32 v[14:15], v[14:15], s[40:41], v[12:13]
    v_pk_fma_f32 v[20:21], v[20:21], s[40:41], v[12:13]
    s_waitcnt lgkmcnt(15)
    v_mfma_f32_32x32x16_bf16 v[64:79], a[136:139], a[28:31], v[64:79]
    ds_read_b64_tr_b16 a[128:129], v6 offset:53248
    ds_read_b64_tr_b16 a[130:131], v6 offset:53760
    v_pk_mul_f32 v[14:15], v[14:15], v[40:41]
    v_pk_mul_f32 v[20:21], v[20:21], v[42:43]
    v_exp_f32 v14, v14
    v_exp_f32 v20, v20
    v_exp_f32 v15, v15
    v_mfma_f32_32x32x16_bf16 v[80:95], a[140:143], a[28:31], v[80:95]
    ds_read_b64_tr_b16 a[132:133], v7 offset:53248
    ds_read_b64_tr_b16 a[134:135], v7 offset:53760
    v_exp_f32 v21, v21
    v_pk_add_f32 v[14:15], v[14:15], s[42:43]
    v_pk_add_f32 v[20:21], v[20:21], s[42:43]
    v_rcp_f32 v14, v14
    v_rcp_f32 v20, v20
    s_waitcnt lgkmcnt(15)
    v_mfma_f32_32x32x16_bf16 v[64:79], a[112:115], a[32:35], v[64:79]
    ds_read_b64_tr_b16 a[136:137], v6 offset:55296
    ds_read_b64_tr_b16 a[138:139], v6 offset:55808
    v_rcp_f32 v15, v15
    v_rcp_f32 v21, v21
    v_pk_mul_f32 v[40:41], v[40:41], v[14:15]
    v_pk_mul_f32 v[42:43], v[42:43], v[20:21]
    v_cvt_pk_bf16_f32 v40, 0, v40
    s_waitcnt lgkmcnt(10)
    v_mfma_f32_32x32x16_bf16 v[80:95], a[116:119], a[32:35], v[80:95]
    ds_read_b64_tr_b16 a[140:141], v7 offset:55296
    ds_read_b64_tr_b16 a[142:143], v7 offset:55808
    v_cvt_pk_bf16_f32 v42, 0, v42
    v_cvt_pk_bf16_f32 v41, 0, v41
    v_cvt_pk_bf16_f32 v43, 0, v43
    v_cvt_pk_bf16_f32 v44, 0, v44
    v_cvt_pk_bf16_f32 v46, 0, v46
    s_waitcnt lgkmcnt(10)
    v_mfma_f32_32x32x16_bf16 v[64:79], a[120:123], a[36:39], v[64:79]
    ds_read_b64_tr_b16 a[112:113], v6 offset:57344
    ds_read_b64_tr_b16 a[114:115], v6 offset:57856
    s_add_u32 m0, s53, 81920
    s_add_u32 s33, s44, 1536
    buffer_load_dwordx4 v114, s[12:15], s33 offen offset:0 lds
    v_cvt_pk_bf16_f32 v45, 0, v45
    v_cvt_pk_bf16_f32 v47, 0, v47
    v_pk_mul_f32 v[14:15], v[44:45], v[44:45]
    v_pk_mul_f32 v[20:21], v[46:47], v[46:47]
    v_pk_fma_f32 v[14:15], v[14:15], s[40:41], v[12:13]
    s_waitcnt lgkmcnt(10)
    v_mfma_f32_32x32x16_bf16 v[80:95], a[124:127], a[36:39], v[80:95]
    ds_read_b64_tr_b16 a[116:117], v7 offset:57344
    ds_read_b64_tr_b16 a[118:119], v7 offset:57856
    buffer_load_dwordx4 v115, s[12:15], s33 offen offset:1024 lds
    v_pk_fma_f32 v[20:21], v[20:21], s[40:41], v[12:13]
    v_pk_mul_f32 v[14:15], v[14:15], v[44:45]
    v_pk_mul_f32 v[20:21], v[20:21], v[46:47]
    v_exp_f32 v14, v14
    v_exp_f32 v20, v20
    s_waitcnt lgkmcnt(10)
    v_mfma_f32_32x32x16_bf16 v[64:79], a[128:131], a[40:43], v[64:79]
    ds_read_b64_tr_b16 a[120:121], v6 offset:59392
    ds_read_b64_tr_b16 a[122:123], v6 offset:59904
    buffer_load_dwordx4 v116, s[12:15], s33 offen offset:2048 lds
    v_exp_f32 v15, v15
    v_exp_f32 v21, v21
    v_pk_add_f32 v[14:15], v[14:15], s[42:43]
    v_pk_add_f32 v[20:21], v[20:21], s[42:43]
    v_rcp_f32 v14, v14
    s_waitcnt lgkmcnt(10)
    v_mfma_f32_32x32x16_bf16 v[80:95], a[132:135], a[40:43], v[80:95]
    ds_read_b64_tr_b16 a[124:125], v7 offset:59392
    ds_read_b64_tr_b16 a[126:127], v7 offset:59904
    buffer_load_dwordx4 v117, s[12:15], s33 offen offset:3072 lds
    v_rcp_f32 v20, v20
    v_rcp_f32 v15, v15
    v_rcp_f32 v21, v21
    v_pk_mul_f32 v[44:45], v[44:45], v[14:15]
    v_pk_mul_f32 v[46:47], v[46:47], v[20:21]
    s_waitcnt lgkmcnt(10)
    v_mfma_f32_32x32x16_bf16 v[64:79], a[136:139], a[44:47], v[64:79]
    ds_read_b64_tr_b16 a[128:129], v8 offset:0
    ds_read_b64_tr_b16 a[130:131], v8 offset:512
    s_add_u32 m0, s53, 86016
    s_add_u32 s33, s44, 67072
    buffer_load_dwordx4 v114, s[12:15], s33 offen offset:0 lds
    v_cvt_pk_bf16_f32 v44, 0, v44
    v_cvt_pk_bf16_f32 v46, 0, v46
    v_cvt_pk_bf16_f32 v45, 0, v45
    v_cvt_pk_bf16_f32 v47, 0, v47
    v_cvt_pk_bf16_f32 v48, 0, v48
    s_waitcnt lgkmcnt(10)
    v_mfma_f32_32x32x16_bf16 v[80:95], a[140:143], a[44:47], v[80:95]
    ds_read_b64_tr_b16 a[132:133], v9 offset:0
    ds_read_b64_tr_b16 a[134:135], v9 offset:512
    buffer_load_dwordx4 v115, s[12:15], s33 offen offset:1024 lds
    v_cvt_pk_bf16_f32 v50, 0, v50
    v_cvt_pk_bf16_f32 v49, 0, v49
    v_cvt_pk_bf16_f32 v51, 0, v51
    v_pk_mul_f32 v[14:15], v[48:49], v[48:49]
    v_pk_mul_f32 v[20:21], v[50:51], v[50:51]
    s_waitcnt lgkmcnt(10)
    v_mfma_f32_32x32x16_bf16 v[64:79], a[112:115], a[48:51], v[64:79]
    ds_read_b64_tr_b16 a[136:137], v8 offset:2048
    ds_read_b64_tr_b16 a[138:139], v8 offset:2560
    buffer_load_dwordx4 v116, s[12:15], s33 offen offset:2048 lds
    v_pk_fma_f32 v[14:15], v[14:15], s[40:41], v[12:13]
    v_pk_fma_f32 v[20:21], v[20:21], s[40:41], v[12:13]
    v_pk_mul_f32 v[14:15], v[14:15], v[48:49]
    v_pk_mul_f32 v[20:21], v[20:21], v[50:51]
    v_exp_f32 v14, v14
    s_waitcnt lgkmcnt(10)
    v_mfma_f32_32x32x16_bf16 v[80:95], a[116:119], a[48:51], v[80:95]
    ds_read_b64_tr_b16 a[140:141], v9 offset:2048
    ds_read_b64_tr_b16 a[142:143], v9 offset:2560
    buffer_load_dwordx4 v117, s[12:15], s33 offen offset:3072 lds
    v_exp_f32 v20, v20
    v_exp_f32 v15, v15
    v_exp_f32 v21, v21
    v_pk_add_f32 v[14:15], v[14:15], s[42:43]
    v_pk_add_f32 v[20:21], v[20:21], s[42:43]
    s_waitcnt lgkmcnt(10)
    v_mfma_f32_32x32x16_bf16 v[64:79], a[120:123], a[52:55], v[64:79]
    ds_read_b64_tr_b16 a[112:113], v8 offset:4096
    ds_read_b64_tr_b16 a[114:115], v8 offset:4608
    v_rcp_f32 v14, v14
    v_rcp_f32 v20, v20
    v_rcp_f32 v15, v15
    v_rcp_f32 v21, v21
    v_pk_mul_f32 v[48:49], v[48:49], v[14:15]
    s_waitcnt lgkmcnt(10)
    v_mfma_f32_32x32x16_bf16 v[80:95], a[124:127], a[52:55], v[80:95]
    ds_read_b64_tr_b16 a[116:117], v9 offset:4096
    ds_read_b64_tr_b16 a[118:119], v9 offset:4608
    v_pk_mul_f32 v[50:51], v[50:51], v[20:21]
    v_cvt_pk_bf16_f32 v48, 0, v48
    v_cvt_pk_bf16_f32 v50, 0, v50
    v_cvt_pk_bf16_f32 v49, 0, v49
    v_cvt_pk_bf16_f32 v51, 0, v51
    s_waitcnt lgkmcnt(10)
    v_mfma_f32_32x32x16_bf16 v[64:79], a[128:131], a[56:59], v[64:79]
    ds_read_b64_tr_b16 a[120:121], v8 offset:6144
    ds_read_b64_tr_b16 a[122:123], v8 offset:6656
    v_cvt_pk_bf16_f32 v52, 0, v52
    v_cvt_pk_bf16_f32 v54, 0, v54
    v_cvt_pk_bf16_f32 v53, 0, v53
    v_cvt_pk_bf16_f32 v55, 0, v55
    v_pk_mul_f32 v[14:15], v[52:53], v[52:53]
    s_waitcnt lgkmcnt(10)
    v_mfma_f32_32x32x16_bf16 v[80:95], a[132:135], a[56:59], v[80:95]
    ds_read_b64_tr_b16 a[124:125], v9 offset:6144
    ds_read_b64_tr_b16 a[126:127], v9 offset:6656
    v_pk_mul_f32 v[20:21], v[54:55], v[54:55]
    v_pk_fma_f32 v[14:15], v[14:15], s[40:41], v[12:13]
    v_pk_fma_f32 v[20:21], v[20:21], s[40:41], v[12:13]
    v_pk_mul_f32 v[14:15], v[14:15], v[52:53]
    v_pk_mul_f32 v[20:21], v[20:21], v[54:55]
    s_waitcnt lgkmcnt(10)
    v_mfma_f32_32x32x16_bf16 v[64:79], a[136:139], a[60:63], v[64:79]
    ds_read_b64_tr_b16 a[128:129], v8 offset:8192
    ds_read_b64_tr_b16 a[130:131], v8 offset:8704
    v_exp_f32 v14, v14
    v_exp_f32 v20, v20
    v_exp_f32 v15, v15
    v_exp_f32 v21, v21
    v_pk_add_f32 v[14:15], v[14:15], s[42:43]
    s_waitcnt lgkmcnt(10)
    v_mfma_f32_32x32x16_bf16 v[80:95], a[140:143], a[60:63], v[80:95]
    ds_read_b64_tr_b16 a[132:133], v9 offset:8192
    ds_read_b64_tr_b16 a[134:135], v9 offset:8704
    v_pk_add_f32 v[20:21], v[20:21], s[42:43]
    v_rcp_f32 v14, v14
    v_rcp_f32 v20, v20
    v_rcp_f32 v15, v15
    v_rcp_f32 v21, v21
    s_waitcnt lgkmcnt(10)
    v_mfma_f32_32x32x16_bf16 v[64:79], a[112:115], a[64:67], v[64:79]
    ds_read_b64_tr_b16 a[136:137], v8 offset:10240
    ds_read_b64_tr_b16 a[138:139], v8 offset:10752
    v_pk_mul_f32 v[52:53], v[52:53], v[14:15]
    v_pk_mul_f32 v[54:55], v[54:55], v[20:21]
    v_cvt_pk_bf16_f32 v52, 0, v52
    v_cvt_pk_bf16_f32 v54, 0, v54
    v_cvt_pk_bf16_f32 v53, 0, v53
    s_waitcnt lgkmcnt(10)
    v_mfma_f32_32x32x16_bf16 v[80:95], a[116:119], a[64:67], v[80:95]
    ds_read_b64_tr_b16 a[140:141], v9 offset:10240
    ds_read_b64_tr_b16 a[142:143], v9 offset:10752
    v_cvt_pk_bf16_f32 v55, 0, v55
    v_cvt_pk_bf16_f32 v56, 0, v56
    v_cvt_pk_bf16_f32 v58, 0, v58
    v_cvt_pk_bf16_f32 v57, 0, v57
    v_cvt_pk_bf16_f32 v59, 0, v59
    s_waitcnt lgkmcnt(10)
    v_mfma_f32_32x32x16_bf16 v[64:79], a[120:123], a[68:71], v[64:79]
    ds_read_b64_tr_b16 a[112:113], v8 offset:12288
    ds_read_b64_tr_b16 a[114:115], v8 offset:12800
    v_pk_mul_f32 v[14:15], v[56:57], v[56:57]
    v_pk_mul_f32 v[20:21], v[58:59], v[58:59]
    v_pk_fma_f32 v[14:15], v[14:15], s[40:41], v[12:13]
    v_pk_fma_f32 v[20:21], v[20:21], s[40:41], v[12:13]
    v_pk_mul_f32 v[14:15], v[14:15], v[56:57]
    s_waitcnt lgkmcnt(10)
    v_mfma_f32_32x32x16_bf16 v[80:95], a[124:127], a[68:71], v[80:95]
    ds_read_b64_tr_b16 a[116:117], v9 offset:12288
    ds_read_b64_tr_b16 a[118:119], v9 offset:12800
    v_pk_mul_f32 v[20:21], v[20:21], v[58:59]
    v_exp_f32 v14, v14
    v_exp_f32 v20, v20
    v_exp_f32 v15, v15
    v_exp_f32 v21, v21
    s_waitcnt lgkmcnt(10)
    v_mfma_f32_32x32x16_bf16 v[64:79], a[128:131], a[72:75], v[64:79]
    ds_read_b64_tr_b16 a[120:121], v8 offset:14336
    ds_read_b64_tr_b16 a[122:123], v8 offset:14848
    v_pk_add_f32 v[14:15], v[14:15], s[42:43]
    v_pk_add_f32 v[20:21], v[20:21], s[42:43]
    v_rcp_f32 v14, v14
    v_rcp_f32 v20, v20
    v_rcp_f32 v15, v15
    s_waitcnt lgkmcnt(10)
    v_mfma_f32_32x32x16_bf16 v[80:95], a[132:135], a[72:75], v[80:95]
    ds_read_b64_tr_b16 a[124:125], v9 offset:14336
    ds_read_b64_tr_b16 a[126:127], v9 offset:14848
    v_rcp_f32 v21, v21
    v_pk_mul_f32 v[56:57], v[56:57], v[14:15]
    v_pk_mul_f32 v[58:59], v[58:59], v[20:21]
    v_cvt_pk_bf16_f32 v56, 0, v56
    v_cvt_pk_bf16_f32 v58, 0, v58
    s_waitcnt lgkmcnt(10)
    v_mfma_f32_32x32x16_bf16 v[64:79], a[136:139], a[76:79], v[64:79]
    ds_read_b64_tr_b16 a[128:129], v8 offset:16384
    ds_read_b64_tr_b16 a[130:131], v8 offset:16896
    v_cvt_pk_bf16_f32 v57, 0, v57
    v_cvt_pk_bf16_f32 v59, 0, v59
    v_cvt_pk_bf16_f32 v60, 0, v60
    v_cvt_pk_bf16_f32 v62, 0, v62
    v_cvt_pk_bf16_f32 v61, 0, v61
    s_waitcnt lgkmcnt(10)
    v_mfma_f32_32x32x16_bf16 v[80:95], a[140:143], a[76:79], v[80:95]
    ds_read_b64_tr_b16 a[132:133], v9 offset:16384
    ds_read_b64_tr_b16 a[134:135], v9 offset:16896
    v_cvt_pk_bf16_f32 v63, 0, v63
    v_pk_mul_f32 v[14:15], v[60:61], v[60:61]
    v_pk_mul_f32 v[20:21], v[62:63], v[62:63]
    v_pk_fma_f32 v[14:15], v[14:15], s[40:41], v[12:13]
    v_pk_fma_f32 v[20:21], v[20:21], s[40:41], v[12:13]
    s_waitcnt lgkmcnt(10)
    v_mfma_f32_32x32x16_bf16 v[64:79], a[112:115], a[80:83], v[64:79]
    ds_read_b64_tr_b16 a[136:137], v8 offset:18432
    ds_read_b64_tr_b16 a[138:139], v8 offset:18944
    v_pk_mul_f32 v[14:15], v[14:15], v[60:61]
    v_pk_mul_f32 v[20:21], v[20:21], v[62:63]
    v_exp_f32 v14, v14
    v_exp_f32 v20, v20
    v_exp_f32 v15, v15
    s_waitcnt lgkmcnt(10)
    v_mfma_f32_32x32x16_bf16 v[80:95], a[116:119], a[80:83], v[80:95]
    ds_read_b64_tr_b16 a[140:141], v9 offset:18432
    ds_read_b64_tr_b16 a[142:143], v9 offset:18944
    v_exp_f32 v21, v21
    v_pk_add_f32 v[14:15], v[14:15], s[42:43]
    v_pk_add_f32 v[20:21], v[20:21], s[42:43]
    v_rcp_f32 v14, v14
    v_rcp_f32 v20, v20
    s_waitcnt lgkmcnt(10)
    v_mfma_f32_32x32x16_bf16 v[64:79], a[120:123], a[84:87], v[64:79]
    s_waitcnt vmcnt(0)
    ds_read_b128 a[240:243], v128
    ds_read_b128 a[244:247], v129
    ds_read_b128 a[248:251], v130
    ds_read_b128 a[252:255], v131
    ds_read_b128 v[144:147], v132
    ds_read_b128 v[148:151], v133
    ds_read_b128 v[152:155], v134
    ds_read_b128 v[156:159], v135
    ds_read_b64_tr_b16 a[112:113], v8 offset:20480
    ds_read_b64_tr_b16 a[114:115], v8 offset:20992
    v_rcp_f32 v15, v15
    v_rcp_f32 v21, v21
    v_pk_mul_f32 v[60:61], v[60:61], v[14:15]
    v_pk_mul_f32 v[62:63], v[62:63], v[20:21]
    v_cvt_pk_bf16_f32 v60, 0, v60
    s_waitcnt lgkmcnt(15)
    v_mfma_f32_32x32x16_bf16 v[80:95], a[124:127], a[84:87], v[80:95]
    ds_read_b64_tr_b16 a[116:117], v9 offset:20480
    ds_read_b64_tr_b16 a[118:119], v9 offset:20992
    v_cvt_pk_bf16_f32 v62, 0, v62
    v_cvt_pk_bf16_f32 v61, 0, v61
    v_cvt_pk_bf16_f32 v63, 0, v63
    v_pk_add_f32 v[16:17], v[32:33], v[34:35]
    v_pk_add_f32 v[16:17], v[16:17], v[36:37]
    v_mfma_f32_32x32x16_bf16 v[64:79], a[128:131], a[88:91], v[64:79]
    ds_read_b64_tr_b16 a[120:121], v8 offset:22528
    ds_read_b64_tr_b16 a[122:123], v8 offset:23040
    v_pk_add_f32 v[16:17], v[16:17], v[38:39]
    v_pk_add_f32 v[16:17], v[16:17], v[40:41]
    v_pk_add_f32 v[16:17], v[16:17], v[42:43]
    v_pk_add_f32 v[16:17], v[16:17], v[44:45]
    v_pk_add_f32 v[16:17], v[16:17], v[46:47]
    s_waitcnt lgkmcnt(15)
    v_mfma_f32_32x32x16_bf16 v[80:95], a[132:135], a[88:91], v[80:95]
    ds_read_b64_tr_b16 a[124:125], v9 offset:22528
    ds_read_b64_tr_b16 a[126:127], v9 offset:23040
    v_pk_add_f32 v[16:17], v[16:17], v[48:49]
    v_pk_add_f32 v[16:17], v[16:17], v[50:51]
    v_pk_add_f32 v[16:17], v[16:17], v[52:53]
    v_pk_add_f32 v[16:17], v[16:17], v[54:55]
    v_pk_add_f32 v[16:17], v[16:17], v[56:57]
    v_mfma_f32_32x32x16_bf16 v[64:79], a[136:139], a[92:95], v[64:79]
    ds_read_b64_tr_b16 a[128:129], v8 offset:24576
    ds_read_b64_tr_b16 a[130:131], v8 offset:25088
    v_pk_add_f32 v[16:17], v[16:17], v[58:59]
    v_pk_add_f32 v[16:17], v[16:17], v[60:61]
    v_pk_add_f32 v[16:17], v[16:17], v[62:63]
    v_add_f32 v16, v16, v17
    v_mov_b32 v14, v16
    s_waitcnt lgkmcnt(15)
    v_mfma_f32_32x32x16_bf16 v[80:95], a[140:143], a[92:95], v[80:95]
    ds_read_b64_tr_b16 a[132:133], v9 offset:24576
    ds_read_b64_tr_b16 a[134:135], v9 offset:25088
    s_nop 1
    v_permlane32_swap_b32 v16, v14
    v_add_f32 v16, v16, v14
    v_mul_f32 v16, 0x3c800000, v16
    v_pk_add_f32 v[14:15], v[32:33], v[16:17] op_sel_hi:[1,0] neg_lo:[0,1] neg_hi:[0,1]
    s_waitcnt lgkmcnt(10)
    v_mfma_f32_32x32x16_bf16 v[64:79], a[112:115], a[96:99], v[64:79]
    ds_read_b64_tr_b16 a[136:137], v8 offset:26624
    ds_read_b64_tr_b16 a[138:139], v8 offset:27136
    v_pk_mul_f32 v[20:21], v[14:15], v[14:15]
    v_pk_add_f32 v[14:15], v[34:35], v[16:17] op_sel_hi:[1,0] neg_lo:[0,1] neg_hi:[0,1]
    v_pk_fma_f32 v[20:21], v[14:15], v[14:15], v[20:21]
    v_pk_add_f32 v[14:15], v[36:37], v[16:17] op_sel_hi:[1,0] neg_lo:[0,1] neg_hi:[0,1]
    v_pk_fma_f32 v[20:21], v[14:15], v[14:15], v[20:21]
    s_waitcnt lgkmcnt(10)
    v_mfma_f32_32x32x16_bf16 v[80:95], a[116:119], a[96:99], v[80:95]
    ds_read_b64_tr_b16 a[140:141], v9 offset:26624
    ds_read_b64_tr_b16 a[142:143], v9 offset:27136
    v_pk_add_f32 v[14:15], v[38:39], v[16:17] op_sel_hi:[1,0] neg_lo:[0,1] neg_hi:[0,1]
    v_pk_fma_f32 v[20:21], v[14:15], v[14:15], v[20:21]
    v_pk_add_f32 v[14:15], v[40:41], v[16:17] op_sel_hi:[1,0] neg_lo:[0,1] neg_hi:[0,1]
    v_pk_fma_f32 v[20:21], v[14:15], v[14:15], v[20:21]
    v_pk_add_f32 v[14:15], v[42:43], v[16:17] op_sel_hi:[1,0] neg_lo:[0,1] neg_hi:[0,1]
    s_waitcnt lgkmcnt(10)
    v_mfma_f32_32x32x16_bf16 v[64:79], a[120:123], a[100:103], v[64:79]
    v_pk_fma_f32 v[20:21], v[14:15], v[14:15], v[20:21]
    v_pk_add_f32 v[14:15], v[44:45], v[16:17] op_sel_hi:[1,0] neg_lo:[0,1] neg_hi:[0,1]
    v_pk_fma_f32 v[20:21], v[14:15], v[14:15], v[20:21]
    v_pk_add_f32 v[14:15], v[46:47], v[16:17] op_sel_hi:[1,0] neg_lo:[0,1] neg_hi:[0,1]
    v_pk_fma_f32 v[20:21], v[14:15], v[14:15], v[20:21]
    s_waitcnt lgkmcnt(0)
    s_barrier
    v_mfma_f32_32x32x16_bf16 v[80:95], a[124:127], a[100:103], v[80:95]
    v_pk_add_f32 v[14:15], v[48:49], v[16:17] op_sel_hi:[1,0] neg_lo:[0,1] neg_hi:[0,1]
    v_pk_fma_f32 v[20:21], v[14:15], v[14:15], v[20:21]
    v_pk_add_f32 v[14:15], v[50:51], v[16:17] op_sel_hi:[1,0] neg_lo:[0,1] neg_hi:[0,1]
    v_pk_fma_f32 v[20:21], v[14:15], v[14:15], v[20:21]
    v_pk_add_f32 v[14:15], v[52:53], v[16:17] op_sel_hi:[1,0] neg_lo:[0,1] neg_hi:[0,1]
    s_add_u32 m0, s53, 98304
    s_add_u32 s33, s44, 1792
    buffer_load_dwordx4 v114, s[12:15], s33 offen offset:0 lds
    buffer_load_dwordx4 v115, s[12:15], s33 offen offset:1024 lds
    v_mfma_f32_32x32x16_bf16 v[64:79], a[128:131], a[104:107], v[64:79]
    v_pk_fma_f32 v[20:21], v[14:15], v[14:15], v[20:21]
    v_pk_add_f32 v[14:15], v[54:55], v[16:17] op_sel_hi:[1,0] neg_lo:[0,1] neg_hi:[0,1]
    v_pk_fma_f32 v[20:21], v[14:15], v[14:15], v[20:21]
    v_pk_add_f32 v[14:15], v[56:57], v[16:17] op_sel_hi:[1,0] neg_lo:[0,1] neg_hi:[0,1]
    v_pk_fma_f32 v[20:21], v[14:15], v[14:15], v[20:21]
    buffer_load_dwordx4 v116, s[12:15], s33 offen offset:2048 lds
    buffer_load_dwordx4 v117, s[12:15], s33 offen offset:3072 lds
    v_mfma_f32_32x32x16_bf16 v[80:95], a[132:135], a[104:107], v[80:95]
    v_pk_add_f32 v[14:15], v[58:59], v[16:17] op_sel_hi:[1,0] neg_lo:[0,1] neg_hi:[0,1]
    v_pk_fma_f32 v[20:21], v[14:15], v[14:15], v[20:21]
    v_pk_add_f32 v[14:15], v[60:61], v[16:17] op_sel_hi:[1,0] neg_lo:[0,1] neg_hi:[0,1]
    v_pk_fma_f32 v[20:21], v[14:15], v[14:15], v[20:21]
    v_pk_add_f32 v[14:15], v[62:63], v[16:17] op_sel_hi:[1,0] neg_lo:[0,1] neg_hi:[0,1]
    s_add_u32 m0, s53, 102400
    s_add_u32 s33, s44, 67328
    buffer_load_dwordx4 v114, s[12:15], s33 offen offset:0 lds
    buffer_load_dwordx4 v115, s[12:15], s33 offen offset:1024 lds
    v_mfma_f32_32x32x16_bf16 v[64:79], a[136:139], a[108:111], v[64:79]
    v_pk_fma_f32 v[20:21], v[14:15], v[14:15], v[20:21]
    v_add_f32 v17, v20, v21
    v_mov_b32 v14, v17
    s_nop 1
    v_permlane32_swap_b32 v17, v14
    buffer_load_dwordx4 v116, s[12:15], s33 offen offset:2048 lds
    buffer_load_dwordx4 v117, s[12:15], s33 offen offset:3072 lds
    v_mfma_f32_32x32x16_bf16 v[80:95], a[140:143], a[108:111], v[80:95]
    v_add_f32 v17, v17, v14
    buffer_store_dwordx2 v[16:17], v18, s[24:27], s51 offen sc1
    s_add_u32 m0, s53, 0
    s_add_u32 s33, s44, 2048
    buffer_load_dwordx4 v114, s[12:15], s33 offen offset:0 lds
    buffer_load_dwordx4 v115, s[12:15], s33 offen offset:1024 lds
    v_cvt_pk_bf16_f32 v64, 0, v64
    v_cvt_pk_bf16_f32 v66, 0, v66
    v_cvt_pk_bf16_f32 v65, 0, v65
    v_cvt_pk_bf16_f32 v67, 0, v67
    v_pk_mul_f32 v[14:15], v[64:65], v[64:65]
    v_pk_mul_f32 v[20:21], v[66:67], v[66:67]
    v_pk_fma_f32 v[14:15], v[14:15], s[40:41], v[12:13]
    v_pk_fma_f32 v[20:21], v[20:21], s[40:41], v[12:13]
    v_pk_mul_f32 v[14:15], v[14:15], v[64:65]
    v_pk_mul_f32 v[20:21], v[20:21], v[66:67]
    v_exp_f32 v14, v14
    v_exp_f32 v20, v20
    buffer_load_dwordx4 v116, s[12:15], s33 offen offset:2048 lds
    v_exp_f32 v15, v15
    v_exp_f32 v21, v21
    v_pk_add_f32 v[14:15], v[14:15], s[42:43]
    v_pk_add_f32 v[20:21], v[20:21], s[42:43]
    v_rcp_f32 v14, v14
    v_rcp_f32 v20, v20
    v_rcp_f32 v15, v15
    v_rcp_f32 v21, v21
    v_pk_mul_f32 v[64:65], v[64:65], v[14:15]
    v_pk_mul_f32 v[66:67], v[66:67], v[20:21]
    v_cvt_pk_bf16_f32 v96, v64, v65
    v_cvt_pk_bf16_f32 v97, v66, v67
    buffer_load_dwordx4 v117, s[12:15], s33 offen offset:3072 lds
    v_cvt_pk_bf16_f32 v68, 0, v68
    v_cvt_pk_bf16_f32 v70, 0, v70
    v_cvt_pk_bf16_f32 v69, 0, v69
    v_cvt_pk_bf16_f32 v71, 0, v71
    v_pk_mul_f32 v[14:15], v[68:69], v[68:69]
    v_pk_mul_f32 v[20:21], v[70:71], v[70:71]
    v_pk_fma_f32 v[14:15], v[14:15], s[40:41], v[12:13]
    v_pk_fma_f32 v[20:21], v[20:21], s[40:41], v[12:13]
    v_pk_mul_f32 v[14:15], v[14:15], v[68:69]
    v_pk_mul_f32 v[20:21], v[20:21], v[70:71]
    v_exp_f32 v14, v14
    v_exp_f32 v20, v20
    s_add_u32 m0, s53, 4096
    s_add_u32 s33, s44, 67584
    buffer_load_dwordx4 v114, s[12:15], s33 offen offset:0 lds
    v_exp_f32 v15, v15
    v_exp_f32 v21, v21
    v_pk_add_f32 v[14:15], v[14:15], s[42:43]
    v_pk_add_f32 v[20:21], v[20:21], s[42:43]
    v_rcp_f32 v14, v14
    v_rcp_f32 v20, v20
    v_rcp_f32 v15, v15
    v_rcp_f32 v21, v21
    v_pk_mul_f32 v[68:69], v[68:69], v[14:15]
    v_pk_mul_f32 v[70:71], v[70:71], v[20:21]
    v_cvt_pk_bf16_f32 v98, v68, v69
    v_cvt_pk_bf16_f32 v99, v70, v71
    buffer_load_dwordx4 v115, s[12:15], s33 offen offset:1024 lds
    v_cvt_pk_bf16_f32 v72, 0, v72
    v_cvt_pk_bf16_f32 v74, 0, v74
    v_cvt_pk_bf16_f32 v73, 0, v73
    v_cvt_pk_bf16_f32 v75, 0, v75
    v_pk_mul_f32 v[14:15], v[72:73], v[72:73]
    v_pk_mul_f32 v[20:21], v[74:75], v[74:75]
    v_pk_fma_f32 v[14:15], v[14:15], s[40:41], v[12:13]
    v_pk_fma_f32 v[20:21], v[20:21], s[40:41], v[12:13]
    v_pk_mul_f32 v[14:15], v[14:15], v[72:73]
    v_pk_mul_f32 v[20:21], v[20:21], v[74:75]
    v_exp_f32 v14, v14
    v_exp_f32 v20, v20
    buffer_load_dwordx4 v116, s[12:15], s33 offen offset:2048 lds
    v_exp_f32 v15, v15
    v_exp_f32 v21, v21
    v_pk_add_f32 v[14:15], v[14:15], s[42:43]
    v_pk_add_f32 v[20:21], v[20:21], s[42:43]
    v_rcp_f32 v14, v14
    v_rcp_f32 v20, v20
    v_rcp_f32 v15, v15
    v_rcp_f32 v21, v21
    v_pk_mul_f32 v[72:73], v[72:73], v[14:15]
    v_pk_mul_f32 v[74:75], v[74:75], v[20:21]
    v_cvt_pk_bf16_f32 v100, v72, v73
    v_cvt_pk_bf16_f32 v101, v74, v75
    buffer_load_dwordx4 v117, s[12:15], s33 offen offset:3072 lds
    v_cvt_pk_bf16_f32 v76, 0, v76
    v_cvt_pk_bf16_f32 v78, 0, v78
    v_cvt_pk_bf16_f32 v77, 0, v77
    v_cvt_pk_bf16_f32 v79, 0, v79
    v_pk_mul_f32 v[14:15], v[76:77], v[76:77]
    v_pk_mul_f32 v[20:21], v[78:79], v[78:79]
    v_pk_fma_f32 v[14:15], v[14:15], s[40:41], v[12:13]
    v_pk_fma_f32 v[20:21], v[20:21], s[40:41], v[12:13]
    v_pk_mul_f32 v[14:15], v[14:15], v[76:77]
    v_pk_mul_f32 v[20:21], v[20:21], v[78:79]
    v_exp_f32 v14, v14
    v_exp_f32 v20, v20
    s_add_u32 m0, s53, 49152
    s_add_u32 s33, s44, 2304
    buffer_load_dwordx4 v114, s[12:15], s33 offen offset:0 lds
    v_exp_f32 v15, v15
    v_exp_f32 v21, v21
    v_pk_add_f32 v[14:15], v[14:15], s[42:43]
    v_pk_add_f32 v[20:21], v[20:21], s[42:43]
    v_rcp_f32 v14, v14
    v_rcp_f32 v20, v20
    v_rcp_f32 v15, v15
    v_rcp_f32 v21, v21
    v_pk_mul_f32 v[76:77], v[76:77], v[14:15]
    v_pk_mul_f32 v[78:79], v[78:79], v[20:21]
    v_cvt_pk_bf16_f32 v102, v76, v77
    v_cvt_pk_bf16_f32 v103, v78, v79
    buffer_load_dwordx4 v115, s[12:15], s33 offen offset:1024 lds
    v_cvt_pk_bf16_f32 v80, 0, v80
    v_cvt_pk_bf16_f32 v82, 0, v82
    v_cvt_pk_bf16_f32 v81, 0, v81
    v_cvt_pk_bf16_f32 v83, 0, v83
    v_pk_mul_f32 v[14:15], v[80:81], v[80:81]
    v_pk_mul_f32 v[20:21], v[82:83], v[82:83]
    v_pk_fma_f32 v[14:15], v[14:15], s[40:41], v[12:13]
    v_pk_fma_f32 v[20:21], v[20:21], s[40:41], v[12:13]
    v_pk_mul_f32 v[14:15], v[14:15], v[80:81]
    v_pk_mul_f32 v[20:21], v[20:21], v[82:83]
    v_exp_f32 v14, v14
    v_exp_f32 v20, v20
    buffer_load_dwordx4 v116, s[12:15], s33 offen offset:2048 lds
    v_exp_f32 v15, v15
    v_exp_f32 v21, v21
    v_pk_add_f32 v[14:15], v[14:15], s[42:43]
    v_pk_add_f32 v[20:21], v[20:21], s[42:43]
    v_rcp_f32 v14, v14
    v_rcp_f32 v20, v20
    v_rcp_f32 v15, v15
    v_rcp_f32 v21, v21
    v_pk_mul_f32 v[80:81], v[80:81], v[14:15]
    v_pk_mul_f32 v[82:83], v[82:83], v[20:21]
    v_cvt_pk_bf16_f32 v104, v80, v81
    v_cvt_pk_bf16_f32 v105, v82, v83
    buffer_load_dwordx4 v117, s[12:15], s33 offen offset:3072 lds
    v_cvt_pk_bf16_f32 v84, 0, v84
    v_cvt_pk_bf16_f32 v86, 0, v86
    v_cvt_pk_bf16_f32 v85, 0, v85
    v_cvt_pk_bf16_f32 v87, 0, v87
    v_pk_mul_f32 v[14:15], v[84:85], v[84:85]
    v_pk_mul_f32 v[20:21], v[86:87], v[86:87]
    v_pk_fma_f32 v[14:15], v[14:15], s[40:41], v[12:13]
    v_pk_fma_f32 v[20:21], v[20:21], s[40:41], v[12:13]
    v_pk_mul_f32 v[14:15], v[14:15], v[84:85]
    v_pk_mul_f32 v[20:21], v[20:21], v[86:87]
    v_exp_f32 v14, v14
    v_exp_f32 v20, v20
    s_add_u32 m0, s53, 53248
    s_add_u32 s33, s44, 67840
    buffer_load_dwordx4 v114, s[12:15], s33 offen offset:0 lds
    v_exp_f32 v15, v15
    v_exp_f32 v21, v21
    v_pk_add_f32 v[14:15], v[14:15], s[42:43]
    v_pk_add_f32 v[20:21], v[20:21], s[42:43]
    v_rcp_f32 v14, v14
    v_rcp_f32 v20, v20
    v_rcp_f32 v15, v15
    v_rcp_f32 v21, v21
    v_pk_mul_f32 v[84:85], v[84:85], v[14:15]
    v_pk_mul_f32 v[86:87], v[86:87], v[20:21]
    v_cvt_pk_bf16_f32 v106, v84, v85
    v_cvt_pk_bf16_f32 v107, v86, v87
    buffer_load_dwordx4 v115, s[12:15], s33 offen offset:1024 lds
    v_cvt_pk_bf16_f32 v88, 0, v88
    v_cvt_pk_bf16_f32 v90, 0, v90
    v_cvt_pk_bf16_f32 v89, 0, v89
    v_cvt_pk_bf16_f32 v91, 0, v91
    v_pk_mul_f32 v[14:15], v[88:89], v[88:89]
    v_pk_mul_f32 v[20:21], v[90:91], v[90:91]
    v_pk_fma_f32 v[14:15], v[14:15], s[40:41], v[12:13]
    v_pk_fma_f32 v[20:21], v[20:21], s[40:41], v[12:13]
    v_pk_mul_f32 v[14:15], v[14:15], v[88:89]
    v_pk_mul_f32 v[20:21], v[20:21], v[90:91]
    v_exp_f32 v14, v14
    v_exp_f32 v20, v20
    buffer_load_dwordx4 v116, s[12:15], s33 offen offset:2048 lds
    v_exp_f32 v15, v15
    v_exp_f32 v21, v21
    v_pk_add_f32 v[14:15], v[14:15], s[42:43]
    v_pk_add_f32 v[20:21], v[20:21], s[42:43]
    v_rcp_f32 v14, v14
    v_rcp_f32 v20, v20
    v_rcp_f32 v15, v15
    v_rcp_f32 v21, v21
    v_pk_mul_f32 v[88:89], v[88:89], v[14:15]
    v_pk_mul_f32 v[90:91], v[90:91], v[20:21]
    v_cvt_pk_bf16_f32 v108, v88, v89
    v_cvt_pk_bf16_f32 v109, v90, v91
    buffer_load_dwordx4 v117, s[12:15], s33 offen offset:3072 lds
    v_cvt_pk_bf16_f32 v92, 0, v92
    v_cvt_pk_bf16_f32 v94, 0, v94
    v_cvt_pk_bf16_f32 v93, 0, v93
    v_cvt_pk_bf16_f32 v95, 0, v95
    v_pk_mul_f32 v[14:15], v[92:93], v[92:93]
    v_pk_mul_f32 v[20:21], v[94:95], v[94:95]
    v_pk_fma_f32 v[14:15], v[14:15], s[40:41], v[12:13]
    v_pk_fma_f32 v[20:21], v[20:21], s[40:41], v[12:13]
    v_pk_mul_f32 v[14:15], v[14:15], v[92:93]
    v_pk_mul_f32 v[20:21], v[20:21], v[94:95]
    v_exp_f32 v14, v14
    v_exp_f32 v20, v20
    v_exp_f32 v15, v15
    v_exp_f32 v21, v21
    v_pk_add_f32 v[14:15], v[14:15], s[42:43]
    v_pk_add_f32 v[20:21], v[20:21], s[42:43]
    v_rcp_f32 v14, v14
    v_rcp_f32 v20, v20
    v_rcp_f32 v15, v15
    v_rcp_f32 v21, v21
    v_pk_mul_f32 v[92:93], v[92:93], v[14:15]
    v_pk_mul_f32 v[94:95], v[94:95], v[20:21]
    v_cvt_pk_bf16_f32 v110, v92, v93
    v_cvt_pk_bf16_f32 v111, v94, v95
    s_mov_b32 s5, 0
k1_kernel_L5:
    buffer_load_dwordx2 v[64:65], v19, s[24:27], s50 offen offset:0 sc1
    buffer_load_dwordx2 v[66:67], v19, s[24:27], s50 offen offset:256 sc1
    buffer_load_dwordx2 v[68:69], v19, s[24:27], s50 offen offset:512 sc1
    buffer_load_dwordx2 v[70:71], v19, s[24:27], s50 offen offset:768 sc1
    buffer_load_dwordx2 v[72:73], v19, s[24:27], s50 offen offset:1024 sc1
    buffer_load_dwordx2 v[74:75], v19, s[24:27], s50 offen offset:1280 sc1
    buffer_load_dwordx2 v[76:77], v19, s[24:27], s50 offen offset:1536 sc1
    s_add_u32 s5, s5, 1
    s_waitcnt vmcnt(0)
    v_and_b32 v14, v64, v65
    v_cmp_eq_u32 vcc, -1, v14
    v_and_b32 v14, v66, v67
    v_cmp_eq_u32 s[34:35], -1, v14
    s_or_b64 vcc, vcc, s[34:35]
    v_and_b32 v14, v68, v69
    v_cmp_eq_u32 s[34:35], -1, v14
    s_or_b64 vcc, vcc, s[34:35]
    v_and_b32 v14, v70, v71
    v_cmp_eq_u32 s[34:35], -1, v14
    s_or_b64 vcc, vcc, s[34:35]
    v_and_b32 v14, v72, v73
    v_cmp_eq_u32 s[34:35], -1, v14
    s_or_b64 vcc, vcc, s[34:35]
    v_and_b32 v14, v74, v75
    v_cmp_eq_u32 s[34:35], -1, v14
    s_or_b64 vcc, vcc, s[34:35]
    v_and_b32 v14, v76, v77
    v_cmp_eq_u32 s[34:35], -1, v14
    s_or_b64 vcc, vcc, s[34:35]
    s_cbranch_vccz k1_kernel_L5_ok
    s_cmp_lt_u32 s5, 0x20000
    s_cbranch_scc1 k1_kernel_L5
k1_kernel_L5_ok:
    v_pk_add_f32 v[16:17], v[64:65], v[66:67]
    v_pk_add_f32 v[16:17], v[16:17], v[68:69]
    v_pk_add_f32 v[16:17], v[16:17], v[70:71]
    v_pk_add_f32 v[16:17], v[16:17], v[72:73]
    v_pk_add_f32 v[16:17], v[16:17], v[74:75]
    v_pk_add_f32 v[16:17], v[16:17], v[76:77]
    v_mov_b32 v14, v16
    s_nop 1
    v_permlane32_swap_b32 v16, v14
    v_add_f32 v16, v16, v14
    v_mul_f32 v16, 0x3d924925, v16
    v_sub_f32 v14, v64, v16
    v_mul_f32 v15, v14, v14
    v_sub_f32 v14, v66, v16
    v_fmac_f32 v15, v14, v14
    v_sub_f32 v14, v68, v16
    v_fmac_f32 v15, v14, v14
    v_sub_f32 v14, v70, v16
    v_fmac_f32 v15, v14, v14
    v_sub_f32 v14, v72, v16
    v_fmac_f32 v15, v14, v14
    v_sub_f32 v14, v74, v16
    v_fmac_f32 v15, v14, v14
    v_sub_f32 v14, v76, v16
    v_fmac_f32 v15, v14, v14
    v_fmac_f32 v17, 0x42800000, v15
    v_mov_b32 v14, v17
    s_nop 1
    v_permlane32_swap_b32 v17, v14
    v_add_f32 v17, v17, v14
    v_mul_f32 v17, 0x3a924925, v17
    v_cvt_pk_bf16_f32 v17, 0, v17
    v_cvt_pk_bf16_f32 v16, 0, v16
    v_add_f32 v17, 0x3727c5ac, v17
    v_cvt_pk_bf16_f32 v17, 0, v17
    v_sqrt_f32 v17, v17
    s_nop 0
    v_cvt_pk_bf16_f32 v17, 0, v17
    v_rcp_f32 v17, v17
    s_add_u32 s33, s49, 25165824
    v_pk_add_f32 v[32:33], v[32:33], v[16:17] op_sel_hi:[1,0] neg_lo:[0,1] neg_hi:[0,1]
    v_pk_add_f32 v[34:35], v[34:35], v[16:17] op_sel_hi:[1,0] neg_lo:[0,1] neg_hi:[0,1]
    v_pk_add_f32 v[36:37], v[36:37], v[16:17] op_sel_hi:[1,0] neg_lo:[0,1] neg_hi:[0,1]
    v_pk_add_f32 v[38:39], v[38:39], v[16:17] op_sel_hi:[1,0] neg_lo:[0,1] neg_hi:[0,1]
    v_cvt_pk_bf16_f32 v32, 0, v32
    v_cvt_pk_bf16_f32 v33, 0, v33
    v_cvt_pk_bf16_f32 v34, 0, v34
    v_cvt_pk_bf16_f32 v35, 0, v35
    v_cvt_pk_bf16_f32 v36, 0, v36
    v_cvt_pk_bf16_f32 v37, 0, v37
    v_cvt_pk_bf16_f32 v38, 0, v38
    v_cvt_pk_bf16_f32 v39, 0, v39
    v_pk_mul_f32 v[32:33], v[32:33], v[16:17] op_sel:[0,1] op_sel_hi:[1,1]
    v_pk_mul_f32 v[34:35], v[34:35], v[16:17] op_sel:[0,1] op_sel_hi:[1,1]
    v_pk_mul_f32 v[36:37], v[36:37], v[16:17] op_sel:[0,1] op_sel_hi:[1,1]
    v_pk_mul_f32 v[38:39], v[38:39], v[16:17] op_sel:[0,1] op_sel_hi:[1,1]
    v_cvt_pk_bf16_f32 v32, v32, v33
    v_cvt_pk_bf16_f32 v33, v34, v35
    v_cvt_pk_bf16_f32 v34, v36, v37
    v_cvt_pk_bf16_f32 v35, v38, v39
    buffer_store_dwordx4 v[32:35], v2, s[24:27], s33 offen offset:0 sc1
    v_pk_add_f32 v[40:41], v[40:41], v[16:17] op_sel_hi:[1,0] neg_lo:[0,1] neg_hi:[0,1]
    v_pk_add_f32 v[42:43], v[42:43], v[16:17] op_sel_hi:[1,0] neg_lo:[0,1] neg_hi:[0,1]
    v_pk_add_f32 v[44:45], v[44:45], v[16:17] op_sel_hi:[1,0] neg_lo:[0,1] neg_hi:[0,1]
    v_pk_add_f32 v[46:47], v[46:47], v[16:17] op_sel_hi:[1,0] neg_lo:[0,1] neg_hi:[0,1]
    v_cvt_pk_bf16_f32 v40, 0, v40
    v_cvt_pk_bf16_f32 v41, 0, v41
    v_cvt_pk_bf16_f32 v42, 0, v42
    v_cvt_pk_bf16_f32 v43, 0, v43
    v_cvt_pk_bf16_f32 v44, 0, v44
    v_cvt_pk_bf16_f32 v45, 0, v45
    v_cvt_pk_bf16_f32 v46, 0, v46
    v_cvt_pk_bf16_f32 v47, 0, v47
    v_pk_mul_f32 v[40:41], v[40:41], v[16:17] op_sel:[0,1] op_sel_hi:[1,1]
    v_pk_mul_f32 v[42:43], v[42:43], v[16:17] op_sel:[0,1] op_sel_hi:[1,1]
    v_pk_mul_f32 v[44:45], v[44:45], v[16:17] op_sel:[0,1] op_sel_hi:[1,1]
    v_pk_mul_f32 v[46:47], v[46:47], v[16:17] op_sel:[0,1] op_sel_hi:[1,1]
    v_cvt_pk_bf16_f32 v40, v40, v41
    v_cvt_pk_bf16_f32 v41, v42, v43
    v_cvt_pk_bf16_f32 v42, v44, v45
    v_cvt_pk_bf16_f32 v43, v46, v47
    buffer_store_dwordx4 v[40:43], v2, s[24:27], s33 offen offset:1024 sc1
    v_pk_add_f32 v[48:49], v[48:49], v[16:17] op_sel_hi:[1,0] neg_lo:[0,1] neg_hi:[0,1]
    v_pk_add_f32 v[50:51], v[50:51], v[16:17] op_sel_hi:[1,0] neg_lo:[0,1] neg_hi:[0,1]
    v_pk_add_f32 v[52:53], v[52:53], v[16:17] op_sel_hi:[1,0] neg_lo:[0,1] neg_hi:[0,1]
    v_pk_add_f32 v[54:55], v[54:55], v[16:17] op_sel_hi:[1,0] neg_lo:[0,1] neg_hi:[0,1]
    v_cvt_pk_bf16_f32 v48, 0, v48
    v_cvt_pk_bf16_f32 v49, 0, v49
    v_cvt_pk_bf16_f32 v50, 0, v50
    v_cvt_pk_bf16_f32 v51, 0, v51
    v_cvt_pk_bf16_f32 v52, 0, v52
    v_cvt_pk_bf16_f32 v53, 0, v53
    v_cvt_pk_bf16_f32 v54, 0, v54
    v_cvt_pk_bf16_f32 v55, 0, v55
    v_pk_mul_f32 v[48:49], v[48:49], v[16:17] op_sel:[0,1] op_sel_hi:[1,1]
    v_pk_mul_f32 v[50:51], v[50:51], v[16:17] op_sel:[0,1] op_sel_hi:[1,1]
    v_pk_mul_f32 v[52:53], v[52:53], v[16:17] op_sel:[0,1] op_sel_hi:[1,1]
    v_pk_mul_f32 v[54:55], v[54:55], v[16:17] op_sel:[0,1] op_sel_hi:[1,1]
    v_cvt_pk_bf16_f32 v48, v48, v49
    v_cvt_pk_bf16_f32 v49, v50, v51
    v_cvt_pk_bf16_f32 v50, v52, v53
    v_cvt_pk_bf16_f32 v51, v54, v55
    buffer_store_dwordx4 v[48:51], v2, s[24:27], s33 offen offset:2048 sc1
    v_pk_add_f32 v[56:57], v[56:57], v[16:17] op_sel_hi:[1,0] neg_lo:[0,1] neg_hi:[0,1]
    v_pk_add_f32 v[58:59], v[58:59], v[16:17] op_sel_hi:[1,0] neg_lo:[0,1] neg_hi:[0,1]
    v_pk_add_f32 v[60:61], v[60:61], v[16:17] op_sel_hi:[1,0] neg_lo:[0,1] neg_hi:[0,1]
    v_pk_add_f32 v[62:63], v[62:63], v[16:17] op_sel_hi:[1,0] neg_lo:[0,1] neg_hi:[0,1]
    v_cvt_pk_bf16_f32 v56, 0, v56
    v_cvt_pk_bf16_f32 v57, 0, v57
    v_cvt_pk_bf16_f32 v58, 0, v58
    v_cvt_pk_bf16_f32 v59, 0, v59
    v_cvt_pk_bf16_f32 v60, 0, v60
    v_cvt_pk_bf16_f32 v61, 0, v61
    v_cvt_pk_bf16_f32 v62, 0, v62
    v_cvt_pk_bf16_f32 v63, 0, v63
    v_pk_mul_f32 v[56:57], v[56:57], v[16:17] op_sel:[0,1] op_sel_hi:[1,1]
    v_pk_mul_f32 v[58:59], v[58:59], v[16:17] op_sel:[0,1] op_sel_hi:[1,1]
    v_pk_mul_f32 v[60:61], v[60:61], v[16:17] op_sel:[0,1] op_sel_hi:[1,1]
    v_pk_mul_f32 v[62:63], v[62:63], v[16:17] op_sel:[0,1] op_sel_hi:[1,1]
    v_cvt_pk_bf16_f32 v56, v56, v57
    v_cvt_pk_bf16_f32 v57, v58, v59
    v_cvt_pk_bf16_f32 v58, v60, v61
    v_cvt_pk_bf16_f32 v59, v62, v63
    buffer_store_dwordx4 v[56:59], v2, s[24:27], s33 offen offset:3072 sc1
    s_lshl_b32 s34, s38, 2
    s_add_u32 s34, s34, s48
    s_lshl_b32 s34, s34, 6
    s_add_u32 s34, s34, 29597696
    s_lshl_b32 s5, s39, 2
    s_add_u32 s35, s34, s5
    v_mov_b32 v22, 0
    s_waitcnt vmcnt(0)
    buffer_store_dword v22, v22, s[24:27], s35 offen sc1
    s_and_b32 s5, s2, 1
    s_mul_i32 s4, s5, 7
    s_sub_u32 s32, s38, s4
    s_lshl_b32 s5, s5, 2
    s_and_b32 s4, s2, 6
    s_lshl_b32 s4, s4, 1
    s_add_u32 s5, s5, s4
    s_add_u32 s5, s5, s39
    s_lshl_b32 s51, s5, 1
    s_add_u32 s51, s51, s37
    s_mov_b32 s52, s36
    s_mul_i32 s50, s48, 7168
    s_lshl_b32 s5, s32, 7
    s_add_u32 s50, s50, s5
    s_lshl_b32 s32, s32, 3
    s_lshl_b32 s5, s52, 2
    s_add_u32 s32, s32, s5
    v_lshrrev_b32 v3, 3, v1
    v_mul_u32_u24 v3, 896, v3
    v_bfe_u32 v4, v1, 4, 1
    v_lshlrev_b32 v4, 2, v4
    v_and_b32 v5, 7, v1
    v_xor_b32 v4, v4, v5
    v_lshl_add_u32 v3, v4, 4, v3
    v_lshlrev_b32 v4, 4, v24
    s_lshl_b32 s40, s32, 9
    s_mul_i32 s5, s51, 28672
    s_add_u32 s40, s40, s5
    s_add_u32 s40, s40, 16777216
    s_lshl_b32 s32, s32, 4
    s_add_u32 s41, s32, 4480
    s_lshl_b32 s42, s48, 10
    v_add_u32 v13, 98304, v119
    v_xor_b32 v14, 0, v13
    ds_read_b128 v[160:163], v14
    v_xor_b32 v15, 32, v13
    ds_read_b128 v[164:167], v15
    v_xor_b32 v16, 64, v13
    ds_read_b128 v[168:171], v16
    v_xor_b32 v17, 96, v13
    ds_read_b128 v[172:175], v17
    v_xor_b32 v18, 128, v13
    ds_read_b128 v[176:179], v18
    v_xor_b32 v19, 160, v13
    ds_read_b128 v[180:183], v19
    v_xor_b32 v20, 192, v13
    ds_read_b128 v[184:187], v20
    v_xor_b32 v21, 224, v13
    ds_read_b128 v[188:191], v21
    s_waitcnt lgkmcnt(0)
    s_add_u32 m0, s53, 98304
    s_add_u32 s33, s44, 2560
    buffer_load_dwordx4 v114, s[12:15], s33 offen offset:0 lds
    buffer_load_dwordx4 v115, s[12:15], s33 offen offset:1024 lds
    buffer_load_dwordx4 v116, s[12:15], s33 offen offset:2048 lds
    buffer_load_dwordx4 v117, s[12:15], s33 offen offset:3072 lds
    s_add_u32 m0, s53, 102400
    s_add_u32 s33, s44, 68096
    buffer_load_dwordx4 v114, s[12:15], s33 offen offset:0 lds
    buffer_load_dwordx4 v115, s[12:15], s33 offen offset:1024 lds
    buffer_load_dwordx4 v116, s[12:15], s33 offen offset:2048 lds
    buffer_load_dwordx4 v117, s[12:15], s33 offen offset:3072 lds
    v_add_u32 v13, 0, v119
    v_xor_b32 v14, 0, v13
    ds_read_b128 v[192:195], v14
    v_xor_b32 v15, 32, v13
    ds_read_b128 v[196:199], v15
    v_xor_b32 v16, 64, v13
    ds_read_b128 v[200:203], v16
    v_xor_b32 v17, 96, v13
    ds_read_b128 v[204:207], v17
    v_xor_b32 v18, 128, v13
    ds_read_b128 v[208:211], v18
    v_xor_b32 v19, 160, v13
    ds_read_b128 v[212:215], v19
    v_xor_b32 v20, 192, v13
    ds_read_b128 v[216:219], v20
    v_xor_b32 v21, 224, v13
    ds_read_b128 v[220:223], v21
    s_waitcnt lgkmcnt(0)
    s_add_u32 m0, s53, 0
    s_add_u32 s33, s44, 2816
    buffer_load_dwordx4 v114, s[12:15], s33 offen offset:0 lds
    buffer_load_dwordx4 v115, s[12:15], s33 offen offset:1024 lds
    buffer_load_dwordx4 v116, s[12:15], s33 offen offset:2048 lds
    buffer_load_dwordx4 v117, s[12:15], s33 offen offset:3072 lds
    s_add_u32 m0, s53, 4096
    s_add_u32 s33, s44, 68352
    buffer_load_dwordx4 v114, s[12:15], s33 offen offset:0 lds
    buffer_load_dwordx4 v115, s[12:15], s33 offen offset:1024 lds
    buffer_load_dwordx4 v116, s[12:15], s33 offen offset:2048 lds
    buffer_load_dwordx4 v117, s[12:15], s33 offen offset:3072 lds
    v_add_u32 v13, 49152, v119
    v_xor_b32 v14, 0, v13
    ds_read_b128 v[224:227], v14
    v_xor_b32 v15, 32, v13
    ds_read_b128 v[228:231], v15
    v_xor_b32 v16, 64, v13
    ds_read_b128 v[232:235], v16
    v_xor_b32 v17, 96, v13
    ds_read_b128 v[236:239], v17
    v_xor_b32 v18, 128, v13
    ds_read_b128 v[240:243], v18
    v_xor_b32 v19, 160, v13
    ds_read_b128 v[244:247], v19
    v_xor_b32 v20, 192, v13
    ds_read_b128 v[248:251], v20
    v_xor_b32 v21, 224, v13
    ds_read_b128 v[252:255], v21
    s_waitcnt lgkmcnt(0)
    s_add_u32 m0, s53, 49152
    s_add_u32 s33, s44, 3072
    buffer_load_dwordx4 v114, s[12:15], s33 offen offset:0 lds
    buffer_load_dwordx4 v115, s[12:15], s33 offen offset:1024 lds
    buffer_load_dwordx4 v116, s[12:15], s33 offen offset:2048 lds
    buffer_load_dwordx4 v117, s[12:15], s33 offen offset:3072 lds
    s_add_u32 m0, s53, 53248
    s_add_u32 s33, s44, 68608
    buffer_load_dwordx4 v114, s[12:15], s33 offen offset:0 lds
    buffer_load_dwordx4 v115, s[12:15], s33 offen offset:1024 lds
    buffer_load_dwordx4 v116, s[12:15], s33 offen offset:2048 lds
    buffer_load_dwordx4 v117, s[12:15], s33 offen offset:3072 lds
    s_waitcnt vmcnt(16)
    v_add_u32 v13, 98304, v119
    v_xor_b32 v14, 0, v13
    ds_read_b128 a[48:51], v14
    v_xor_b32 v15, 32, v13
    ds_read_b128 a[52:55], v15
    v_xor_b32 v16, 64, v13
    ds_read_b128 a[56:59], v16
    v_xor_b32 v17, 96, v13
    ds_read_b128 a[60:63], v17
    v_xor_b32 v18, 128, v13
    ds_read_b128 a[64:67], v18
    v_xor_b32 v19, 160, v13
    ds_read_b128 a[68:71], v19
    v_xor_b32 v20, 192, v13
    ds_read_b128 a[72:75], v20
    v_xor_b32 v21, 224, v13
    ds_read_b128 a[76:79], v21
    s_waitcnt lgkmcnt(0)
    s_add_u32 m0, s53, 98304
    s_add_u32 s33, s44, 3328
    buffer_load_dwordx4 v114, s[12:15], s33 offen offset:0 lds
    buffer_load_dwordx4 v115, s[12:15], s33 offen offset:1024 lds
    buffer_load_dwordx4 v116, s[12:15], s33 offen offset:2048 lds
    buffer_load_dwordx4 v117, s[12:15], s33 offen offset:3072 lds
    s_add_u32 m0, s53, 102400
    s_add_u32 s33, s44, 68864
    buffer_load_dwordx4 v114, s[12:15], s33 offen offset:0 lds
    buffer_load_dwordx4 v115, s[12:15], s33 offen offset:1024 lds
    buffer_load_dwordx4 v116, s[12:15], s33 offen offset:2048 lds
    buffer_load_dwordx4 v117, s[12:15], s33 offen offset:3072 lds
    s_waitcnt vmcnt(16)
    v_add_u32 v13, 0, v119
    v_xor_b32 v14, 0, v13
    ds_read_b128 a[80:83], v14
    v_xor_b32 v15, 32, v13
    ds_read_b128 a[84:87], v15
    v_xor_b32 v16, 64, v13
    ds_read_b128 a[88:91], v16
    v_xor_b32 v17, 96, v13
    ds_read_b128 a[92:95], v17
    v_xor_b32 v18, 128, v13
    ds_read_b128 a[96:99], v18
    v_xor_b32 v19, 160, v13
    ds_read_b128 a[100:103], v19
    v_xor_b32 v20, 192, v13
    ds_read_b128 a[104:107], v20
    v_xor_b32 v21, 224, v13
    ds_read_b128 a[108:111], v21
    s_waitcnt lgkmcnt(0)
    s_add_u32 m0, s53, 0
    s_add_u32 s33, s44, 0
    buffer_load_dwordx4 v114, s[12:15], s33 offen offset:0 lds
    buffer_load_dwordx4 v115, s[12:15], s33 offen offset:1024 lds
    buffer_load_dwordx4 v116, s[12:15], s33 offen offset:2048 lds
    buffer_load_dwordx4 v117, s[12:15], s33 offen offset:3072 lds
    s_add_u32 m0, s53, 4096
    s_add_u32 s33, s44, 65536
    buffer_load_dwordx4 v114, s[12:15], s33 offen offset:0 lds
    buffer_load_dwordx4 v115, s[12:15], s33 offen offset:1024 lds
    buffer_load_dwordx4 v116, s[12:15], s33 offen offset:2048 lds
    buffer_load_dwordx4 v117, s[12:15], s33 offen offset:3072 lds
    s_waitcnt vmcnt(16)
    v_add_u32 v13, 49152, v119
    v_xor_b32 v14, 0, v13
    ds_read_b128 a[112:115], v14
    v_xor_b32 v15, 32, v13
    ds_read_b128 a[116:119], v15
    v_xor_b32 v16, 64, v13
    ds_read_b128 a[120:123], v16
    v_xor_b32 v17, 96, v13
    ds_read_b128 a[124:127], v17
    v_xor_b32 v18, 128, v13
    ds_read_b128 a[128:131], v18
    v_xor_b32 v19, 160, v13
    ds_read_b128 a[132:135], v19
    v_xor_b32 v20, 192, v13
    ds_read_b128 a[136:139], v20
    v_xor_b32 v21, 224, v13
    ds_read_b128 a[140:143], v21
    s_waitcnt lgkmcnt(0)
    s_add_u32 m0, s53, 49152
    s_add_u32 s33, s44, 256
    buffer_load_dwordx4 v114, s[12:15], s33 offen offset:0 lds
    buffer_load_dwordx4 v115, s[12:15], s33 offen offset:1024 lds
    buffer_load_dwordx4 v116, s[12:15], s33 offen offset:2048 lds
    buffer_load_dwordx4 v117, s[12:15], s33 offen offset:3072 lds
    s_add_u32 m0, s53, 53248
    s_add_u32 s33, s44, 65792
    buffer_load_dwordx4 v114, s[12:15], s33 offen offset:0 lds
    buffer_load_dwordx4 v115, s[12:15], s33 offen offset:1024 lds
    buffer_load_dwordx4 v116, s[12:15], s33 offen offset:2048 lds
    buffer_load_dwordx4 v117, s[12:15], s33 offen offset:3072 lds
    s_waitcnt vmcnt(16)
    v_add_u32 v13, 98304, v119
    v_xor_b32 v14, 0, v13
    ds_read_b128 v[64:67], v14
    v_xor_b32 v15, 32, v13
    ds_read_b128 v[68:71], v15
    v_xor_b32 v16, 64, v13
    ds_read_b128 v[72:75], v16
    v_xor_b32 v17, 96, v13
    ds_read_b128 v[76:79], v17
    v_xor_b32 v18, 128, v13
    ds_read_b128 v[80:83], v18
    v_xor_b32 v19, 160, v13
    ds_read_b128 v[84:87], v19
    v_xor_b32 v20, 192, v13
    ds_read_b128 v[88:91], v20
    v_xor_b32 v21, 224, v13
    ds_read_b128 v[92:95], v21
    s_waitcnt lgkmcnt(0)
    s_add_u32 m0, s53, 98304
    s_add_u32 s33, s44, 512
    buffer_load_dwordx4 v114, s[12:15], s33 offen offset:0 lds
    buffer_load_dwordx4 v115, s[12:15], s33 offen offset:1024 lds
    buffer_load_dwordx4 v116, s[12:15], s33 offen offset:2048 lds
    buffer_load_dwordx4 v117, s[12:15], s33 offen offset:3072 lds
    s_add_u32 m0, s53, 102400
    s_add_u32 s33, s44, 66048
    buffer_load_dwordx4 v114, s[12:15], s33 offen offset:0 lds
    buffer_load_dwordx4 v115, s[12:15], s33 offen offset:1024 lds
    buffer_load_dwordx4 v116, s[12:15], s33 offen offset:2048 lds
    buffer_load_dwordx4 v117, s[12:15], s33 offen offset:3072 lds
    s_mov_b32 s5, 0
k1_kernel_L6:
    buffer_load_dword v22, v23, s[24:27], s34 offen sc1
    s_add_u32 s5, s5, 1
    s_waitcnt vmcnt(0)
    v_cmp_eq_u32 vcc, -1, v22
    s_nop 4
    s_cbranch_vccz k1_kernel_L6_ok
    s_cmp_lt_u32 s5, 0x20000
    s_cbranch_scc1 k1_kernel_L6
k1_kernel_L6_ok:
    s_add_u32 m0, s46, 49152
    s_add_u32 s33, s45, 0
    buffer_load_dwordx4 v112, s[24:27], s33 offen offset:0 lds
    buffer_load_dwordx4 v113, s[24:27], s33 offen offset:1024 lds
    buffer_load_dwordx4 v112, s[24:27], s33 offen offset:2048 lds
    buffer_load_dwordx4 v113, s[24:27], s33 offen offset:3072 lds
    s_add_u32 m0, s46, 98304
    s_add_u32 s33, s45, 229376
    buffer_load_dwordx4 v112, s[24:27], s33 offen offset:0 lds
    buffer_load_dwordx4 v113, s[24:27], s33 offen offset:1024 lds
    buffer_load_dwordx4 v112, s[24:27], s33 offen offset:2048 lds
    buffer_load_dwordx4 v113, s[24:27], s33 offen offset:3072 lds
    s_add_u32 m0, s46, 147456
    s_add_u32 s33, s45, 458752
    buffer_load_dwordx4 v112, s[24:27], s33 offen offset:0 lds
    buffer_load_dwordx4 v113, s[24:27], s33 offen offset:1024 lds
    buffer_load_dwordx4 v112, s[24:27], s33 offen offset:2048 lds
    buffer_load_dwordx4 v113, s[24:27], s33 offen offset:3072 lds
    s_add_u32 m0, s46, 0
    s_add_u32 s33, s45, 688128
    buffer_load_dwordx4 v112, s[24:27], s33 offen offset:0 lds
    buffer_load_dwordx4 v113, s[24:27], s33 offen offset:1024 lds
    buffer_load_dwordx4 v112, s[24:27], s33 offen offset:2048 lds
    buffer_load_dwordx4 v113, s[24:27], s33 offen offset:3072 lds
    s_waitcnt vmcnt(12)
    s_barrier
    v_add_u32 v12, 49152, v118
    v_xor_b32 v13, 64, v12
    v_add_u32 v22, 0, v119
    v_xor_b32 v14, 0, v22
    ds_read_b128 a[32:35], v14
    ds_read_b64_tr_b16 a[0:1], v12 offset:0
    ds_read_b64_tr_b16 a[2:3], v13 offset:0
    ds_read_b64_tr_b16 a[4:5], v12 offset:2048
    ds_read_b64_tr_b16 a[6:7], v13 offset:2048
    v_xor_b32 v15, 32, v22
    ds_read_b128 a[36:39], v15
    ds_read_b64_tr_b16 a[8:9], v12 offset:256
    ds_read_b64_tr_b16 a[10:11], v13 offset:256
    ds_read_b64_tr_b16 a[12:13], v12 offset:2304
    ds_read_b64_tr_b16 a[14:15], v13 offset:2304
    v_xor_b32 v16, 64, v22
    ds_read_b128 a[40:43], v16
    ds_read_b64_tr_b16 a[16:17], v12 offset:4096
    ds_read_b64_tr_b16 a[18:19], v13 offset:4096
    ds_read_b64_tr_b16 a[20:21], v12 offset:6144
    ds_read_b64_tr_b16 a[22:23], v13 offset:6144
    buffer_load_dwordx4 v[124:127], v2, s[24:27], s40 offen offset:0
    buffer_load_dwordx4 v[132:135], v4, s[24:27], s41 offen offset:0
    buffer_load_dwordx4 v[128:131], v2, s[24:27], s40 offen offset:1024
    buffer_load_dwordx4 v[136:139], v4, s[24:27], s41 offen offset:32
    s_waitcnt lgkmcnt(12)
    v_mfma_f32_32x32x16_bf16 v[32:47], a[0:3], a[32:35], 0
    v_xor_b32 v17, 96, v22
    ds_read_b128 a[44:47], v17
    ds_read_b64_tr_b16 a[24:25], v12 offset:4352
    ds_read_b64_tr_b16 a[26:27], v13 offset:4352
    s_waitcnt lgkmcnt(13)
    v_mfma_f32_32x32x16_bf16 v[48:63], a[4:7], a[32:35], 0
    ds_read_b64_tr_b16 a[28:29], v12 offset:6400
    ds_read_b64_tr_b16 a[30:31], v13 offset:6400
    s_waitcnt lgkmcnt(12)
    v_mfma_f32_32x32x16_bf16 v[32:47], a[8:11], a[36:39], v[32:47]
    v_xor_b32 v18, 128, v22
    ds_read_b128 a[32:35], v18
    ds_read_b64_tr_b16 a[0:1], v12 offset:8192
    ds_read_b64_tr_b16 a[2:3], v13 offset:8192
    s_waitcnt lgkmcnt(13)
    v_mfma_f32_32x32x16_bf16 v[48:63], a[12:15], a[36:39], v[48:63]
    ds_read_b64_tr_b16 a[4:5], v12 offset:10240
    ds_read_b64_tr_b16 a[6:7], v13 offset:10240
    s_waitcnt lgkmcnt(12)
    v_mfma_f32_32x32x16_bf16 v[32:47], a[16:19], a[40:43], v[32:47]
    v_xor_b32 v19, 160, v22
    ds_read_b128 a[36:39], v19
    ds_read_b64_tr_b16 a[8:9], v12 offset:8448
    ds_read_b64_tr_b16 a[10:11], v13 offset:8448
    s_waitcnt lgkmcnt(13)
    v_mfma_f32_32x32x16_bf16 v[48:63], a[20:23], a[40:43], v[48:63]
    ds_read_b64_tr_b16 a[12:13], v12 offset:10496
    ds_read_b64_tr_b16 a[14:15], v13 offset:10496
    s_waitcnt lgkmcnt(12)
    v_mfma_f32_32x32x16_bf16 v[32:47], a[24:27], a[44:47], v[32:47]
    v_xor_b32 v20, 192, v22
    ds_read_b128 a[40:43], v20
    ds_read_b64_tr_b16 a[16:17], v12 offset:12288
    ds_read_b64_tr_b16 a[18:19], v13 offset:12288
    s_waitcnt lgkmcnt(13)
    v_mfma_f32_32x32x16_bf16 v[48:63], a[28:31], a[44:47], v[48:63]
    ds_read_b64_tr_b16 a[20:21], v12 offset:14336
    ds_read_b64_tr_b16 a[22:23], v13 offset:14336
    s_waitcnt lgkmcnt(12)
    v_mfma_f32_32x32x16_bf16 v[32:47], a[0:3], a[32:35], v[32:47]
    v_xor_b32 v21, 224, v22
    ds_read_b128 a[44:47], v21
    ds_read_b64_tr_b16 a[24:25], v12 offset:12544
    ds_read_b64_tr_b16 a[26:27], v13 offset:12544
    s_waitcnt lgkmcnt(13)
    v_mfma_f32_32x32x16_bf16 v[48:63], a[4:7], a[32:35], v[48:63]
    ds_read_b64_tr_b16 a[28:29], v12 offset:14592
    ds_read_b64_tr_b16 a[30:31], v13 offset:14592
    s_waitcnt lgkmcnt(12)
    v_mfma_f32_32x32x16_bf16 v[32:47], a[8:11], a[36:39], v[32:47]
    s_waitcnt vmcnt(12) lgkmcnt(0)
    s_barrier
    v_add_u32 v12, 98304, v118
    v_xor_b32 v13, 64, v12
    v_add_u32 v22, 49152, v119
    v_xor_b32 v14, 0, v22
    ds_read_b128 a[32:35], v14
    ds_read_b64_tr_b16 a[0:1], v12 offset:0
    ds_read_b64_tr_b16 a[2:3], v13 offset:0
    s_add_u32 m0, s46, 49152
    s_add_u32 s33, s45, 917504
    buffer_load_dwordx4 v112, s[24:27], s33 offen offset:0 lds
    v_mfma_f32_32x32x16_bf16 v[48:63], a[12:15], a[36:39], v[48:63]
    ds_read_b64_tr_b16 a[4:5], v12 offset:2048
    ds_read_b64_tr_b16 a[6:7], v13 offset:2048
    buffer_load_dwordx4 v113, s[24:27], s33 offen offset:1024 lds
    v_mfma_f32_32x32x16_bf16 v[32:47], a[16:19], a[40:43], v[32:47]
    v_xor_b32 v15, 32, v22
    ds_read_b128 a[36:39], v15
    ds_read_b64_tr_b16 a[8:9], v12 offset:256
    ds_read_b64_tr_b16 a[10:11], v13 offset:256
    buffer_load_dwordx4 v112, s[24:27], s33 offen offset:2048 lds
    v_mfma_f32_32x32x16_bf16 v[48:63], a[20:23], a[40:43], v[48:63]
    ds_read_b64_tr_b16 a[12:13], v12 offset:2304
    ds_read_b64_tr_b16 a[14:15], v13 offset:2304
    buffer_load_dwordx4 v113, s[24:27], s33 offen offset:3072 lds
    v_mfma_f32_32x32x16_bf16 v[32:47], a[24:27], a[44:47], v[32:47]
    v_xor_b32 v16, 64, v22
    ds_read_b128 a[40:43], v16
    ds_read_b64_tr_b16 a[16:17], v12 offset:4096
    ds_read_b64_tr_b16 a[18:19], v13 offset:4096
    v_mfma_f32_32x32x16_bf16 v[48:63], a[28:31], a[44:47], v[48:63]
    ds_read_b64_tr_b16 a[20:21], v12 offset:6144
    ds_read_b64_tr_b16 a[22:23], v13 offset:6144
    s_waitcnt lgkmcnt(12)
    v_mfma_f32_32x32x16_bf16 v[32:47], a[0:3], a[32:35], v[32:47]
    v_xor_b32 v17, 96, v22
    ds_read_b128 a[44:47], v17
    ds_read_b64_tr_b16 a[24:25], v12 offset:4352
    ds_read_b64_tr_b16 a[26:27], v13 offset:4352
    s_waitcnt lgkmcnt(13)
    v_mfma_f32_32x32x16_bf16 v[48:63], a[4:7], a[32:35], v[48:63]
    ds_read_b64_tr_b16 a[28:29], v12 offset:6400
    ds_read_b64_tr_b16 a[30:31], v13 offset:6400
    s_waitcnt lgkmcnt(12)
    v_mfma_f32_32x32x16_bf16 v[32:47], a[8:11], a[36:39], v[32:47]
    v_xor_b32 v18, 128, v22
    ds_read_b128 a[32:35], v18
    ds_read_b64_tr_b16 a[0:1], v12 offset:8192
    ds_read_b64_tr_b16 a[2:3], v13 offset:8192
    s_waitcnt lgkmcnt(13)
    v_mfma_f32_32x32x16_bf16 v[48:63], a[12:15], a[36:39], v[48:63]
    ds_read_b64_tr_b16 a[4:5], v12 offset:10240
    ds_read_b64_tr_b16 a[6:7], v13 offset:10240
    s_waitcnt lgkmcnt(12)
    v_mfma_f32_32x32x16_bf16 v[32:47], a[16:19], a[40:43], v[32:47]
    v_xor_b32 v19, 160, v22
    ds_read_b128 a[36:39], v19
    ds_read_b64_tr_b16 a[8:9], v12 offset:8448
    ds_read_b64_tr_b16 a[10:11], v13 offset:8448
    s_waitcnt lgkmcnt(13)
    v_mfma_f32_32x32x16_bf16 v[48:63], a[20:23], a[40:43], v[48:63]
    ds_read_b64_tr_b16 a[12:13], v12 offset:10496
    ds_read_b64_tr_b16 a[14:15], v13 offset:10496
    s_waitcnt lgkmcnt(12)
    v_mfma_f32_32x32x16_bf16 v[32:47], a[24:27], a[44:47], v[32:47]
    v_xor_b32 v20, 192, v22
    ds_read_b128 a[40:43], v20
    ds_read_b64_tr_b16 a[16:17], v12 offset:12288
    ds_read_b64_tr_b16 a[18:19], v13 offset:12288
    s_waitcnt lgkmcnt(13)
    v_mfma_f32_32x32x16_bf16 v[48:63], a[28:31], a[44:47], v[48:63]
    ds_read_b64_tr_b16 a[20:21], v12 offset:14336
    ds_read_b64_tr_b16 a[22:23], v13 offset:14336
    s_waitcnt lgkmcnt(12)
    v_mfma_f32_32x32x16_bf16 v[32:47], a[0:3], a[32:35], v[32:47]
    v_xor_b32 v21, 224, v22
    ds_read_b128 a[44:47], v21
    ds_read_b64_tr_b16 a[24:25], v12 offset:12544
    ds_read_b64_tr_b16 a[26:27], v13 offset:12544
    s_waitcnt lgkmcnt(13)
    v_mfma_f32_32x32x16_bf16 v[48:63], a[4:7], a[32:35], v[48:63]
    ds_read_b64_tr_b16 a[28:29], v12 offset:14592
    ds_read_b64_tr_b16 a[30:31], v13 offset:14592
    s_waitcnt lgkmcnt(12)
    v_mfma_f32_32x32x16_bf16 v[32:47], a[8:11], a[36:39], v[32:47]
    s_waitcnt vmcnt(12) lgkmcnt(0)
    s_barrier
    v_add_u32 v12, 147456, v118
    v_xor_b32 v13, 64, v12
    v_add_u32 v22, 98304, v119
    v_xor_b32 v14, 0, v22
    ds_read_b128 a[32:35], v14
    ds_read_b64_tr_b16 a[0:1], v12 offset:0
    ds_read_b64_tr_b16 a[2:3], v13 offset:0
    s_add_u32 m0, s46, 98304
    s_add_u32 s33, s45, 1146880
    buffer_load_dwordx4 v112, s[24:27], s33 offen offset:0 lds
    v_mfma_f32_32x32x16_bf16 v[48:63], a[12:15], a[36:39], v[48:63]
    ds_read_b64_tr_b16 a[4:5], v12 offset:2048
    ds_read_b64_tr_b16 a[6:7], v13 offset:2048
    buffer_load_dwordx4 v113, s[24:27], s33 offen offset:1024 lds
    v_mfma_f32_32x32x16_bf16 v[32:47], a[16:19], a[40:43], v[32:47]
    v_xor_b32 v15, 32, v22
    ds_read_b128 a[36:39], v15
    ds_read_b64_tr_b16 a[8:9], v12 offset:256
    ds_read_b64_tr_b16 a[10:11], v13 offset:256
    buffer_load_dwordx4 v112, s[24:27], s33 offen offset:2048 lds
    v_mfma_f32_32x32x16_bf16 v[48:63], a[20:23], a[40:43], v[48:63]
    ds_read_b64_tr_b16 a[12:13], v12 offset:2304
    ds_read_b64_tr_b16 a[14:15], v13 offset:2304
    buffer_load_dwordx4 v113, s[24:27], s33 offen offset:3072 lds
    v_mfma_f32_32x32x16_bf16 v[32:47], a[24:27], a[44:47], v[32:47]
    v_xor_b32 v16, 64, v22
    ds_read_b128 a[40:43], v16
    ds_read_b64_tr_b16 a[16:17], v12 offset:4096
    ds_read_b64_tr_b16 a[18:19], v13 offset:4096
    v_mfma_f32_32x32x16_bf16 v[48:63], a[28:31], a[44:47], v[48:63]
    ds_read_b64_tr_b16 a[20:21], v12 offset:6144
    ds_read_b64_tr_b16 a[22:23], v13 offset:6144
    s_waitcnt lgkmcnt(12)
    v_mfma_f32_32x32x16_bf16 v[32:47], a[0:3], a[32:35], v[32:47]
    v_xor_b32 v17, 96, v22
    ds_read_b128 a[44:47], v17
    ds_read_b64_tr_b16 a[24:25], v12 offset:4352
    ds_read_b64_tr_b16 a[26:27], v13 offset:4352
    s_waitcnt lgkmcnt(13)
    v_mfma_f32_32x32x16_bf16 v[48:63], a[4:7], a[32:35], v[48:63]
    ds_read_b64_tr_b16 a[28:29], v12 offset:6400
    ds_read_b64_tr_b16 a[30:31], v13 offset:6400
    s_waitcnt lgkmcnt(12)
    v_mfma_f32_32x32x16_bf16 v[32:47], a[8:11], a[36:39], v[32:47]
    v_xor_b32 v18, 128, v22
    ds_read_b128 a[32:35], v18
    ds_read_b64_tr_b16 a[0:1], v12 offset:8192
    ds_read_b64_tr_b16 a[2:3], v13 offset:8192
    s_waitcnt lgkmcnt(13)
    v_mfma_f32_32x32x16_bf16 v[48:63], a[12:15], a[36:39], v[48:63]
    ds_read_b64_tr_b16 a[4:5], v12 offset:10240
    ds_read_b64_tr_b16 a[6:7], v13 offset:10240
    s_waitcnt lgkmcnt(12)
    v_mfma_f32_32x32x16_bf16 v[32:47], a[16:19], a[40:43], v[32:47]
    v_xor_b32 v19, 160, v22
    ds_read_b128 a[36:39], v19
    ds_read_b64_tr_b16 a[8:9], v12 offset:8448
    ds_read_b64_tr_b16 a[10:11], v13 offset:8448
    s_waitcnt lgkmcnt(13)
    v_mfma_f32_32x32x16_bf16 v[48:63], a[20:23], a[40:43], v[48:63]
    ds_read_b64_tr_b16 a[12:13], v12 offset:10496
    ds_read_b64_tr_b16 a[14:15], v13 offset:10496
    s_waitcnt lgkmcnt(12)
    v_mfma_f32_32x32x16_bf16 v[32:47], a[24:27], a[44:47], v[32:47]
    v_xor_b32 v20, 192, v22
    ds_read_b128 a[40:43], v20
    ds_read_b64_tr_b16 a[16:17], v12 offset:12288
    ds_read_b64_tr_b16 a[18:19], v13 offset:12288
    s_waitcnt lgkmcnt(13)
    v_mfma_f32_32x32x16_bf16 v[48:63], a[28:31], a[44:47], v[48:63]
    ds_read_b64_tr_b16 a[20:21], v12 offset:14336
    ds_read_b64_tr_b16 a[22:23], v13 offset:14336
    s_waitcnt lgkmcnt(12)
    v_mfma_f32_32x32x16_bf16 v[32:47], a[0:3], a[32:35], v[32:47]
    v_xor_b32 v21, 224, v22
    ds_read_b128 a[44:47], v21
    ds_read_b64_tr_b16 a[24:25], v12 offset:12544
    ds_read_b64_tr_b16 a[26:27], v13 offset:12544
    s_waitcnt lgkmcnt(13)
    v_mfma_f32_32x32x16_bf16 v[48:63], a[4:7], a[32:35], v[48:63]
    ds_read_b64_tr_b16 a[28:29], v12 offset:14592
    ds_read_b64_tr_b16 a[30:31], v13 offset:14592
    s_waitcnt lgkmcnt(12)
    v_mfma_f32_32x32x16_bf16 v[32:47], a[8:11], a[36:39], v[32:47]
    s_waitcnt vmcnt(12) lgkmcnt(0)
    s_barrier
    v_add_u32 v12, 0, v118
    v_xor_b32 v13, 64, v12
    v_add_u32 v22, 0, v119
    ds_read_b64_tr_b16 a[0:1], v12 offset:0
    ds_read_b64_tr_b16 a[2:3], v13 offset:0
    s_add_u32 m0, s46, 147456
    s_add_u32 s33, s45, 1376256
    buffer_load_dwordx4 v112, s[24:27], s33 offen offset:0 lds
    v_mfma_f32_32x32x16_bf16 v[48:63], a[12:15], a[36:39], v[48:63]
    ds_read_b64_tr_b16 a[4:5], v12 offset:2048
    ds_read_b64_tr_b16 a[6:7], v13 offset:2048
    buffer_load_dwordx4 v113, s[24:27], s33 offen offset:1024 lds
    v_mfma_f32_32x32x16_bf16 v[32:47], a[16:19], a[40:43], v[32:47]
    ds_read_b64_tr_b16 a[8:9], v12 offset:256
    ds_read_b64_tr_b16 a[10:11], v13 offset:256
    buffer_load_dwordx4 v112, s[24:27], s33 offen offset:2048 lds
    v_mfma_f32_32x32x16_bf16 v[48:63], a[20:23], a[40:43], v[48:63]
    ds_read_b64_tr_b16 a[12:13], v12 offset:2304
    ds_read_b64_tr_b16 a[14:15], v13 offset:2304
    buffer_load_dwordx4 v113, s[24:27], s33 offen offset:3072 lds
    v_mfma_f32_32x32x16_bf16 v[32:47], a[24:27], a[44:47], v[32:47]
    ds_read_b64_tr_b16 a[16:17], v12 offset:4096
    ds_read_b64_tr_b16 a[18:19], v13 offset:4096
    v_mfma_f32_32x32x16_bf16 v[48:63], a[28:31], a[44:47], v[48:63]
    ds_read_b64_tr_b16 a[20:21], v12 offset:6144
    ds_read_b64_tr_b16 a[22:23], v13 offset:6144
    s_waitcnt lgkmcnt(10)
    v_mfma_f32_32x32x16_bf16 v[32:47], a[0:3], a[144:147], v[32:47]
    ds_read_b64_tr_b16 a[24:25], v12 offset:4352
    ds_read_b64_tr_b16 a[26:27], v13 offset:4352
    s_waitcnt lgkmcnt(10)
    v_mfma_f32_32x32x16_bf16 v[48:63], a[4:7], a[144:147], v[48:63]
    ds_read_b64_tr_b16 a[28:29], v12 offset:6400
    ds_read_b64_tr_b16 a[30:31], v13 offset:6400
    s_waitcnt lgkmcnt(10)
    v_mfma_f32_32x32x16_bf16 v[32:47], a[8:11], a[148:151], v[32:47]
    ds_read_b64_tr_b16 a[0:1], v12 offset:8192
    ds_read_b64_tr_b16 a[2:3], v13 offset:8192
    s_waitcnt lgkmcnt(10)
    v_mfma_f32_32x32x16_bf16 v[48:63], a[12:15], a[148:151], v[48:63]
    ds_read_b64_tr_b16 a[4:5], v12 offset:10240
    ds_read_b64_tr_b16 a[6:7], v13 offset:10240
    s_waitcnt lgkmcnt(10)
    v_mfma_f32_32x32x16_bf16 v[32:47], a[16:19], a[152:155], v[32:47]
    ds_read_b64_tr_b16 a[8:9], v12 offset:8448
    ds_read_b64_tr_b16 a[10:11], v13 offset:8448
    s_waitcnt lgkmcnt(10)
    v_mfma_f32_32x32x16_bf16 v[48:63], a[20:23], a[152:155], v[48:63]
    ds_read_b64_tr_b16 a[12:13], v12 offset:10496
    ds_read_b64_tr_b16 a[14:15], v13 offset:10496
    s_waitcnt lgkmcnt(10)
    v_mfma_f32_32x32x16_bf16 v[32:47], a[24:27], a[156:159], v[32:47]
    ds_read_b64_tr_b16 a[16:17], v12 offset:12288
    ds_read_b64_tr_b16 a[18:19], v13 offset:12288
    s_waitcnt lgkmcnt(10)
    v_mfma_f32_32x32x16_bf16 v[48:63], a[28:31], a[156:159], v[48:63]
    ds_read_b64_tr_b16 a[20:21], v12 offset:14336
    ds_read_b64_tr_b16 a[22:23], v13 offset:14336
    s_waitcnt lgkmcnt(10)
    v_mfma_f32_32x32x16_bf16 v[32:47], a[0:3], a[160:163], v[32:47]
    ds_read_b64_tr_b16 a[24:25], v12 offset:12544
    ds_read_b64_tr_b16 a[26:27], v13 offset:12544
    s_waitcnt lgkmcnt(10)
    v_mfma_f32_32x32x16_bf16 v[48:63], a[4:7], a[160:163], v[48:63]
    ds_read_b64_tr_b16 a[28:29], v12 offset:14592
    ds_read_b64_tr_b16 a[30:31], v13 offset:14592
    s_waitcnt lgkmcnt(10)
    v_mfma_f32_32x32x16_bf16 v[32:47], a[8:11], a[164:167], v[32:47]
    s_waitcnt vmcnt(8) lgkmcnt(0)
    s_barrier
    v_add_u32 v12, 49152, v118
    v_xor_b32 v13, 64, v12
    v_add_u32 v22, 49152, v119
    ds_read_b64_tr_b16 a[0:1], v12 offset:0
    ds_read_b64_tr_b16 a[2:3], v13 offset:0
    s_add_u32 m0, s46, 0
    s_add_u32 s33, s45, 1605632
    buffer_load_dwordx4 v112, s[24:27], s33 offen offset:0 lds
    v_mfma_f32_32x32x16_bf16 v[48:63], a[12:15], a[164:167], v[48:63]
    ds_read_b64_tr_b16 a[4:5], v12 offset:2048
    ds_read_b64_tr_b16 a[6:7], v13 offset:2048
    buffer_load_dwordx4 v113, s[24:27], s33 offen offset:1024 lds
    v_mfma_f32_32x32x16_bf16 v[32:47], a[16:19], a[168:171], v[32:47]
    ds_read_b64_tr_b16 a[8:9], v12 offset:256
    ds_read_b64_tr_b16 a[10:11], v13 offset:256
    buffer_load_dwordx4 v112, s[24:27], s33 offen offset:2048 lds
    v_mfma_f32_32x32x16_bf16 v[48:63], a[20:23], a[168:171], v[48:63]
    ds_read_b64_tr_b16 a[12:13], v12 offset:2304
    ds_read_b64_tr_b16 a[14:15], v13 offset:2304
    buffer_load_dwordx4 v113, s[24:27], s33 offen offset:3072 lds
    v_mfma_f32_32x32x16_bf16 v[32:47], a[24:27], a[172:175], v[32:47]
    ds_read_b64_tr_b16 a[16:17], v12 offset:4096
    ds_read_b64_tr_b16 a[18:19], v13 offset:4096
    s_add_u32 m0, s53, 98304
    s_add_u32 s33, s44, 3584
    buffer_load_dwordx4 v114, s[12:15], s33 offen offset:0 lds
    v_mfma_f32_32x32x16_bf16 v[48:63], a[28:31], a[172:175], v[48:63]
    ds_read_b64_tr_b16 a[20:21], v12 offset:6144
    ds_read_b64_tr_b16 a[22:23], v13 offset:6144
    buffer_load_dwordx4 v115, s[12:15], s33 offen offset:1024 lds
    s_waitcnt lgkmcnt(10)
    v_mfma_f32_32x32x16_bf16 v[32:47], a[0:3], a[176:179], v[32:47]
    ds_read_b64_tr_b16 a[24:25], v12 offset:4352
    ds_read_b64_tr_b16 a[26:27], v13 offset:4352
    buffer_load_dwordx4 v116, s[12:15], s33 offen offset:2048 lds
    s_waitcnt lgkmcnt(10)
    v_mfma_f32_32x32x16_bf16 v[48:63], a[4:7], a[176:179], v[48:63]
    ds_read_b64_tr_b16 a[28:29], v12 offset:6400
    ds_read_b64_tr_b16 a[30:31], v13 offset:6400
    buffer_load_dwordx4 v117, s[12:15], s33 offen offset:3072 lds
    s_waitcnt lgkmcnt(10)
    v_mfma_f32_32x32x16_bf16 v[32:47], a[8:11], a[180:183], v[32:47]
    ds_read_b64_tr_b16 a[0:1], v12 offset:8192
    ds_read_b64_tr_b16 a[2:3], v13 offset:8192
    s_add_u32 m0, s53, 102400
    s_add_u32 s33, s44, 69120
    buffer_load_dwordx4 v114, s[12:15], s33 offen offset:0 lds
    s_waitcnt lgkmcnt(10)
    v_mfma_f32_32x32x16_bf16 v[48:63], a[12:15], a[180:183], v[48:63]
    ds_read_b64_tr_b16 a[4:5], v12 offset:10240
    ds_read_b64_tr_b16 a[6:7], v13 offset:10240
    buffer_load_dwordx4 v115, s[12:15], s33 offen offset:1024 lds
    s_waitcnt lgkmcnt(10)
    v_mfma_f32_32x32x16_bf16 v[32:47], a[16:19], a[184:187], v[32:47]
    ds_read_b64_tr_b16 a[8:9], v12 offset:8448
    ds_read_b64_tr_b16 a[10:11], v13 offset:8448
    buffer_load_dwordx4 v116, s[12:15], s33 offen offset:2048 lds
    s_waitcnt lgkmcnt(10)
    v_mfma_f32_32x32x16_bf16 v[48:63], a[20:23], a[184:187], v[48:63]
    ds_read_b64_tr_b16 a[12:13], v12 offset:10496
    ds_read_b64_tr_b16 a[14:15], v13 offset:10496
    buffer_load_dwordx4 v117, s[12:15], s33 offen offset:3072 lds
    s_waitcnt lgkmcnt(10)
    v_mfma_f32_32x32x16_bf16 v[32:47], a[24:27], a[188:191], v[32:47]
    ds_read_b64_tr_b16 a[16:17], v12 offset:12288
    ds_read_b64_tr_b16 a[18:19], v13 offset:12288
    s_waitcnt lgkmcnt(10)
    v_mfma_f32_32x32x16_bf16 v[48:63], a[28:31], a[188:191], v[48:63]
    ds_read_b64_tr_b16 a[20:21], v12 offset:14336
    ds_read_b64_tr_b16 a[22:23], v13 offset:14336
    s_waitcnt lgkmcnt(10)
    v_mfma_f32_32x32x16_bf16 v[32:47], a[0:3], a[192:195], v[32:47]
    ds_read_b64_tr_b16 a[24:25], v12 offset:12544
    ds_read_b64_tr_b16 a[26:27], v13 offset:12544
    s_waitcnt lgkmcnt(10)
    v_mfma_f32_32x32x16_bf16 v[48:63], a[4:7], a[192:195], v[48:63]
    ds_read_b64_tr_b16 a[28:29], v12 offset:14592
    ds_read_b64_tr_b16 a[30:31], v13 offset:14592
    s_waitcnt lgkmcnt(10)
    v_mfma_f32_32x32x16_bf16 v[32:47], a[8:11], a[196:199], v[32:47]
    s_waitcnt vmcnt(16) lgkmcnt(0)
    s_barrier
    v_add_u32 v12, 98304, v118
    v_xor_b32 v13, 64, v12
    v_add_u32 v22, 98304, v119
    ds_read_b64_tr_b16 a[0:1], v12 offset:0
    ds_read_b64_tr_b16 a[2:3], v13 offset:0
    s_add_u32 m0, s46, 49152
    s_add_u32 s33, s45, 1835008
    buffer_load_dwordx4 v112, s[24:27], s33 offen offset:0 lds
    v_mfma_f32_32x32x16_bf16 v[48:63], a[12:15], a[196:199], v[48:63]
    ds_read_b64_tr_b16 a[4:5], v12 offset:2048
    ds_read_b64_tr_b16 a[6:7], v13 offset:2048
    buffer_load_dwordx4 v113, s[24:27], s33 offen offset:1024 lds
    v_mfma_f32_32x32x16_bf16 v[32:47], a[16:19], a[200:203], v[32:47]
    ds_read_b64_tr_b16 a[8:9], v12 offset:256
    ds_read_b64_tr_b16 a[10:11], v13 offset:256
    buffer_load_dwordx4 v112, s[24:27], s33 offen offset:2048 lds
    v_mfma_f32_32x32x16_bf16 v[48:63], a[20:23], a[200:203], v[48:63]
    ds_read_b64_tr_b16 a[12:13], v12 offset:2304
    ds_read_b64_tr_b16 a[14:15], v13 offset:2304
    buffer_load_dwordx4 v113, s[24:27], s33 offen offset:3072 lds
    v_mfma_f32_32x32x16_bf16 v[32:47], a[24:27], a[204:207], v[32:47]
    ds_read_b64_tr_b16 a[16:17], v12 offset:4096
    ds_read_b64_tr_b16 a[18:19], v13 offset:4096
    v_mfma_f32_32x32x16_bf16 v[48:63], a[28:31], a[204:207], v[48:63]
    ds_read_b64_tr_b16 a[20:21], v12 offset:6144
    ds_read_b64_tr_b16 a[22:23], v13 offset:6144
    s_waitcnt lgkmcnt(10)
    v_mfma_f32_32x32x16_bf16 v[32:47], a[0:3], a[208:211], v[32:47]
    ds_read_b64_tr_b16 a[24:25], v12 offset:4352
    ds_read_b64_tr_b16 a[26:27], v13 offset:4352
    s_waitcnt lgkmcnt(10)
    v_mfma_f32_32x32x16_bf16 v[48:63], a[4:7], a[208:211], v[48:63]
    ds_read_b64_tr_b16 a[28:29], v12 offset:6400
    ds_read_b64_tr_b16 a[30:31], v13 offset:6400
    s_waitcnt lgkmcnt(10)
    v_mfma_f32_32x32x16_bf16 v[32:47], a[8:11], a[212:215], v[32:47]
    ds_read_b64_tr_b16 a[0:1], v12 offset:8192
    ds_read_b64_tr_b16 a[2:3], v13 offset:8192
    s_waitcnt lgkmcnt(10)
    v_mfma_f32_32x32x16_bf16 v[48:63], a[12:15], a[212:215], v[48:63]
    ds_read_b64_tr_b16 a[4:5], v12 offset:10240
    ds_read_b64_tr_b16 a[6:7], v13 offset:10240
    s_waitcnt lgkmcnt(10)
    v_mfma_f32_32x32x16_bf16 v[32:47], a[16:19], a[216:219], v[32:47]
    ds_read_b64_tr_b16 a[8:9], v12 offset:8448
    ds_read_b64_tr_b16 a[10:11], v13 offset:8448
    s_waitcnt lgkmcnt(10)
    v_mfma_f32_32x32x16_bf16 v[48:63], a[20:23], a[216:219], v[48:63]
    ds_read_b64_tr_b16 a[12:13], v12 offset:10496
    ds_read_b64_tr_b16 a[14:15], v13 offset:10496
    s_waitcnt lgkmcnt(10)
    v_mfma_f32_32x32x16_bf16 v[32:47], a[24:27], a[220:223], v[32:47]
    ds_read_b64_tr_b16 a[16:17], v12 offset:12288
    ds_read_b64_tr_b16 a[18:19], v13 offset:12288
    s_waitcnt lgkmcnt(10)
    v_mfma_f32_32x32x16_bf16 v[48:63], a[28:31], a[220:223], v[48:63]
    ds_read_b64_tr_b16 a[20:21], v12 offset:14336
    ds_read_b64_tr_b16 a[22:23], v13 offset:14336
    s_waitcnt lgkmcnt(10)
    v_mfma_f32_32x32x16_bf16 v[32:47], a[0:3], a[224:227], v[32:47]
    ds_read_b64_tr_b16 a[24:25], v12 offset:12544
    ds_read_b64_tr_b16 a[26:27], v13 offset:12544
    s_waitcnt lgkmcnt(10)
    v_mfma_f32_32x32x16_bf16 v[48:63], a[4:7], a[224:227], v[48:63]
    ds_read_b64_tr_b16 a[28:29], v12 offset:14592
    ds_read_b64_tr_b16 a[30:31], v13 offset:14592
    s_waitcnt lgkmcnt(10)
    v_mfma_f32_32x32x16_bf16 v[32:47], a[8:11], a[228:231], v[32:47]
    s_waitcnt vmcnt(16) lgkmcnt(0)
    s_barrier
    v_add_u32 v12, 147456, v118
    v_xor_b32 v13, 64, v12
    v_add_u32 v22, 0, v119
    ds_read_b64_tr_b16 a[0:1], v12 offset:0
    ds_read_b64_tr_b16 a[2:3], v13 offset:0
    s_add_u32 m0, s46, 98304
    s_add_u32 s33, s45, 2064384
    buffer_load_dwordx4 v112, s[24:27], s33 offen offset:0 lds
    v_mfma_f32_32x32x16_bf16 v[48:63], a[12:15], a[228:231], v[48:63]
    ds_read_b64_tr_b16 a[4:5], v12 offset:2048
    ds_read_b64_tr_b16 a[6:7], v13 offset:2048
    buffer_load_dwordx4 v113, s[24:27], s33 offen offset:1024 lds
    v_mfma_f32_32x32x16_bf16 v[32:47], a[16:19], a[232:235], v[32:47]
    ds_read_b64_tr_b16 a[8:9], v12 offset:256
    ds_read_b64_tr_b16 a[10:11], v13 offset:256
    buffer_load_dwordx4 v112, s[24:27], s33 offen offset:2048 lds
    v_mfma_f32_32x32x16_bf16 v[48:63], a[20:23], a[232:235], v[48:63]
    ds_read_b64_tr_b16 a[12:13], v12 offset:2304
    ds_read_b64_tr_b16 a[14:15], v13 offset:2304
    buffer_load_dwordx4 v113, s[24:27], s33 offen offset:3072 lds
    v_mfma_f32_32x32x16_bf16 v[32:47], a[24:27], a[236:239], v[32:47]
    ds_read_b64_tr_b16 a[16:17], v12 offset:4096
    ds_read_b64_tr_b16 a[18:19], v13 offset:4096
    v_mfma_f32_32x32x16_bf16 v[48:63], a[28:31], a[236:239], v[48:63]
    ds_read_b64_tr_b16 a[20:21], v12 offset:6144
    ds_read_b64_tr_b16 a[22:23], v13 offset:6144
    s_waitcnt lgkmcnt(10)
    v_mfma_f32_32x32x16_bf16 v[32:47], a[0:3], a[240:243], v[32:47]
    ds_read_b64_tr_b16 a[24:25], v12 offset:4352
    ds_read_b64_tr_b16 a[26:27], v13 offset:4352
    s_waitcnt lgkmcnt(10)
    v_mfma_f32_32x32x16_bf16 v[48:63], a[4:7], a[240:243], v[48:63]
    ds_read_b64_tr_b16 a[28:29], v12 offset:6400
    ds_read_b64_tr_b16 a[30:31], v13 offset:6400
    s_waitcnt lgkmcnt(10)
    v_mfma_f32_32x32x16_bf16 v[32:47], a[8:11], a[244:247], v[32:47]
    ds_read_b64_tr_b16 a[0:1], v12 offset:8192
    ds_read_b64_tr_b16 a[2:3], v13 offset:8192
    s_waitcnt lgkmcnt(10)
    v_mfma_f32_32x32x16_bf16 v[48:63], a[12:15], a[244:247], v[48:63]
    ds_read_b64_tr_b16 a[4:5], v12 offset:10240
    ds_read_b64_tr_b16 a[6:7], v13 offset:10240
    s_waitcnt lgkmcnt(10)
    v_mfma_f32_32x32x16_bf16 v[32:47], a[16:19], a[248:251], v[32:47]
    ds_read_b64_tr_b16 a[8:9], v12 offset:8448
    ds_read_b64_tr_b16 a[10:11], v13 offset:8448
    s_waitcnt lgkmcnt(10)
    v_mfma_f32_32x32x16_bf16 v[48:63], a[20:23], a[248:251], v[48:63]
    ds_read_b64_tr_b16 a[12:13], v12 offset:10496
    ds_read_b64_tr_b16 a[14:15], v13 offset:10496
    s_waitcnt lgkmcnt(10)
    v_mfma_f32_32x32x16_bf16 v[32:47], a[24:27], a[252:255], v[32:47]
    ds_read_b64_tr_b16 a[16:17], v12 offset:12288
    ds_read_b64_tr_b16 a[18:19], v13 offset:12288
    s_waitcnt lgkmcnt(10)
    v_mfma_f32_32x32x16_bf16 v[48:63], a[28:31], a[252:255], v[48:63]
    ds_read_b64_tr_b16 a[20:21], v12 offset:14336
    ds_read_b64_tr_b16 a[22:23], v13 offset:14336
    s_waitcnt lgkmcnt(10)
    v_mfma_f32_32x32x16_bf16 v[32:47], a[0:3], v[144:147], v[32:47]
    ds_read_b64_tr_b16 a[24:25], v12 offset:12544
    ds_read_b64_tr_b16 a[26:27], v13 offset:12544
    s_waitcnt lgkmcnt(10)
    v_mfma_f32_32x32x16_bf16 v[48:63], a[4:7], v[144:147], v[48:63]
    ds_read_b64_tr_b16 a[28:29], v12 offset:14592
    ds_read_b64_tr_b16 a[30:31], v13 offset:14592
    s_waitcnt lgkmcnt(10)
    v_mfma_f32_32x32x16_bf16 v[32:47], a[8:11], v[148:151], v[32:47]
    s_waitcnt vmcnt(16) lgkmcnt(0)
    s_barrier
    v_add_u32 v12, 0, v118
    v_xor_b32 v13, 64, v12
    v_add_u32 v22, 49152, v119
    ds_read_b64_tr_b16 a[0:1], v12 offset:0
    ds_read_b64_tr_b16 a[2:3], v13 offset:0
    s_add_u32 m0, s46, 147456
    s_add_u32 s33, s45, 2293760
    buffer_load_dwordx4 v112, s[24:27], s33 offen offset:0 lds
    v_mfma_f32_32x32x16_bf16 v[48:63], a[12:15], v[148:151], v[48:63]
    ds_read_b64_tr_b16 a[4:5], v12 offset:2048
    ds_read_b64_tr_b16 a[6:7], v13 offset:2048
    buffer_load_dwordx4 v113, s[24:27], s33 offen offset:1024 lds
    v_mfma_f32_32x32x16_bf16 v[32:47], a[16:19], v[152:155], v[32:47]
    ds_read_b64_tr_b16 a[8:9], v12 offset:256
    ds_read_b64_tr_b16 a[10:11], v13 offset:256
    buffer_load_dwordx4 v112, s[24:27], s33 offen offset:2048 lds
    v_mfma_f32_32x32x16_bf16 v[48:63], a[20:23], v[152:155], v[48:63]
    ds_read_b64_tr_b16 a[12:13], v12 offset:2304
    ds_read_b64_tr_b16 a[14:15], v13 offset:2304
    buffer_load_dwordx4 v113, s[24:27], s33 offen offset:3072 lds
    v_mfma_f32_32x32x16_bf16 v[32:47], a[24:27], v[156:159], v[32:47]
    ds_read_b64_tr_b16 a[16:17], v12 offset:4096
    ds_read_b64_tr_b16 a[18:19], v13 offset:4096
    s_add_u32 m0, s53, 0
    s_add_u32 s33, s44, 3840
    buffer_load_dwordx4 v114, s[12:15], s33 offen offset:0 lds
    v_mfma_f32_32x32x16_bf16 v[48:63], a[28:31], v[156:159], v[48:63]
    ds_read_b64_tr_b16 a[20:21], v12 offset:6144
    ds_read_b64_tr_b16 a[22:23], v13 offset:6144
    buffer_load_dwordx4 v115, s[12:15], s33 offen offset:1024 lds
    s_waitcnt lgkmcnt(10)
    v_mfma_f32_32x32x16_bf16 v[32:47], a[0:3], v[160:163], v[32:47]
    ds_read_b64_tr_b16 a[24:25], v12 offset:4352
    ds_read_b64_tr_b16 a[26:27], v13 offset:4352
    buffer_load_dwordx4 v116, s[12:15], s33 offen offset:2048 lds
    s_waitcnt lgkmcnt(10)
    v_mfma_f32_32x32x16_bf16 v[48:63], a[4:7], v[160:163], v[48:63]
    ds_read_b64_tr_b16 a[28:29], v12 offset:6400
    ds_read_b64_tr_b16 a[30:31], v13 offset:6400
    buffer_load_dwordx4 v117, s[12:15], s33 offen offset:3072 lds
    s_waitcnt lgkmcnt(10)
    v_mfma_f32_32x32x16_bf16 v[32:47], a[8:11], v[164:167], v[32:47]
    ds_read_b64_tr_b16 a[0:1], v12 offset:8192
    ds_read_b64_tr_b16 a[2:3], v13 offset:8192
    s_add_u32 m0, s53, 4096
    s_add_u32 s33, s44, 69376
    buffer_load_dwordx4 v114, s[12:15], s33 offen offset:0 lds
    s_waitcnt lgkmcnt(10)
    v_mfma_f32_32x32x16_bf16 v[48:63], a[12:15], v[164:167], v[48:63]
    ds_read_b64_tr_b16 a[4:5], v12 offset:10240
    ds_read_b64_tr_b16 a[6:7], v13 offset:10240
    buffer_load_dwordx4 v115, s[12:15], s33 offen offset:1024 lds
    s_waitcnt lgkmcnt(10)
    v_mfma_f32_32x32x16_bf16 v[32:47], a[16:19], v[168:171], v[32:47]
    ds_read_b64_tr_b16 a[8:9], v12 offset:8448
    ds_read_b64_tr_b16 a[10:11], v13 offset:8448
    buffer_load_dwordx4 v116, s[12:15], s33 offen offset:2048 lds
    s_waitcnt lgkmcnt(10)
    v_mfma_f32_32x32x16_bf16 v[48:63], a[20:23], v[168:171], v[48:63]
    ds_read_b64_tr_b16 a[12:13], v12 offset:10496
    ds_read_b64_tr_b16 a[14:15], v13 offset:10496
    buffer_load_dwordx4 v117, s[12:15], s33 offen offset:3072 lds
    s_waitcnt lgkmcnt(10)
    v_mfma_f32_32x32x16_bf16 v[32:47], a[24:27], v[172:175], v[32:47]
    ds_read_b64_tr_b16 a[16:17], v12 offset:12288
    ds_read_b64_tr_b16 a[18:19], v13 offset:12288
    s_waitcnt lgkmcnt(10)
    v_mfma_f32_32x32x16_bf16 v[48:63], a[28:31], v[172:175], v[48:63]
    ds_read_b64_tr_b16 a[20:21], v12 offset:14336
    ds_read_b64_tr_b16 a[22:23], v13 offset:14336
    s_waitcnt lgkmcnt(10)
    v_mfma_f32_32x32x16_bf16 v[32:47], a[0:3], v[176:179], v[32:47]
    ds_read_b64_tr_b16 a[24:25], v12 offset:12544
    ds_read_b64_tr_b16 a[26:27], v13 offset:12544
    s_waitcnt lgkmcnt(10)
    v_mfma_f32_32x32x16_bf16 v[48:63], a[4:7], v[176:179], v[48:63]
    ds_read_b64_tr_b16 a[28:29], v12 offset:14592
    ds_read_b64_tr_b16 a[30:31], v13 offset:14592
    s_waitcnt lgkmcnt(10)
    v_mfma_f32_32x32x16_bf16 v[32:47], a[8:11], v[180:183], v[32:47]
    s_waitcnt vmcnt(16) lgkmcnt(0)
    s_barrier
    v_add_u32 v12, 49152, v118
    v_xor_b32 v13, 64, v12
    v_add_u32 v22, 98304, v119
    ds_read_b64_tr_b16 a[0:1], v12 offset:0
    ds_read_b64_tr_b16 a[2:3], v13 offset:0
    s_add_u32 m0, s46, 0
    s_add_u32 s33, s45, 2523136
    buffer_load_dwordx4 v112, s[24:27], s33 offen offset:0 lds
    v_mfma_f32_32x32x16_bf16 v[48:63], a[12:15], v[180:183], v[48:63]
    ds_read_b64_tr_b16 a[4:5], v12 offset:2048
    ds_read_b64_tr_b16 a[6:7], v13 offset:2048
    buffer_load_dwordx4 v113, s[24:27], s33 offen offset:1024 lds
    v_mfma_f32_32x32x16_bf16 v[32:47], a[16:19], v[184:187], v[32:47]
    ds_read_b64_tr_b16 a[8:9], v12 offset:256
    ds_read_b64_tr_b16 a[10:11], v13 offset:256
    buffer_load_dwordx4 v112, s[24:27], s33 offen offset:2048 lds
    v_mfma_f32_32x32x16_bf16 v[48:63], a[20:23], v[184:187], v[48:63]
    ds_read_b64_tr_b16 a[12:13], v12 offset:2304
    ds_read_b64_tr_b16 a[14:15], v13 offset:2304
    buffer_load_dwordx4 v113, s[24:27], s33 offen offset:3072 lds
    v_mfma_f32_32x32x16_bf16 v[32:47], a[24:27], v[188:191], v[32:47]
    ds_read_b64_tr_b16 a[16:17], v12 offset:4096
    ds_read_b64_tr_b16 a[18:19], v13 offset:4096
    v_mfma_f32_32x32x16_bf16 v[48:63], a[28:31], v[188:191], v[48:63]
    ds_read_b64_tr_b16 a[20:21], v12 offset:6144
    ds_read_b64_tr_b16 a[22:23], v13 offset:6144
    s_waitcnt lgkmcnt(10)
    v_mfma_f32_32x32x16_bf16 v[32:47], a[0:3], v[192:195], v[32:47]
    ds_read_b64_tr_b16 a[24:25], v12 offset:4352
    ds_read_b64_tr_b16 a[26:27], v13 offset:4352
    s_waitcnt lgkmcnt(10)
    v_mfma_f32_32x32x16_bf16 v[48:63], a[4:7], v[192:195], v[48:63]
    ds_read_b64_tr_b16 a[28:29], v12 offset:6400
    ds_read_b64_tr_b16 a[30:31], v13 offset:6400
    s_waitcnt lgkmcnt(10)
    v_mfma_f32_32x32x16_bf16 v[32:47], a[8:11], v[196:199], v[32:47]
    ds_read_b64_tr_b16 a[0:1], v12 offset:8192
    ds_read_b64_tr_b16 a[2:3], v13 offset:8192
    s_waitcnt lgkmcnt(10)
    v_mfma_f32_32x32x16_bf16 v[48:63], a[12:15], v[196:199], v[48:63]
    ds_read_b64_tr_b16 a[4:5], v12 offset:10240
    ds_read_b64_tr_b16 a[6:7], v13 offset:10240
    s_waitcnt lgkmcnt(10)
    v_mfma_f32_32x32x16_bf16 v[32:47], a[16:19], v[200:203], v[32:47]
    ds_read_b64_tr_b16 a[8:9], v12 offset:8448
    ds_read_b64_tr_b16 a[10:11], v13 offset:8448
    s_waitcnt lgkmcnt(10)
    v_mfma_f32_32x32x16_bf16 v[48:63], a[20:23], v[200:203], v[48:63]
    ds_read_b64_tr_b16 a[12:13], v12 offset:10496
    ds_read_b64_tr_b16 a[14:15], v13 offset:10496
    s_waitcnt lgkmcnt(10)
    v_mfma_f32_32x32x16_bf16 v[32:47], a[24:27], v[204:207], v[32:47]
    ds_read_b64_tr_b16 a[16:17], v12 offset:12288
    ds_read_b64_tr_b16 a[18:19], v13 offset:12288
    s_waitcnt lgkmcnt(10)
    v_mfma_f32_32x32x16_bf16 v[48:63], a[28:31], v[204:207], v[48:63]
    ds_read_b64_tr_b16 a[20:21], v12 offset:14336
    ds_read_b64_tr_b16 a[22:23], v13 offset:14336
    s_waitcnt lgkmcnt(10)
    v_mfma_f32_32x32x16_bf16 v[32:47], a[0:3], v[208:211], v[32:47]
    ds_read_b64_tr_b16 a[24:25], v12 offset:12544
    ds_read_b64_tr_b16 a[26:27], v13 offset:12544
    s_waitcnt lgkmcnt(10)
    v_mfma_f32_32x32x16_bf16 v[48:63], a[4:7], v[208:211], v[48:63]
    ds_read_b64_tr_b16 a[28:29], v12 offset:14592
    ds_read_b64_tr_b16 a[30:31], v13 offset:14592
    s_waitcnt lgkmcnt(10)
    v_mfma_f32_32x32x16_bf16 v[32:47], a[8:11], v[212:215], v[32:47]
    s_waitcnt vmcnt(16) lgkmcnt(0)
    s_barrier
    v_add_u32 v12, 98304, v118
    v_xor_b32 v13, 64, v12
    v_add_u32 v22, 0, v119
    ds_read_b64_tr_b16 a[0:1], v12 offset:0
    ds_read_b64_tr_b16 a[2:3], v13 offset:0
    s_add_u32 m0, s46, 49152
    s_add_u32 s33, s45, 2752512
    buffer_load_dwordx4 v112, s[24:27], s33 offen offset:0 lds
    v_mfma_f32_32x32x16_bf16 v[48:63], a[12:15], v[212:215], v[48:63]
    ds_read_b64_tr_b16 a[4:5], v12 offset:2048
    ds_read_b64_tr_b16 a[6:7], v13 offset:2048
    buffer_load_dwordx4 v113, s[24:27], s33 offen offset:1024 lds
    v_mfma_f32_32x32x16_bf16 v[32:47], a[16:19], v[216:219], v[32:47]
    ds_read_b64_tr_b16 a[8:9], v12 offset:256
    ds_read_b64_tr_b16 a[10:11], v13 offset:256
    buffer_load_dwordx4 v112, s[24:27], s33 offen offset:2048 lds
    v_mfma_f32_32x32x16_bf16 v[48:63], a[20:23], v[216:219], v[48:63]
    ds_read_b64_tr_b16 a[12:13], v12 offset:2304
    ds_read_b64_tr_b16 a[14:15], v13 offset:2304
    buffer_load_dwordx4 v113, s[24:27], s33 offen offset:3072 lds
    v_mfma_f32_32x32x16_bf16 v[32:47], a[24:27], v[220:223], v[32:47]
    ds_read_b64_tr_b16 a[16:17], v12 offset:4096
    ds_read_b64_tr_b16 a[18:19], v13 offset:4096
    v_mfma_f32_32x32x16_bf16 v[48:63], a[28:31], v[220:223], v[48:63]
    ds_read_b64_tr_b16 a[20:21], v12 offset:6144
    ds_read_b64_tr_b16 a[22:23], v13 offset:6144
    s_waitcnt lgkmcnt(10)
    v_mfma_f32_32x32x16_bf16 v[32:47], a[0:3], v[224:227], v[32:47]
    ds_read_b64_tr_b16 a[24:25], v12 offset:4352
    ds_read_b64_tr_b16 a[26:27], v13 offset:4352
    s_waitcnt lgkmcnt(10)
    v_mfma_f32_32x32x16_bf16 v[48:63], a[4:7], v[224:227], v[48:63]
    ds_read_b64_tr_b16 a[28:29], v12 offset:6400
    ds_read_b64_tr_b16 a[30:31], v13 offset:6400
    s_waitcnt lgkmcnt(10)
    v_mfma_f32_32x32x16_bf16 v[32:47], a[8:11], v[228:231], v[32:47]
    ds_read_b64_tr_b16 a[0:1], v12 offset:8192
    ds_read_b64_tr_b16 a[2:3], v13 offset:8192
    s_waitcnt lgkmcnt(10)
    v_mfma_f32_32x32x16_bf16 v[48:63], a[12:15], v[228:231], v[48:63]
    ds_read_b64_tr_b16 a[4:5], v12 offset:10240
    ds_read_b64_tr_b16 a[6:7], v13 offset:10240
    s_waitcnt lgkmcnt(10)
    v_mfma_f32_32x32x16_bf16 v[32:47], a[16:19], v[232:235], v[32:47]
    ds_read_b64_tr_b16 a[8:9], v12 offset:8448
    ds_read_b64_tr_b16 a[10:11], v13 offset:8448
    s_waitcnt lgkmcnt(10)
    v_mfma_f32_32x32x16_bf16 v[48:63], a[20:23], v[232:235], v[48:63]
    ds_read_b64_tr_b16 a[12:13], v12 offset:10496
    ds_read_b64_tr_b16 a[14:15], v13 offset:10496
    s_waitcnt lgkmcnt(10)
    v_mfma_f32_32x32x16_bf16 v[32:47], a[24:27], v[236:239], v[32:47]
    ds_read_b64_tr_b16 a[16:17], v12 offset:12288
    ds_read_b64_tr_b16 a[18:19], v13 offset:12288
    s_waitcnt lgkmcnt(10)
    v_mfma_f32_32x32x16_bf16 v[48:63], a[28:31], v[236:239], v[48:63]
    ds_read_b64_tr_b16 a[20:21], v12 offset:14336
    ds_read_b64_tr_b16 a[22:23], v13 offset:14336
    s_waitcnt lgkmcnt(10)
    v_mfma_f32_32x32x16_bf16 v[32:47], a[0:3], v[240:243], v[32:47]
    ds_read_b64_tr_b16 a[24:25], v12 offset:12544
    ds_read_b64_tr_b16 a[26:27], v13 offset:12544
    s_waitcnt lgkmcnt(10)
    v_mfma_f32_32x32x16_bf16 v[48:63], a[4:7], v[240:243], v[48:63]
    ds_read_b64_tr_b16 a[28:29], v12 offset:14592
    ds_read_b64_tr_b16 a[30:31], v13 offset:14592
    s_waitcnt lgkmcnt(10)
    v_mfma_f32_32x32x16_bf16 v[32:47], a[8:11], v[244:247], v[32:47]
    s_waitcnt vmcnt(16) lgkmcnt(0)
    s_barrier
    v_add_u32 v12, 147456, v118
    v_xor_b32 v13, 64, v12
    v_add_u32 v22, 49152, v119
    ds_read_b64_tr_b16 a[0:1], v12 offset:0
    ds_read_b64_tr_b16 a[2:3], v13 offset:0
    s_add_u32 m0, s46, 98304
    s_add_u32 s33, s45, 2981888
    buffer_load_dwordx4 v112, s[24:27], s33 offen offset:0 lds
    v_mfma_f32_32x32x16_bf16 v[48:63], a[12:15], v[244:247], v[48:63]
    ds_read_b64_tr_b16 a[4:5], v12 offset:2048
    ds_read_b64_tr_b16 a[6:7], v13 offset:2048
    buffer_load_dwordx4 v113, s[24:27], s33 offen offset:1024 lds
    v_mfma_f32_32x32x16_bf16 v[32:47], a[16:19], v[248:251], v[32:47]
    ds_read_b64_tr_b16 a[8:9], v12 offset:256
    ds_read_b64_tr_b16 a[10:11], v13 offset:256
    buffer_load_dwordx4 v112, s[24:27], s33 offen offset:2048 lds
    v_mfma_f32_32x32x16_bf16 v[48:63], a[20:23], v[248:251], v[48:63]
    ds_read_b64_tr_b16 a[12:13], v12 offset:2304
    ds_read_b64_tr_b16 a[14:15], v13 offset:2304
    buffer_load_dwordx4 v113, s[24:27], s33 offen offset:3072 lds
    v_mfma_f32_32x32x16_bf16 v[32:47], a[24:27], v[252:255], v[32:47]
    ds_read_b64_tr_b16 a[16:17], v12 offset:4096
    ds_read_b64_tr_b16 a[18:19], v13 offset:4096
    v_mfma_f32_32x32x16_bf16 v[48:63], a[28:31], v[252:255], v[48:63]
    ds_read_b64_tr_b16 a[20:21], v12 offset:6144
    ds_read_b64_tr_b16 a[22:23], v13 offset:6144
    s_waitcnt lgkmcnt(10)
    v_mfma_f32_32x32x16_bf16 v[32:47], a[0:3], a[48:51], v[32:47]
    ds_read_b64_tr_b16 a[24:25], v12 offset:4352
    ds_read_b64_tr_b16 a[26:27], v13 offset:4352
    s_waitcnt lgkmcnt(10)
    v_mfma_f32_32x32x16_bf16 v[48:63], a[4:7], a[48:51], v[48:63]
    ds_read_b64_tr_b16 a[28:29], v12 offset:6400
    ds_read_b64_tr_b16 a[30:31], v13 offset:6400
    s_waitcnt lgkmcnt(10)
    v_mfma_f32_32x32x16_bf16 v[32:47], a[8:11], a[52:55], v[32:47]
    ds_read_b64_tr_b16 a[0:1], v12 offset:8192
    ds_read_b64_tr_b16 a[2:3], v13 offset:8192
    s_waitcnt lgkmcnt(10)
    v_mfma_f32_32x32x16_bf16 v[48:63], a[12:15], a[52:55], v[48:63]
    ds_read_b64_tr_b16 a[4:5], v12 offset:10240
    ds_read_b64_tr_b16 a[6:7], v13 offset:10240
    s_waitcnt lgkmcnt(10)
    v_mfma_f32_32x32x16_bf16 v[32:47], a[16:19], a[56:59], v[32:47]
    ds_read_b64_tr_b16 a[8:9], v12 offset:8448
    ds_read_b64_tr_b16 a[10:11], v13 offset:8448
    s_waitcnt lgkmcnt(10)
    v_mfma_f32_32x32x16_bf16 v[48:63], a[20:23], a[56:59], v[48:63]
    ds_read_b64_tr_b16 a[12:13], v12 offset:10496
    ds_read_b64_tr_b16 a[14:15], v13 offset:10496
    s_waitcnt lgkmcnt(10)
    v_mfma_f32_32x32x16_bf16 v[32:47], a[24:27], a[60:63], v[32:47]
    ds_read_b64_tr_b16 a[16:17], v12 offset:12288
    ds_read_b64_tr_b16 a[18:19], v13 offset:12288
    s_waitcnt lgkmcnt(10)
    v_mfma_f32_32x32x16_bf16 v[48:63], a[28:31], a[60:63], v[48:63]
    ds_read_b64_tr_b16 a[20:21], v12 offset:14336
    ds_read_b64_tr_b16 a[22:23], v13 offset:14336
    s_waitcnt lgkmcnt(10)
    v_mfma_f32_32x32x16_bf16 v[32:47], a[0:3], a[64:67], v[32:47]
    ds_read_b64_tr_b16 a[24:25], v12 offset:12544
    ds_read_b64_tr_b16 a[26:27], v13 offset:12544
    s_waitcnt lgkmcnt(10)
    v_mfma_f32_32x32x16_bf16 v[48:63], a[4:7], a[64:67], v[48:63]
    ds_read_b64_tr_b16 a[28:29], v12 offset:14592
    ds_read_b64_tr_b16 a[30:31], v13 offset:14592
    s_waitcnt lgkmcnt(10)
    v_mfma_f32_32x32x16_bf16 v[32:47], a[8:11], a[68:71], v[32:47]
    s_waitcnt vmcnt(8) lgkmcnt(0)
    s_barrier
    v_add_u32 v12, 0, v118
    v_xor_b32 v13, 64, v12
    v_add_u32 v22, 98304, v119
    ds_read_b64_tr_b16 a[0:1], v12 offset:0
    ds_read_b64_tr_b16 a[2:3], v13 offset:0
    s_add_u32 m0, s46, 147456
    s_add_u32 s33, s45, 3211264
    buffer_load_dwordx4 v112, s[24:27], s33 offen offset:0 lds
    v_mfma_f32_32x32x16_bf16 v[48:63], a[12:15], a[68:71], v[48:63]
    ds_read_b64_tr_b16 a[4:5], v12 offset:2048
    ds_read_b64_tr_b16 a[6:7], v13 offset:2048
    buffer_load_dwordx4 v113, s[24:27], s33 offen offset:1024 lds
    v_mfma_f32_32x32x16_bf16 v[32:47], a[16:19], a[72:75], v[32:47]
    ds_read_b64_tr_b16 a[8:9], v12 offset:256
    ds_read_b64_tr_b16 a[10:11], v13 offset:256
    buffer_load_dwordx4 v112, s[24:27], s33 offen offset:2048 lds
    v_mfma_f32_32x32x16_bf16 v[48:63], a[20:23], a[72:75], v[48:63]
    ds_read_b64_tr_b16 a[12:13], v12 offset:2304
    ds_read_b64_tr_b16 a[14:15], v13 offset:2304
    buffer_load_dwordx4 v113, s[24:27], s33 offen offset:3072 lds
    v_mfma_f32_32x32x16_bf16 v[32:47], a[24:27], a[76:79], v[32:47]
    ds_read_b64_tr_b16 a[16:17], v12 offset:4096
    ds_read_b64_tr_b16 a[18:19], v13 offset:4096
    v_mfma_f32_32x32x16_bf16 v[48:63], a[28:31], a[76:79], v[48:63]
    ds_read_b64_tr_b16 a[20:21], v12 offset:6144
    ds_read_b64_tr_b16 a[22:23], v13 offset:6144
    s_waitcnt lgkmcnt(10)
    v_mfma_f32_32x32x16_bf16 v[32:47], a[0:3], a[80:83], v[32:47]
    ds_read_b64_tr_b16 a[24:25], v12 offset:4352
    ds_read_b64_tr_b16 a[26:27], v13 offset:4352
    s_waitcnt lgkmcnt(10)
    v_mfma_f32_32x32x16_bf16 v[48:63], a[4:7], a[80:83], v[48:63]
    ds_read_b64_tr_b16 a[28:29], v12 offset:6400
    ds_read_b64_tr_b16 a[30:31], v13 offset:6400
    s_waitcnt lgkmcnt(10)
    v_mfma_f32_32x32x16_bf16 v[32:47], a[8:11], a[84:87], v[32:47]
    ds_read_b64_tr_b16 a[0:1], v12 offset:8192
    ds_read_b64_tr_b16 a[2:3], v13 offset:8192
    s_waitcnt lgkmcnt(10)
    v_mfma_f32_32x32x16_bf16 v[48:63], a[12:15], a[84:87], v[48:63]
    ds_read_b64_tr_b16 a[4:5], v12 offset:10240
    ds_read_b64_tr_b16 a[6:7], v13 offset:10240
    s_waitcnt lgkmcnt(10)
    v_mfma_f32_32x32x16_bf16 v[32:47], a[16:19], a[88:91], v[32:47]
    ds_read_b64_tr_b16 a[8:9], v12 offset:8448
    ds_read_b64_tr_b16 a[10:11], v13 offset:8448
    s_waitcnt lgkmcnt(10)
    v_mfma_f32_32x32x16_bf16 v[48:63], a[20:23], a[88:91], v[48:63]
    ds_read_b64_tr_b16 a[12:13], v12 offset:10496
    ds_read_b64_tr_b16 a[14:15], v13 offset:10496
    s_waitcnt lgkmcnt(10)
    v_mfma_f32_32x32x16_bf16 v[32:47], a[24:27], a[92:95], v[32:47]
    ds_read_b64_tr_b16 a[16:17], v12 offset:12288
    ds_read_b64_tr_b16 a[18:19], v13 offset:12288
    s_waitcnt lgkmcnt(10)
    v_mfma_f32_32x32x16_bf16 v[48:63], a[28:31], a[92:95], v[48:63]
    ds_read_b64_tr_b16 a[20:21], v12 offset:14336
    ds_read_b64_tr_b16 a[22:23], v13 offset:14336
    s_waitcnt lgkmcnt(10)
    v_mfma_f32_32x32x16_bf16 v[32:47], a[0:3], a[96:99], v[32:47]
    ds_read_b64_tr_b16 a[24:25], v12 offset:12544
    ds_read_b64_tr_b16 a[26:27], v13 offset:12544
    s_waitcnt lgkmcnt(10)
    v_mfma_f32_32x32x16_bf16 v[48:63], a[4:7], a[96:99], v[48:63]
    ds_read_b64_tr_b16 a[28:29], v12 offset:14592
    ds_read_b64_tr_b16 a[30:31], v13 offset:14592
    s_waitcnt lgkmcnt(10)
    v_mfma_f32_32x32x16_bf16 v[32:47], a[8:11], a[100:103], v[32:47]
    s_waitcnt vmcnt(8) lgkmcnt(0)
    s_barrier
    v_add_u32 v12, 49152, v118
    v_xor_b32 v13, 64, v12
    v_add_u32 v22, 0, v119
    ds_read_b64_tr_b16 a[0:1], v12 offset:0
    ds_read_b64_tr_b16 a[2:3], v13 offset:0
    s_add_u32 m0, s46, 0
    s_add_u32 s33, s45, 3440640
    buffer_load_dwordx4 v112, s[24:27], s33 offen offset:0 lds
    v_mfma_f32_32x32x16_bf16 v[48:63], a[12:15], a[100:103], v[48:63]
    ds_read_b64_tr_b16 a[4:5], v12 offset:2048
    ds_read_b64_tr_b16 a[6:7], v13 offset:2048
    buffer_load_dwordx4 v113, s[24:27], s33 offen offset:1024 lds
    v_mfma_f32_32x32x16_bf16 v[32:47], a[16:19], a[104:107], v[32:47]
    ds_read_b64_tr_b16 a[8:9], v12 offset:256
    ds_read_b64_tr_b16 a[10:11], v13 offset:256
    buffer_load_dwordx4 v112, s[24:27], s33 offen offset:2048 lds
    v_mfma_f32_32x32x16_bf16 v[48:63], a[20:23], a[104:107], v[48:63]
    ds_read_b64_tr_b16 a[12:13], v12 offset:2304
    ds_read_b64_tr_b16 a[14:15], v13 offset:2304
    buffer_load_dwordx4 v113, s[24:27], s33 offen offset:3072 lds
    v_mfma_f32_32x32x16_bf16 v[32:47], a[24:27], a[108:111], v[32:47]
    ds_read_b64_tr_b16 a[16:17], v12 offset:4096
    ds_read_b64_tr_b16 a[18:19], v13 offset:4096
    v_mfma_f32_32x32x16_bf16 v[48:63], a[28:31], a[108:111], v[48:63]
    ds_read_b64_tr_b16 a[20:21], v12 offset:6144
    ds_read_b64_tr_b16 a[22:23], v13 offset:6144
    s_waitcnt lgkmcnt(10)
    v_mfma_f32_32x32x16_bf16 v[32:47], a[0:3], a[112:115], v[32:47]
    ds_read_b64_tr_b16 a[24:25], v12 offset:4352
    ds_read_b64_tr_b16 a[26:27], v13 offset:4352
    s_waitcnt lgkmcnt(10)
    v_mfma_f32_32x32x16_bf16 v[48:63], a[4:7], a[112:115], v[48:63]
    ds_read_b64_tr_b16 a[28:29], v12 offset:6400
    ds_read_b64_tr_b16 a[30:31], v13 offset:6400
    s_waitcnt lgkmcnt(10)
    v_mfma_f32_32x32x16_bf16 v[32:47], a[8:11], a[116:119], v[32:47]
    ds_read_b64_tr_b16 a[0:1], v12 offset:8192
    ds_read_b64_tr_b16 a[2:3], v13 offset:8192
    s_waitcnt lgkmcnt(10)
    v_mfma_f32_32x32x16_bf16 v[48:63], a[12:15], a[116:119], v[48:63]
    ds_read_b64_tr_b16 a[4:5], v12 offset:10240
    ds_read_b64_tr_b16 a[6:7], v13 offset:10240
    s_waitcnt lgkmcnt(10)
    v_mfma_f32_32x32x16_bf16 v[32:47], a[16:19], a[120:123], v[32:47]
    ds_read_b64_tr_b16 a[8:9], v12 offset:8448
    ds_read_b64_tr_b16 a[10:11], v13 offset:8448
    s_waitcnt lgkmcnt(10)
    v_mfma_f32_32x32x16_bf16 v[48:63], a[20:23], a[120:123], v[48:63]
    ds_read_b64_tr_b16 a[12:13], v12 offset:10496
    ds_read_b64_tr_b16 a[14:15], v13 offset:10496
    s_waitcnt lgkmcnt(10)
    v_mfma_f32_32x32x16_bf16 v[32:47], a[24:27], a[124:127], v[32:47]
    ds_read_b64_tr_b16 a[16:17], v12 offset:12288
    ds_read_b64_tr_b16 a[18:19], v13 offset:12288
    s_waitcnt lgkmcnt(10)
    v_mfma_f32_32x32x16_bf16 v[48:63], a[28:31], a[124:127], v[48:63]
    ds_read_b64_tr_b16 a[20:21], v12 offset:14336
    ds_read_b64_tr_b16 a[22:23], v13 offset:14336
    s_waitcnt lgkmcnt(10)
    v_mfma_f32_32x32x16_bf16 v[32:47], a[0:3], a[128:131], v[32:47]
    ds_read_b64_tr_b16 a[24:25], v12 offset:12544
    ds_read_b64_tr_b16 a[26:27], v13 offset:12544
    s_waitcnt lgkmcnt(10)
    v_mfma_f32_32x32x16_bf16 v[48:63], a[4:7], a[128:131], v[48:63]
    ds_read_b64_tr_b16 a[28:29], v12 offset:14592
    ds_read_b64_tr_b16 a[30:31], v13 offset:14592
    s_waitcnt lgkmcnt(10)
    v_mfma_f32_32x32x16_bf16 v[32:47], a[8:11], a[132:135], v[32:47]
    s_waitcnt vmcnt(8) lgkmcnt(0)
    s_barrier
    v_add_u32 v12, 98304, v118
    v_xor_b32 v13, 64, v12
    v_add_u32 v22, 49152, v119
    ds_read_b64_tr_b16 a[0:1], v12 offset:0
    ds_read_b64_tr_b16 a[2:3], v13 offset:0
    v_mfma_f32_32x32x16_bf16 v[48:63], a[12:15], a[132:135], v[48:63]
    ds_read_b64_tr_b16 a[4:5], v12 offset:2048
    ds_read_b64_tr_b16 a[6:7], v13 offset:2048
    v_mfma_f32_32x32x16_bf16 v[32:47], a[16:19], a[136:139], v[32:47]
    ds_read_b64_tr_b16 a[8:9], v12 offset:256
    ds_read_b64_tr_b16 a[10:11], v13 offset:256
    v_mfma_f32_32x32x16_bf16 v[48:63], a[20:23], a[136:139], v[48:63]
    ds_read_b64_tr_b16 a[12:13], v12 offset:2304
    ds_read_b64_tr_b16 a[14:15], v13 offset:2304
    v_mfma_f32_32x32x16_bf16 v[32:47], a[24:27], a[140:143], v[32:47]
    ds_read_b64_tr_b16 a[16:17], v12 offset:4096
    ds_read_b64_tr_b16 a[18:19], v13 offset:4096
    v_mfma_f32_32x32x16_bf16 v[48:63], a[28:31], a[140:143], v[48:63]
    ds_read_b64_tr_b16 a[20:21], v12 offset:6144
    ds_read_b64_tr_b16 a[22:23], v13 offset:6144
    s_waitcnt lgkmcnt(10)
    v_mfma_f32_32x32x16_bf16 v[32:47], a[0:3], v[64:67], v[32:47]
    ds_read_b64_tr_b16 a[24:25], v12 offset:4352
    ds_read_b64_tr_b16 a[26:27], v13 offset:4352
    s_waitcnt lgkmcnt(10)
    v_mfma_f32_32x32x16_bf16 v[48:63], a[4:7], v[64:67], v[48:63]
    ds_read_b64_tr_b16 a[28:29], v12 offset:6400
    ds_read_b64_tr_b16 a[30:31], v13 offset:6400
    s_waitcnt lgkmcnt(10)
    v_mfma_f32_32x32x16_bf16 v[32:47], a[8:11], v[68:71], v[32:47]
    ds_read_b64_tr_b16 a[0:1], v12 offset:8192
    ds_read_b64_tr_b16 a[2:3], v13 offset:8192
    s_waitcnt lgkmcnt(10)
    v_mfma_f32_32x32x16_bf16 v[48:63], a[12:15], v[68:71], v[48:63]
    ds_read_b64_tr_b16 a[4:5], v12 offset:10240
    ds_read_b64_tr_b16 a[6:7], v13 offset:10240
    s_waitcnt lgkmcnt(10)
    v_mfma_f32_32x32x16_bf16 v[32:47], a[16:19], v[72:75], v[32:47]
    ds_read_b64_tr_b16 a[8:9], v12 offset:8448
    ds_read_b64_tr_b16 a[10:11], v13 offset:8448
    s_waitcnt lgkmcnt(10)
    v_mfma_f32_32x32x16_bf16 v[48:63], a[20:23], v[72:75], v[48:63]
    ds_read_b64_tr_b16 a[12:13], v12 offset:10496
    ds_read_b64_tr_b16 a[14:15], v13 offset:10496
    s_waitcnt lgkmcnt(10)
    v_mfma_f32_32x32x16_bf16 v[32:47], a[24:27], v[76:79], v[32:47]
    ds_read_b64_tr_b16 a[16:17], v12 offset:12288
    ds_read_b64_tr_b16 a[18:19], v13 offset:12288
    s_waitcnt lgkmcnt(10)
    v_mfma_f32_32x32x16_bf16 v[48:63], a[28:31], v[76:79], v[48:63]
    ds_read_b64_tr_b16 a[20:21], v12 offset:14336
    ds_read_b64_tr_b16 a[22:23], v13 offset:14336
    s_waitcnt lgkmcnt(10)
    v_mfma_f32_32x32x16_bf16 v[32:47], a[0:3], v[80:83], v[32:47]
    ds_read_b64_tr_b16 a[24:25], v12 offset:12544
    ds_read_b64_tr_b16 a[26:27], v13 offset:12544
    s_waitcnt lgkmcnt(10)
    v_mfma_f32_32x32x16_bf16 v[48:63], a[4:7], v[80:83], v[48:63]
    ds_read_b64_tr_b16 a[28:29], v12 offset:14592
    ds_read_b64_tr_b16 a[30:31], v13 offset:14592
    s_waitcnt lgkmcnt(10)
    v_mfma_f32_32x32x16_bf16 v[32:47], a[8:11], v[84:87], v[32:47]
    s_waitcnt vmcnt(4) lgkmcnt(0)
    s_barrier
    v_add_u32 v12, 147456, v118
    v_xor_b32 v13, 64, v12
    v_add_u32 v22, 98304, v119
    v_xor_b32 v14, 0, v22
    ds_read_b128 a[32:35], v14
    ds_read_b64_tr_b16 a[0:1], v12 offset:0
    ds_read_b64_tr_b16 a[2:3], v13 offset:0
    s_add_u32 m0, s42, 49152
    s_add_u32 s33, s50, 0
    buffer_load_dwordx4 v3, s[20:23], s33 offen lds
    v_mfma_f32_32x32x16_bf16 v[48:63], a[12:15], v[84:87], v[48:63]
    ds_read_b64_tr_b16 a[4:5], v12 offset:2048
    ds_read_b64_tr_b16 a[6:7], v13 offset:2048
    s_add_u32 m0, s42, 53248
    s_add_u32 s33, s50, 28672
    buffer_load_dwordx4 v3, s[20:23], s33 offen lds
    v_mfma_f32_32x32x16_bf16 v[32:47], a[16:19], v[88:91], v[32:47]
    v_xor_b32 v15, 32, v22
    ds_read_b128 a[36:39], v15
    ds_read_b64_tr_b16 a[8:9], v12 offset:256
    ds_read_b64_tr_b16 a[10:11], v13 offset:256
    s_add_u32 m0, s42, 57344
    s_add_u32 s33, s50, 57344
    buffer_load_dwordx4 v3, s[20:23], s33 offen lds
    v_mfma_f32_32x32x16_bf16 v[48:63], a[20:23], v[88:91], v[48:63]
    ds_read_b64_tr_b16 a[12:13], v12 offset:2304
    ds_read_b64_tr_b16 a[14:15], v13 offset:2304
    s_add_u32 m0, s42, 61440
    s_add_u32 s33, s50, 86016
    buffer_load_dwordx4 v3, s[20:23], s33 offen lds
    v_mfma_f32_32x32x16_bf16 v[32:47], a[24:27], v[92:95], v[32:47]
    v_xor_b32 v16, 64, v22
    ds_read_b128 a[40:43], v16
    ds_read_b64_tr_b16 a[16:17], v12 offset:4096
    ds_read_b64_tr_b16 a[18:19], v13 offset:4096
    s_add_u32 m0, s42, 65536
    s_add_u32 s33, s50, 114688
    buffer_load_dwordx4 v3, s[20:23], s33 offen lds
    v_mfma_f32_32x32x16_bf16 v[48:63], a[28:31], v[92:95], v[48:63]
    ds_read_b64_tr_b16 a[20:21], v12 offset:6144
    ds_read_b64_tr_b16 a[22:23], v13 offset:6144
    s_add_u32 m0, s42, 69632
    s_add_u32 s33, s50, 143360
    buffer_load_dwordx4 v3, s[20:23], s33 offen lds
    s_waitcnt lgkmcnt(12)
    v_mfma_f32_32x32x16_bf16 v[32:47], a[0:3], a[32:35], v[32:47]
    v_xor_b32 v17, 96, v22
    ds_read_b128 a[44:47], v17
    ds_read_b64_tr_b16 a[24:25], v12 offset:4352
    ds_read_b64_tr_b16 a[26:27], v13 offset:4352
    s_add_u32 m0, s42, 73728
    s_add_u32 s33, s50, 172032
    buffer_load_dwordx4 v3, s[20:23], s33 offen lds
    s_waitcnt lgkmcnt(13)
    v_mfma_f32_32x32x16_bf16 v[48:63], a[4:7], a[32:35], v[48:63]
    ds_read_b64_tr_b16 a[28:29], v12 offset:6400
    ds_read_b64_tr_b16 a[30:31], v13 offset:6400
    s_waitcnt lgkmcnt(12)
    v_mfma_f32_32x32x16_bf16 v[32:47], a[8:11], a[36:39], v[32:47]
    v_xor_b32 v18, 128, v22
    ds_read_b128 a[32:35], v18
    ds_read_b64_tr_b16 a[0:1], v12 offset:8192
    ds_read_b64_tr_b16 a[2:3], v13 offset:8192
    s_waitcnt lgkmcnt(13)
    v_mfma_f32_32x32x16_bf16 v[48:63], a[12:15], a[36:39], v[48:63]
    ds_read_b64_tr_b16 a[4:5], v12 offset:10240
    ds_read_b64_tr_b16 a[6:7], v13 offset:10240
    s_waitcnt lgkmcnt(12)
    v_mfma_f32_32x32x16_bf16 v[32:47], a[16:19], a[40:43], v[32:47]
    v_xor_b32 v19, 160, v22
    ds_read_b128 a[36:39], v19
    ds_read_b64_tr_b16 a[8:9], v12 offset:8448
    ds_read_b64_tr_b16 a[10:11], v13 offset:8448
    s_waitcnt lgkmcnt(13)
    v_mfma_f32_32x32x16_bf16 v[48:63], a[20:23], a[40:43], v[48:63]
    ds_read_b64_tr_b16 a[12:13], v12 offset:10496
    ds_read_b64_tr_b16 a[14:15], v13 offset:10496
    s_waitcnt lgkmcnt(12)
    v_mfma_f32_32x32x16_bf16 v[32:47], a[24:27], a[44:47], v[32:47]
    v_xor_b32 v20, 192, v22
    ds_read_b128 a[40:43], v20
    ds_read_b64_tr_b16 a[16:17], v12 offset:12288
    ds_read_b64_tr_b16 a[18:19], v13 offset:12288
    s_waitcnt lgkmcnt(13)
    v_mfma_f32_32x32x16_bf16 v[48:63], a[28:31], a[44:47], v[48:63]
    ds_read_b64_tr_b16 a[20:21], v12 offset:14336
    ds_read_b64_tr_b16 a[22:23], v13 offset:14336
    s_waitcnt lgkmcnt(12)
    v_mfma_f32_32x32x16_bf16 v[32:47], a[0:3], a[32:35], v[32:47]
    v_xor_b32 v21, 224, v22
    ds_read_b128 a[44:47], v21
    ds_read_b64_tr_b16 a[24:25], v12 offset:12544
    ds_read_b64_tr_b16 a[26:27], v13 offset:12544
    s_waitcnt lgkmcnt(13)
    v_mfma_f32_32x32x16_bf16 v[48:63], a[4:7], a[32:35], v[48:63]
    ds_read_b64_tr_b16 a[28:29], v12 offset:14592
    ds_read_b64_tr_b16 a[30:31], v13 offset:14592
    s_waitcnt lgkmcnt(12)
    v_mfma_f32_32x32x16_bf16 v[32:47], a[8:11], a[36:39], v[32:47]
    s_waitcnt vmcnt(7) lgkmcnt(0)
    s_barrier
    v_add_u32 v12, 0, v118
    v_xor_b32 v13, 64, v12
    v_add_u32 v22, 0, v119
    v_xor_b32 v14, 0, v22
    ds_read_b128 a[32:35], v14
    ds_read_b64_tr_b16 a[0:1], v12 offset:0
    ds_read_b64_tr_b16 a[2:3], v13 offset:0
    s_add_u32 m0, s42, 106496
    s_add_u32 s33, s50, 401408
    buffer_load_dwordx4 v3, s[20:23], s33 offen lds
    v_mfma_f32_32x32x16_bf16 v[48:63], a[12:15], a[36:39], v[48:63]
    ds_read_b64_tr_b16 a[4:5], v12 offset:2048
    ds_read_b64_tr_b16 a[6:7], v13 offset:2048
    s_add_u32 m0, s42, 110592
    s_add_u32 s33, s50, 430080
    buffer_load_dwordx4 v3, s[20:23], s33 offen lds
    v_mfma_f32_32x32x16_bf16 v[32:47], a[16:19], a[40:43], v[32:47]
    v_xor_b32 v15, 32, v22
    ds_read_b128 a[36:39], v15
    ds_read_b64_tr_b16 a[8:9], v12 offset:256
    ds_read_b64_tr_b16 a[10:11], v13 offset:256
    s_add_u32 m0, s42, 114688
    s_add_u32 s33, s50, 458752
    buffer_load_dwordx4 v3, s[20:23], s33 offen lds
    v_mfma_f32_32x32x16_bf16 v[48:63], a[20:23], a[40:43], v[48:63]
    ds_read_b64_tr_b16 a[12:13], v12 offset:2304
    ds_read_b64_tr_b16 a[14:15], v13 offset:2304
    s_add_u32 m0, s42, 118784
    s_add_u32 s33, s50, 487424
    buffer_load_dwordx4 v3, s[20:23], s33 offen lds
    v_mfma_f32_32x32x16_bf16 v[32:47], a[24:27], a[44:47], v[32:47]
    v_xor_b32 v16, 64, v22
    ds_read_b128 a[40:43], v16
    ds_read_b64_tr_b16 a[16:17], v12 offset:4096
    ds_read_b64_tr_b16 a[18:19], v13 offset:4096
    s_add_u32 m0, s42, 122880
    s_add_u32 s33, s50, 516096
    buffer_load_dwordx4 v3, s[20:23], s33 offen lds
    v_mfma_f32_32x32x16_bf16 v[48:63], a[28:31], a[44:47], v[48:63]
    ds_read_b64_tr_b16 a[20:21], v12 offset:6144
    ds_read_b64_tr_b16 a[22:23], v13 offset:6144
    s_add_u32 m0, s42, 126976
    s_add_u32 s33, s50, 544768
    buffer_load_dwordx4 v3, s[20:23], s33 offen lds
    s_waitcnt lgkmcnt(12)
    v_mfma_f32_32x32x16_bf16 v[32:47], a[0:3], a[32:35], v[32:47]
    v_xor_b32 v17, 96, v22
    ds_read_b128 a[44:47], v17
    ds_read_b64_tr_b16 a[24:25], v12 offset:4352
    ds_read_b64_tr_b16 a[26:27], v13 offset:4352
    s_add_u32 m0, s42, 131072
    s_add_u32 s33, s50, 573440
    buffer_load_dwordx4 v3, s[20:23], s33 offen lds
    s_waitcnt lgkmcnt(13)
    v_mfma_f32_32x32x16_bf16 v[48:63], a[4:7], a[32:35], v[48:63]
    ds_read_b64_tr_b16 a[28:29], v12 offset:6400
    ds_read_b64_tr_b16 a[30:31], v13 offset:6400
    s_add_u32 m0, s42, 77824
    s_add_u32 s33, s50, 200704
    buffer_load_dwordx4 v3, s[20:23], s33 offen lds
    s_waitcnt lgkmcnt(12)
    v_mfma_f32_32x32x16_bf16 v[32:47], a[8:11], a[36:39], v[32:47]
    v_xor_b32 v18, 128, v22
    ds_read_b128 a[32:35], v18
    ds_read_b64_tr_b16 a[0:1], v12 offset:8192
    ds_read_b64_tr_b16 a[2:3], v13 offset:8192
    s_add_u32 m0, s42, 81920
    s_add_u32 s33, s50, 229376
    buffer_load_dwordx4 v3, s[20:23], s33 offen lds
    s_waitcnt lgkmcnt(13)
    v_mfma_f32_32x32x16_bf16 v[48:63], a[12:15], a[36:39], v[48:63]
    ds_read_b64_tr_b16 a[4:5], v12 offset:10240
    ds_read_b64_tr_b16 a[6:7], v13 offset:10240
    s_add_u32 m0, s42, 86016
    s_add_u32 s33, s50, 258048
    buffer_load_dwordx4 v3, s[20:23], s33 offen lds
    s_waitcnt lgkmcnt(12)
    v_mfma_f32_32x32x16_bf16 v[32:47], a[16:19], a[40:43], v[32:47]
    v_xor_b32 v19, 160, v22
    ds_read_b128 a[36:39], v19
    ds_read_b64_tr_b16 a[8:9], v12 offset:8448
    ds_read_b64_tr_b16 a[10:11], v13 offset:8448
    s_add_u32 m0, s42, 90112
    s_add_u32 s33, s50, 286720
    buffer_load_dwordx4 v3, s[20:23], s33 offen lds
    s_waitcnt lgkmcnt(13)
    v_mfma_f32_32x32x16_bf16 v[48:63], a[20:23], a[40:43], v[48:63]
    ds_read_b64_tr_b16 a[12:13], v12 offset:10496
    ds_read_b64_tr_b16 a[14:15], v13 offset:10496
    s_add_u32 m0, s42, 94208
    s_add_u32 s33, s50, 315392
    buffer_load_dwordx4 v3, s[20:23], s33 offen lds
    s_waitcnt lgkmcnt(12)
    v_mfma_f32_32x32x16_bf16 v[32:47], a[24:27], a[44:47], v[32:47]
    v_xor_b32 v20, 192, v22
    ds_read_b128 a[40:43], v20
    ds_read_b64_tr_b16 a[16:17], v12 offset:12288
    ds_read_b64_tr_b16 a[18:19], v13 offset:12288
    s_add_u32 m0, s42, 98304
    s_add_u32 s33, s50, 344064
    buffer_load_dwordx4 v3, s[20:23], s33 offen lds
    s_waitcnt lgkmcnt(13)
    v_mfma_f32_32x32x16_bf16 v[48:63], a[28:31], a[44:47], v[48:63]
    ds_read_b64_tr_b16 a[20:21], v12 offset:14336
    ds_read_b64_tr_b16 a[22:23], v13 offset:14336
    s_add_u32 m0, s42, 102400
    s_add_u32 s33, s50, 372736
    buffer_load_dwordx4 v3, s[20:23], s33 offen lds
    s_waitcnt lgkmcnt(12)
    v_mfma_f32_32x32x16_bf16 v[32:47], a[0:3], a[32:35], v[32:47]
    v_xor_b32 v21, 224, v22
    ds_read_b128 a[44:47], v21
    ds_read_b64_tr_b16 a[24:25], v12 offset:12544
    ds_read_b64_tr_b16 a[26:27], v13 offset:12544
    s_add_u32 m0, s42, 135168
    s_add_u32 s33, s50, 602112
    buffer_load_dwordx4 v3, s[20:23], s33 offen lds
    s_waitcnt lgkmcnt(13)
    v_mfma_f32_32x32x16_bf16 v[48:63], a[4:7], a[32:35], v[48:63]
    ds_read_b64_tr_b16 a[28:29], v12 offset:14592
    ds_read_b64_tr_b16 a[30:31], v13 offset:14592
    s_add_u32 m0, s42, 139264
    s_add_u32 s33, s50, 630784
    buffer_load_dwordx4 v3, s[20:23], s33 offen lds
    s_waitcnt lgkmcnt(12)
    v_mfma_f32_32x32x16_bf16 v[32:47], a[8:11], a[36:39], v[32:47]
    s_add_u32 m0, s42, 143360
    s_add_u32 s33, s50, 659456
    buffer_load_dwordx4 v3, s[20:23], s33 offen lds
    s_waitcnt lgkmcnt(10)
    v_mfma_f32_32x32x16_bf16 v[48:63], a[12:15], a[36:39], v[48:63]
    s_add_u32 m0, s42, 147456
    s_add_u32 s33, s50, 688128
    buffer_load_dwordx4 v3, s[20:23], s33 offen lds
    s_waitcnt lgkmcnt(7)
    v_mfma_f32_32x32x16_bf16 v[32:47], a[16:19], a[40:43], v[32:47]
    s_add_u32 m0, s42, 151552
    s_add_u32 s33, s50, 716800
    buffer_load_dwordx4 v3, s[20:23], s33 offen lds
    s_waitcnt lgkmcnt(5)
    v_mfma_f32_32x32x16_bf16 v[48:63], a[20:23], a[40:43], v[48:63]
    s_add_u32 m0, s42, 155648
    s_add_u32 s33, s50, 745472
    buffer_load_dwordx4 v3, s[20:23], s33 offen lds
    s_waitcnt lgkmcnt(2)
    v_mfma_f32_32x32x16_bf16 v[32:47], a[24:27], a[44:47], v[32:47]
    s_add_u32 m0, s42, 159744
    s_add_u32 s33, s50, 774144
    buffer_load_dwordx4 v3, s[20:23], s33 offen lds
    s_waitcnt lgkmcnt(0)
    v_mfma_f32_32x32x16_bf16 v[48:63], a[28:31], a[44:47], v[48:63]
    v_lshlrev_b32 v120, 16, v120
    s_add_u32 s33, s49, 30408704
    v_lshlrev_b32 v64, 16, v96
    v_and_b32 v65, s47, v96
    v_lshlrev_b32 v66, 16, v97
    v_and_b32 v67, s47, v97
    v_lshlrev_b32 v68, 16, v98
    v_and_b32 v69, s47, v98
    v_lshlrev_b32 v70, 16, v99
    v_and_b32 v71, s47, v99
    v_cvt_pk_bf16_f32 v32, 0, v32
    v_cvt_pk_bf16_f32 v33, 0, v33
    v_cvt_pk_bf16_f32 v34, 0, v34
    v_cvt_pk_bf16_f32 v35, 0, v35
    v_cvt_pk_bf16_f32 v36, 0, v36
    v_cvt_pk_bf16_f32 v37, 0, v37
    v_cvt_pk_bf16_f32 v38, 0, v38
    v_cvt_pk_bf16_f32 v39, 0, v39
    v_pk_add_f32 v[32:33], v[32:33], v[120:121] op_sel_hi:[1,0]
    v_pk_add_f32 v[34:35], v[34:35], v[120:121] op_sel_hi:[1,0]
    v_pk_add_f32 v[36:37], v[36:37], v[120:121] op_sel_hi:[1,0]
    v_pk_add_f32 v[38:39], v[38:39], v[120:121] op_sel_hi:[1,0]
    v_cvt_pk_bf16_f32 v32, 0, v32
    v_cvt_pk_bf16_f32 v33, 0, v33
    v_cvt_pk_bf16_f32 v34, 0, v34
    v_cvt_pk_bf16_f32 v35, 0, v35
    v_cvt_pk_bf16_f32 v36, 0, v36
    v_cvt_pk_bf16_f32 v37, 0, v37
    v_cvt_pk_bf16_f32 v38, 0, v38
    v_cvt_pk_bf16_f32 v39, 0, v39
    v_pk_mul_f32 v[32:33], v[32:33], v[64:65]
    v_pk_mul_f32 v[34:35], v[34:35], v[66:67]
    v_pk_mul_f32 v[36:37], v[36:37], v[68:69]
    v_pk_mul_f32 v[38:39], v[38:39], v[70:71]
    v_cvt_pk_bf16_f32 v32, v32, v33
    v_cvt_pk_bf16_f32 v33, v34, v35
    v_cvt_pk_bf16_f32 v34, v36, v37
    v_cvt_pk_bf16_f32 v35, v38, v39
    buffer_store_dwordx4 v[32:35], v2, s[24:27], s33 offen offset:0 sc1
    v_lshlrev_b32 v64, 16, v100
    v_and_b32 v65, s47, v100
    v_lshlrev_b32 v66, 16, v101
    v_and_b32 v67, s47, v101
    v_lshlrev_b32 v68, 16, v102
    v_and_b32 v69, s47, v102
    v_lshlrev_b32 v70, 16, v103
    v_and_b32 v71, s47, v103
    v_cvt_pk_bf16_f32 v40, 0, v40
    v_cvt_pk_bf16_f32 v41, 0, v41
    v_cvt_pk_bf16_f32 v42, 0, v42
    v_cvt_pk_bf16_f32 v43, 0, v43
    v_cvt_pk_bf16_f32 v44, 0, v44
    v_cvt_pk_bf16_f32 v45, 0, v45
    v_cvt_pk_bf16_f32 v46, 0, v46
    v_cvt_pk_bf16_f32 v47, 0, v47
    v_pk_add_f32 v[40:41], v[40:41], v[120:121] op_sel_hi:[1,0]
    v_pk_add_f32 v[42:43], v[42:43], v[120:121] op_sel_hi:[1,0]
    v_pk_add_f32 v[44:45], v[44:45], v[120:121] op_sel_hi:[1,0]
    v_pk_add_f32 v[46:47], v[46:47], v[120:121] op_sel_hi:[1,0]
    v_cvt_pk_bf16_f32 v40, 0, v40
    v_cvt_pk_bf16_f32 v41, 0, v41
    v_cvt_pk_bf16_f32 v42, 0, v42
    v_cvt_pk_bf16_f32 v43, 0, v43
    v_cvt_pk_bf16_f32 v44, 0, v44
    v_cvt_pk_bf16_f32 v45, 0, v45
    v_cvt_pk_bf16_f32 v46, 0, v46
    v_cvt_pk_bf16_f32 v47, 0, v47
    v_pk_mul_f32 v[40:41], v[40:41], v[64:65]
    v_pk_mul_f32 v[42:43], v[42:43], v[66:67]
    v_pk_mul_f32 v[44:45], v[44:45], v[68:69]
    v_pk_mul_f32 v[46:47], v[46:47], v[70:71]
    v_cvt_pk_bf16_f32 v40, v40, v41
    v_cvt_pk_bf16_f32 v41, v42, v43
    v_cvt_pk_bf16_f32 v42, v44, v45
    v_cvt_pk_bf16_f32 v43, v46, v47
    buffer_store_dwordx4 v[40:43], v2, s[24:27], s33 offen offset:1024 sc1
    v_lshlrev_b32 v64, 16, v104
    v_and_b32 v65, s47, v104
    v_lshlrev_b32 v66, 16, v105
    v_and_b32 v67, s47, v105
    v_lshlrev_b32 v68, 16, v106
    v_and_b32 v69, s47, v106
    v_lshlrev_b32 v70, 16, v107
    v_and_b32 v71, s47, v107
    v_cvt_pk_bf16_f32 v48, 0, v48
    v_cvt_pk_bf16_f32 v49, 0, v49
    v_cvt_pk_bf16_f32 v50, 0, v50
    v_cvt_pk_bf16_f32 v51, 0, v51
    v_cvt_pk_bf16_f32 v52, 0, v52
    v_cvt_pk_bf16_f32 v53, 0, v53
    v_cvt_pk_bf16_f32 v54, 0, v54
    v_cvt_pk_bf16_f32 v55, 0, v55
    v_pk_add_f32 v[48:49], v[48:49], v[120:121] op_sel_hi:[1,0]
    v_pk_add_f32 v[50:51], v[50:51], v[120:121] op_sel_hi:[1,0]
    v_pk_add_f32 v[52:53], v[52:53], v[120:121] op_sel_hi:[1,0]
    v_pk_add_f32 v[54:55], v[54:55], v[120:121] op_sel_hi:[1,0]
    v_cvt_pk_bf16_f32 v48, 0, v48
    v_cvt_pk_bf16_f32 v49, 0, v49
    v_cvt_pk_bf16_f32 v50, 0, v50
    v_cvt_pk_bf16_f32 v51, 0, v51
    v_cvt_pk_bf16_f32 v52, 0, v52
    v_cvt_pk_bf16_f32 v53, 0, v53
    v_cvt_pk_bf16_f32 v54, 0, v54
    v_cvt_pk_bf16_f32 v55, 0, v55
    v_pk_mul_f32 v[48:49], v[48:49], v[64:65]
    v_pk_mul_f32 v[50:51], v[50:51], v[66:67]
    v_pk_mul_f32 v[52:53], v[52:53], v[68:69]
    v_pk_mul_f32 v[54:55], v[54:55], v[70:71]
    v_cvt_pk_bf16_f32 v48, v48, v49
    v_cvt_pk_bf16_f32 v49, v50, v51
    v_cvt_pk_bf16_f32 v50, v52, v53
    v_cvt_pk_bf16_f32 v51, v54, v55
    buffer_store_dwordx4 v[48:51], v2, s[24:27], s33 offen offset:2048 sc1
    v_lshlrev_b32 v64, 16, v108
    v_and_b32 v65, s47, v108
    v_lshlrev_b32 v66, 16, v109
    v_and_b32 v67, s47, v109
    v_lshlrev_b32 v68, 16, v110
    v_and_b32 v69, s47, v110
    v_lshlrev_b32 v70, 16, v111
    v_and_b32 v71, s47, v111
    v_cvt_pk_bf16_f32 v56, 0, v56
    v_cvt_pk_bf16_f32 v57, 0, v57
    v_cvt_pk_bf16_f32 v58, 0, v58
    v_cvt_pk_bf16_f32 v59, 0, v59
    v_cvt_pk_bf16_f32 v60, 0, v60
    v_cvt_pk_bf16_f32 v61, 0, v61
    v_cvt_pk_bf16_f32 v62, 0, v62
    v_cvt_pk_bf16_f32 v63, 0, v63
    v_pk_add_f32 v[56:57], v[56:57], v[120:121] op_sel_hi:[1,0]
    v_pk_add_f32 v[58:59], v[58:59], v[120:121] op_sel_hi:[1,0]
    v_pk_add_f32 v[60:61], v[60:61], v[120:121] op_sel_hi:[1,0]
    v_pk_add_f32 v[62:63], v[62:63], v[120:121] op_sel_hi:[1,0]
    v_cvt_pk_bf16_f32 v56, 0, v56
    v_cvt_pk_bf16_f32 v57, 0, v57
    v_cvt_pk_bf16_f32 v58, 0, v58
    v_cvt_pk_bf16_f32 v59, 0, v59
    v_cvt_pk_bf16_f32 v60, 0, v60
    v_cvt_pk_bf16_f32 v61, 0, v61
    v_cvt_pk_bf16_f32 v62, 0, v62
    v_cvt_pk_bf16_f32 v63, 0, v63
    v_pk_mul_f32 v[56:57], v[56:57], v[64:65]
    v_pk_mul_f32 v[58:59], v[58:59], v[66:67]
    v_pk_mul_f32 v[60:61], v[60:61], v[68:69]
    v_pk_mul_f32 v[62:63], v[62:63], v[70:71]
    v_cvt_pk_bf16_f32 v56, v56, v57
    v_cvt_pk_bf16_f32 v57, v58, v59
    v_cvt_pk_bf16_f32 v58, v60, v61
    v_cvt_pk_bf16_f32 v59, v62, v63
    buffer_store_dwordx4 v[56:59], v2, s[24:27], s33 offen offset:3072 sc1
    s_lshl_b32 s5, s3, 4
    s_add_u32 s5, s5, s38
    s_lshl_b32 s5, s5, 2
    s_add_u32 s35, s5, 29601792
    v_mov_b32 v22, 0
    s_waitcnt vmcnt(0)
    buffer_store_dword v22, v22, s[24:27], s35 offen sc1
    s_barrier
    s_lshl_b32 s5, s51, 4
    s_mul_i32 s4, s52, 7
    s_add_u32 s5, s5, s4
    s_lshl_b32 s5, s5, 2
    s_add_u32 s34, s5, 29601792
    v_min_u32 v23, 6, v1
    v_lshlrev_b32 v23, 2, v23
    s_mul_i32 s44, s51, 57344
    s_mul_i32 s5, s52, 28672
    s_add_u32 s44, s44, s5
    s_add_u32 s44, s44, 30408704
    s_mul_i32 s49, s51, 28672
    s_add_u32 s49, s49, s32
    s_lshl_b32 s5, s52, 6
    v_xor_b32 v6, s5, v6
    s_mul_i32 s5, s52, 57344
    s_add_u32 s5, s5, 49152
    v_add_u32 v6, s5, v6
    v_xor_b32 v7, 64, v6
    s_lshl_b32 s5, s48, 12
    v_add_u32 v8, s5, v2
    v_xor_b32 v9, 8192, v8
    v_mul_u32_u24 v11, 896, v25
    v_add_u32 v11, v11, v4
    v_lshlrev_b32 v80, 16, v124
    v_and_b32 v81, s47, v124
    v_lshlrev_b32 v82, 16, v125
    v_and_b32 v83, s47, v125
    v_lshlrev_b32 v84, 16, v126
    v_and_b32 v85, s47, v126
    v_lshlrev_b32 v86, 16, v127
    v_and_b32 v87, s47, v127
    v_lshlrev_b32 v88, 16, v128
    v_and_b32 v89, s47, v128
    v_lshlrev_b32 v90, 16, v129
    v_and_b32 v91, s47, v129
    v_lshlrev_b32 v92, 16, v130
    v_and_b32 v93, s47, v130
    v_lshlrev_b32 v94, 16, v131
    v_and_b32 v95, s47, v131
    v_lshlrev_b32 v96, 16, v132
    v_and_b32 v97, s47, v132
    v_lshlrev_b32 v98, 16, v133
    v_and_b32 v99, s47, v133
    v_lshlrev_b32 v100, 16, v134
    v_and_b32 v101, s47, v134
    v_lshlrev_b32 v102, 16, v135
    v_and_b32 v103, s47, v135
    v_lshlrev_b32 v104, 16, v136
    v_and_b32 v105, s47, v136
    v_lshlrev_b32 v106, 16, v137
    v_and_b32 v107, s47, v137
    v_lshlrev_b32 v108, 16, v138
    v_and_b32 v109, s47, v138
    v_lshlrev_b32 v110, 16, v139
    v_and_b32 v111, s47, v139
    ds_read_b64_tr_b16 a[112:113], v6 offset:0
    ds_read_b64_tr_b16 a[114:115], v6 offset:512
    ds_read_b64_tr_b16 a[116:117], v7 offset:0
    ds_read_b64_tr_b16 a[118:119], v7 offset:512
    ds_read_b64_tr_b16 a[120:121], v6 offset:2048
    ds_read_b64_tr_b16 a[122:123], v6 offset:2560
    ds_read_b64_tr_b16 a[124:125], v7 offset:2048
    ds_read_b64_tr_b16 a[126:127], v7 offset:2560
    ds_read_b64_tr_b16 a[128:129], v6 offset:4096
    ds_read_b64_tr_b16 a[130:131], v6 offset:4608
    ds_read_b64_tr_b16 a[132:133], v7 offset:4096
    ds_read_b64_tr_b16 a[134:135], v7 offset:4608
    s_mov_b32 s5, 0
k1_kernel_L7:
    buffer_load_dword v22, v23, s[24:27], s34 offen sc1
    s_add_u32 s5, s5, 1
    s_waitcnt vmcnt(0)
    v_cmp_eq_u32 vcc, -1, v22
    s_nop 4
    s_cbranch_vccz k1_kernel_L7_ok
    s_cmp_lt_u32 s5, 0x20000
    s_cbranch_scc1 k1_kernel_L7
k1_kernel_L7_ok:
    buffer_load_dwordx4 a[0:3], v2, s[24:27], s44 offen offset:0
    buffer_load_dwordx4 a[4:7], v2, s[24:27], s44 offen offset:1024
    buffer_load_dwordx4 a[8:11], v2, s[24:27], s44 offen offset:2048
    buffer_load_dwordx4 a[12:15], v2, s[24:27], s44 offen offset:3072
    s_add_u32 s44, s44, 4096
    buffer_load_dwordx4 a[16:19], v2, s[24:27], s44 offen offset:0
    buffer_load_dwordx4 a[20:23], v2, s[24:27], s44 offen offset:1024
    buffer_load_dwordx4 a[24:27], v2, s[24:27], s44 offen offset:2048
    buffer_load_dwordx4 a[28:31], v2, s[24:27], s44 offen offset:3072
    s_add_u32 s44, s44, 4096
    buffer_load_dwordx4 a[32:35], v2, s[24:27], s44 offen offset:0
    buffer_load_dwordx4 a[36:39], v2, s[24:27], s44 offen offset:1024
    buffer_load_dwordx4 a[40:43], v2, s[24:27], s44 offen offset:2048
    buffer_load_dwordx4 a[44:47], v2, s[24:27], s44 offen offset:3072
    s_add_u32 s44, s44, 4096
    buffer_load_dwordx4 a[48:51], v2, s[24:27], s44 offen offset:0
    buffer_load_dwordx4 a[52:55], v2, s[24:27], s44 offen offset:1024
    buffer_load_dwordx4 a[56:59], v2, s[24:27], s44 offen offset:2048
    buffer_load_dwordx4 a[60:63], v2, s[24:27], s44 offen offset:3072
    s_add_u32 s44, s44, 4096
    buffer_load_dwordx4 a[64:67], v2, s[24:27], s44 offen offset:0
    buffer_load_dwordx4 a[68:71], v2, s[24:27], s44 offen offset:1024
    buffer_load_dwordx4 a[72:75], v2, s[24:27], s44 offen offset:2048
    buffer_load_dwordx4 a[76:79], v2, s[24:27], s44 offen offset:3072
    s_add_u32 s44, s44, 4096
    buffer_load_dwordx4 a[80:83], v2, s[24:27], s44 offen offset:0
    buffer_load_dwordx4 a[84:87], v2, s[24:27], s44 offen offset:1024
    buffer_load_dwordx4 a[88:91], v2, s[24:27], s44 offen offset:2048
    buffer_load_dwordx4 a[92:95], v2, s[24:27], s44 offen offset:3072
    s_add_u32 s44, s44, 4096
    buffer_load_dwordx4 a[96:99], v2, s[24:27], s44 offen offset:0
    buffer_load_dwordx4 a[100:103], v2, s[24:27], s44 offen offset:1024
    buffer_load_dwordx4 a[104:107], v2, s[24:27], s44 offen offset:2048
    buffer_load_dwordx4 a[108:111], v2, s[24:27], s44 offen offset:3072
    s_waitcnt vmcnt(27) lgkmcnt(10)
    v_mfma_f32_32x32x16_bf16 v[32:47], a[112:115], a[0:3], 0
    ds_read_b64_tr_b16 a[136:137], v6 offset:6144
    ds_read_b64_tr_b16 a[138:139], v6 offset:6656
    s_waitcnt lgkmcnt(10)
    v_mfma_f32_32x32x16_bf16 v[48:63], a[116:119], a[0:3], 0
    ds_read_b64_tr_b16 a[140:141], v7 offset:6144
    ds_read_b64_tr_b16 a[142:143], v7 offset:6656
    s_waitcnt vmcnt(26) lgkmcnt(10)
    v_mfma_f32_32x32x16_bf16 v[32:47], a[120:123], a[4:7], v[32:47]
    ds_read_b64_tr_b16 a[112:113], v6 offset:8192
    ds_read_b64_tr_b16 a[114:115], v6 offset:8704
    s_waitcnt lgkmcnt(10)
    v_mfma_f32_32x32x16_bf16 v[48:63], a[124:127], a[4:7], v[48:63]
    ds_read_b64_tr_b16 a[116:117], v7 offset:8192
    ds_read_b64_tr_b16 a[118:119], v7 offset:8704
    s_waitcnt vmcnt(25) lgkmcnt(10)
    v_mfma_f32_32x32x16_bf16 v[32:47], a[128:131], a[8:11], v[32:47]
    ds_read_b64_tr_b16 a[120:121], v6 offset:10240
    ds_read_b64_tr_b16 a[122:123], v6 offset:10752
    s_waitcnt lgkmcnt(10)
    v_mfma_f32_32x32x16_bf16 v[48:63], a[132:135], a[8:11], v[48:63]
    ds_read_b64_tr_b16 a[124:125], v7 offset:10240
    ds_read_b64_tr_b16 a[126:127], v7 offset:10752
    s_waitcnt vmcnt(24) lgkmcnt(10)
    v_mfma_f32_32x32x16_bf16 v[32:47], a[136:139], a[12:15], v[32:47]
    ds_read_b64_tr_b16 a[128:129], v6 offset:12288
    ds_read_b64_tr_b16 a[130:131], v6 offset:12800
    s_waitcnt lgkmcnt(10)
    v_mfma_f32_32x32x16_bf16 v[48:63], a[140:143], a[12:15], v[48:63]
    ds_read_b64_tr_b16 a[132:133], v7 offset:12288
    ds_read_b64_tr_b16 a[134:135], v7 offset:12800
    s_waitcnt vmcnt(23) lgkmcnt(10)
    v_mfma_f32_32x32x16_bf16 v[32:47], a[112:115], a[16:19], v[32:47]
    ds_read_b64_tr_b16 a[136:137], v6 offset:14336
    ds_read_b64_tr_b16 a[138:139], v6 offset:14848
    s_waitcnt lgkmcnt(10)
    v_mfma_f32_32x32x16_bf16 v[48:63], a[116:119], a[16:19], v[48:63]
    ds_read_b64_tr_b16 a[140:141], v7 offset:14336
    ds_read_b64_tr_b16 a[142:143], v7 offset:14848
    s_waitcnt vmcnt(22) lgkmcnt(10)
    v_mfma_f32_32x32x16_bf16 v[32:47], a[120:123], a[20:23], v[32:47]
    ds_read_b64_tr_b16 a[112:113], v6 offset:16384
    ds_read_b64_tr_b16 a[114:115], v6 offset:16896
    s_waitcnt lgkmcnt(10)
    v_mfma_f32_32x32x16_bf16 v[48:63], a[124:127], a[20:23], v[48:63]
    ds_read_b64_tr_b16 a[116:117], v7 offset:16384
    ds_read_b64_tr_b16 a[118:119], v7 offset:16896
    s_waitcnt vmcnt(21) lgkmcnt(10)
    v_mfma_f32_32x32x16_bf16 v[32:47], a[128:131], a[24:27], v[32:47]
    ds_read_b64_tr_b16 a[120:121], v6 offset:18432
    ds_read_b64_tr_b16 a[122:123], v6 offset:18944
    s_waitcnt lgkmcnt(10)
    v_mfma_f32_32x32x16_bf16 v[48:63], a[132:135], a[24:27], v[48:63]
    ds_read_b64_tr_b16 a[124:125], v7 offset:18432
    ds_read_b64_tr_b16 a[126:127], v7 offset:18944
    s_waitcnt vmcnt(20) lgkmcnt(10)
    v_mfma_f32_32x32x16_bf16 v[32:47], a[136:139], a[28:31], v[32:47]
    ds_read_b64_tr_b16 a[128:129], v6 offset:20480
    ds_read_b64_tr_b16 a[130:131], v6 offset:20992
    s_waitcnt lgkmcnt(10)
    v_mfma_f32_32x32x16_bf16 v[48:63], a[140:143], a[28:31], v[48:63]
    ds_read_b64_tr_b16 a[132:133], v7 offset:20480
    ds_read_b64_tr_b16 a[134:135], v7 offset:20992
    s_waitcnt vmcnt(19) lgkmcnt(10)
    v_mfma_f32_32x32x16_bf16 v[32:47], a[112:115], a[32:35], v[32:47]
    ds_read_b64_tr_b16 a[136:137], v6 offset:22528
    ds_read_b64_tr_b16 a[138:139], v6 offset:23040
    s_waitcnt lgkmcnt(10)
    v_mfma_f32_32x32x16_bf16 v[48:63], a[116:119], a[32:35], v[48:63]
    ds_read_b64_tr_b16 a[140:141], v7 offset:22528
    ds_read_b64_tr_b16 a[142:143], v7 offset:23040
    s_waitcnt vmcnt(18) lgkmcnt(10)
    v_mfma_f32_32x32x16_bf16 v[32:47], a[120:123], a[36:39], v[32:47]
    ds_read_b64_tr_b16 a[112:113], v6 offset:24576
    ds_read_b64_tr_b16 a[114:115], v6 offset:25088
    s_waitcnt lgkmcnt(10)
    v_mfma_f32_32x32x16_bf16 v[48:63], a[124:127], a[36:39], v[48:63]
    ds_read_b64_tr_b16 a[116:117], v7 offset:24576
    ds_read_b64_tr_b16 a[118:119], v7 offset:25088
    s_waitcnt vmcnt(17) lgkmcnt(10)
    v_mfma_f32_32x32x16_bf16 v[32:47], a[128:131], a[40:43], v[32:47]
    ds_read_b64_tr_b16 a[120:121], v6 offset:26624
    ds_read_b64_tr_b16 a[122:123], v6 offset:27136
    s_waitcnt lgkmcnt(10)
    v_mfma_f32_32x32x16_bf16 v[48:63], a[132:135], a[40:43], v[48:63]
    ds_read_b64_tr_b16 a[124:125], v7 offset:26624
    ds_read_b64_tr_b16 a[126:127], v7 offset:27136
    s_waitcnt vmcnt(16) lgkmcnt(10)
    v_mfma_f32_32x32x16_bf16 v[32:47], a[136:139], a[44:47], v[32:47]
    ds_read_b64_tr_b16 a[128:129], v6 offset:28672
    ds_read_b64_tr_b16 a[130:131], v6 offset:29184
    s_waitcnt lgkmcnt(10)
    v_mfma_f32_32x32x16_bf16 v[48:63], a[140:143], a[44:47], v[48:63]
    ds_read_b64_tr_b16 a[132:133], v7 offset:28672
    ds_read_b64_tr_b16 a[134:135], v7 offset:29184
    s_waitcnt vmcnt(15) lgkmcnt(10)
    v_mfma_f32_32x32x16_bf16 v[32:47], a[112:115], a[48:51], v[32:47]
    ds_read_b64_tr_b16 a[136:137], v6 offset:30720
    ds_read_b64_tr_b16 a[138:139], v6 offset:31232
    s_waitcnt lgkmcnt(10)
    v_mfma_f32_32x32x16_bf16 v[48:63], a[116:119], a[48:51], v[48:63]
    ds_read_b64_tr_b16 a[140:141], v7 offset:30720
    ds_read_b64_tr_b16 a[142:143], v7 offset:31232
    s_waitcnt vmcnt(14) lgkmcnt(10)
    v_mfma_f32_32x32x16_bf16 v[32:47], a[120:123], a[52:55], v[32:47]
    ds_read_b64_tr_b16 a[112:113], v6 offset:32768
    ds_read_b64_tr_b16 a[114:115], v6 offset:33280
    s_waitcnt lgkmcnt(10)
    v_mfma_f32_32x32x16_bf16 v[48:63], a[124:127], a[52:55], v[48:63]
    ds_read_b64_tr_b16 a[116:117], v7 offset:32768
    ds_read_b64_tr_b16 a[118:119], v7 offset:33280
    s_waitcnt vmcnt(13) lgkmcnt(10)
    v_mfma_f32_32x32x16_bf16 v[32:47], a[128:131], a[56:59], v[32:47]
    ds_read_b64_tr_b16 a[120:121], v6 offset:34816
    ds_read_b64_tr_b16 a[122:123], v6 offset:35328
    s_waitcnt lgkmcnt(10)
    v_mfma_f32_32x32x16_bf16 v[48:63], a[132:135], a[56:59], v[48:63]
    ds_read_b64_tr_b16 a[124:125], v7 offset:34816
    ds_read_b64_tr_b16 a[126:127], v7 offset:35328
    s_waitcnt vmcnt(12) lgkmcnt(10)
    v_mfma_f32_32x32x16_bf16 v[32:47], a[136:139], a[60:63], v[32:47]
    ds_read_b64_tr_b16 a[128:129], v6 offset:36864
    ds_read_b64_tr_b16 a[130:131], v6 offset:37376
    s_waitcnt lgkmcnt(10)
    v_mfma_f32_32x32x16_bf16 v[48:63], a[140:143], a[60:63], v[48:63]
    ds_read_b64_tr_b16 a[132:133], v7 offset:36864
    ds_read_b64_tr_b16 a[134:135], v7 offset:37376
    s_waitcnt vmcnt(11) lgkmcnt(10)
    v_mfma_f32_32x32x16_bf16 v[32:47], a[112:115], a[64:67], v[32:47]
    ds_read_b64_tr_b16 a[136:137], v6 offset:38912
    ds_read_b64_tr_b16 a[138:139], v6 offset:39424
    s_waitcnt lgkmcnt(10)
    v_mfma_f32_32x32x16_bf16 v[48:63], a[116:119], a[64:67], v[48:63]
    ds_read_b64_tr_b16 a[140:141], v7 offset:38912
    ds_read_b64_tr_b16 a[142:143], v7 offset:39424
    s_waitcnt vmcnt(10) lgkmcnt(10)
    v_mfma_f32_32x32x16_bf16 v[32:47], a[120:123], a[68:71], v[32:47]
    ds_read_b64_tr_b16 a[112:113], v6 offset:40960
    ds_read_b64_tr_b16 a[114:115], v6 offset:41472
    s_waitcnt lgkmcnt(10)
    v_mfma_f32_32x32x16_bf16 v[48:63], a[124:127], a[68:71], v[48:63]
    ds_read_b64_tr_b16 a[116:117], v7 offset:40960
    ds_read_b64_tr_b16 a[118:119], v7 offset:41472
    s_waitcnt vmcnt(9) lgkmcnt(10)
    v_mfma_f32_32x32x16_bf16 v[32:47], a[128:131], a[72:75], v[32:47]
    ds_read_b64_tr_b16 a[120:121], v6 offset:43008
    ds_read_b64_tr_b16 a[122:123], v6 offset:43520
    s_waitcnt lgkmcnt(10)
    v_mfma_f32_32x32x16_bf16 v[48:63], a[132:135], a[72:75], v[48:63]
    ds_read_b64_tr_b16 a[124:125], v7 offset:43008
    ds_read_b64_tr_b16 a[126:127], v7 offset:43520
    s_waitcnt vmcnt(8) lgkmcnt(10)
    v_mfma_f32_32x32x16_bf16 v[32:47], a[136:139], a[76:79], v[32:47]
    ds_read_b64_tr_b16 a[128:129], v6 offset:45056
    ds_read_b64_tr_b16 a[130:131], v6 offset:45568
    s_waitcnt lgkmcnt(10)
    v_mfma_f32_32x32x16_bf16 v[48:63], a[140:143], a[76:79], v[48:63]
    ds_read_b64_tr_b16 a[132:133], v7 offset:45056
    ds_read_b64_tr_b16 a[134:135], v7 offset:45568
    s_waitcnt vmcnt(7) lgkmcnt(10)
    v_mfma_f32_32x32x16_bf16 v[32:47], a[112:115], a[80:83], v[32:47]
    ds_read_b64_tr_b16 a[136:137], v6 offset:47104
    ds_read_b64_tr_b16 a[138:139], v6 offset:47616
    s_waitcnt lgkmcnt(10)
    v_mfma_f32_32x32x16_bf16 v[48:63], a[116:119], a[80:83], v[48:63]
    ds_read_b64_tr_b16 a[140:141], v7 offset:47104
    ds_read_b64_tr_b16 a[142:143], v7 offset:47616
    s_waitcnt vmcnt(6) lgkmcnt(10)
    v_mfma_f32_32x32x16_bf16 v[32:47], a[120:123], a[84:87], v[32:47]
    ds_read_b64_tr_b16 a[112:113], v6 offset:49152
    ds_read_b64_tr_b16 a[114:115], v6 offset:49664
    s_waitcnt lgkmcnt(10)
    v_mfma_f32_32x32x16_bf16 v[48:63], a[124:127], a[84:87], v[48:63]
    ds_read_b64_tr_b16 a[116:117], v7 offset:49152
    ds_read_b64_tr_b16 a[118:119], v7 offset:49664
    s_waitcnt vmcnt(5) lgkmcnt(10)
    v_mfma_f32_32x32x16_bf16 v[32:47], a[128:131], a[88:91], v[32:47]
    ds_read_b64_tr_b16 a[120:121], v6 offset:51200
    ds_read_b64_tr_b16 a[122:123], v6 offset:51712
    s_waitcnt lgkmcnt(10)
    v_mfma_f32_32x32x16_bf16 v[48:63], a[132:135], a[88:91], v[48:63]
    ds_read_b64_tr_b16 a[124:125], v7 offset:51200
    ds_read_b64_tr_b16 a[126:127], v7 offset:51712
    s_waitcnt vmcnt(4) lgkmcnt(10)
    v_mfma_f32_32x32x16_bf16 v[32:47], a[136:139], a[92:95], v[32:47]
    ds_read_b64_tr_b16 a[128:129], v6 offset:53248
    ds_read_b64_tr_b16 a[130:131], v6 offset:53760
    s_waitcnt lgkmcnt(10)
    v_mfma_f32_32x32x16_bf16 v[48:63], a[140:143], a[92:95], v[48:63]
    ds_read_b64_tr_b16 a[132:133], v7 offset:53248
    ds_read_b64_tr_b16 a[134:135], v7 offset:53760
    s_waitcnt vmcnt(3) lgkmcnt(10)
    v_mfma_f32_32x32x16_bf16 v[32:47], a[112:115], a[96:99], v[32:47]
    ds_read_b64_tr_b16 a[136:137], v6 offset:55296
    ds_read_b64_tr_b16 a[138:139], v6 offset:55808
    s_waitcnt lgkmcnt(10)
    v_mfma_f32_32x32x16_bf16 v[48:63], a[116:119], a[96:99], v[48:63]
    ds_read_b64_tr_b16 a[140:141], v7 offset:55296
    ds_read_b64_tr_b16 a[142:143], v7 offset:55808
    s_waitcnt vmcnt(2) lgkmcnt(10)
    v_mfma_f32_32x32x16_bf16 v[32:47], a[120:123], a[100:103], v[32:47]
    s_waitcnt lgkmcnt(8)
    v_mfma_f32_32x32x16_bf16 v[48:63], a[124:127], a[100:103], v[48:63]
    s_waitcnt vmcnt(1) lgkmcnt(6)
    v_mfma_f32_32x32x16_bf16 v[32:47], a[128:131], a[104:107], v[32:47]
    s_waitcnt lgkmcnt(4)
    v_mfma_f32_32x32x16_bf16 v[48:63], a[132:135], a[104:107], v[48:63]
    s_waitcnt vmcnt(0) lgkmcnt(2)
    v_mfma_f32_32x32x16_bf16 v[32:47], a[136:139], a[108:111], v[32:47]
    s_waitcnt lgkmcnt(0)
    v_mfma_f32_32x32x16_bf16 v[48:63], a[140:143], a[108:111], v[48:63]
    s_nop 11
    ds_write_b128 v8, v[48:51] offset:0
    ds_write_b128 v8, v[52:55] offset:1024
    ds_write_b128 v8, v[56:59] offset:2048
    ds_write_b128 v8, v[60:63] offset:3072
    s_waitcnt lgkmcnt(0)
    s_barrier
    ds_read_b128 v[48:51], v9 offset:0
    ds_read_b128 v[52:55], v9 offset:1024
    ds_read_b128 v[56:59], v9 offset:2048
    ds_read_b128 v[60:63], v9 offset:3072
    s_waitcnt lgkmcnt(3)
    v_pk_add_f32 v[32:33], v[32:33], v[48:49]
    v_pk_add_f32 v[34:35], v[34:35], v[50:51]
    s_waitcnt lgkmcnt(2)
    v_pk_add_f32 v[36:37], v[36:37], v[52:53]
    v_pk_add_f32 v[38:39], v[38:39], v[54:55]
    v_cvt_pk_bf16_f32 v32, 0, v32
    v_cvt_pk_bf16_f32 v33, 0, v33
    v_cvt_pk_bf16_f32 v34, 0, v34
    v_cvt_pk_bf16_f32 v35, 0, v35
    v_cvt_pk_bf16_f32 v36, 0, v36
    v_cvt_pk_bf16_f32 v37, 0, v37
    v_cvt_pk_bf16_f32 v38, 0, v38
    v_cvt_pk_bf16_f32 v39, 0, v39
    v_pk_mul_f32 v[32:33], v[32:33], v[96:97]
    v_pk_mul_f32 v[34:35], v[34:35], v[98:99]
    v_pk_mul_f32 v[36:37], v[36:37], v[100:101]
    v_pk_mul_f32 v[38:39], v[38:39], v[102:103]
    v_cvt_pk_bf16_f32 v32, 0, v32
    v_cvt_pk_bf16_f32 v33, 0, v33
    v_cvt_pk_bf16_f32 v34, 0, v34
    v_cvt_pk_bf16_f32 v35, 0, v35
    v_cvt_pk_bf16_f32 v36, 0, v36
    v_cvt_pk_bf16_f32 v37, 0, v37
    v_cvt_pk_bf16_f32 v38, 0, v38
    v_cvt_pk_bf16_f32 v39, 0, v39
    v_pk_add_f32 v[32:33], v[32:33], v[80:81]
    v_pk_add_f32 v[34:35], v[34:35], v[82:83]
    v_pk_add_f32 v[36:37], v[36:37], v[84:85]
    v_pk_add_f32 v[38:39], v[38:39], v[86:87]
    v_cvt_pk_bf16_f32 v32, v32, v33
    v_cvt_pk_bf16_f32 v33, v34, v35
    v_cvt_pk_bf16_f32 v34, v36, v37
    v_cvt_pk_bf16_f32 v35, v38, v39
    buffer_store_dwordx4 v[32:35], v11, s[8:11], s49 offen offset:0
    s_waitcnt lgkmcnt(1)
    v_pk_add_f32 v[40:41], v[40:41], v[56:57]
    v_pk_add_f32 v[42:43], v[42:43], v[58:59]
    s_waitcnt lgkmcnt(0)
    v_pk_add_f32 v[44:45], v[44:45], v[60:61]
    v_pk_add_f32 v[46:47], v[46:47], v[62:63]
    v_cvt_pk_bf16_f32 v40, 0, v40
    v_cvt_pk_bf16_f32 v41, 0, v41
    v_cvt_pk_bf16_f32 v42, 0, v42
    v_cvt_pk_bf16_f32 v43, 0, v43
    v_cvt_pk_bf16_f32 v44, 0, v44
    v_cvt_pk_bf16_f32 v45, 0, v45
    v_cvt_pk_bf16_f32 v46, 0, v46
    v_cvt_pk_bf16_f32 v47, 0, v47
    v_pk_mul_f32 v[40:41], v[40:41], v[104:105]
    v_pk_mul_f32 v[42:43], v[42:43], v[106:107]
    v_pk_mul_f32 v[44:45], v[44:45], v[108:109]
    v_pk_mul_f32 v[46:47], v[46:47], v[110:111]
    v_cvt_pk_bf16_f32 v40, 0, v40
    v_cvt_pk_bf16_f32 v41, 0, v41
    v_cvt_pk_bf16_f32 v42, 0, v42
    v_cvt_pk_bf16_f32 v43, 0, v43
    v_cvt_pk_bf16_f32 v44, 0, v44
    v_cvt_pk_bf16_f32 v45, 0, v45
    v_cvt_pk_bf16_f32 v46, 0, v46
    v_cvt_pk_bf16_f32 v47, 0, v47
    v_pk_add_f32 v[40:41], v[40:41], v[88:89]
    v_pk_add_f32 v[42:43], v[42:43], v[90:91]
    v_pk_add_f32 v[44:45], v[44:45], v[92:93]
    v_pk_add_f32 v[46:47], v[46:47], v[94:95]
    v_cvt_pk_bf16_f32 v40, v40, v41
    v_cvt_pk_bf16_f32 v41, v42, v43
    v_cvt_pk_bf16_f32 v42, v44, v45
    v_cvt_pk_bf16_f32 v43, v46, v47
    buffer_store_dwordx4 v[40:43], v11, s[8:11], s49 offen offset:32
k1_kernel_fin:
k1_kernel_end:
    s_endpgm
.section .rodata,"a"
.p2align 6
.amdhsa_kernel k1_kernel
  .amdhsa_next_free_vgpr 512
  .amdhsa_next_free_sgpr 102
  .amdhsa_accum_offset 256
  .amdhsa_group_segment_fixed_size 0
  .amdhsa_kernarg_size 120
  .amdhsa_user_sgpr_count 2
  .amdhsa_user_sgpr_kernarg_segment_ptr 1
  .amdhsa_system_sgpr_workgroup_id_x 1
  .amdhsa_float_denorm_mode_32 3
  .amdhsa_float_denorm_mode_16_64 3
.end_amdhsa_kernel
```
